```python
import torch

def _softmax(x, axis=-1):
    return torch.softmax(x, dim=axis)
def _gelu(x):
    return torch.nn.functional.gelu(x, approximate="tanh")
def _silu(x):
    return torch.nn.functional.silu(x)
def _sigmoid(x):
    return torch.sigmoid(x)
def _layernorm(x, axis=-1, eps=1e-5):
    m = x.mean(dim=axis, keepdim=True)
    v = x.var(dim=axis, keepdim=True, unbiased=False)
    return (x - m) / torch.sqrt(v + eps)
def _scatter_add(tgt, idx, src, axis=0):
    return tgt.clone().index_add_(axis, idx, src)
def _segment_sum(src, seg, n):
    out = torch.zeros((n,) + src.shape[1:], dtype=src.dtype)
    return out.index_add_(0, seg, src)
def _pad(x, pw):
    flat = tuple(v for pair in reversed(pw) for v in pair)
    return torch.nn.functional.pad(x, flat)

kernel_name = 'standalone__dcn_v2_cross__recsys'

def setup_inputs():

    _w = (lambda a: (lambda t: t.to(torch.bfloat16) if t.is_floating_point() else t)(torch.as_tensor(a)))
    B, F, D, L = 16384, 26, 32, 3
    Din = min(F * D, 1024)
    return {
        "x0": _w((lambda *s: torch.randn(*s, dtype=torch.bfloat16) * 0.05)(B, Din)),
        "ws": _w((lambda *s: torch.randn(*s, dtype=torch.bfloat16) * 0.05)(L, Din, Din)),
        "bs": _w((lambda *s: torch.randn(*s, dtype=torch.bfloat16) * 0.05)(L, Din)),
    }

def reference(x0, ws, bs):
    x = x0
    for l in range(ws.shape[0]):
        x = x0 * (x @ ws[l] + bs[l]) + x
    return x
```

```asm
; @launch grid=(256,1,1) block=(256,1,1) lds=163840
.amdgcn_target "amdgcn-amd-amdhsa--gfx950"
.text
.globl standalone__dcn_v2_cross__recsys_kernel
.p2align 8
.type standalone__dcn_v2_cross__recsys_kernel,@function
standalone__dcn_v2_cross__recsys_kernel:
  s_cmp_ge_u32 s2, 256
  s_cbranch_scc1 Lend
  s_load_dwordx4 s[64:67], s[0:1], 0
  s_load_dwordx4 s[68:71], s[0:1], 16
  s_load_dwordx4 s[72:75], s[0:1], 32
  v_lshrrev_b32 v31, 6, v0
  v_and_b32 v0, 63, v0
  s_and_b32 s33, s2, 7
  s_lshr_b32 s3, s2, 5
  v_readfirstlane_b32 s34, v31
  s_lshl_b32 s55, s3, 2
  s_lshl_b32 s3, s3, 3
  s_add_u32 s33, s33, s3
  s_lshr_b32 s32, s2, 3
  s_and_b32 s32, s32, 3
  s_mul_i32 s35, s32, 384
  s_lshl_b32 s3, s33, 2
  s_add_u32 s3, s3, s34
  s_mul_i32 s41, s3, 106496
  s_add_u32 s55, s55, s34
  s_mul_i32 s55, s55, 1664
  s_mul_i32 s36, s34, 1032
  s_lshl_b32 s37, s34, 3
  s_mul_i32 s45, s34, 26624
  s_add_u32 s45, s45, 57344
  s_nop 0
  s_add_u32 s92, s41, 0
  s_add_u32 s93, s41, 12288
  s_add_u32 s94, s41, 26624
  s_add_u32 s95, s41, 38912
  s_add_u32 s96, s41, 53248
  s_add_u32 s97, s41, 65536
  s_add_u32 s98, s41, 79872
  s_add_u32 s99, s41, 92160
  v_lshlrev_b32 v11, 4, v0
  v_lshrrev_b32 v20, 3, v0
  v_and_b32 v21, 7, v0
  v_and_b32 v23, 6, v20
  v_lshlrev_b32 v22, 1, v20
  v_xor_b32 v23, v21, v23
  v_and_b32 v22, 4, v22
  v_lshlrev_b32 v23, 4, v23
  v_mul_u32_u24 v24, 1664, v20
  v_xor_b32 v22, v21, v22
  v_add_u32 v13, v23, v24
  v_lshlrev_b32 v22, 4, v22
  v_add_u32 v23, s37, v20
  v_mul_u32_u24 v23, 1664, v23
  v_add_u32 v4, v23, v22
  s_lshl_b32 s56, s32, 4
  v_and_b32 v26, 15, v0
  v_lshrrev_b32 v27, 4, v0
  v_add_u32 v26, s56, v26
  v_lshlrev_b32 v27, 7, v27
  v_mul_u32_u24 v26, 1664, v26
  v_add_u32 v31, v26, v27
  v_lshrrev_b32 v27, 5, v0
  v_lshlrev_b32 v27, 30, v27
  v_add_u32 v31, v31, v27
  v_lshrrev_b32 v28, 6, v11
  v_mul_u32_u24 v17, 53248, v28
  v_lshrrev_b32 v28, 2, v28
  v_min_u32 v28, 1, v28
  v_lshlrev_b32 v28, 30, v28
  v_and_b32 v17, 0x3fffffff, v17
  v_add_u32 v17, v17, v28
  v_lshrrev_b32 v28, 4, v11
  v_and_b32 v28, 3, v28
  v_lshlrev_b32 v29, 7, v28
  v_add_u32 v29, s35, v29
  v_cmp_eq_u32 vcc, 3, v28
  v_mov_b32 v28, 0x600
  v_cndmask_b32 v29, v29, v28, vcc
  v_add_u32 v17, v17, v29
  v_add_u32 v17, s55, v17
  v_lshlrev_b32 v29, 7, v0
  v_lshrrev_b32 v28, 3, v0
  v_min_u32 v28, 1, v28
  v_lshlrev_b32 v28, 30, v28
  v_add_u32 v29, v28, v29
  s_lshl_b32 s91, s2, 2
  s_add_u32 s91, s91, s34
  s_lshl_b32 s91, s91, 12
  s_waitcnt lgkmcnt(0)
  s_mov_b32 s12, s64
  s_and_b32 s13, s65, 0xffff
  s_mov_b32 s14, 27262976
  s_mov_b32 s15, 0x20000
  s_mov_b32 s8, s66
  s_and_b32 s9, s67, 0xffff
  s_mov_b32 s10, 4153344
  s_mov_b32 s11, 0x20000
  s_getpc_b64 s[64:65]
Lpc:
  s_and_b32 s65, s65, 0xffff
  s_mov_b32 s66, Lcode_end-Lpc
  s_mov_b32 s67, 0x20000
  s_lshr_b32 s72, s2, 3
  s_lshl_b32 s72, s72, 2
  s_add_u32 s72, s72, s34
  s_lshl_b32 s72, s72, 7
  s_mov_b32 s54, 0
  buffer_load_dword v19, v17, s[8:11], s54 offen
  s_add_u32 s54, s72, 0
  buffer_load_dword v19, off, s[64:67], s54
  s_lshl_b32 s54, s2, 2
  s_add_u32 s54, s54, s34
  s_lshl_b32 s54, s54, 7
  buffer_load_dword v19, off, s[64:67], s54
  s_add_u32 m0, s45, 0
  s_nop 0
  buffer_load_dwordx4 v13, s[12:15], s92 offen offset:0 lds
  buffer_load_dwordx4 v13, s[12:15], s93 offen offset:1024 lds
  s_add_u32 m0, s45, 2048
  s_nop 0
  buffer_load_dwordx4 v13, s[12:15], s94 offen offset:0 lds
  buffer_load_dwordx4 v13, s[12:15], s95 offen offset:1024 lds
  s_add_u32 m0, s45, 4096
  s_nop 0
  buffer_load_dwordx4 v13, s[12:15], s96 offen offset:0 lds
  buffer_load_dwordx4 v13, s[12:15], s97 offen offset:1024 lds
  s_add_u32 m0, s45, 6144
  s_nop 0
  buffer_load_dwordx4 v13, s[12:15], s98 offen offset:0 lds
  buffer_load_dwordx4 v13, s[12:15], s99 offen offset:1024 lds
  s_add_u32 s51, s35, 0
  s_add_u32 m0, s36, 0
  s_nop 0
  buffer_load_dwordx4 v4, s[8:11], s51 offen lds
  s_add_u32 s50, s35, 128
  s_add_u32 m0, s36, 4128
  s_nop 0
  buffer_load_dwordx4 v4, s[8:11], s50 offen lds
  s_add_u32 s51, s35, 256
  s_add_u32 m0, s36, 8256
  s_nop 0
  buffer_load_dwordx4 v4, s[8:11], s51 offen lds
  s_lshl_b32 s38, s32, 5
  s_add_u32 s38, s38, 1536
  s_lshl_b32 s39, s34, 10
  s_lshl_b32 s3, s33, 2
  s_add_u32 s3, s3, s34
  s_mul_i32 s40, s3, 106496
  s_add_u32 s40, s40, 1048576
  s_mov_b32 s44, 0xffff0000
  s_mul_i32 s42, s32, 24576
  s_add_u32 s42, s42, s40
  s_lshr_b32 s43, s32, 1
  s_add_u32 s43, s43, 24
  s_lshl_b32 s43, s43, 12
  s_and_b32 s3, s32, 1
  s_lshl_b32 s3, s3, 11
  s_add_u32 s43, s43, s3
  s_add_u32 s43, s43, s40
  s_mul_i32 s76, s32, 352
  s_sub_u32 s76, 1536, s76
  s_add_u32 s46, s41, 0
  s_add_u32 s46, s46, s35
  s_add_u32 s47, s41, 26624
  s_add_u32 s47, s47, s35
  s_add_u32 s48, s41, 53248
  s_add_u32 s48, s48, s35
  s_add_u32 s49, s41, 79872
  s_add_u32 s49, s49, s35
  s_mov_b32 s28, s68
  s_and_b32 s29, s69, 0xffff
  s_mov_b32 s30, 4992
  s_mov_b32 s31, 0x20000
  s_mov_b32 s16, s70
  s_and_b32 s17, s71, 0xffff
  s_mov_b32 s18, 27262976
  s_mov_b32 s19, 0x20000
  s_mov_b32 s20, s74
  s_and_b32 s21, s75, 0xffff
  s_mov_b32 s22, 268435456
  s_mov_b32 s23, 0x20000
  v_lshrrev_b32 v23, 2, v20
  v_lshlrev_b32 v23, 4, v23
  v_and_b32 v24, 3, v20
  v_add_u32 v23, v23, v24
  s_lshl_b32 s3, s34, 2
  v_add_u32 v23, s3, v23
  v_mul_u32_u24 v23, 1664, v23
  v_add_u32 v5, v23, v22
  v_lshrrev_b32 v20, 1, v0
  v_and_b32 v21, 1, v0
  v_lshlrev_b32 v21, 4, v21
  v_mul_u32_u24 v23, 1664, v20
  v_add_u32 v14, v23, v21
  v_and_b32 v23, 19, v20
  v_and_b32 v24, 4, v20
  v_lshlrev_b32 v24, 1, v24
  v_or_b32 v23, v23, v24
  v_and_b32 v24, 8, v20
  v_lshrrev_b32 v24, 1, v24
  v_or_b32 v23, v23, v24
  v_mul_u32_u24 v23, 1664, v23
  v_add_u32 v6, v23, v21
  v_and_b32 v23, 7, v20
  v_and_b32 v24, 8, v20
  v_lshlrev_b32 v24, 1, v24
  v_or_b32 v23, v23, v24
  v_and_b32 v24, 16, v20
  v_lshrrev_b32 v24, 1, v24
  v_or_b32 v23, v23, v24
  v_mul_u32_u24 v23, 1664, v23
  v_add_u32 v7, v23, v21
  v_lshrrev_b32 v20, 4, v0
  v_and_b32 v21, 15, v0
  v_lshrrev_b32 v22, 2, v0
  v_and_b32 v22, 3, v22
  v_and_b32 v23, 3, v0
  v_mul_u32_u24 v24, 1032, v20
  v_lshlrev_b32 v25, 7, v22
  v_add_u32 v24, v24, v25
  v_lshlrev_b32 v25, 4, v23
  v_add_u32 v24, v24, v25
  v_lshrrev_b32 v25, 1, v22
  v_lshlrev_b32 v25, 6, v25
  v_add_u32 v1, v24, v25
  v_sub_u32 v25, 64, v25
  v_add_u32 v2, v24, v25
  v_lshrrev_b32 v24, 1, v20
  v_lshlrev_b32 v24, 9, v24
  v_and_b32 v25, 1, v20
  v_lshlrev_b32 v25, 7, v25
  v_add_u32 v24, v24, v25
  v_lshlrev_b32 v25, 5, v22
  v_add_u32 v24, v24, v25
  v_lshlrev_b32 v25, 3, v23
  v_add_u32 v3, v24, v25
  v_and_b32 v24, 6, v21
  v_xor_b32 v24, v20, v24
  v_lshlrev_b32 v24, 4, v24
  v_lshlrev_b32 v25, 7, v21
  v_add_u32 v24, v24, v25
  v_add_u32 v8, s45, v24
  v_xor_b32 v9, 64, v8
  v_lshlrev_b32 v24, 5, v21
  v_lshlrev_b32 v25, 3, v20
  v_add_u32 v24, v24, v25
  v_add_u32 v24, s45, v24
  v_add_u32 v10, 24576, v24
  v_lshlrev_b32 v11, 4, v0
  v_lshlrev_b32 v12, 3, v0
  v_lshlrev_b32 v24, 4, v20
  v_add_u32 v15, 54848, v24
  s_lshl_b32 s3, s33, 2
  s_add_u32 s3, s3, s34
  s_lshl_b32 s3, s3, 9
  s_add_u32 s3, s3, 262144
  v_and_b32 v24, 3, v0
  v_lshlrev_b32 v24, 7, v24
  v_add_u32 v18, s3, v24
  v_mov_b32 v16, 0x7fffff00
  v_cmp_eq_u32 vcc, s32, v0
  s_nop 1
  v_cndmask_b32 v16, v16, v18, vcc
  s_lshl_b32 s3, s34, 6
  v_add_u32 v20, s3, v0
  v_min_u32 v20, 207, v20
  v_lshrrev_b32 v21, 4, v20
  v_and_b32 v22, 15, v20
  v_lshrrev_b32 v23, 1, v21
  v_lshlrev_b32 v23, 5, v23
  v_lshrrev_b32 v24, 2, v22
  v_lshlrev_b32 v24, 3, v24
  v_add_u32 v23, v23, v24
  v_and_b32 v24, 1, v21
  v_lshlrev_b32 v24, 2, v24
  v_add_u32 v23, v23, v24
  v_and_b32 v24, 3, v22
  v_add_u32 v23, v23, v24
  s_mul_i32 s3, s32, 192
  v_add_u32 v23, s3, v23
  s_lshl_b32 s3, s32, 4
  s_add_u32 s3, s3, 768
  v_add_u32 v24, s3, v22
  v_cmp_eq_u32 vcc, 12, v21
  s_nop 1
  v_cndmask_b32 v23, v23, v24, vcc
  v_lshlrev_b32 v23, 1, v23
  v_lshlrev_b32 v22, 2, v20
  v_add_u32 v22, 54848, v22
  s_lshl_b32 s91, s2, 2
  s_add_u32 s91, s91, s34
  s_lshl_b32 s91, s91, 12
  s_add_u32 s50, s35, 53248
  s_add_u32 m0, s36, 12384
  s_nop 0
  buffer_load_dwordx4 v4, s[8:11], s50 offen lds
  s_add_u32 s51, s35, 53376
  s_add_u32 m0, s36, 16512
  s_nop 0
  buffer_load_dwordx4 v4, s[8:11], s51 offen lds
  s_add_u32 s50, s35, 53504
  s_add_u32 m0, s36, 20640
  s_nop 0
  buffer_load_dwordx4 v4, s[8:11], s50 offen lds
  s_add_u32 m0, s45, 8064
  s_nop 0
  buffer_load_dwordx4 v13, s[12:15], s92 offen offset:128 lds
  buffer_load_dwordx4 v13, s[12:15], s93 offen offset:1152 lds
  s_add_u32 m0, s45, 10112
  s_nop 0
  buffer_load_dwordx4 v13, s[12:15], s94 offen offset:128 lds
  buffer_load_dwordx4 v13, s[12:15], s95 offen offset:1152 lds
  s_add_u32 m0, s45, 12160
  s_nop 0
  buffer_load_dwordx4 v13, s[12:15], s96 offen offset:128 lds
  buffer_load_dwordx4 v13, s[12:15], s97 offen offset:1152 lds
  s_add_u32 m0, s45, 14208
  s_nop 0
  buffer_load_dwordx4 v13, s[12:15], s98 offen offset:128 lds
  buffer_load_dwordx4 v13, s[12:15], s99 offen offset:1152 lds
  buffer_load_dword v30, v18, s[20:23], 0 offen sc1
  buffer_load_ushort v25, v23, s[28:31], 0 offen offset:0
  buffer_load_ushort v26, v23, s[28:31], 0 offen offset:1664
  buffer_load_ushort v27, v23, s[28:31], 0 offen offset:3328
  s_add_u32 s54, s91, 0
  buffer_load_dword v19, v29, s[8:11], s54 offen
  s_add_u32 s54, s91, 1024
  buffer_load_dword v19, v29, s[8:11], s54 offen
  s_add_u32 s54, s91, 2048
  buffer_load_dword v19, v29, s[8:11], s54 offen
  s_add_u32 s54, s91, 3072
  buffer_load_dword v19, v29, s[8:11], s54 offen
  s_waitcnt vmcnt(28)
  ds_read_b128 a[208:211], v8 offset:0
  s_waitcnt vmcnt(26)
  ds_read_b128 a[212:215], v8 offset:2048
  s_waitcnt vmcnt(24)
  ds_read_b128 a[216:219], v8 offset:4096
  s_waitcnt vmcnt(22)
  ds_read_b128 a[220:223], v8 offset:6144
  ds_read_b128 a[224:227], v9 offset:0
  ds_read_b128 a[228:231], v9 offset:2048
  ds_read_b128 a[232:235], v9 offset:4096
  ds_read_b128 a[236:239], v9 offset:6144
  s_waitcnt vmcnt(19)
  s_barrier
  ds_read_b64_tr_b16 v[32:33], v1 offset:0
  ds_read_b64_tr_b16 v[34:35], v1 offset:512
  ds_read_b64_tr_b16 v[36:37], v1 offset:8
  ds_read_b64_tr_b16 v[38:39], v1 offset:520
  ds_read_b64_tr_b16 v[40:41], v2 offset:0
  ds_read_b64_tr_b16 v[42:43], v2 offset:512
  s_waitcnt lgkmcnt(4)
  v_mfma_f32_16x16x32_bf16 v[48:51], v[32:35], a[208:211], 0
  ds_read_b64_tr_b16 v[44:45], v2 offset:8
  s_add_u32 s51, s35, 106496
  v_mfma_f32_16x16x32_bf16 v[52:55], v[32:35], a[212:215], 0
  ds_read_b64_tr_b16 v[46:47], v2 offset:520
  s_waitcnt lgkmcnt(4)
  v_mfma_f32_16x16x32_bf16 v[56:59], v[32:35], a[216:219], 0
  s_add_u32 m0, s36, 24768
  s_waitcnt vmcnt(14)
  v_mfma_f32_16x16x32_bf16 v[60:63], v[32:35], a[220:223], 0
  buffer_load_dwordx4 v4, s[8:11], s51 offen lds
  v_mfma_f32_16x16x32_bf16 v[64:67], v[36:39], a[208:211], 0
  ds_read_b64_tr_b16 v[32:33], v1 offset:4128
  s_add_u32 s50, s35, 106624
  v_mfma_f32_16x16x32_bf16 v[68:71], v[36:39], a[212:215], 0
  ds_read_b64_tr_b16 v[34:35], v1 offset:4640
  s_waitcnt lgkmcnt(4)
  v_mfma_f32_16x16x32_bf16 v[72:75], v[36:39], a[216:219], 0
  s_add_u32 m0, s36, 28896
  ds_read_b128 a[240:243], v8 offset:8192
  v_mfma_f32_16x16x32_bf16 v[76:79], v[36:39], a[220:223], 0
  buffer_load_dwordx4 v4, s[8:11], s50 offen lds
  v_mfma_f32_16x16x32_bf16 v[80:83], v[40:43], a[208:211], 0
  ds_read_b64_tr_b16 v[36:37], v1 offset:4136
  s_add_u32 s51, s35, 106752
  v_mfma_f32_16x16x32_bf16 v[84:87], v[40:43], a[212:215], 0
  ds_read_b64_tr_b16 v[38:39], v1 offset:4648
  s_waitcnt lgkmcnt(5)
  v_mfma_f32_16x16x32_bf16 v[88:91], v[40:43], a[216:219], 0
  s_add_u32 m0, s36, 33024
  s_waitcnt vmcnt(14)
  v_mfma_f32_16x16x32_bf16 v[92:95], v[40:43], a[220:223], 0
  buffer_load_dwordx4 v4, s[8:11], s51 offen lds
  v_mfma_f32_16x16x32_bf16 v[96:99], v[44:47], a[208:211], 0
  ds_read_b64_tr_b16 v[40:41], v2 offset:4128
  s_add_u32 s50, s35, 159744
  v_mfma_f32_16x16x32_bf16 v[100:103], v[44:47], a[212:215], 0
  ds_read_b64_tr_b16 v[42:43], v2 offset:4640
  s_waitcnt lgkmcnt(5)
  v_mfma_f32_16x16x32_bf16 v[104:107], v[44:47], a[216:219], 0
  s_add_u32 m0, s36, 37152
  ds_read_b128 a[244:247], v8 offset:10240
  v_mfma_f32_16x16x32_bf16 v[108:111], v[44:47], a[220:223], 0
  buffer_load_dwordx4 v4, s[8:11], s50 offen lds
  v_mfma_f32_16x16x32_bf16 v[112:115], v[32:35], a[208:211], 0
  ds_read_b64_tr_b16 v[44:45], v2 offset:4136
  s_add_u32 s51, s35, 159872
  v_mfma_f32_16x16x32_bf16 v[116:119], v[32:35], a[212:215], 0
  ds_read_b64_tr_b16 v[46:47], v2 offset:4648
  s_waitcnt lgkmcnt(5)
  v_mfma_f32_16x16x32_bf16 v[120:123], v[32:35], a[216:219], 0
  s_add_u32 m0, s36, 41280
  s_waitcnt vmcnt(14)
  v_mfma_f32_16x16x32_bf16 v[124:127], v[32:35], a[220:223], 0
  buffer_load_dwordx4 v4, s[8:11], s51 offen lds
  v_mfma_f32_16x16x32_bf16 v[128:131], v[36:39], a[208:211], 0
  ds_read_b64_tr_b16 v[32:33], v1 offset:8256
  s_add_u32 s50, s35, 160000
  v_mfma_f32_16x16x32_bf16 v[132:135], v[36:39], a[212:215], 0
  ds_read_b64_tr_b16 v[34:35], v1 offset:8768
  s_waitcnt lgkmcnt(5)
  v_mfma_f32_16x16x32_bf16 v[136:139], v[36:39], a[216:219], 0
  s_add_u32 m0, s36, 45408
  ds_read_b128 a[248:251], v8 offset:12288
  v_mfma_f32_16x16x32_bf16 v[140:143], v[36:39], a[220:223], 0
  buffer_load_dwordx4 v4, s[8:11], s50 offen lds
  v_mfma_f32_16x16x32_bf16 v[144:147], v[40:43], a[208:211], 0
  ds_read_b64_tr_b16 v[36:37], v1 offset:8264
  s_add_u32 s51, s35, 212992
  v_mfma_f32_16x16x32_bf16 v[148:151], v[40:43], a[212:215], 0
  ds_read_b64_tr_b16 v[38:39], v1 offset:8776
  s_waitcnt lgkmcnt(5)
  v_mfma_f32_16x16x32_bf16 v[152:155], v[40:43], a[216:219], 0
  s_add_u32 m0, s36, 49536
  s_waitcnt vmcnt(14)
  v_mfma_f32_16x16x32_bf16 v[156:159], v[40:43], a[220:223], 0
  buffer_load_dwordx4 v4, s[8:11], s51 offen lds
  v_mfma_f32_16x16x32_bf16 v[160:163], v[44:47], a[208:211], 0
  ds_read_b64_tr_b16 v[40:41], v2 offset:8256
  s_add_u32 s54, s41, 256
  v_mfma_f32_16x16x32_bf16 v[164:167], v[44:47], a[212:215], 0
  ds_read_b64_tr_b16 v[42:43], v2 offset:8768
  s_waitcnt lgkmcnt(5)
  v_mfma_f32_16x16x32_bf16 v[168:171], v[44:47], a[216:219], 0
  buffer_load_dword v19, v31, s[12:15], s54 offen
  v_mfma_f32_16x16x32_bf16 v[172:175], v[44:47], a[220:223], 0
  ds_read_b128 a[252:255], v8 offset:14336
  v_mfma_f32_16x16x32_bf16 v[176:179], v[32:35], a[208:211], 0
  ds_read_b64_tr_b16 v[44:45], v2 offset:8264
  v_mfma_f32_16x16x32_bf16 v[180:183], v[32:35], a[212:215], 0
  ds_read_b64_tr_b16 v[46:47], v2 offset:8776
  s_waitcnt lgkmcnt(5)
  v_mfma_f32_16x16x32_bf16 v[184:187], v[32:35], a[216:219], 0
  s_barrier
  s_add_u32 s50, s35, 213120
  s_add_u32 m0, s36, 0
  v_mfma_f32_16x16x32_bf16 v[188:191], v[32:35], a[220:223], 0
  buffer_load_dwordx4 v4, s[8:11], s50 offen lds
  v_mfma_f32_16x16x32_bf16 v[192:195], v[36:39], a[208:211], 0
  ds_read_b64_tr_b16 v[32:33], v1 offset:12384
  s_add_u32 s51, s35, 213248
  v_mfma_f32_16x16x32_bf16 v[196:199], v[36:39], a[212:215], 0
  ds_read_b64_tr_b16 v[34:35], v1 offset:12896
  s_waitcnt lgkmcnt(5)
  v_mfma_f32_16x16x32_bf16 v[200:203], v[36:39], a[216:219], 0
  s_add_u32 m0, s36, 4128
  ds_read_b128 a[0:3], v9 offset:8192
  v_mfma_f32_16x16x32_bf16 v[204:207], v[36:39], a[220:223], 0
  buffer_load_dwordx4 v4, s[8:11], s51 offen lds
  v_mfma_f32_16x16x32_bf16 v[208:211], v[40:43], a[208:211], 0
  ds_read_b64_tr_b16 v[36:37], v1 offset:12392
  s_mov_b32 s54, 212992
  v_mfma_f32_16x16x32_bf16 v[212:215], v[40:43], a[212:215], 0
  ds_read_b64_tr_b16 v[38:39], v1 offset:12904
  s_waitcnt lgkmcnt(5)
  v_mfma_f32_16x16x32_bf16 v[216:219], v[40:43], a[216:219], 0
  ds_read_b128 a[4:7], v9 offset:10240
  v_mfma_f32_16x16x32_bf16 v[220:223], v[40:43], a[220:223], 0
  ds_read_b128 a[8:11], v9 offset:12288
  v_mfma_f32_16x16x32_bf16 v[224:227], v[44:47], a[208:211], 0
  ds_read_b64_tr_b16 v[40:41], v2 offset:12384
  v_mfma_f32_16x16x32_bf16 v[228:231], v[44:47], a[212:215], 0
  ds_read_b64_tr_b16 v[42:43], v2 offset:12896
  s_waitcnt lgkmcnt(7)
  v_mfma_f32_16x16x32_bf16 v[232:235], v[44:47], a[216:219], 0
  buffer_load_dword v19, v17, s[8:11], s54 offen
  v_mfma_f32_16x16x32_bf16 v[236:239], v[44:47], a[220:223], 0
  ds_read_b128 a[12:15], v9 offset:14336
  v_mfma_f32_16x16x32_bf16 v[48:51], v[32:35], a[224:227], v[48:51]
  ds_read_b64_tr_b16 v[44:45], v2 offset:12392
  v_mfma_f32_16x16x32_bf16 v[52:55], v[32:35], a[228:231], v[52:55]
  ds_read_b64_tr_b16 v[46:47], v2 offset:12904
  s_waitcnt lgkmcnt(7)
  v_mfma_f32_16x16x32_bf16 v[56:59], v[32:35], a[232:235], v[56:59]
  v_mfma_f32_16x16x32_bf16 v[60:63], v[32:35], a[236:239], v[60:63]
  v_mfma_f32_16x16x32_bf16 v[64:67], v[36:39], a[224:227], v[64:67]
  ds_read_b64_tr_b16 v[32:33], v1 offset:16512
  s_add_u32 m0, s45, 16128
  v_mfma_f32_16x16x32_bf16 v[68:71], v[36:39], a[228:231], v[68:71]
  ds_read_b64_tr_b16 v[34:35], v1 offset:17024
  s_waitcnt lgkmcnt(5)
  v_mfma_f32_16x16x32_bf16 v[72:75], v[36:39], a[232:235], v[72:75]
  buffer_load_dwordx4 v13, s[12:15], s92 offen offset:256 lds
  v_mfma_f32_16x16x32_bf16 v[76:79], v[36:39], a[236:239], v[76:79]
  v_mfma_f32_16x16x32_bf16 v[80:83], v[40:43], a[224:227], v[80:83]
  ds_read_b64_tr_b16 v[36:37], v1 offset:16520
  v_mfma_f32_16x16x32_bf16 v[84:87], v[40:43], a[228:231], v[84:87]
  ds_read_b64_tr_b16 v[38:39], v1 offset:17032
  s_waitcnt lgkmcnt(4)
  v_mfma_f32_16x16x32_bf16 v[88:91], v[40:43], a[232:235], v[88:91]
  buffer_load_dwordx4 v13, s[12:15], s93 offen offset:1280 lds
  v_mfma_f32_16x16x32_bf16 v[92:95], v[40:43], a[236:239], v[92:95]
  v_mfma_f32_16x16x32_bf16 v[96:99], v[44:47], a[224:227], v[96:99]
  ds_read_b64_tr_b16 v[40:41], v2 offset:16512
  s_add_u32 m0, s45, 18176
  v_mfma_f32_16x16x32_bf16 v[100:103], v[44:47], a[228:231], v[100:103]
  ds_read_b64_tr_b16 v[42:43], v2 offset:17024
  s_waitcnt lgkmcnt(4)
  v_mfma_f32_16x16x32_bf16 v[104:107], v[44:47], a[232:235], v[104:107]
  buffer_load_dwordx4 v13, s[12:15], s94 offen offset:256 lds
  v_mfma_f32_16x16x32_bf16 v[108:111], v[44:47], a[236:239], v[108:111]
  v_mfma_f32_16x16x32_bf16 v[112:115], v[32:35], a[224:227], v[112:115]
  ds_read_b64_tr_b16 v[44:45], v2 offset:16520
  v_mfma_f32_16x16x32_bf16 v[116:119], v[32:35], a[228:231], v[116:119]
  ds_read_b64_tr_b16 v[46:47], v2 offset:17032
  s_waitcnt lgkmcnt(4)
  v_mfma_f32_16x16x32_bf16 v[120:123], v[32:35], a[232:235], v[120:123]
  buffer_load_dwordx4 v13, s[12:15], s95 offen offset:1280 lds
  v_mfma_f32_16x16x32_bf16 v[124:127], v[32:35], a[236:239], v[124:127]
  v_mfma_f32_16x16x32_bf16 v[128:131], v[36:39], a[224:227], v[128:131]
  ds_read_b64_tr_b16 v[32:33], v1 offset:20640
  v_mfma_f32_16x16x32_bf16 v[132:135], v[36:39], a[228:231], v[132:135]
  ds_read_b64_tr_b16 v[34:35], v1 offset:21152
  s_waitcnt lgkmcnt(4)
  v_mfma_f32_16x16x32_bf16 v[136:139], v[36:39], a[232:235], v[136:139]
  v_mfma_f32_16x16x32_bf16 v[140:143], v[36:39], a[236:239], v[140:143]
  v_mfma_f32_16x16x32_bf16 v[144:147], v[40:43], a[224:227], v[144:147]
  ds_read_b64_tr_b16 v[36:37], v1 offset:20648
  s_add_u32 m0, s45, 20224
  v_mfma_f32_16x16x32_bf16 v[148:151], v[40:43], a[228:231], v[148:151]
  ds_read_b64_tr_b16 v[38:39], v1 offset:21160
  s_waitcnt lgkmcnt(4)
  v_mfma_f32_16x16x32_bf16 v[152:155], v[40:43], a[232:235], v[152:155]
  buffer_load_dwordx4 v13, s[12:15], s96 offen offset:256 lds
  v_mfma_f32_16x16x32_bf16 v[156:159], v[40:43], a[236:239], v[156:159]
  v_mfma_f32_16x16x32_bf16 v[160:163], v[44:47], a[224:227], v[160:163]
  ds_read_b64_tr_b16 v[40:41], v2 offset:20640
  v_mfma_f32_16x16x32_bf16 v[164:167], v[44:47], a[228:231], v[164:167]
  ds_read_b64_tr_b16 v[42:43], v2 offset:21152
  s_waitcnt lgkmcnt(4)
  v_mfma_f32_16x16x32_bf16 v[168:171], v[44:47], a[232:235], v[168:171]
  v_mfma_f32_16x16x32_bf16 v[172:175], v[44:47], a[236:239], v[172:175]
  v_mfma_f32_16x16x32_bf16 v[176:179], v[32:35], a[224:227], v[176:179]
  ds_read_b64_tr_b16 v[44:45], v2 offset:20648
  s_waitcnt vmcnt(20)
  v_mfma_f32_16x16x32_bf16 v[180:183], v[32:35], a[228:231], v[180:183]
  ds_read_b64_tr_b16 v[46:47], v2 offset:21160
  s_waitcnt vmcnt(13) lgkmcnt(4)
  v_mfma_f32_16x16x32_bf16 v[184:187], v[32:35], a[232:235], v[184:187]
  s_barrier
  s_add_u32 s50, s35, 266240
  v_lshlrev_b32 v25, 16, v25
  v_mfma_f32_16x16x32_bf16 v[188:191], v[32:35], a[236:239], v[188:191]
  buffer_load_dwordx4 v13, s[12:15], s97 offen offset:1280 lds
  v_mfma_f32_16x16x32_bf16 v[192:195], v[36:39], a[224:227], v[192:195]
  ds_read_b64_tr_b16 v[32:33], v1 offset:24768
  s_add_u32 m0, s36, 8256
  v_mfma_f32_16x16x32_bf16 v[196:199], v[36:39], a[228:231], v[196:199]
  ds_read_b64_tr_b16 v[34:35], v1 offset:25280
  v_lshlrev_b32 v26, 16, v26
  v_mfma_f32_16x16x32_bf16 v[200:203], v[36:39], a[232:235], v[200:203]
  buffer_load_dwordx4 v4, s[8:11], s50 offen lds
  v_mfma_f32_16x16x32_bf16 v[204:207], v[36:39], a[236:239], v[204:207]
  s_waitcnt lgkmcnt(4)
  s_add_u32 m0, s45, 22272
  s_add_u32 s51, s35, 266368
  v_mfma_f32_16x16x32_bf16 v[208:211], v[40:43], a[224:227], v[208:211]
  ds_read_b64_tr_b16 v[36:37], v1 offset:24776
  v_lshlrev_b32 v27, 16, v27
  v_mfma_f32_16x16x32_bf16 v[212:215], v[40:43], a[228:231], v[212:215]
  ds_read_b64_tr_b16 v[38:39], v1 offset:25288
  v_add_f32 v25, 1.0, v25
  v_mfma_f32_16x16x32_bf16 v[216:219], v[40:43], a[232:235], v[216:219]
  buffer_load_dwordx4 v13, s[12:15], s98 offen offset:256 lds
  v_mfma_f32_16x16x32_bf16 v[220:223], v[40:43], a[236:239], v[220:223]
  s_waitcnt lgkmcnt(4)
  ds_write_b32 v22, v25 offset:0
  v_mfma_f32_16x16x32_bf16 v[224:227], v[44:47], a[224:227], v[224:227]
  ds_read_b64_tr_b16 v[40:41], v2 offset:24768
  v_mfma_f32_16x16x32_bf16 v[228:231], v[44:47], a[228:231], v[228:231]
  ds_read_b64_tr_b16 v[42:43], v2 offset:25280
  s_waitcnt lgkmcnt(5)
  v_mfma_f32_16x16x32_bf16 v[232:235], v[44:47], a[232:235], v[232:235]
  buffer_load_dwordx4 v13, s[12:15], s99 offen offset:1280 lds
  v_mfma_f32_16x16x32_bf16 v[236:239], v[44:47], a[236:239], v[236:239]
  s_add_u32 m0, s36, 12384
  ds_write_b32 v22, v26 offset:832
  v_mfma_f32_16x16x32_bf16 v[48:51], v[32:35], a[240:243], v[48:51]
  ds_read_b64_tr_b16 v[44:45], v2 offset:24776
  v_mfma_f32_16x16x32_bf16 v[52:55], v[32:35], a[244:247], v[52:55]
  ds_read_b64_tr_b16 v[46:47], v2 offset:25288
  s_waitcnt lgkmcnt(6)
  v_mfma_f32_16x16x32_bf16 v[56:59], v[32:35], a[248:251], v[56:59]
  buffer_load_dwordx4 v4, s[8:11], s51 offen lds
  v_mfma_f32_16x16x32_bf16 v[60:63], v[32:35], a[252:255], v[60:63]
  s_add_u32 s50, s35, 266496
  s_add_u32 m0, s36, 16512
  v_mfma_f32_16x16x32_bf16 v[64:67], v[36:39], a[240:243], v[64:67]
  ds_read_b64_tr_b16 v[32:33], v1 offset:28896
  v_mfma_f32_16x16x32_bf16 v[68:71], v[36:39], a[244:247], v[68:71]
  ds_read_b64_tr_b16 v[34:35], v1 offset:29408
  s_waitcnt lgkmcnt(5)
  v_mfma_f32_16x16x32_bf16 v[72:75], v[36:39], a[248:251], v[72:75]
  buffer_load_dwordx4 v4, s[8:11], s50 offen lds
  v_mfma_f32_16x16x32_bf16 v[76:79], v[36:39], a[252:255], v[76:79]
  ds_write_b32 v22, v27 offset:1664
  v_mfma_f32_16x16x32_bf16 v[80:83], v[40:43], a[240:243], v[80:83]
  ds_read_b64_tr_b16 v[36:37], v1 offset:28904
  v_mfma_f32_16x16x32_bf16 v[84:87], v[40:43], a[244:247], v[84:87]
  ds_read_b64_tr_b16 v[38:39], v1 offset:29416
  s_waitcnt lgkmcnt(5)
  v_mfma_f32_16x16x32_bf16 v[88:91], v[40:43], a[248:251], v[88:91]
  v_mfma_f32_16x16x32_bf16 v[92:95], v[40:43], a[252:255], v[92:95]
  v_mfma_f32_16x16x32_bf16 v[96:99], v[44:47], a[240:243], v[96:99]
  ds_read_b64_tr_b16 v[40:41], v2 offset:28896
  s_add_u32 m0, s45, -384
  v_mfma_f32_16x16x32_bf16 v[100:103], v[44:47], a[244:247], v[100:103]
  ds_read_b64_tr_b16 v[42:43], v2 offset:29408
  s_waitcnt lgkmcnt(5)
  v_mfma_f32_16x16x32_bf16 v[104:107], v[44:47], a[248:251], v[104:107]
  buffer_load_dwordx4 v13, s[12:15], s92 offen offset:384 lds
  v_mfma_f32_16x16x32_bf16 v[108:111], v[44:47], a[252:255], v[108:111]
  v_mfma_f32_16x16x32_bf16 v[112:115], v[32:35], a[240:243], v[112:115]
  ds_read_b64_tr_b16 v[44:45], v2 offset:28904
  v_mfma_f32_16x16x32_bf16 v[116:119], v[32:35], a[244:247], v[116:119]
  ds_read_b64_tr_b16 v[46:47], v2 offset:29416
  s_waitcnt lgkmcnt(4)
  v_mfma_f32_16x16x32_bf16 v[120:123], v[32:35], a[248:251], v[120:123]
  buffer_load_dwordx4 v13, s[12:15], s93 offen offset:1408 lds
  v_mfma_f32_16x16x32_bf16 v[124:127], v[32:35], a[252:255], v[124:127]
  v_mfma_f32_16x16x32_bf16 v[128:131], v[36:39], a[240:243], v[128:131]
  ds_read_b64_tr_b16 v[32:33], v1 offset:33024
  v_mfma_f32_16x16x32_bf16 v[132:135], v[36:39], a[244:247], v[132:135]
  ds_read_b64_tr_b16 v[34:35], v1 offset:33536
  s_waitcnt lgkmcnt(4)
  v_mfma_f32_16x16x32_bf16 v[136:139], v[36:39], a[248:251], v[136:139]
  v_mfma_f32_16x16x32_bf16 v[140:143], v[36:39], a[252:255], v[140:143]
  v_mfma_f32_16x16x32_bf16 v[144:147], v[40:43], a[240:243], v[144:147]
  ds_read_b64_tr_b16 v[36:37], v1 offset:33032
  s_add_u32 m0, s45, 1664
  v_mfma_f32_16x16x32_bf16 v[148:151], v[40:43], a[244:247], v[148:151]
  ds_read_b64_tr_b16 v[38:39], v1 offset:33544
  s_waitcnt lgkmcnt(4)
  v_mfma_f32_16x16x32_bf16 v[152:155], v[40:43], a[248:251], v[152:155]
  buffer_load_dwordx4 v13, s[12:15], s94 offen offset:384 lds
  v_mfma_f32_16x16x32_bf16 v[156:159], v[40:43], a[252:255], v[156:159]
  s_waitcnt vmcnt(12)
  ds_read_b128 a[16:19], v8 offset:16384
  v_mfma_f32_16x16x32_bf16 v[160:163], v[44:47], a[240:243], v[160:163]
  ds_read_b64_tr_b16 v[40:41], v2 offset:33024
  s_add_u32 s54, s41, 512
  v_mfma_f32_16x16x32_bf16 v[164:167], v[44:47], a[244:247], v[164:167]
  ds_read_b64_tr_b16 v[42:43], v2 offset:33536
  s_waitcnt lgkmcnt(5)
  v_mfma_f32_16x16x32_bf16 v[168:171], v[44:47], a[248:251], v[168:171]
  buffer_load_dwordx4 v13, s[12:15], s95 offen offset:1408 lds
  v_mfma_f32_16x16x32_bf16 v[172:175], v[44:47], a[252:255], v[172:175]
  buffer_load_dword v19, v31, s[12:15], s54 offen
  v_mfma_f32_16x16x32_bf16 v[176:179], v[32:35], a[240:243], v[176:179]
  ds_read_b64_tr_b16 v[44:45], v2 offset:33032
  s_waitcnt vmcnt(12)
  v_mfma_f32_16x16x32_bf16 v[180:183], v[32:35], a[244:247], v[180:183]
  ds_read_b64_tr_b16 v[46:47], v2 offset:33544
  s_waitcnt lgkmcnt(5)
  v_mfma_f32_16x16x32_bf16 v[184:187], v[32:35], a[248:251], v[184:187]
  s_barrier
  s_lshr_b32 s51, 0x3020100, s37
  s_and_b32 s51, s51, 0xff
  v_mfma_f32_16x16x32_bf16 v[188:191], v[32:35], a[252:255], v[188:191]
  s_mul_i32 s51, s51, 53248
  s_add_u32 s51, s51, s38
  s_add_u32 m0, s39, 20640
  v_mfma_f32_16x16x32_bf16 v[192:195], v[36:39], a[240:243], v[192:195]
  ds_read_b64_tr_b16 v[32:33], v1 offset:37152
  s_add_u32 s54, s72, 8192
  v_mfma_f32_16x16x32_bf16 v[196:199], v[36:39], a[244:247], v[196:199]
  ds_read_b64_tr_b16 v[34:35], v1 offset:37664
  s_waitcnt lgkmcnt(4)
  v_mfma_f32_16x16x32_bf16 v[200:203], v[36:39], a[248:251], v[200:203]
  buffer_load_dwordx4 v6, s[8:11], s51 offen lds
  v_mfma_f32_16x16x32_bf16 v[204:207], v[36:39], a[252:255], v[204:207]
  s_lshr_b32 s50, 0x5050504, s37
  s_and_b32 s50, s50, 0xff
  s_mul_i32 s50, s50, 53248
  v_mfma_f32_16x16x32_bf16 v[208:211], v[40:43], a[240:243], v[208:211]
  ds_read_b64_tr_b16 v[36:37], v1 offset:37160
  s_add_u32 s50, s50, s38
  v_mfma_f32_16x16x32_bf16 v[212:215], v[40:43], a[244:247], v[212:215]
  ds_read_b64_tr_b16 v[38:39], v1 offset:37672
  s_waitcnt lgkmcnt(4)
  v_mfma_f32_16x16x32_bf16 v[216:219], v[40:43], a[248:251], v[216:219]
  ds_read_b128 a[20:23], v8 offset:18432
  v_mfma_f32_16x16x32_bf16 v[220:223], v[40:43], a[252:255], v[220:223]
  v_mfma_f32_16x16x32_bf16 v[224:227], v[44:47], a[240:243], v[224:227]
  ds_read_b64_tr_b16 v[40:41], v2 offset:37152
  v_mfma_f32_16x16x32_bf16 v[228:231], v[44:47], a[244:247], v[228:231]
  ds_read_b64_tr_b16 v[42:43], v2 offset:37664
  s_waitcnt lgkmcnt(5)
  v_mfma_f32_16x16x32_bf16 v[232:235], v[44:47], a[248:251], v[232:235]
  v_mfma_f32_16x16x32_bf16 v[236:239], v[44:47], a[252:255], v[236:239]
  s_add_u32 m0, s39, 24736
  v_mfma_f32_16x16x32_bf16 v[48:51], v[32:35], a[0:3], v[48:51]
  ds_read_b64_tr_b16 v[44:45], v2 offset:37160
  s_waitcnt vmcnt(11)
  v_mfma_f32_16x16x32_bf16 v[52:55], v[32:35], a[4:7], v[52:55]
  ds_read_b64_tr_b16 v[46:47], v2 offset:37672
  s_waitcnt lgkmcnt(5)
  v_mfma_f32_16x16x32_bf16 v[56:59], v[32:35], a[8:11], v[56:59]
  buffer_load_dwordx4 v6, s[8:11], s50 offen lds
  v_mfma_f32_16x16x32_bf16 v[60:63], v[32:35], a[12:15], v[60:63]
  s_add_u32 s51, s35, 319488
  ds_read_b128 a[24:27], v8 offset:20480
  v_mfma_f32_16x16x32_bf16 v[64:67], v[36:39], a[0:3], v[64:67]
  ds_read_b64_tr_b16 v[32:33], v1 offset:41280
  v_mfma_f32_16x16x32_bf16 v[68:71], v[36:39], a[4:7], v[68:71]
  ds_read_b64_tr_b16 v[34:35], v1 offset:41792
  s_waitcnt lgkmcnt(5)
  v_mfma_f32_16x16x32_bf16 v[72:75], v[36:39], a[8:11], v[72:75]
  v_mfma_f32_16x16x32_bf16 v[76:79], v[36:39], a[12:15], v[76:79]
  v_mfma_f32_16x16x32_bf16 v[80:83], v[40:43], a[0:3], v[80:83]
  ds_read_b64_tr_b16 v[36:37], v1 offset:41288
  v_mfma_f32_16x16x32_bf16 v[84:87], v[40:43], a[4:7], v[84:87]
  ds_read_b64_tr_b16 v[38:39], v1 offset:41800
  s_waitcnt lgkmcnt(5)
  v_mfma_f32_16x16x32_bf16 v[88:91], v[40:43], a[8:11], v[88:91]
  v_mfma_f32_16x16x32_bf16 v[92:95], v[40:43], a[12:15], v[92:95]
  v_mfma_f32_16x16x32_bf16 v[96:99], v[44:47], a[0:3], v[96:99]
  ds_read_b64_tr_b16 v[40:41], v2 offset:41280
  s_waitcnt vmcnt(9)
  v_mfma_f32_16x16x32_bf16 v[100:103], v[44:47], a[4:7], v[100:103]
  ds_read_b64_tr_b16 v[42:43], v2 offset:41792
  s_waitcnt lgkmcnt(4)
  v_mfma_f32_16x16x32_bf16 v[104:107], v[44:47], a[8:11], v[104:107]
  s_add_u32 m0, s36, 28832
  ds_read_b128 a[28:31], v8 offset:22528
  v_mfma_f32_16x16x32_bf16 v[108:111], v[44:47], a[12:15], v[108:111]
  buffer_load_dwordx4 v4, s[8:11], s51 offen lds
  v_mfma_f32_16x16x32_bf16 v[112:115], v[32:35], a[0:3], v[112:115]
  ds_read_b64_tr_b16 v[44:45], v2 offset:41288
  v_mfma_f32_16x16x32_bf16 v[116:119], v[32:35], a[4:7], v[116:119]
  ds_read_b64_tr_b16 v[46:47], v2 offset:41800
  s_waitcnt lgkmcnt(5)
  v_mfma_f32_16x16x32_bf16 v[120:123], v[32:35], a[8:11], v[120:123]
  buffer_load_dword v19, off, s[64:67], s54
  v_mfma_f32_16x16x32_bf16 v[124:127], v[32:35], a[12:15], v[124:127]
  s_add_u32 m0, s45, 3712
  ds_read_b128 a[32:35], v9 offset:16384
  v_mfma_f32_16x16x32_bf16 v[128:131], v[36:39], a[0:3], v[128:131]
  ds_read_b64_tr_b16 v[32:33], v1 offset:45408
  v_mfma_f32_16x16x32_bf16 v[132:135], v[36:39], a[4:7], v[132:135]
  ds_read_b64_tr_b16 v[34:35], v1 offset:45920
  s_waitcnt lgkmcnt(6)
  v_mfma_f32_16x16x32_bf16 v[136:139], v[36:39], a[8:11], v[136:139]
  buffer_load_dwordx4 v13, s[12:15], s96 offen offset:384 lds
  v_mfma_f32_16x16x32_bf16 v[140:143], v[36:39], a[12:15], v[140:143]
  buffer_load_dwordx4 v13, s[12:15], s97 offen offset:1408 lds
  v_mfma_f32_16x16x32_bf16 v[144:147], v[40:43], a[0:3], v[144:147]
  ds_read_b64_tr_b16 v[36:37], v1 offset:45416
  s_add_u32 m0, s45, 5760
  v_mfma_f32_16x16x32_bf16 v[148:151], v[40:43], a[4:7], v[148:151]
  ds_read_b64_tr_b16 v[38:39], v1 offset:45928
  s_waitcnt lgkmcnt(5)
  v_mfma_f32_16x16x32_bf16 v[152:155], v[40:43], a[8:11], v[152:155]
  buffer_load_dwordx4 v13, s[12:15], s98 offen offset:384 lds
  v_mfma_f32_16x16x32_bf16 v[156:159], v[40:43], a[12:15], v[156:159]
  ds_read_b128 a[36:39], v9 offset:18432
  v_mfma_f32_16x16x32_bf16 v[160:163], v[44:47], a[0:3], v[160:163]
  ds_read_b64_tr_b16 v[40:41], v2 offset:45408
  v_mfma_f32_16x16x32_bf16 v[164:167], v[44:47], a[4:7], v[164:167]
  ds_read_b64_tr_b16 v[42:43], v2 offset:45920
  s_waitcnt lgkmcnt(5)
  v_mfma_f32_16x16x32_bf16 v[168:171], v[44:47], a[8:11], v[168:171]
  ds_read_b128 a[40:43], v9 offset:20480
  v_mfma_f32_16x16x32_bf16 v[172:175], v[44:47], a[12:15], v[172:175]
  ds_read_b128 a[44:47], v9 offset:22528
  v_mfma_f32_16x16x32_bf16 v[176:179], v[32:35], a[0:3], v[176:179]
  ds_read_b64_tr_b16 v[44:45], v2 offset:45416
  s_waitcnt vmcnt(10)
  v_mfma_f32_16x16x32_bf16 v[180:183], v[32:35], a[4:7], v[180:183]
  ds_read_b64_tr_b16 v[46:47], v2 offset:45928
  s_waitcnt lgkmcnt(7)
  v_mfma_f32_16x16x32_bf16 v[184:187], v[32:35], a[8:11], v[184:187]
  s_barrier
  s_add_u32 s50, s35, 372736
  v_mfma_f32_16x16x32_bf16 v[188:191], v[32:35], a[12:15], v[188:191]
  buffer_load_dwordx4 v13, s[12:15], s99 offen offset:1408 lds
  v_mfma_f32_16x16x32_bf16 v[192:195], v[36:39], a[0:3], v[192:195]
  ds_read_b64_tr_b16 v[32:33], v1 offset:49536
  s_add_u32 m0, s36, 32960
  v_mfma_f32_16x16x32_bf16 v[196:199], v[36:39], a[4:7], v[196:199]
  ds_read_b64_tr_b16 v[34:35], v1 offset:50048
  s_waitcnt lgkmcnt(6)
  v_mfma_f32_16x16x32_bf16 v[200:203], v[36:39], a[8:11], v[200:203]
  buffer_load_dwordx4 v4, s[8:11], s50 offen lds
  v_mfma_f32_16x16x32_bf16 v[204:207], v[36:39], a[12:15], v[204:207]
  s_add_u32 s51, s35, 425984
  s_add_u32 m0, s36, 37088
  v_mfma_f32_16x16x32_bf16 v[208:211], v[40:43], a[0:3], v[208:211]
  ds_read_b64_tr_b16 v[36:37], v1 offset:49544
  v_mfma_f32_16x16x32_bf16 v[212:215], v[40:43], a[4:7], v[212:215]
  ds_read_b64_tr_b16 v[38:39], v1 offset:50056
  s_waitcnt lgkmcnt(4)
  v_mfma_f32_16x16x32_bf16 v[216:219], v[40:43], a[8:11], v[216:219]
  buffer_load_dwordx4 v4, s[8:11], s51 offen lds
  v_mfma_f32_16x16x32_bf16 v[220:223], v[40:43], a[12:15], v[220:223]
  s_add_u32 s50, s35, 479232
  s_add_u32 m0, s36, 41216
  v_mfma_f32_16x16x32_bf16 v[224:227], v[44:47], a[0:3], v[224:227]
  ds_read_b64_tr_b16 v[40:41], v2 offset:49536
  v_mfma_f32_16x16x32_bf16 v[228:231], v[44:47], a[4:7], v[228:231]
  ds_read_b64_tr_b16 v[42:43], v2 offset:50048
  s_waitcnt lgkmcnt(4)
  v_mfma_f32_16x16x32_bf16 v[232:235], v[44:47], a[8:11], v[232:235]
  buffer_load_dwordx4 v4, s[8:11], s50 offen lds
  v_mfma_f32_16x16x32_bf16 v[236:239], v[44:47], a[12:15], v[236:239]
  ds_read_b128 a[48:51], v8 offset:0
  s_waitcnt vmcnt(12)
  v_mfma_f32_16x16x32_bf16 v[48:51], v[32:35], a[16:19], v[48:51]
  ds_read_b64_tr_b16 v[44:45], v2 offset:49544
  s_add_u32 m0, s45, 7680
  v_mfma_f32_16x16x32_bf16 v[52:55], v[32:35], a[20:23], v[52:55]
  ds_read_b64_tr_b16 v[46:47], v2 offset:50056
  s_waitcnt lgkmcnt(5)
  v_mfma_f32_16x16x32_bf16 v[56:59], v[32:35], a[24:27], v[56:59]
  buffer_load_dwordx4 v13, s[12:15], s92 offen offset:512 lds
  v_mfma_f32_16x16x32_bf16 v[60:63], v[32:35], a[28:31], v[60:63]
  ds_read_b128 a[52:55], v8 offset:2048
  v_mfma_f32_16x16x32_bf16 v[64:67], v[36:39], a[16:19], v[64:67]
  ds_read_b64_tr_b16 v[32:33], v1 offset:0
  v_mfma_f32_16x16x32_bf16 v[68:71], v[36:39], a[20:23], v[68:71]
  ds_read_b64_tr_b16 v[34:35], v1 offset:512
  s_waitcnt lgkmcnt(6)
  v_mfma_f32_16x16x32_bf16 v[72:75], v[36:39], a[24:27], v[72:75]
  buffer_load_dwordx4 v13, s[12:15], s93 offen offset:1536 lds
  v_mfma_f32_16x16x32_bf16 v[76:79], v[36:39], a[28:31], v[76:79]
  v_mfma_f32_16x16x32_bf16 v[80:83], v[40:43], a[16:19], v[80:83]
  ds_read_b64_tr_b16 v[36:37], v1 offset:8
  s_add_u32 m0, s45, 9728
  v_mfma_f32_16x16x32_bf16 v[84:87], v[40:43], a[20:23], v[84:87]
  ds_read_b64_tr_b16 v[38:39], v1 offset:520
  s_waitcnt lgkmcnt(5)
  v_mfma_f32_16x16x32_bf16 v[88:91], v[40:43], a[24:27], v[88:91]
  buffer_load_dwordx4 v13, s[12:15], s94 offen offset:512 lds
  v_mfma_f32_16x16x32_bf16 v[92:95], v[40:43], a[28:31], v[92:95]
  v_mfma_f32_16x16x32_bf16 v[96:99], v[44:47], a[16:19], v[96:99]
  ds_read_b64_tr_b16 v[40:41], v2 offset:0
  v_mfma_f32_16x16x32_bf16 v[100:103], v[44:47], a[20:23], v[100:103]
  ds_read_b64_tr_b16 v[42:43], v2 offset:512
  s_waitcnt lgkmcnt(4)
  v_mfma_f32_16x16x32_bf16 v[104:107], v[44:47], a[24:27], v[104:107]
  buffer_load_dwordx4 v13, s[12:15], s95 offen offset:1536 lds
  v_mfma_f32_16x16x32_bf16 v[108:111], v[44:47], a[28:31], v[108:111]
  s_add_u32 m0, s45, 11776
  v_mfma_f32_16x16x32_bf16 v[112:115], v[32:35], a[16:19], v[112:115]
  ds_read_b64_tr_b16 v[44:45], v2 offset:8
  v_mfma_f32_16x16x32_bf16 v[116:119], v[32:35], a[20:23], v[116:119]
  ds_read_b64_tr_b16 v[46:47], v2 offset:520
  s_waitcnt lgkmcnt(4)
  v_mfma_f32_16x16x32_bf16 v[120:123], v[32:35], a[24:27], v[120:123]
  buffer_load_dwordx4 v13, s[12:15], s96 offen offset:512 lds
  v_mfma_f32_16x16x32_bf16 v[124:127], v[32:35], a[28:31], v[124:127]
  buffer_load_dwordx4 v13, s[12:15], s97 offen offset:1536 lds
  v_mfma_f32_16x16x32_bf16 v[128:131], v[36:39], a[16:19], v[128:131]
  ds_read_b64_tr_b16 v[32:33], v1 offset:4128
  v_mfma_f32_16x16x32_bf16 v[132:135], v[36:39], a[20:23], v[132:135]
  ds_read_b64_tr_b16 v[34:35], v1 offset:4640
  s_waitcnt lgkmcnt(4)
  v_mfma_f32_16x16x32_bf16 v[136:139], v[36:39], a[24:27], v[136:139]
  s_add_u32 m0, s45, 13824
  v_mfma_f32_16x16x32_bf16 v[140:143], v[36:39], a[28:31], v[140:143]
  buffer_load_dwordx4 v13, s[12:15], s98 offen offset:512 lds
  v_mfma_f32_16x16x32_bf16 v[144:147], v[40:43], a[16:19], v[144:147]
  ds_read_b64_tr_b16 v[36:37], v1 offset:4136
  v_mfma_f32_16x16x32_bf16 v[148:151], v[40:43], a[20:23], v[148:151]
  ds_read_b64_tr_b16 v[38:39], v1 offset:4648
  s_waitcnt lgkmcnt(4)
  v_mfma_f32_16x16x32_bf16 v[152:155], v[40:43], a[24:27], v[152:155]
  buffer_load_dwordx4 v13, s[12:15], s99 offen offset:1536 lds
  v_mfma_f32_16x16x32_bf16 v[156:159], v[40:43], a[28:31], v[156:159]
  v_mfma_f32_16x16x32_bf16 v[160:163], v[44:47], a[16:19], v[160:163]
  ds_read_b64_tr_b16 v[40:41], v2 offset:4128
  v_mfma_f32_16x16x32_bf16 v[164:167], v[44:47], a[20:23], v[164:167]
  ds_read_b64_tr_b16 v[42:43], v2 offset:4640
  s_waitcnt lgkmcnt(4)
  v_mfma_f32_16x16x32_bf16 v[168:171], v[44:47], a[24:27], v[168:171]
  v_mfma_f32_16x16x32_bf16 v[172:175], v[44:47], a[28:31], v[172:175]
  v_mfma_f32_16x16x32_bf16 v[176:179], v[32:35], a[16:19], v[176:179]
  ds_read_b64_tr_b16 v[44:45], v2 offset:4136
  s_add_u32 s54, s41, 768
  v_mfma_f32_16x16x32_bf16 v[180:183], v[32:35], a[20:23], v[180:183]
  ds_read_b64_tr_b16 v[46:47], v2 offset:4648
  s_waitcnt lgkmcnt(4)
  v_mfma_f32_16x16x32_bf16 v[184:187], v[32:35], a[24:27], v[184:187]
  s_barrier
  s_add_u32 s51, s35, 319616
  s_add_u32 m0, s36, 45344
  v_mfma_f32_16x16x32_bf16 v[188:191], v[32:35], a[28:31], v[188:191]
  buffer_load_dwordx4 v4, s[8:11], s51 offen lds
  v_mfma_f32_16x16x32_bf16 v[192:195], v[36:39], a[16:19], v[192:195]
  ds_read_b64_tr_b16 v[32:33], v1 offset:8256
  s_add_u32 m0, s45, 15744
  v_mfma_f32_16x16x32_bf16 v[196:199], v[36:39], a[20:23], v[196:199]
  ds_read_b64_tr_b16 v[34:35], v1 offset:8768
  s_waitcnt lgkmcnt(4)
  v_mfma_f32_16x16x32_bf16 v[200:203], v[36:39], a[24:27], v[200:203]
  buffer_load_dwordx4 v13, s[12:15], s92 offen offset:640 lds
  v_mfma_f32_16x16x32_bf16 v[204:207], v[36:39], a[28:31], v[204:207]
  buffer_load_dword v19, v31, s[12:15], s54 offen
  v_mfma_f32_16x16x32_bf16 v[208:211], v[40:43], a[16:19], v[208:211]
  ds_read_b64_tr_b16 v[36:37], v1 offset:8264
  s_add_u32 s50, s35, 372864
  v_mfma_f32_16x16x32_bf16 v[212:215], v[40:43], a[20:23], v[212:215]
  ds_read_b64_tr_b16 v[38:39], v1 offset:8776
  s_waitcnt lgkmcnt(4)
  v_mfma_f32_16x16x32_bf16 v[216:219], v[40:43], a[24:27], v[216:219]
  s_waitcnt vmcnt(16)
  ds_read_b128 a[56:59], v8 offset:4096
  v_mfma_f32_16x16x32_bf16 v[220:223], v[40:43], a[28:31], v[220:223]
  v_mfma_f32_16x16x32_bf16 v[224:227], v[44:47], a[16:19], v[224:227]
  ds_read_b64_tr_b16 v[40:41], v2 offset:8256
  v_mfma_f32_16x16x32_bf16 v[228:231], v[44:47], a[20:23], v[228:231]
  ds_read_b64_tr_b16 v[42:43], v2 offset:8768
  s_waitcnt lgkmcnt(5)
  v_mfma_f32_16x16x32_bf16 v[232:235], v[44:47], a[24:27], v[232:235]
  v_mfma_f32_16x16x32_bf16 v[236:239], v[44:47], a[28:31], v[236:239]
  v_mfma_f32_16x16x32_bf16 v[48:51], v[32:35], a[32:35], v[48:51]
  ds_read_b64_tr_b16 v[44:45], v2 offset:8264
  s_waitcnt vmcnt(14)
  v_mfma_f32_16x16x32_bf16 v[52:55], v[32:35], a[36:39], v[52:55]
  ds_read_b64_tr_b16 v[46:47], v2 offset:8776
  s_waitcnt lgkmcnt(5)
  v_mfma_f32_16x16x32_bf16 v[56:59], v[32:35], a[40:43], v[56:59]
  buffer_load_dwordx4 v13, s[12:15], s93 offen offset:1664 lds
  v_mfma_f32_16x16x32_bf16 v[60:63], v[32:35], a[44:47], v[60:63]
  s_add_u32 m0, s36, 49472
  ds_read_b128 a[60:63], v8 offset:6144
  v_mfma_f32_16x16x32_bf16 v[64:67], v[36:39], a[32:35], v[64:67]
  ds_read_b64_tr_b16 v[32:33], v1 offset:12384
  v_mfma_f32_16x16x32_bf16 v[68:71], v[36:39], a[36:39], v[68:71]
  ds_read_b64_tr_b16 v[34:35], v1 offset:12896
  s_waitcnt lgkmcnt(5)
  v_mfma_f32_16x16x32_bf16 v[72:75], v[36:39], a[40:43], v[72:75]
  buffer_load_dwordx4 v4, s[8:11], s50 offen lds
  v_mfma_f32_16x16x32_bf16 v[76:79], v[36:39], a[44:47], v[76:79]
  s_add_u32 s51, s35, 426112
  s_add_u32 m0, s36, 0
  v_mfma_f32_16x16x32_bf16 v[80:83], v[40:43], a[32:35], v[80:83]
  ds_read_b64_tr_b16 v[36:37], v1 offset:12392
  v_mfma_f32_16x16x32_bf16 v[84:87], v[40:43], a[36:39], v[84:87]
  ds_read_b64_tr_b16 v[38:39], v1 offset:12904
  s_waitcnt lgkmcnt(5)
  v_mfma_f32_16x16x32_bf16 v[88:91], v[40:43], a[40:43], v[88:91]
  buffer_load_dwordx4 v4, s[8:11], s51 offen lds
  v_mfma_f32_16x16x32_bf16 v[92:95], v[40:43], a[44:47], v[92:95]
  ds_read_b128 a[64:67], v9 offset:0
  v_mfma_f32_16x16x32_bf16 v[96:99], v[44:47], a[32:35], v[96:99]
  ds_read_b64_tr_b16 v[40:41], v2 offset:12384
  s_add_u32 m0, s45, 17792
  v_mfma_f32_16x16x32_bf16 v[100:103], v[44:47], a[36:39], v[100:103]
  ds_read_b64_tr_b16 v[42:43], v2 offset:12896
  s_waitcnt lgkmcnt(5)
  v_mfma_f32_16x16x32_bf16 v[104:107], v[44:47], a[40:43], v[104:107]
  buffer_load_dwordx4 v13, s[12:15], s94 offen offset:640 lds
  v_mfma_f32_16x16x32_bf16 v[108:111], v[44:47], a[44:47], v[108:111]
  ds_read_b128 a[68:71], v9 offset:2048
  v_mfma_f32_16x16x32_bf16 v[112:115], v[32:35], a[32:35], v[112:115]
  ds_read_b64_tr_b16 v[44:45], v2 offset:12392
  v_mfma_f32_16x16x32_bf16 v[116:119], v[32:35], a[36:39], v[116:119]
  ds_read_b64_tr_b16 v[46:47], v2 offset:12904
  s_waitcnt lgkmcnt(6)
  v_mfma_f32_16x16x32_bf16 v[120:123], v[32:35], a[40:43], v[120:123]
  buffer_load_dwordx4 v13, s[12:15], s95 offen offset:1664 lds
  v_mfma_f32_16x16x32_bf16 v[124:127], v[32:35], a[44:47], v[124:127]
  s_add_u32 m0, s45, 19840
  ds_read_b128 a[72:75], v9 offset:4096
  v_mfma_f32_16x16x32_bf16 v[128:131], v[36:39], a[32:35], v[128:131]
  ds_read_b64_tr_b16 v[32:33], v1 offset:16512
  v_mfma_f32_16x16x32_bf16 v[132:135], v[36:39], a[36:39], v[132:135]
  ds_read_b64_tr_b16 v[34:35], v1 offset:17024
  s_waitcnt lgkmcnt(6)
  v_mfma_f32_16x16x32_bf16 v[136:139], v[36:39], a[40:43], v[136:139]
  buffer_load_dwordx4 v13, s[12:15], s96 offen offset:640 lds
  v_mfma_f32_16x16x32_bf16 v[140:143], v[36:39], a[44:47], v[140:143]
  buffer_load_dwordx4 v13, s[12:15], s97 offen offset:1664 lds
  v_mfma_f32_16x16x32_bf16 v[144:147], v[40:43], a[32:35], v[144:147]
  ds_read_b64_tr_b16 v[36:37], v1 offset:16520
  v_mfma_f32_16x16x32_bf16 v[148:151], v[40:43], a[36:39], v[148:151]
  ds_read_b64_tr_b16 v[38:39], v1 offset:17032
  s_waitcnt lgkmcnt(5)
  v_mfma_f32_16x16x32_bf16 v[152:155], v[40:43], a[40:43], v[152:155]
  s_add_u32 m0, s45, 21888
  ds_read_b128 a[76:79], v9 offset:6144
  v_mfma_f32_16x16x32_bf16 v[156:159], v[40:43], a[44:47], v[156:159]
  buffer_load_dwordx4 v13, s[12:15], s98 offen offset:640 lds
  v_mfma_f32_16x16x32_bf16 v[160:163], v[44:47], a[32:35], v[160:163]
  ds_read_b64_tr_b16 v[40:41], v2 offset:16512
  s_waitcnt vmcnt(17)
  v_mfma_f32_16x16x32_bf16 v[164:167], v[44:47], a[36:39], v[164:167]
  ds_read_b64_tr_b16 v[42:43], v2 offset:17024
  s_waitcnt lgkmcnt(5)
  v_mfma_f32_16x16x32_bf16 v[168:171], v[44:47], a[40:43], v[168:171]
  ds_read_b128 a[80:83], v8 offset:8192
  s_waitcnt vmcnt(15)
  v_mfma_f32_16x16x32_bf16 v[172:175], v[44:47], a[44:47], v[172:175]
  ds_read_b128 a[84:87], v8 offset:10240
  v_mfma_f32_16x16x32_bf16 v[176:179], v[32:35], a[32:35], v[176:179]
  ds_read_b64_tr_b16 v[44:45], v2 offset:16520
  s_waitcnt vmcnt(13)
  v_mfma_f32_16x16x32_bf16 v[180:183], v[32:35], a[36:39], v[180:183]
  ds_read_b64_tr_b16 v[46:47], v2 offset:17032
  s_waitcnt lgkmcnt(7)
  v_mfma_f32_16x16x32_bf16 v[184:187], v[32:35], a[40:43], v[184:187]
  s_barrier
  s_add_u32 s50, s35, 479360
  v_mfma_f32_16x16x32_bf16 v[188:191], v[32:35], a[44:47], v[188:191]
  buffer_load_dwordx4 v13, s[12:15], s99 offen offset:1664 lds
  v_mfma_f32_16x16x32_bf16 v[192:195], v[36:39], a[32:35], v[192:195]
  ds_read_b64_tr_b16 v[32:33], v3 offset:20640
  s_add_u32 m0, s36, 4128
  v_mfma_f32_16x16x32_bf16 v[196:199], v[36:39], a[36:39], v[196:199]
  ds_read_b64_tr_b16 v[34:35], v3 offset:20896
  s_waitcnt lgkmcnt(6)
  v_mfma_f32_16x16x32_bf16 v[200:203], v[36:39], a[40:43], v[200:203]
  buffer_load_dwordx4 v4, s[8:11], s50 offen lds
  v_mfma_f32_16x16x32_bf16 v[204:207], v[36:39], a[44:47], v[204:207]
  s_add_u32 s51, s35, 319744
  s_add_u32 m0, s36, 8256
  v_mfma_f32_16x16x32_bf16 v[208:211], v[40:43], a[32:35], v[208:211]
  ds_read_b64_tr_b16 v[36:37], v3 offset:21664
  v_mfma_f32_16x16x32_bf16 v[212:215], v[40:43], a[36:39], v[212:215]
  ds_read_b64_tr_b16 v[38:39], v3 offset:21920
  s_waitcnt lgkmcnt(4)
  v_mfma_f32_16x16x32_bf16 v[216:219], v[40:43], a[40:43], v[216:219]
  buffer_load_dwordx4 v4, s[8:11], s51 offen lds
  v_mfma_f32_16x16x32_bf16 v[220:223], v[40:43], a[44:47], v[220:223]
  s_add_u32 s50, s35, 372992
  s_add_u32 m0, s36, 12384
  v_mfma_f32_16x16x32_bf16 v[224:227], v[44:47], a[32:35], v[224:227]
  ds_read_b64_tr_b16 v[40:41], v3 offset:22688
  v_mfma_f32_16x16x32_bf16 v[228:231], v[44:47], a[36:39], v[228:231]
  ds_read_b64_tr_b16 v[42:43], v3 offset:22944
  s_waitcnt lgkmcnt(4)
  v_mfma_f32_16x16x32_bf16 v[232:235], v[44:47], a[40:43], v[232:235]
  buffer_load_dwordx4 v4, s[8:11], s50 offen lds
  v_mfma_f32_16x16x32_bf16 v[236:239], v[44:47], a[44:47], v[236:239]
  ds_read_b128 a[88:91], v8 offset:12288
  s_waitcnt vmcnt(15)
  v_mfma_f32_16x16x32_bf16 v[240:243], v[32:35], a[208:211], 0
  ds_read_b64_tr_b16 v[44:45], v3 offset:23712
  s_add_u32 m0, s45, -768
  v_mfma_f32_16x16x32_bf16 v[244:247], v[32:35], a[212:215], 0
  ds_read_b64_tr_b16 v[46:47], v3 offset:23968
  s_waitcnt lgkmcnt(5)
  v_mfma_f32_16x16x32_bf16 v[248:251], v[32:35], a[216:219], 0
  buffer_load_dwordx4 v13, s[12:15], s92 offen offset:768 lds
  v_mfma_f32_16x16x32_bf16 v[252:255], v[32:35], a[220:223], 0
  ds_read_b128 a[92:95], v8 offset:14336
  v_mfma_f32_16x16x32_bf16 v[240:243], v[36:39], a[224:227], v[240:243]
  ds_read_b64_tr_b16 v[32:33], v3 offset:24736
  v_mfma_f32_16x16x32_bf16 v[244:247], v[36:39], a[228:231], v[244:247]
  ds_read_b64_tr_b16 v[34:35], v3 offset:24992
  s_waitcnt lgkmcnt(6)
  v_mfma_f32_16x16x32_bf16 v[248:251], v[36:39], a[232:235], v[248:251]
  buffer_load_dwordx4 v13, s[12:15], s93 offen offset:1792 lds
  v_mfma_f32_16x16x32_bf16 v[252:255], v[36:39], a[236:239], v[252:255]
  ds_read_b128 a[96:99], v9 offset:8192
  v_mfma_f32_16x16x32_bf16 v[240:243], v[40:43], a[240:243], v[240:243]
  ds_read_b64_tr_b16 v[36:37], v3 offset:25760
  v_mfma_f32_16x16x32_bf16 v[244:247], v[40:43], a[244:247], v[244:247]
  ds_read_b64_tr_b16 v[38:39], v3 offset:26016
  s_waitcnt lgkmcnt(6)
  v_mfma_f32_16x16x32_bf16 v[248:251], v[40:43], a[248:251], v[248:251]
  ds_read_b128 a[100:103], v9 offset:10240
  v_mfma_f32_16x16x32_bf16 v[252:255], v[40:43], a[252:255], v[252:255]
  ds_read_b128 a[104:107], v9 offset:12288
  v_mfma_f32_16x16x32_bf16 v[240:243], v[44:47], a[0:3], v[240:243]
  ds_read_b64_tr_b16 v[40:41], v1 offset:28832
  s_add_u32 m0, s45, 1280
  v_mfma_f32_16x16x32_bf16 v[244:247], v[44:47], a[4:7], v[244:247]
  ds_read_b64_tr_b16 v[42:43], v1 offset:29344
  s_waitcnt lgkmcnt(7)
  v_mfma_f32_16x16x32_bf16 v[248:251], v[44:47], a[8:11], v[248:251]
  buffer_load_dwordx4 v13, s[12:15], s94 offen offset:768 lds
  v_mfma_f32_16x16x32_bf16 v[252:255], v[44:47], a[12:15], v[252:255]
  ds_read_b128 a[108:111], v9 offset:14336
  v_mfma_f32_16x16x32_bf16 v[240:243], v[32:35], a[16:19], v[240:243]
  ds_read_b64_tr_b16 v[44:45], v1 offset:28840
  s_waitcnt vmcnt(14)
  v_mfma_f32_16x16x32_bf16 v[244:247], v[32:35], a[20:23], v[244:247]
  ds_read_b64_tr_b16 v[46:47], v1 offset:29352
  s_waitcnt lgkmcnt(7)
  v_mfma_f32_16x16x32_bf16 v[248:251], v[32:35], a[24:27], v[248:251]
  buffer_load_dwordx4 v13, s[12:15], s95 offen offset:1792 lds
  v_mfma_f32_16x16x32_bf16 v[252:255], v[32:35], a[28:31], v[252:255]
  ds_read_b128 a[208:211], v8 offset:16384
  v_mfma_f32_16x16x32_bf16 v[240:243], v[36:39], a[32:35], v[240:243]
  ds_read_b64_tr_b16 v[32:33], v2 offset:28832
  v_mfma_f32_16x16x32_bf16 v[244:247], v[36:39], a[36:39], v[244:247]
  ds_read_b64_tr_b16 v[34:35], v2 offset:29344
  s_waitcnt lgkmcnt(6)
  v_mfma_f32_16x16x32_bf16 v[248:251], v[36:39], a[40:43], v[248:251]
  v_mfma_f32_16x16x32_bf16 v[252:255], v[36:39], a[44:47], v[252:255]
  v_mfma_f32_16x16x32_bf16 v[48:51], v[40:43], a[48:51], v[48:51]
  ds_read_b64_tr_b16 v[36:37], v2 offset:28840
  s_add_u32 m0, s45, 3328
  v_mfma_f32_16x16x32_bf16 v[52:55], v[40:43], a[52:55], v[52:55]
  ds_read_b64_tr_b16 v[38:39], v2 offset:29352
  s_waitcnt lgkmcnt(5)
  v_mfma_f32_16x16x32_bf16 v[56:59], v[40:43], a[56:59], v[56:59]
  buffer_load_dwordx4 v13, s[12:15], s96 offen offset:768 lds
  v_mfma_f32_16x16x32_bf16 v[60:63], v[40:43], a[60:63], v[60:63]
  v_mfma_f32_16x16x32_bf16 v[64:67], v[44:47], a[48:51], v[64:67]
  ds_read_b64_tr_b16 v[40:41], v1 offset:32960
  v_mfma_f32_16x16x32_bf16 v[68:71], v[44:47], a[52:55], v[68:71]
  ds_read_b64_tr_b16 v[42:43], v1 offset:33472
  s_waitcnt lgkmcnt(4)
  v_mfma_f32_16x16x32_bf16 v[72:75], v[44:47], a[56:59], v[72:75]
  v_mfma_f32_16x16x32_bf16 v[76:79], v[44:47], a[60:63], v[76:79]
  v_mfma_f32_16x16x32_bf16 v[80:83], v[32:35], a[48:51], v[80:83]
  ds_read_b64_tr_b16 v[44:45], v1 offset:32968
  s_waitcnt vmcnt(12)
  v_mfma_f32_16x16x32_bf16 v[84:87], v[32:35], a[52:55], v[84:87]
  ds_read_b64_tr_b16 v[46:47], v1 offset:33480
  s_waitcnt lgkmcnt(4)
  v_mfma_f32_16x16x32_bf16 v[88:91], v[32:35], a[56:59], v[88:91]
  s_barrier
  s_add_u32 s51, s35, 426240
  v_mfma_f32_16x16x32_bf16 v[92:95], v[32:35], a[60:63], v[92:95]
  buffer_load_dwordx4 v13, s[12:15], s97 offen offset:1792 lds
  v_mfma_f32_16x16x32_bf16 v[96:99], v[36:39], a[48:51], v[96:99]
  ds_read_b64_tr_b16 v[32:33], v2 offset:32960
  s_add_u32 m0, s36, 16512
  v_mfma_f32_16x16x32_bf16 v[100:103], v[36:39], a[52:55], v[100:103]
  ds_read_b64_tr_b16 v[34:35], v2 offset:33472
  s_waitcnt lgkmcnt(4)
  v_mfma_f32_16x16x32_bf16 v[104:107], v[36:39], a[56:59], v[104:107]
  buffer_load_dwordx4 v4, s[8:11], s51 offen lds
  v_mfma_f32_16x16x32_bf16 v[108:111], v[36:39], a[60:63], v[108:111]
  s_add_u32 m0, s45, 5376
  s_add_u32 s50, s35, 479488
  v_mfma_f32_16x16x32_bf16 v[48:51], v[40:43], a[64:67], v[48:51]
  ds_read_b64_tr_b16 v[36:37], v2 offset:32968
  s_add_u32 s54, s41, 1024
  v_mfma_f32_16x16x32_bf16 v[52:55], v[40:43], a[68:71], v[52:55]
  ds_read_b64_tr_b16 v[38:39], v2 offset:33480
  s_waitcnt lgkmcnt(4)
  v_mfma_f32_16x16x32_bf16 v[56:59], v[40:43], a[72:75], v[56:59]
  buffer_load_dwordx4 v13, s[12:15], s98 offen offset:768 lds
  v_mfma_f32_16x16x32_bf16 v[60:63], v[40:43], a[76:79], v[60:63]
  buffer_load_dword v19, v31, s[12:15], s54 offen
  v_mfma_f32_16x16x32_bf16 v[64:67], v[44:47], a[64:67], v[64:67]
  ds_read_b64_tr_b16 v[40:41], v1 offset:37088
  v_mfma_f32_16x16x32_bf16 v[68:71], v[44:47], a[68:71], v[68:71]
  ds_read_b64_tr_b16 v[42:43], v1 offset:37600
  s_waitcnt lgkmcnt(4)
  v_mfma_f32_16x16x32_bf16 v[72:75], v[44:47], a[72:75], v[72:75]
  ds_read_b128 a[212:215], v8 offset:18432
  s_waitcnt vmcnt(14)
  v_mfma_f32_16x16x32_bf16 v[76:79], v[44:47], a[76:79], v[76:79]
  ds_read_b128 a[216:219], v8 offset:20480
  v_mfma_f32_16x16x32_bf16 v[80:83], v[32:35], a[64:67], v[80:83]
  ds_read_b64_tr_b16 v[44:45], v1 offset:37096
  s_waitcnt vmcnt(12)
  v_mfma_f32_16x16x32_bf16 v[84:87], v[32:35], a[68:71], v[84:87]
  ds_read_b64_tr_b16 v[46:47], v1 offset:37608
  s_waitcnt lgkmcnt(6)
  v_mfma_f32_16x16x32_bf16 v[88:91], v[32:35], a[72:75], v[88:91]
  ds_read_b128 a[220:223], v8 offset:22528
  v_mfma_f32_16x16x32_bf16 v[92:95], v[32:35], a[76:79], v[92:95]
  ds_read_b128 a[224:227], v9 offset:16384
  v_mfma_f32_16x16x32_bf16 v[96:99], v[36:39], a[64:67], v[96:99]
  ds_read_b64_tr_b16 v[32:33], v2 offset:37088
  v_mfma_f32_16x16x32_bf16 v[100:103], v[36:39], a[68:71], v[100:103]
  ds_read_b64_tr_b16 v[34:35], v2 offset:37600
  s_waitcnt lgkmcnt(8)
  v_mfma_f32_16x16x32_bf16 v[104:107], v[36:39], a[72:75], v[104:107]
  buffer_load_dwordx4 v13, s[12:15], s99 offen offset:1792 lds
  v_mfma_f32_16x16x32_bf16 v[108:111], v[36:39], a[76:79], v[108:111]
  s_add_u32 m0, s36, 20640
  ds_read_b128 a[228:231], v9 offset:18432
  v_mfma_f32_16x16x32_bf16 v[48:51], v[40:43], a[80:83], v[48:51]
  ds_read_b64_tr_b16 v[36:37], v2 offset:37096
  v_mfma_f32_16x16x32_bf16 v[52:55], v[40:43], a[84:87], v[52:55]
  ds_read_b64_tr_b16 v[38:39], v2 offset:37608
  s_waitcnt lgkmcnt(7)
  v_mfma_f32_16x16x32_bf16 v[56:59], v[40:43], a[88:91], v[56:59]
  buffer_load_dwordx4 v4, s[8:11], s50 offen lds
  v_mfma_f32_16x16x32_bf16 v[60:63], v[40:43], a[92:95], v[60:63]
  s_lshr_b32 s51, 0x9080706, s37
  s_and_b32 s51, s51, 0xff
  s_mul_i32 s51, s51, 53248
  v_mfma_f32_16x16x32_bf16 v[64:67], v[44:47], a[80:83], v[64:67]
  ds_read_b64_tr_b16 v[40:41], v1 offset:41216
  s_add_u32 m0, s45, 7296
  v_mfma_f32_16x16x32_bf16 v[68:71], v[44:47], a[84:87], v[68:71]
  ds_read_b64_tr_b16 v[42:43], v1 offset:41728
  s_waitcnt lgkmcnt(5)
  v_mfma_f32_16x16x32_bf16 v[72:75], v[44:47], a[88:91], v[72:75]
  buffer_load_dwordx4 v13, s[12:15], s92 offen offset:896 lds
  v_mfma_f32_16x16x32_bf16 v[76:79], v[44:47], a[92:95], v[76:79]
  s_add_u32 s51, s51, s38
  ds_read_b128 a[232:235], v9 offset:20480
  v_mfma_f32_16x16x32_bf16 v[80:83], v[32:35], a[80:83], v[80:83]
  ds_read_b64_tr_b16 v[44:45], v1 offset:41224
  v_mfma_f32_16x16x32_bf16 v[84:87], v[32:35], a[84:87], v[84:87]
  ds_read_b64_tr_b16 v[46:47], v1 offset:41736
  s_waitcnt lgkmcnt(5)
  v_mfma_f32_16x16x32_bf16 v[88:91], v[32:35], a[88:91], v[88:91]
  buffer_load_dwordx4 v13, s[12:15], s93 offen offset:1920 lds
  v_mfma_f32_16x16x32_bf16 v[92:95], v[32:35], a[92:95], v[92:95]
  s_add_u32 m0, s39, 24768
  ds_read_b128 a[236:239], v9 offset:22528
  v_mfma_f32_16x16x32_bf16 v[96:99], v[36:39], a[80:83], v[96:99]
  ds_read_b64_tr_b16 v[32:33], v2 offset:41216
  s_waitcnt vmcnt(11)
  v_mfma_f32_16x16x32_bf16 v[100:103], v[36:39], a[84:87], v[100:103]
  ds_read_b64_tr_b16 v[34:35], v2 offset:41728
  s_waitcnt lgkmcnt(6)
  v_mfma_f32_16x16x32_bf16 v[104:107], v[36:39], a[88:91], v[104:107]
  buffer_load_dwordx4 v6, s[8:11], s51 offen lds
  v_mfma_f32_16x16x32_bf16 v[108:111], v[36:39], a[92:95], v[108:111]
  ds_read_b128 a[240:243], v8 offset:0
  v_mfma_f32_16x16x32_bf16 v[48:51], v[40:43], a[96:99], v[48:51]
  ds_read_b64_tr_b16 v[36:37], v2 offset:41224
  v_mfma_f32_16x16x32_bf16 v[52:55], v[40:43], a[100:103], v[52:55]
  ds_read_b64_tr_b16 v[38:39], v2 offset:41736
  s_waitcnt lgkmcnt(6)
  v_mfma_f32_16x16x32_bf16 v[56:59], v[40:43], a[104:107], v[56:59]
  v_mfma_f32_16x16x32_bf16 v[60:63], v[40:43], a[108:111], v[60:63]
  v_mfma_f32_16x16x32_bf16 v[64:67], v[44:47], a[96:99], v[64:67]
  ds_read_b64_tr_b16 v[40:41], v1 offset:45344
  v_mfma_f32_16x16x32_bf16 v[68:71], v[44:47], a[100:103], v[68:71]
  ds_read_b64_tr_b16 v[42:43], v1 offset:45856
  s_waitcnt lgkmcnt(5)
  v_mfma_f32_16x16x32_bf16 v[72:75], v[44:47], a[104:107], v[72:75]
  v_mfma_f32_16x16x32_bf16 v[76:79], v[44:47], a[108:111], v[76:79]
  v_mfma_f32_16x16x32_bf16 v[80:83], v[32:35], a[96:99], v[80:83]
  ds_read_b64_tr_b16 v[44:45], v1 offset:45352
  s_waitcnt vmcnt(10)
  v_mfma_f32_16x16x32_bf16 v[84:87], v[32:35], a[100:103], v[84:87]
  ds_read_b64_tr_b16 v[46:47], v1 offset:45864
  s_waitcnt lgkmcnt(4)
  v_mfma_f32_16x16x32_bf16 v[88:91], v[32:35], a[104:107], v[88:91]
  s_barrier
  s_add_u32 m0, s45, 9344
  s_add_u32 s50, s35, 532480
  v_mfma_f32_16x16x32_bf16 v[92:95], v[32:35], a[108:111], v[92:95]
  buffer_load_dwordx4 v13, s[12:15], s94 offen offset:896 lds
  v_mfma_f32_16x16x32_bf16 v[96:99], v[36:39], a[96:99], v[96:99]
  ds_read_b64_tr_b16 v[32:33], v2 offset:45344
  v_mfma_f32_16x16x32_bf16 v[100:103], v[36:39], a[100:103], v[100:103]
  ds_read_b64_tr_b16 v[34:35], v2 offset:45856
  s_waitcnt lgkmcnt(4)
  v_mfma_f32_16x16x32_bf16 v[104:107], v[36:39], a[104:107], v[104:107]
  buffer_load_dwordx4 v13, s[12:15], s95 offen offset:1920 lds
  v_mfma_f32_16x16x32_bf16 v[108:111], v[36:39], a[108:111], v[108:111]
  s_add_u32 m0, s36, 28864
  ds_read_b128 a[244:247], v8 offset:2048
  v_mfma_f32_16x16x32_bf16 v[112:115], v[40:43], a[48:51], v[112:115]
  ds_read_b64_tr_b16 v[36:37], v2 offset:45352
  v_mfma_f32_16x16x32_bf16 v[116:119], v[40:43], a[52:55], v[116:119]
  ds_read_b64_tr_b16 v[38:39], v2 offset:45864
  s_waitcnt lgkmcnt(5)
  v_mfma_f32_16x16x32_bf16 v[120:123], v[40:43], a[56:59], v[120:123]
  buffer_load_dwordx4 v4, s[8:11], s50 offen lds
  v_mfma_f32_16x16x32_bf16 v[124:127], v[40:43], a[60:63], v[124:127]
  s_add_u32 m0, s45, 11392
  s_add_u32 s51, s35, 585728
  v_mfma_f32_16x16x32_bf16 v[128:131], v[44:47], a[48:51], v[128:131]
  ds_read_b64_tr_b16 v[40:41], v1 offset:49472
  v_mfma_f32_16x16x32_bf16 v[132:135], v[44:47], a[52:55], v[132:135]
  ds_read_b64_tr_b16 v[42:43], v1 offset:49984
  v_mfma_f32_16x16x32_bf16 v[136:139], v[44:47], a[56:59], v[136:139]
  buffer_load_dwordx4 v13, s[12:15], s96 offen offset:896 lds
  v_mfma_f32_16x16x32_bf16 v[140:143], v[44:47], a[60:63], v[140:143]
  s_waitcnt lgkmcnt(5)
  ds_read_b128 v[20:23], v15 offset:0
  v_mfma_f32_16x16x32_bf16 v[144:147], v[32:35], a[48:51], v[144:147]
  ds_read_b64_tr_b16 v[44:45], v1 offset:49480
  s_waitcnt vmcnt(12)
  v_mfma_f32_16x16x32_bf16 v[148:151], v[32:35], a[52:55], v[148:151]
  ds_read_b64_tr_b16 v[46:47], v1 offset:49992
  s_waitcnt lgkmcnt(2)
  v_mfma_f32_16x16x32_bf16 v[152:155], v[32:35], a[56:59], v[152:155]
  buffer_load_dwordx4 v13, s[12:15], s97 offen offset:1920 lds
  v_mfma_f32_16x16x32_bf16 v[156:159], v[32:35], a[60:63], v[156:159]
  s_add_u32 m0, s36, 32992
  ds_read_b128 a[248:251], v8 offset:4096
  v_mfma_f32_16x16x32_bf16 v[160:163], v[36:39], a[48:51], v[160:163]
  ds_read_b64_tr_b16 v[32:33], v2 offset:49472
  v_add_f32 v48, v48, v20
  v_mfma_f32_16x16x32_bf16 v[164:167], v[36:39], a[52:55], v[164:167]
  ds_read_b64_tr_b16 v[34:35], v2 offset:49984
  v_add_f32 v49, v49, v21
  v_mfma_f32_16x16x32_bf16 v[168:171], v[36:39], a[56:59], v[168:171]
  buffer_load_dwordx4 v4, s[8:11], s51 offen lds
  v_mfma_f32_16x16x32_bf16 v[172:175], v[36:39], a[60:63], v[172:175]
  s_add_u32 m0, s45, 13440
  s_add_u32 s50, s35, 638976
  v_add_f32 v50, v50, v22
  v_mfma_f32_16x16x32_bf16 v[112:115], v[40:43], a[64:67], v[112:115]
  ds_read_b64_tr_b16 v[36:37], v2 offset:49480
  v_add_f32 v51, v51, v23
  v_mfma_f32_16x16x32_bf16 v[116:119], v[40:43], a[68:71], v[116:119]
  ds_read_b64_tr_b16 v[38:39], v2 offset:49992
  v_add_f32 v52, v52, v20
  v_mfma_f32_16x16x32_bf16 v[120:123], v[40:43], a[72:75], v[120:123]
  buffer_load_dwordx4 v13, s[12:15], s98 offen offset:896 lds
  v_mfma_f32_16x16x32_bf16 v[124:127], v[40:43], a[76:79], v[124:127]
  s_waitcnt lgkmcnt(5)
  ds_read_b128 v[24:27], v15 offset:64
  v_mfma_f32_16x16x32_bf16 v[128:131], v[44:47], a[64:67], v[128:131]
  ds_read_b64_tr_b16 v[40:41], v1 offset:0
  v_add_f32 v53, v53, v21
  v_mfma_f32_16x16x32_bf16 v[132:135], v[44:47], a[68:71], v[132:135]
  ds_read_b64_tr_b16 v[42:43], v1 offset:512
  v_add_f32 v54, v54, v22
  v_mfma_f32_16x16x32_bf16 v[136:139], v[44:47], a[72:75], v[136:139]
  buffer_load_dwordx4 v13, s[12:15], s99 offen offset:1920 lds
  v_mfma_f32_16x16x32_bf16 v[140:143], v[44:47], a[76:79], v[140:143]
  s_waitcnt lgkmcnt(5)
  s_add_u32 m0, s36, 37120
  v_add_f32 v55, v55, v23
  v_mfma_f32_16x16x32_bf16 v[144:147], v[32:35], a[64:67], v[144:147]
  ds_read_b64_tr_b16 v[44:45], v1 offset:8
  v_add_f32 v56, v56, v20
  v_mfma_f32_16x16x32_bf16 v[148:151], v[32:35], a[68:71], v[148:151]
  ds_read_b64_tr_b16 v[46:47], v1 offset:520
  v_add_f32 v57, v57, v21
  v_mfma_f32_16x16x32_bf16 v[152:155], v[32:35], a[72:75], v[152:155]
  buffer_load_dwordx4 v4, s[8:11], s50 offen lds
  v_mfma_f32_16x16x32_bf16 v[156:159], v[32:35], a[76:79], v[156:159]
  s_waitcnt lgkmcnt(5)
  v_add_f32 v58, v58, v22
  v_add_f32 v59, v59, v23
  v_mfma_f32_16x16x32_bf16 v[160:163], v[36:39], a[64:67], v[160:163]
  ds_read_b64_tr_b16 v[32:33], v2 offset:0
  s_waitcnt vmcnt(13)
  v_mfma_f32_16x16x32_bf16 v[164:167], v[36:39], a[68:71], v[164:167]
  ds_read_b64_tr_b16 v[34:35], v2 offset:512
  v_add_f32 v60, v60, v20
  v_mfma_f32_16x16x32_bf16 v[168:171], v[36:39], a[72:75], v[168:171]
  s_waitcnt lgkmcnt(4)
  ds_read_b128 a[252:255], v8 offset:6144
  v_mfma_f32_16x16x32_bf16 v[172:175], v[36:39], a[76:79], v[172:175]
  ds_read_b128 a[112:115], v9 offset:0
  v_add_f32 v61, v61, v21
  v_mfma_f32_16x16x32_bf16 v[112:115], v[40:43], a[80:83], v[112:115]
  ds_read_b64_tr_b16 v[36:37], v2 offset:8
  s_add_u32 m0, s45, 15360
  v_mfma_f32_16x16x32_bf16 v[116:119], v[40:43], a[84:87], v[116:119]
  ds_read_b64_tr_b16 v[38:39], v2 offset:520
  v_add_f32 v62, v62, v22
  v_mfma_f32_16x16x32_bf16 v[120:123], v[40:43], a[88:91], v[120:123]
  buffer_load_dwordx4 v13, s[12:15], s92 offen offset:1024 lds
  v_mfma_f32_16x16x32_bf16 v[124:127], v[40:43], a[92:95], v[124:127]
  s_waitcnt lgkmcnt(6)
  ds_read_b128 a[116:119], v9 offset:2048
  v_mfma_f32_16x16x32_bf16 v[128:131], v[44:47], a[80:83], v[128:131]
  ds_read_b64_tr_b16 v[40:41], v1 offset:4128
  v_add_f32 v63, v63, v23
  v_mfma_f32_16x16x32_bf16 v[132:135], v[44:47], a[84:87], v[132:135]
  ds_read_b64_tr_b16 v[42:43], v1 offset:4640
  v_add_f32 v64, v64, v24
  v_mfma_f32_16x16x32_bf16 v[136:139], v[44:47], a[88:91], v[136:139]
  buffer_load_dwordx4 v13, s[12:15], s93 offen offset:2048 lds
  v_mfma_f32_16x16x32_bf16 v[140:143], v[44:47], a[92:95], v[140:143]
  s_waitcnt lgkmcnt(7)
  ds_read_b128 a[120:123], v9 offset:4096
  v_mfma_f32_16x16x32_bf16 v[144:147], v[32:35], a[80:83], v[144:147]
  ds_read_b64_tr_b16 v[44:45], v1 offset:4136
  v_add_f32 v65, v65, v25
  v_mfma_f32_16x16x32_bf16 v[148:151], v[32:35], a[84:87], v[148:151]
  ds_read_b64_tr_b16 v[46:47], v1 offset:4648
  s_waitcnt lgkmcnt(6)
  v_mfma_f32_16x16x32_bf16 v[152:155], v[32:35], a[88:91], v[152:155]
  s_barrier
  s_add_u32 s51, s35, 532608
  s_add_u32 m0, s36, 41248
  v_mfma_f32_16x16x32_bf16 v[156:159], v[32:35], a[92:95], v[156:159]
  buffer_load_dwordx4 v4, s[8:11], s51 offen lds
  v_mfma_f32_16x16x32_bf16 v[160:163], v[36:39], a[80:83], v[160:163]
  ds_read_b64_tr_b16 v[32:33], v2 offset:4128
  s_add_u32 m0, s45, 17408
  v_mfma_f32_16x16x32_bf16 v[164:167], v[36:39], a[84:87], v[164:167]
  ds_read_b64_tr_b16 v[34:35], v2 offset:4640
  s_add_u32 s50, s35, 585856
  v_mfma_f32_16x16x32_bf16 v[168:171], v[36:39], a[88:91], v[168:171]
  buffer_load_dwordx4 v13, s[12:15], s94 offen offset:1024 lds
  v_mfma_f32_16x16x32_bf16 v[172:175], v[36:39], a[92:95], v[172:175]
  s_waitcnt lgkmcnt(5)
  ds_read_b128 a[124:127], v9 offset:6144
  v_mfma_f32_16x16x32_bf16 v[112:115], v[40:43], a[96:99], v[112:115]
  ds_read_b64_tr_b16 v[36:37], v2 offset:4136
  s_waitcnt vmcnt(14)
  v_mfma_f32_16x16x32_bf16 v[116:119], v[40:43], a[100:103], v[116:119]
  ds_read_b64_tr_b16 v[38:39], v2 offset:4648
  v_add_f32 v66, v66, v26
  v_mfma_f32_16x16x32_bf16 v[120:123], v[40:43], a[104:107], v[120:123]
  buffer_load_dwordx4 v13, s[12:15], s95 offen offset:2048 lds
  v_mfma_f32_16x16x32_bf16 v[124:127], v[40:43], a[108:111], v[124:127]
  s_waitcnt lgkmcnt(5)
  s_add_u32 m0, s36, 45376
  v_add_f32 v67, v67, v27
  v_mfma_f32_16x16x32_bf16 v[128:131], v[44:47], a[96:99], v[128:131]
  ds_read_b64_tr_b16 v[40:41], v1 offset:8256
  v_add_f32 v68, v68, v24
  v_mfma_f32_16x16x32_bf16 v[132:135], v[44:47], a[100:103], v[132:135]
  ds_read_b64_tr_b16 v[42:43], v1 offset:8768
  v_add_f32 v69, v69, v25
  v_mfma_f32_16x16x32_bf16 v[136:139], v[44:47], a[104:107], v[136:139]
  buffer_load_dwordx4 v4, s[8:11], s50 offen lds
  v_mfma_f32_16x16x32_bf16 v[140:143], v[44:47], a[108:111], v[140:143]
  s_waitcnt lgkmcnt(5)
  s_add_u32 s51, s35, 639104
  s_add_u32 m0, s36, 49504
  v_mfma_f32_16x16x32_bf16 v[144:147], v[32:35], a[96:99], v[144:147]
  ds_read_b64_tr_b16 v[44:45], v1 offset:8264
  s_add_u32 s54, s41, 1280
  v_mfma_f32_16x16x32_bf16 v[148:151], v[32:35], a[100:103], v[148:151]
  ds_read_b64_tr_b16 v[46:47], v1 offset:8776
  v_add_f32 v70, v70, v26
  v_mfma_f32_16x16x32_bf16 v[152:155], v[32:35], a[104:107], v[152:155]
  buffer_load_dwordx4 v4, s[8:11], s51 offen lds
  v_mfma_f32_16x16x32_bf16 v[156:159], v[32:35], a[108:111], v[156:159]
  s_waitcnt lgkmcnt(4)
  s_add_u32 m0, s45, 19456
  s_add_u32 s50, s35, 532736
  v_mfma_f32_16x16x32_bf16 v[160:163], v[36:39], a[96:99], v[160:163]
  ds_read_b64_tr_b16 v[32:33], v2 offset:8256
  v_add_f32 v71, v71, v27
  v_mfma_f32_16x16x32_bf16 v[164:167], v[36:39], a[100:103], v[164:167]
  ds_read_b64_tr_b16 v[34:35], v2 offset:8768
  v_add_f32 v72, v72, v24
  v_mfma_f32_16x16x32_bf16 v[168:171], v[36:39], a[104:107], v[168:171]
  buffer_load_dwordx4 v13, s[12:15], s96 offen offset:1024 lds
  v_mfma_f32_16x16x32_bf16 v[172:175], v[36:39], a[108:111], v[172:175]
  s_waitcnt lgkmcnt(4)
  ds_read_b128 a[128:131], v8 offset:8192
  v_mfma_f32_16x16x32_bf16 v[176:179], v[40:43], a[48:51], v[176:179]
  ds_read_b64_tr_b16 v[36:37], v2 offset:8264
  s_waitcnt vmcnt(15)
  v_mfma_f32_16x16x32_bf16 v[180:183], v[40:43], a[52:55], v[180:183]
  ds_read_b64_tr_b16 v[38:39], v2 offset:8776
  v_add_f32 v73, v73, v25
  v_mfma_f32_16x16x32_bf16 v[184:187], v[40:43], a[56:59], v[184:187]
  buffer_load_dword v19, v31, s[12:15], s54 offen
  v_add_f32 v74, v74, v26
  v_mfma_f32_16x16x32_bf16 v[188:191], v[40:43], a[60:63], v[188:191]
  s_waitcnt lgkmcnt(5)
  ds_read_b128 a[132:135], v8 offset:10240
  v_mfma_f32_16x16x32_bf16 v[192:195], v[44:47], a[48:51], v[192:195]
  ds_read_b64_tr_b16 v[40:41], v1 offset:12384
  v_add_f32 v75, v75, v27
  v_mfma_f32_16x16x32_bf16 v[196:199], v[44:47], a[52:55], v[196:199]
  ds_read_b64_tr_b16 v[42:43], v1 offset:12896
  v_add_f32 v76, v76, v24
  v_mfma_f32_16x16x32_bf16 v[200:203], v[44:47], a[56:59], v[200:203]
  ds_read_b128 v[20:23], v15 offset:128
  v_add_f32 v77, v77, v25
  v_mfma_f32_16x16x32_bf16 v[204:207], v[44:47], a[60:63], v[204:207]
  s_waitcnt lgkmcnt(7)
  v_add_f32 v78, v78, v26
  v_add_f32 v79, v79, v27
  v_mfma_f32_16x16x32_bf16 v[208:211], v[32:35], a[48:51], v[208:211]
  ds_read_b64_tr_b16 v[44:45], v1 offset:12392
  s_waitcnt vmcnt(13)
  v_mfma_f32_16x16x32_bf16 v[212:215], v[32:35], a[52:55], v[212:215]
  ds_read_b64_tr_b16 v[46:47], v1 offset:12904
  s_waitcnt lgkmcnt(2)
  v_mfma_f32_16x16x32_bf16 v[216:219], v[32:35], a[56:59], v[216:219]
  ds_read_b128 a[136:139], v8 offset:12288
  v_add_f32 v80, v80, v20
  v_mfma_f32_16x16x32_bf16 v[220:223], v[32:35], a[60:63], v[220:223]
  buffer_load_dwordx4 v13, s[12:15], s97 offen offset:2048 lds
  v_mfma_f32_16x16x32_bf16 v[224:227], v[36:39], a[48:51], v[224:227]
  ds_read_b64_tr_b16 v[32:33], v2 offset:12384
  s_add_u32 m0, s36, 0
  v_mfma_f32_16x16x32_bf16 v[228:231], v[36:39], a[52:55], v[228:231]
  ds_read_b64_tr_b16 v[34:35], v2 offset:12896
  v_add_f32 v81, v81, v21
  v_mfma_f32_16x16x32_bf16 v[232:235], v[36:39], a[56:59], v[232:235]
  buffer_load_dwordx4 v4, s[8:11], s50 offen lds
  v_mfma_f32_16x16x32_bf16 v[236:239], v[36:39], a[60:63], v[236:239]
  ds_read_b128 v[24:27], v15 offset:192
  v_add_f32 v82, v82, v22
  v_mfma_f32_16x16x32_bf16 v[176:179], v[40:43], a[64:67], v[176:179]
  ds_read_b64_tr_b16 v[36:37], v2 offset:12392
  v_add_f32 v83, v83, v23
  v_mfma_f32_16x16x32_bf16 v[180:183], v[40:43], a[68:71], v[180:183]
  ds_read_b64_tr_b16 v[38:39], v2 offset:12904
  s_add_u32 m0, s45, 21504
  v_mfma_f32_16x16x32_bf16 v[184:187], v[40:43], a[72:75], v[184:187]
  buffer_load_dwordx4 v13, s[12:15], s98 offen offset:1024 lds
  v_mfma_f32_16x16x32_bf16 v[188:191], v[40:43], a[76:79], v[188:191]
  s_waitcnt lgkmcnt(6)
  v_add_f32 v84, v84, v20
  v_add_f32 v85, v85, v21
  v_mfma_f32_16x16x32_bf16 v[192:195], v[44:47], a[64:67], v[192:195]
  ds_read_b64_tr_b16 v[40:41], v1 offset:16512
  s_waitcnt vmcnt(13)
  v_mfma_f32_16x16x32_bf16 v[196:199], v[44:47], a[68:71], v[196:199]
  ds_read_b64_tr_b16 v[42:43], v1 offset:17024
  v_add_f32 v86, v86, v22
  v_mfma_f32_16x16x32_bf16 v[200:203], v[44:47], a[72:75], v[200:203]
  buffer_load_dwordx4 v13, s[12:15], s99 offen offset:2048 lds
  v_mfma_f32_16x16x32_bf16 v[204:207], v[44:47], a[76:79], v[204:207]
  s_waitcnt lgkmcnt(5)
  ds_read_b128 a[140:143], v8 offset:14336
  v_mfma_f32_16x16x32_bf16 v[208:211], v[32:35], a[64:67], v[208:211]
  ds_read_b64_tr_b16 v[44:45], v1 offset:16520
  v_add_f32 v87, v87, v23
  v_mfma_f32_16x16x32_bf16 v[212:215], v[32:35], a[68:71], v[212:215]
  ds_read_b64_tr_b16 v[46:47], v1 offset:17032
  s_waitcnt lgkmcnt(5)
  v_mfma_f32_16x16x32_bf16 v[216:219], v[32:35], a[72:75], v[216:219]
  s_barrier
  s_add_u32 s51, s35, 585984
  s_add_u32 m0, s36, 4128
  v_mfma_f32_16x16x32_bf16 v[220:223], v[32:35], a[76:79], v[220:223]
  buffer_load_dwordx4 v4, s[8:11], s51 offen lds
  v_mfma_f32_16x16x32_bf16 v[224:227], v[36:39], a[64:67], v[224:227]
  ds_read_b64_tr_b16 v[32:33], v2 offset:16512
  s_add_u32 m0, s45, -1152
  v_mfma_f32_16x16x32_bf16 v[228:231], v[36:39], a[68:71], v[228:231]
  ds_read_b64_tr_b16 v[34:35], v2 offset:17024
  s_add_u32 s50, s35, 639232
  v_mfma_f32_16x16x32_bf16 v[232:235], v[36:39], a[72:75], v[232:235]
  buffer_load_dwordx4 v13, s[12:15], s92 offen offset:1152 lds
  v_mfma_f32_16x16x32_bf16 v[236:239], v[36:39], a[76:79], v[236:239]
  s_waitcnt lgkmcnt(5)
  ds_read_b128 a[144:147], v9 offset:8192
  v_mfma_f32_16x16x32_bf16 v[176:179], v[40:43], a[80:83], v[176:179]
  ds_read_b64_tr_b16 v[36:37], v2 offset:16520
  v_add_f32 v88, v88, v20
  v_mfma_f32_16x16x32_bf16 v[180:183], v[40:43], a[84:87], v[180:183]
  ds_read_b64_tr_b16 v[38:39], v2 offset:17032
  v_add_f32 v89, v89, v21
  v_mfma_f32_16x16x32_bf16 v[184:187], v[40:43], a[88:91], v[184:187]
  buffer_load_dwordx4 v13, s[12:15], s93 offen offset:2176 lds
  v_mfma_f32_16x16x32_bf16 v[188:191], v[40:43], a[92:95], v[188:191]
  s_waitcnt lgkmcnt(5)
  s_add_u32 m0, s36, 8256
  v_add_f32 v90, v90, v22
  v_mfma_f32_16x16x32_bf16 v[192:195], v[44:47], a[80:83], v[192:195]
  ds_read_b64_tr_b16 v[40:41], v1 offset:20640
  v_add_f32 v91, v91, v23
  v_mfma_f32_16x16x32_bf16 v[196:199], v[44:47], a[84:87], v[196:199]
  ds_read_b64_tr_b16 v[42:43], v1 offset:21152
  v_add_f32 v92, v92, v20
  v_mfma_f32_16x16x32_bf16 v[200:203], v[44:47], a[88:91], v[200:203]
  buffer_load_dwordx4 v4, s[8:11], s50 offen lds
  v_mfma_f32_16x16x32_bf16 v[204:207], v[44:47], a[92:95], v[204:207]
  s_waitcnt lgkmcnt(5)
  s_lshr_b32 s51, 0xc0c0b0a, s37
  s_and_b32 s51, s51, 0xff
  v_mfma_f32_16x16x32_bf16 v[208:211], v[32:35], a[80:83], v[208:211]
  ds_read_b64_tr_b16 v[44:45], v1 offset:20648
  s_add_u32 m0, s45, 896
  v_mfma_f32_16x16x32_bf16 v[212:215], v[32:35], a[84:87], v[212:215]
  ds_read_b64_tr_b16 v[46:47], v1 offset:21160
  s_mul_i32 s51, s51, 53248
  v_mfma_f32_16x16x32_bf16 v[216:219], v[32:35], a[88:91], v[216:219]
  buffer_load_dwordx4 v13, s[12:15], s94 offen offset:1152 lds
  v_mfma_f32_16x16x32_bf16 v[220:223], v[32:35], a[92:95], v[220:223]
  s_waitcnt lgkmcnt(4)
  s_add_u32 s51, s51, s38
  v_add_f32 v93, v93, v21
  v_mfma_f32_16x16x32_bf16 v[224:227], v[36:39], a[80:83], v[224:227]
  ds_read_b64_tr_b16 v[32:33], v2 offset:20640
  v_add_f32 v94, v94, v22
  v_mfma_f32_16x16x32_bf16 v[228:231], v[36:39], a[84:87], v[228:231]
  ds_read_b64_tr_b16 v[34:35], v2 offset:21152
  v_add_f32 v95, v95, v23
  v_mfma_f32_16x16x32_bf16 v[232:235], v[36:39], a[88:91], v[232:235]
  buffer_load_dwordx4 v13, s[12:15], s95 offen offset:2176 lds
  v_mfma_f32_16x16x32_bf16 v[236:239], v[36:39], a[92:95], v[236:239]
  s_waitcnt lgkmcnt(4)
  s_add_u32 m0, s39, 12384
  v_add_f32 v96, v96, v24
  v_mfma_f32_16x16x32_bf16 v[176:179], v[40:43], a[96:99], v[176:179]
  ds_read_b64_tr_b16 v[36:37], v2 offset:20648
  v_add_f32 v97, v97, v25
  v_mfma_f32_16x16x32_bf16 v[180:183], v[40:43], a[100:103], v[180:183]
  ds_read_b64_tr_b16 v[38:39], v2 offset:21160
  v_add_f32 v98, v98, v26
  v_mfma_f32_16x16x32_bf16 v[184:187], v[40:43], a[104:107], v[184:187]
  buffer_load_dwordx4 v6, s[8:11], s51 offen lds
  v_mfma_f32_16x16x32_bf16 v[188:191], v[40:43], a[108:111], v[188:191]
  s_waitcnt lgkmcnt(4)
  ds_read_b128 a[148:151], v9 offset:10240
  v_mfma_f32_16x16x32_bf16 v[192:195], v[44:47], a[96:99], v[192:195]
  ds_read_b64_tr_b16 v[40:41], v3 offset:24768
  v_add_f32 v99, v99, v27
  v_mfma_f32_16x16x32_bf16 v[196:199], v[44:47], a[100:103], v[196:199]
  ds_read_b64_tr_b16 v[42:43], v3 offset:25024
  v_add_f32 v100, v100, v24
  v_mfma_f32_16x16x32_bf16 v[200:203], v[44:47], a[104:107], v[200:203]
  ds_read_b128 a[152:155], v9 offset:12288
  v_add_f32 v101, v101, v25
  v_mfma_f32_16x16x32_bf16 v[204:207], v[44:47], a[108:111], v[204:207]
  s_waitcnt lgkmcnt(6)
  ds_read_b128 a[156:159], v9 offset:14336
  v_mfma_f32_16x16x32_bf16 v[208:211], v[32:35], a[96:99], v[208:211]
  ds_read_b64_tr_b16 v[44:45], v3 offset:25792
  s_waitcnt vmcnt(18)
  v_mfma_f32_16x16x32_bf16 v[212:215], v[32:35], a[100:103], v[212:215]
  ds_read_b64_tr_b16 v[46:47], v3 offset:26048
  v_add_f32 v102, v102, v26
  v_mfma_f32_16x16x32_bf16 v[216:219], v[32:35], a[104:107], v[216:219]
  s_add_u32 m0, s45, 2944
  ds_read_b128 a[160:163], v8 offset:16384
  v_mfma_f32_16x16x32_bf16 v[220:223], v[32:35], a[108:111], v[220:223]
  s_waitcnt lgkmcnt(8)
  s_waitcnt vmcnt(15)
  v_add_f32 v103, v103, v27
  v_mfma_f32_16x16x32_bf16 v[224:227], v[36:39], a[96:99], v[224:227]
  ds_read_b64_tr_b16 v[32:33], v3 offset:26816
  v_add_f32 v104, v104, v24
  v_mfma_f32_16x16x32_bf16 v[228:231], v[36:39], a[100:103], v[228:231]
  ds_read_b64_tr_b16 v[34:35], v3 offset:27072
  v_add_f32 v105, v105, v25
  v_mfma_f32_16x16x32_bf16 v[232:235], v[36:39], a[104:107], v[232:235]
  buffer_load_dwordx4 v13, s[12:15], s96 offen offset:1152 lds
  v_mfma_f32_16x16x32_bf16 v[236:239], v[36:39], a[108:111], v[236:239]
  s_waitcnt lgkmcnt(7)
  ds_read_b128 a[164:167], v8 offset:18432
  v_mfma_f32_16x16x32_bf16 v[240:243], v[40:43], a[48:51], v[240:243]
  ds_read_b64_tr_b16 v[36:37], v3 offset:27840
  s_waitcnt vmcnt(11)
  v_mfma_f32_16x16x32_bf16 v[244:247], v[40:43], a[52:55], v[244:247]
  ds_read_b64_tr_b16 v[38:39], v3 offset:28096
  v_add_f32 v106, v106, v26
  v_mfma_f32_16x16x32_bf16 v[248:251], v[40:43], a[56:59], v[248:251]
  buffer_load_dwordx4 v13, s[12:15], s97 offen offset:2176 lds
  v_mfma_f32_16x16x32_bf16 v[252:255], v[40:43], a[60:63], v[252:255]
  s_waitcnt lgkmcnt(6)
  s_add_u32 m0, s45, 4992
  v_add_f32 v107, v107, v27
  v_mfma_f32_16x16x32_bf16 v[240:243], v[44:47], a[64:67], v[240:243]
  ds_read_b64_tr_b16 v[40:41], v1 offset:28864
  v_add_f32 v108, v108, v24
  v_mfma_f32_16x16x32_bf16 v[244:247], v[44:47], a[68:71], v[244:247]
  ds_read_b64_tr_b16 v[42:43], v1 offset:29376
  v_add_f32 v109, v109, v25
  v_mfma_f32_16x16x32_bf16 v[248:251], v[44:47], a[72:75], v[248:251]
  buffer_load_dwordx4 v13, s[12:15], s98 offen offset:1152 lds
  v_mfma_f32_16x16x32_bf16 v[252:255], v[44:47], a[76:79], v[252:255]
  s_waitcnt lgkmcnt(5)
  ds_read_b128 a[168:171], v8 offset:20480
  v_mfma_f32_16x16x32_bf16 v[240:243], v[32:35], a[80:83], v[240:243]
  ds_read_b64_tr_b16 v[44:45], v1 offset:28872
  s_waitcnt vmcnt(10)
  v_mfma_f32_16x16x32_bf16 v[244:247], v[32:35], a[84:87], v[244:247]
  ds_read_b64_tr_b16 v[46:47], v1 offset:29384
  s_waitcnt lgkmcnt(5)
  v_mfma_f32_16x16x32_bf16 v[248:251], v[32:35], a[88:91], v[248:251]
  s_barrier
  s_add_u32 s50, s35, 692224
  s_add_u32 s54, s72, 16384
  v_mfma_f32_16x16x32_bf16 v[252:255], v[32:35], a[92:95], v[252:255]
  buffer_load_dwordx4 v13, s[12:15], s99 offen offset:2176 lds
  v_mfma_f32_16x16x32_bf16 v[240:243], v[36:39], a[96:99], v[240:243]
  ds_read_b64_tr_b16 v[32:33], v2 offset:28864
  s_add_u32 m0, s36, 16480
  v_mfma_f32_16x16x32_bf16 v[244:247], v[36:39], a[100:103], v[244:247]
  ds_read_b64_tr_b16 v[34:35], v2 offset:29376
  v_add_f32 v110, v110, v26
  v_mfma_f32_16x16x32_bf16 v[248:251], v[36:39], a[104:107], v[248:251]
  buffer_load_dwordx4 v4, s[8:11], s50 offen lds
  v_mfma_f32_16x16x32_bf16 v[252:255], v[36:39], a[108:111], v[252:255]
  s_waitcnt lgkmcnt(5)
  s_add_u32 s51, s35, 745472
  s_add_u32 m0, s36, 20608
  v_mfma_f32_16x16x32_bf16 v[48:51], v[40:43], a[208:211], v[48:51]
  ds_read_b64_tr_b16 v[36:37], v2 offset:28872
  v_add_f32 v111, v111, v27
  v_mfma_f32_16x16x32_bf16 v[52:55], v[40:43], a[212:215], v[52:55]
  ds_read_b64_tr_b16 v[38:39], v2 offset:29384
  v_mfma_f32_16x16x32_bf16 v[56:59], v[40:43], a[216:219], v[56:59]
  buffer_load_dwordx4 v4, s[8:11], s51 offen lds
  v_mfma_f32_16x16x32_bf16 v[60:63], v[40:43], a[220:223], v[60:63]
  s_waitcnt lgkmcnt(4)
  s_add_u32 s50, s35, 798720
  s_add_u32 m0, s36, 24736
  v_mfma_f32_16x16x32_bf16 v[64:67], v[44:47], a[208:211], v[64:67]
  ds_read_b64_tr_b16 v[40:41], v1 offset:32992
  v_mfma_f32_16x16x32_bf16 v[68:71], v[44:47], a[212:215], v[68:71]
  ds_read_b64_tr_b16 v[42:43], v1 offset:33504
  v_mfma_f32_16x16x32_bf16 v[72:75], v[44:47], a[216:219], v[72:75]
  buffer_load_dwordx4 v4, s[8:11], s50 offen lds
  v_mfma_f32_16x16x32_bf16 v[76:79], v[44:47], a[220:223], v[76:79]
  s_waitcnt lgkmcnt(4)
  ds_read_b128 a[172:175], v8 offset:22528
  v_mfma_f32_16x16x32_bf16 v[80:83], v[32:35], a[208:211], v[80:83]
  ds_read_b64_tr_b16 v[44:45], v1 offset:33000
  s_add_u32 m0, s45, 6912
  v_mfma_f32_16x16x32_bf16 v[84:87], v[32:35], a[212:215], v[84:87]
  ds_read_b64_tr_b16 v[46:47], v1 offset:33512
  v_mfma_f32_16x16x32_bf16 v[88:91], v[32:35], a[216:219], v[88:91]
  buffer_load_dword v19, off, s[64:67], s54
  v_mfma_f32_16x16x32_bf16 v[92:95], v[32:35], a[220:223], v[92:95]
  s_waitcnt lgkmcnt(5)
  ds_read_b128 a[176:179], v9 offset:16384
  v_mfma_f32_16x16x32_bf16 v[96:99], v[36:39], a[208:211], v[96:99]
  ds_read_b64_tr_b16 v[32:33], v2 offset:32992
  v_mfma_f32_16x16x32_bf16 v[100:103], v[36:39], a[212:215], v[100:103]
  ds_read_b64_tr_b16 v[34:35], v2 offset:33504
  v_mfma_f32_16x16x32_bf16 v[104:107], v[36:39], a[216:219], v[104:107]
  buffer_load_dwordx4 v13, s[12:15], s92 offen offset:1280 lds
  v_mfma_f32_16x16x32_bf16 v[108:111], v[36:39], a[220:223], v[108:111]
  s_waitcnt lgkmcnt(6)
  ds_read_b128 a[180:183], v9 offset:18432
  v_mfma_f32_16x16x32_bf16 v[48:51], v[40:43], a[224:227], v[48:51]
  ds_read_b64_tr_b16 v[36:37], v2 offset:33000
  s_add_u32 s54, s41, 1536
  v_mfma_f32_16x16x32_bf16 v[52:55], v[40:43], a[228:231], v[52:55]
  ds_read_b64_tr_b16 v[38:39], v2 offset:33512
  v_mfma_f32_16x16x32_bf16 v[56:59], v[40:43], a[232:235], v[56:59]
  buffer_load_dwordx4 v13, s[12:15], s93 offen offset:2304 lds
  v_mfma_f32_16x16x32_bf16 v[60:63], v[40:43], a[236:239], v[60:63]
  s_waitcnt lgkmcnt(6)
  ds_read_b128 a[184:187], v9 offset:20480
  v_mfma_f32_16x16x32_bf16 v[64:67], v[44:47], a[224:227], v[64:67]
  ds_read_b64_tr_b16 v[40:41], v1 offset:37120
  s_add_u32 m0, s45, 8960
  v_mfma_f32_16x16x32_bf16 v[68:71], v[44:47], a[228:231], v[68:71]
  ds_read_b64_tr_b16 v[42:43], v1 offset:37632
  v_mfma_f32_16x16x32_bf16 v[72:75], v[44:47], a[232:235], v[72:75]
  buffer_load_dwordx4 v13, s[12:15], s94 offen offset:1280 lds
  v_mfma_f32_16x16x32_bf16 v[76:79], v[44:47], a[236:239], v[76:79]
  s_waitcnt lgkmcnt(6)
  ds_read_b128 a[188:191], v9 offset:22528
  v_mfma_f32_16x16x32_bf16 v[80:83], v[32:35], a[224:227], v[80:83]
  ds_read_b64_tr_b16 v[44:45], v1 offset:37128
  s_waitcnt vmcnt(15)
  v_mfma_f32_16x16x32_bf16 v[84:87], v[32:35], a[228:231], v[84:87]
  ds_read_b64_tr_b16 v[46:47], v1 offset:37640
  v_mfma_f32_16x16x32_bf16 v[88:91], v[32:35], a[232:235], v[88:91]
  buffer_load_dword v19, v31, s[12:15], s54 offen
  v_mfma_f32_16x16x32_bf16 v[92:95], v[32:35], a[236:239], v[92:95]
  s_waitcnt lgkmcnt(6)
  ds_read_b128 a[192:195], v8 offset:0
  v_mfma_f32_16x16x32_bf16 v[96:99], v[36:39], a[224:227], v[96:99]
  ds_read_b64_tr_b16 v[32:33], v2 offset:37120
  s_waitcnt vmcnt(13)
  v_mfma_f32_16x16x32_bf16 v[100:103], v[36:39], a[228:231], v[100:103]
  ds_read_b64_tr_b16 v[34:35], v2 offset:37632
  v_mfma_f32_16x16x32_bf16 v[104:107], v[36:39], a[232:235], v[104:107]
  ds_read_b128 a[196:199], v8 offset:2048
  v_mfma_f32_16x16x32_bf16 v[108:111], v[36:39], a[236:239], v[108:111]
  s_waitcnt lgkmcnt(7)
  ds_read_b128 v[20:23], v15 offset:256
  v_mfma_f32_16x16x32_bf16 v[48:51], v[40:43], a[240:243], v[48:51]
  ds_read_b64_tr_b16 v[36:37], v2 offset:37128
  s_waitcnt vmcnt(10)
  v_mfma_f32_16x16x32_bf16 v[52:55], v[40:43], a[244:247], v[52:55]
  ds_read_b64_tr_b16 v[38:39], v2 offset:37640
  s_waitcnt lgkmcnt(2)
  v_mfma_f32_16x16x32_bf16 v[56:59], v[40:43], a[248:251], v[56:59]
  ds_read_b128 a[200:203], v8 offset:4096
  v_add_f32 v112, v112, v20
  v_mfma_f32_16x16x32_bf16 v[60:63], v[40:43], a[252:255], v[60:63]
  buffer_load_dwordx4 v13, s[12:15], s95 offen offset:2304 lds
  v_mfma_f32_16x16x32_bf16 v[64:67], v[44:47], a[240:243], v[64:67]
  ds_read_b64_tr_b16 v[40:41], v1 offset:41248
  v_add_f32 v113, v113, v21
  v_mfma_f32_16x16x32_bf16 v[68:71], v[44:47], a[244:247], v[68:71]
  ds_read_b64_tr_b16 v[42:43], v1 offset:41760
  s_add_u32 m0, s45, 11008
  v_mfma_f32_16x16x32_bf16 v[72:75], v[44:47], a[248:251], v[72:75]
  buffer_load_dwordx4 v13, s[12:15], s96 offen offset:1280 lds
  v_mfma_f32_16x16x32_bf16 v[76:79], v[44:47], a[252:255], v[76:79]
  ds_read_b128 v[24:27], v15 offset:320
  v_add_f32 v114, v114, v22
  v_mfma_f32_16x16x32_bf16 v[80:83], v[32:35], a[240:243], v[80:83]
  ds_read_b64_tr_b16 v[44:45], v1 offset:41256
  s_waitcnt vmcnt(10)
  v_mfma_f32_16x16x32_bf16 v[84:87], v[32:35], a[244:247], v[84:87]
  ds_read_b64_tr_b16 v[46:47], v1 offset:41768
  s_waitcnt lgkmcnt(6)
  v_mfma_f32_16x16x32_bf16 v[88:91], v[32:35], a[248:251], v[88:91]
  s_barrier
  s_add_u32 s51, s35, 851968
  v_add_f32 v115, v115, v23
  v_mfma_f32_16x16x32_bf16 v[92:95], v[32:35], a[252:255], v[92:95]
  buffer_load_dwordx4 v13, s[12:15], s97 offen offset:2304 lds
  v_mfma_f32_16x16x32_bf16 v[96:99], v[36:39], a[240:243], v[96:99]
  ds_read_b64_tr_b16 v[32:33], v2 offset:41248
  s_add_u32 m0, s36, 28864
  v_mfma_f32_16x16x32_bf16 v[100:103], v[36:39], a[244:247], v[100:103]
  ds_read_b64_tr_b16 v[34:35], v2 offset:41760
  v_add_f32 v116, v116, v20
  v_mfma_f32_16x16x32_bf16 v[104:107], v[36:39], a[248:251], v[104:107]
  buffer_load_dwordx4 v4, s[8:11], s51 offen lds
  v_mfma_f32_16x16x32_bf16 v[108:111], v[36:39], a[252:255], v[108:111]
  s_waitcnt lgkmcnt(5)
  s_add_u32 s50, s35, 905216
  s_add_u32 m0, s36, 32992
  v_mfma_f32_16x16x32_bf16 v[112:115], v[40:43], a[208:211], v[112:115]
  ds_read_b64_tr_b16 v[36:37], v2 offset:41256
  v_mfma_f32_16x16x32_bf16 v[116:119], v[40:43], a[212:215], v[116:119]
  ds_read_b64_tr_b16 v[38:39], v2 offset:41768
  v_mfma_f32_16x16x32_bf16 v[120:123], v[40:43], a[216:219], v[120:123]
  buffer_load_dwordx4 v4, s[8:11], s50 offen lds
  v_mfma_f32_16x16x32_bf16 v[124:127], v[40:43], a[220:223], v[124:127]
  s_waitcnt lgkmcnt(4)
  s_add_u32 m0, s45, 13056
  s_add_u32 s51, s35, 958464
  v_mfma_f32_16x16x32_bf16 v[128:131], v[44:47], a[208:211], v[128:131]
  ds_read_b64_tr_b16 v[40:41], v1 offset:45376
  v_add_f32 v117, v117, v21
  v_mfma_f32_16x16x32_bf16 v[132:135], v[44:47], a[212:215], v[132:135]
  ds_read_b64_tr_b16 v[42:43], v1 offset:45888
  v_add_f32 v118, v118, v22
  v_mfma_f32_16x16x32_bf16 v[136:139], v[44:47], a[216:219], v[136:139]
  buffer_load_dwordx4 v13, s[12:15], s98 offen offset:1280 lds
  v_mfma_f32_16x16x32_bf16 v[140:143], v[44:47], a[220:223], v[140:143]
  s_waitcnt lgkmcnt(4)
  ds_read_b128 a[204:207], v8 offset:6144
  v_mfma_f32_16x16x32_bf16 v[144:147], v[32:35], a[208:211], v[144:147]
  ds_read_b64_tr_b16 v[44:45], v1 offset:45384
  v_add_f32 v119, v119, v23
  v_mfma_f32_16x16x32_bf16 v[148:151], v[32:35], a[212:215], v[148:151]
  ds_read_b64_tr_b16 v[46:47], v1 offset:45896
  v_add_f32 v120, v120, v20
  v_mfma_f32_16x16x32_bf16 v[152:155], v[32:35], a[216:219], v[152:155]
  buffer_load_dwordx4 v13, s[12:15], s99 offen offset:2304 lds
  v_mfma_f32_16x16x32_bf16 v[156:159], v[32:35], a[220:223], v[156:159]
  s_waitcnt lgkmcnt(5)
  s_add_u32 m0, s36, 37120
  v_add_f32 v121, v121, v21
  v_mfma_f32_16x16x32_bf16 v[160:163], v[36:39], a[208:211], v[160:163]
  ds_read_b64_tr_b16 v[32:33], v2 offset:45376
  v_add_f32 v122, v122, v22
  v_mfma_f32_16x16x32_bf16 v[164:167], v[36:39], a[212:215], v[164:167]
  ds_read_b64_tr_b16 v[34:35], v2 offset:45888
  v_add_f32 v123, v123, v23
  v_mfma_f32_16x16x32_bf16 v[168:171], v[36:39], a[216:219], v[168:171]
  buffer_load_dwordx4 v4, s[8:11], s51 offen lds
  v_mfma_f32_16x16x32_bf16 v[172:175], v[36:39], a[220:223], v[172:175]
  s_waitcnt lgkmcnt(5)
  ds_read_b128 a[0:3], v9 offset:0
  v_mfma_f32_16x16x32_bf16 v[112:115], v[40:43], a[224:227], v[112:115]
  ds_read_b64_tr_b16 v[36:37], v2 offset:45384
  v_add_f32 v124, v124, v20
  v_mfma_f32_16x16x32_bf16 v[116:119], v[40:43], a[228:231], v[116:119]
  ds_read_b64_tr_b16 v[38:39], v2 offset:45896
  v_mfma_f32_16x16x32_bf16 v[120:123], v[40:43], a[232:235], v[120:123]
  s_waitcnt lgkmcnt(5)
  ds_read_b128 a[4:7], v9 offset:2048
  v_mfma_f32_16x16x32_bf16 v[124:127], v[40:43], a[236:239], v[124:127]
  ds_read_b128 a[8:11], v9 offset:4096
  v_mfma_f32_16x16x32_bf16 v[128:131], v[44:47], a[224:227], v[128:131]
  ds_read_b64_tr_b16 v[40:41], v1 offset:49504
  s_add_u32 m0, s45, 14976
  v_mfma_f32_16x16x32_bf16 v[132:135], v[44:47], a[228:231], v[132:135]
  ds_read_b64_tr_b16 v[42:43], v1 offset:50016
  v_mfma_f32_16x16x32_bf16 v[136:139], v[44:47], a[232:235], v[136:139]
  buffer_load_dwordx4 v13, s[12:15], s92 offen offset:1408 lds
  v_mfma_f32_16x16x32_bf16 v[140:143], v[44:47], a[236:239], v[140:143]
  s_waitcnt lgkmcnt(7)
  ds_read_b128 a[12:15], v9 offset:6144
  v_mfma_f32_16x16x32_bf16 v[144:147], v[32:35], a[224:227], v[144:147]
  ds_read_b64_tr_b16 v[44:45], v1 offset:49512
  s_waitcnt vmcnt(11)
  v_mfma_f32_16x16x32_bf16 v[148:151], v[32:35], a[228:231], v[148:151]
  ds_read_b64_tr_b16 v[46:47], v1 offset:50024
  v_add_f32 v125, v125, v21
  v_mfma_f32_16x16x32_bf16 v[152:155], v[32:35], a[232:235], v[152:155]
  buffer_load_dwordx4 v13, s[12:15], s93 offen offset:2432 lds
  v_mfma_f32_16x16x32_bf16 v[156:159], v[32:35], a[236:239], v[156:159]
  s_waitcnt lgkmcnt(7)
  ds_read_b128 a[16:19], v8 offset:8192
  v_mfma_f32_16x16x32_bf16 v[160:163], v[36:39], a[224:227], v[160:163]
  ds_read_b64_tr_b16 v[32:33], v2 offset:49504
  v_add_f32 v126, v126, v22
  v_mfma_f32_16x16x32_bf16 v[164:167], v[36:39], a[228:231], v[164:167]
  ds_read_b64_tr_b16 v[34:35], v2 offset:50016
  v_add_f32 v127, v127, v23
  v_mfma_f32_16x16x32_bf16 v[168:171], v[36:39], a[232:235], v[168:171]
  s_waitcnt lgkmcnt(6)
  ds_read_b128 v[20:23], v15 offset:384
  v_mfma_f32_16x16x32_bf16 v[172:175], v[36:39], a[236:239], v[172:175]
  v_add_f32 v128, v128, v24
  v_add_f32 v129, v129, v25
  v_mfma_f32_16x16x32_bf16 v[112:115], v[40:43], a[240:243], v[112:115]
  ds_read_b64_tr_b16 v[36:37], v2 offset:49512
  s_add_u32 m0, s45, 17024
  v_mfma_f32_16x16x32_bf16 v[116:119], v[40:43], a[244:247], v[116:119]
  ds_read_b64_tr_b16 v[38:39], v2 offset:50024
  s_waitcnt vmcnt(9)
  v_mfma_f32_16x16x32_bf16 v[120:123], v[40:43], a[248:251], v[120:123]
  buffer_load_dwordx4 v13, s[12:15], s94 offen offset:1408 lds
  v_mfma_f32_16x16x32_bf16 v[124:127], v[40:43], a[252:255], v[124:127]
  s_waitcnt lgkmcnt(6)
  ds_read_b128 a[20:23], v8 offset:10240
  v_mfma_f32_16x16x32_bf16 v[128:131], v[44:47], a[240:243], v[128:131]
  ds_read_b64_tr_b16 v[40:41], v1 offset:0
  v_mfma_f32_16x16x32_bf16 v[132:135], v[44:47], a[244:247], v[132:135]
  ds_read_b64_tr_b16 v[42:43], v1 offset:512
  v_mfma_f32_16x16x32_bf16 v[136:139], v[44:47], a[248:251], v[136:139]
  buffer_load_dwordx4 v13, s[12:15], s95 offen offset:2432 lds
  v_mfma_f32_16x16x32_bf16 v[140:143], v[44:47], a[252:255], v[140:143]
  s_waitcnt lgkmcnt(6)
  v_mfma_f32_16x16x32_bf16 v[144:147], v[32:35], a[240:243], v[144:147]
  ds_read_b64_tr_b16 v[44:45], v1 offset:8
  s_waitcnt vmcnt(9)
  v_mfma_f32_16x16x32_bf16 v[148:151], v[32:35], a[244:247], v[148:151]
  ds_read_b64_tr_b16 v[46:47], v1 offset:520
  s_waitcnt lgkmcnt(5)
  v_mfma_f32_16x16x32_bf16 v[152:155], v[32:35], a[248:251], v[152:155]
  s_barrier
  s_add_u32 s50, s35, 1011712
  s_add_u32 m0, s36, 41248
  v_mfma_f32_16x16x32_bf16 v[156:159], v[32:35], a[252:255], v[156:159]
  buffer_load_dwordx4 v4, s[8:11], s50 offen lds
  v_mfma_f32_16x16x32_bf16 v[160:163], v[36:39], a[240:243], v[160:163]
  ds_read_b64_tr_b16 v[32:33], v2 offset:0
  s_add_u32 m0, s45, 19072
  v_mfma_f32_16x16x32_bf16 v[164:167], v[36:39], a[244:247], v[164:167]
  ds_read_b64_tr_b16 v[34:35], v2 offset:512
  s_add_u32 s51, s35, 1064960
  v_mfma_f32_16x16x32_bf16 v[168:171], v[36:39], a[248:251], v[168:171]
  buffer_load_dwordx4 v13, s[12:15], s96 offen offset:1408 lds
  v_mfma_f32_16x16x32_bf16 v[172:175], v[36:39], a[252:255], v[172:175]
  s_waitcnt lgkmcnt(4)
  ds_read_b128 a[24:27], v8 offset:12288
  v_mfma_f32_16x16x32_bf16 v[176:179], v[40:43], a[208:211], v[176:179]
  ds_read_b64_tr_b16 v[36:37], v2 offset:8
  v_add_f32 v130, v130, v26
  v_mfma_f32_16x16x32_bf16 v[180:183], v[40:43], a[212:215], v[180:183]
  ds_read_b64_tr_b16 v[38:39], v2 offset:520
  v_add_f32 v131, v131, v27
  v_mfma_f32_16x16x32_bf16 v[184:187], v[40:43], a[216:219], v[184:187]
  v_add_f32 v132, v132, v24
  v_add_f32 v133, v133, v25
  v_mfma_f32_16x16x32_bf16 v[188:191], v[40:43], a[220:223], v[188:191]
  s_waitcnt lgkmcnt(5)
  v_add_f32 v134, v134, v26
  v_add_f32 v135, v135, v27
  v_mfma_f32_16x16x32_bf16 v[192:195], v[44:47], a[208:211], v[192:195]
  ds_read_b64_tr_b16 v[40:41], v1 offset:4128
  v_add_f32 v136, v136, v24
  v_mfma_f32_16x16x32_bf16 v[196:199], v[44:47], a[212:215], v[196:199]
  ds_read_b64_tr_b16 v[42:43], v1 offset:4640
  v_add_f32 v137, v137, v25
  v_mfma_f32_16x16x32_bf16 v[200:203], v[44:47], a[216:219], v[200:203]
  buffer_load_dwordx4 v13, s[12:15], s97 offen offset:2432 lds
  v_mfma_f32_16x16x32_bf16 v[204:207], v[44:47], a[220:223], v[204:207]
  s_waitcnt lgkmcnt(5)
  s_add_u32 m0, s36, 45376
  v_add_f32 v138, v138, v26
  v_mfma_f32_16x16x32_bf16 v[208:211], v[32:35], a[208:211], v[208:211]
  ds_read_b64_tr_b16 v[44:45], v1 offset:4136
  s_waitcnt vmcnt(8)
  v_mfma_f32_16x16x32_bf16 v[212:215], v[32:35], a[212:215], v[212:215]
  ds_read_b64_tr_b16 v[46:47], v1 offset:4648
  v_add_f32 v139, v139, v27
  v_mfma_f32_16x16x32_bf16 v[216:219], v[32:35], a[216:219], v[216:219]
  buffer_load_dwordx4 v4, s[8:11], s51 offen lds
  v_mfma_f32_16x16x32_bf16 v[220:223], v[32:35], a[220:223], v[220:223]
  s_waitcnt lgkmcnt(4)
  s_add_u32 m0, s45, 21120
  s_add_u32 s50, s35, 1118208
  v_mfma_f32_16x16x32_bf16 v[224:227], v[36:39], a[208:211], v[224:227]
  ds_read_b64_tr_b16 v[32:33], v2 offset:4128
  v_add_f32 v140, v140, v24
  v_mfma_f32_16x16x32_bf16 v[228:231], v[36:39], a[212:215], v[228:231]
  ds_read_b64_tr_b16 v[34:35], v2 offset:4640
  v_add_f32 v141, v141, v25
  v_mfma_f32_16x16x32_bf16 v[232:235], v[36:39], a[216:219], v[232:235]
  buffer_load_dwordx4 v13, s[12:15], s98 offen offset:1408 lds
  v_mfma_f32_16x16x32_bf16 v[236:239], v[36:39], a[220:223], v[236:239]
  s_waitcnt lgkmcnt(4)
  ds_read_b128 a[28:31], v8 offset:14336
  v_mfma_f32_16x16x32_bf16 v[176:179], v[40:43], a[224:227], v[176:179]
  ds_read_b64_tr_b16 v[36:37], v2 offset:4136
  v_add_f32 v142, v142, v26
  v_mfma_f32_16x16x32_bf16 v[180:183], v[40:43], a[228:231], v[180:183]
  ds_read_b64_tr_b16 v[38:39], v2 offset:4648
  v_add_f32 v143, v143, v27
  v_mfma_f32_16x16x32_bf16 v[184:187], v[40:43], a[232:235], v[184:187]
  buffer_load_dwordx4 v13, s[12:15], s99 offen offset:2432 lds
  v_mfma_f32_16x16x32_bf16 v[188:191], v[40:43], a[236:239], v[188:191]
  s_waitcnt lgkmcnt(5)
  s_add_u32 m0, s36, 49504
  v_add_f32 v144, v144, v20
  v_mfma_f32_16x16x32_bf16 v[192:195], v[44:47], a[224:227], v[192:195]
  ds_read_b64_tr_b16 v[40:41], v1 offset:8256
  v_add_f32 v145, v145, v21
  v_mfma_f32_16x16x32_bf16 v[196:199], v[44:47], a[228:231], v[196:199]
  ds_read_b64_tr_b16 v[42:43], v1 offset:8768
  v_add_f32 v146, v146, v22
  v_mfma_f32_16x16x32_bf16 v[200:203], v[44:47], a[232:235], v[200:203]
  buffer_load_dwordx4 v4, s[8:11], s50 offen lds
  v_mfma_f32_16x16x32_bf16 v[204:207], v[44:47], a[236:239], v[204:207]
  s_waitcnt lgkmcnt(5)
  ds_read_b128 a[32:35], v9 offset:8192
  v_mfma_f32_16x16x32_bf16 v[208:211], v[32:35], a[224:227], v[208:211]
  ds_read_b64_tr_b16 v[44:45], v1 offset:8264
  v_add_f32 v147, v147, v23
  v_mfma_f32_16x16x32_bf16 v[212:215], v[32:35], a[228:231], v[212:215]
  ds_read_b64_tr_b16 v[46:47], v1 offset:8776
  v_add_f32 v148, v148, v20
  v_mfma_f32_16x16x32_bf16 v[216:219], v[32:35], a[232:235], v[216:219]
  s_waitcnt lgkmcnt(5)
  ds_read_b128 a[36:39], v9 offset:10240
  v_mfma_f32_16x16x32_bf16 v[220:223], v[32:35], a[236:239], v[220:223]
  ds_read_b128 a[40:43], v9 offset:12288
  v_add_f32 v149, v149, v21
  v_mfma_f32_16x16x32_bf16 v[224:227], v[36:39], a[224:227], v[224:227]
  ds_read_b64_tr_b16 v[32:33], v2 offset:8256
  v_add_f32 v150, v150, v22
  v_mfma_f32_16x16x32_bf16 v[228:231], v[36:39], a[228:231], v[228:231]
  ds_read_b64_tr_b16 v[34:35], v2 offset:8768
  v_add_f32 v151, v151, v23
  v_mfma_f32_16x16x32_bf16 v[232:235], v[36:39], a[232:235], v[232:235]
  s_waitcnt lgkmcnt(7)
  ds_read_b128 a[44:47], v9 offset:14336
  v_mfma_f32_16x16x32_bf16 v[236:239], v[36:39], a[236:239], v[236:239]
  s_waitcnt vmcnt(9)
  ds_read_b128 a[48:51], v8 offset:16384
  v_mfma_f32_16x16x32_bf16 v[176:179], v[40:43], a[240:243], v[176:179]
  ds_read_b64_tr_b16 v[36:37], v2 offset:8264
  s_add_u32 m0, s45, -1536
  v_mfma_f32_16x16x32_bf16 v[180:183], v[40:43], a[244:247], v[180:183]
  ds_read_b64_tr_b16 v[38:39], v2 offset:8776
  v_add_f32 v152, v152, v20
  v_mfma_f32_16x16x32_bf16 v[184:187], v[40:43], a[248:251], v[184:187]
  buffer_load_dwordx4 v13, s[12:15], s92 offen offset:1536 lds
  v_mfma_f32_16x16x32_bf16 v[188:191], v[40:43], a[252:255], v[188:191]
  s_waitcnt lgkmcnt(8)
  ds_read_b128 v[24:27], v15 offset:448
  v_mfma_f32_16x16x32_bf16 v[192:195], v[44:47], a[240:243], v[192:195]
  ds_read_b64_tr_b16 v[40:41], v3 offset:12384
  s_waitcnt vmcnt(8)
  v_mfma_f32_16x16x32_bf16 v[196:199], v[44:47], a[244:247], v[196:199]
  ds_read_b64_tr_b16 v[42:43], v3 offset:12640
  v_add_f32 v153, v153, v21
  v_mfma_f32_16x16x32_bf16 v[200:203], v[44:47], a[248:251], v[200:203]
  buffer_load_dwordx4 v13, s[12:15], s93 offen offset:2560 lds
  v_mfma_f32_16x16x32_bf16 v[204:207], v[44:47], a[252:255], v[204:207]
  s_waitcnt lgkmcnt(7)
  ds_read_b128 a[52:55], v8 offset:18432
  v_mfma_f32_16x16x32_bf16 v[208:211], v[32:35], a[240:243], v[208:211]
  ds_read_b64_tr_b16 v[44:45], v3 offset:13408
  v_add_f32 v154, v154, v22
  v_mfma_f32_16x16x32_bf16 v[212:215], v[32:35], a[244:247], v[212:215]
  ds_read_b64_tr_b16 v[46:47], v3 offset:13664
  s_waitcnt lgkmcnt(6)
  v_mfma_f32_16x16x32_bf16 v[216:219], v[32:35], a[248:251], v[216:219]
  s_barrier
  s_add_u32 s51, s35, 1171456
  s_add_u32 m0, s36, 0
  v_mfma_f32_16x16x32_bf16 v[220:223], v[32:35], a[252:255], v[220:223]
  buffer_load_dwordx4 v4, s[8:11], s51 offen lds
  v_mfma_f32_16x16x32_bf16 v[224:227], v[36:39], a[240:243], v[224:227]
  ds_read_b64_tr_b16 v[32:33], v3 offset:14432
  s_add_u32 m0, s45, 512
  v_mfma_f32_16x16x32_bf16 v[228:231], v[36:39], a[244:247], v[228:231]
  ds_read_b64_tr_b16 v[34:35], v3 offset:14688
  s_add_u32 s50, s35, 1224704
  v_mfma_f32_16x16x32_bf16 v[232:235], v[36:39], a[248:251], v[232:235]
  buffer_load_dwordx4 v13, s[12:15], s94 offen offset:1536 lds
  v_mfma_f32_16x16x32_bf16 v[236:239], v[36:39], a[252:255], v[236:239]
  s_waitcnt lgkmcnt(5)
  v_add_f32 v155, v155, v23
  v_add_f32 v156, v156, v20
  v_mfma_f32_16x16x32_bf16 v[240:243], v[40:43], a[208:211], v[240:243]
  ds_read_b64_tr_b16 v[36:37], v1 offset:16480
  v_add_f32 v157, v157, v21
  v_mfma_f32_16x16x32_bf16 v[244:247], v[40:43], a[212:215], v[244:247]
  ds_read_b64_tr_b16 v[38:39], v1 offset:16992
  v_add_f32 v158, v158, v22
  v_mfma_f32_16x16x32_bf16 v[248:251], v[40:43], a[216:219], v[248:251]
  buffer_load_dwordx4 v13, s[12:15], s95 offen offset:2560 lds
  v_mfma_f32_16x16x32_bf16 v[252:255], v[40:43], a[220:223], v[252:255]
  s_waitcnt lgkmcnt(4)
  s_add_u32 m0, s36, 4128
  v_add_f32 v159, v159, v23
  v_mfma_f32_16x16x32_bf16 v[240:243], v[44:47], a[224:227], v[240:243]
  ds_read_b64_tr_b16 v[40:41], v1 offset:16488
  s_waitcnt vmcnt(9)
  v_mfma_f32_16x16x32_bf16 v[244:247], v[44:47], a[228:231], v[244:247]
  ds_read_b64_tr_b16 v[42:43], v1 offset:17000
  v_add_f32 v160, v160, v24
  v_mfma_f32_16x16x32_bf16 v[248:251], v[44:47], a[232:235], v[248:251]
  buffer_load_dwordx4 v4, s[8:11], s50 offen lds
  v_mfma_f32_16x16x32_bf16 v[252:255], v[44:47], a[236:239], v[252:255]
  s_waitcnt lgkmcnt(4)
  s_add_u32 s51, s35, 1277952
  s_add_u32 m0, s36, 8256
  v_mfma_f32_16x16x32_bf16 v[240:243], v[32:35], a[240:243], v[240:243]
  ds_read_b64_tr_b16 v[44:45], v2 offset:16480
  v_add_f32 v161, v161, v25
  v_mfma_f32_16x16x32_bf16 v[244:247], v[32:35], a[244:247], v[244:247]
  ds_read_b64_tr_b16 v[46:47], v2 offset:16992
  v_add_f32 v162, v162, v26
  v_mfma_f32_16x16x32_bf16 v[248:251], v[32:35], a[248:251], v[248:251]
  buffer_load_dwordx4 v4, s[8:11], s51 offen lds
  v_mfma_f32_16x16x32_bf16 v[252:255], v[32:35], a[252:255], v[252:255]
  s_waitcnt lgkmcnt(4)
  s_add_u32 m0, s45, 2560
  v_add_f32 v163, v163, v27
  v_mfma_f32_16x16x32_bf16 v[48:51], v[36:39], a[112:115], v[48:51]
  ds_read_b64_tr_b16 v[32:33], v2 offset:16488
  v_add_f32 v164, v164, v24
  v_mfma_f32_16x16x32_bf16 v[52:55], v[36:39], a[116:119], v[52:55]
  ds_read_b64_tr_b16 v[34:35], v2 offset:17000
  v_add_f32 v165, v165, v25
  v_mfma_f32_16x16x32_bf16 v[56:59], v[36:39], a[120:123], v[56:59]
  buffer_load_dwordx4 v13, s[12:15], s96 offen offset:1536 lds
  v_mfma_f32_16x16x32_bf16 v[60:63], v[36:39], a[124:127], v[60:63]
  s_waitcnt lgkmcnt(4)
  ds_read_b128 a[56:59], v8 offset:20480
  v_mfma_f32_16x16x32_bf16 v[64:67], v[40:43], a[112:115], v[64:67]
  ds_read_b64_tr_b16 v[36:37], v1 offset:20608
  s_waitcnt vmcnt(9)
  v_mfma_f32_16x16x32_bf16 v[68:71], v[40:43], a[116:119], v[68:71]
  ds_read_b64_tr_b16 v[38:39], v1 offset:21120
  v_add_f32 v166, v166, v26
  v_mfma_f32_16x16x32_bf16 v[72:75], v[40:43], a[120:123], v[72:75]
  buffer_load_dwordx4 v13, s[12:15], s97 offen offset:2560 lds
  v_mfma_f32_16x16x32_bf16 v[76:79], v[40:43], a[124:127], v[76:79]
  s_waitcnt lgkmcnt(5)
  ds_read_b128 a[60:63], v8 offset:22528
  v_mfma_f32_16x16x32_bf16 v[80:83], v[44:47], a[112:115], v[80:83]
  ds_read_b64_tr_b16 v[40:41], v1 offset:20616
  s_add_u32 m0, s45, 4608
  v_mfma_f32_16x16x32_bf16 v[84:87], v[44:47], a[116:119], v[84:87]
  ds_read_b64_tr_b16 v[42:43], v1 offset:21128
  v_add_f32 v167, v167, v27
  v_mfma_f32_16x16x32_bf16 v[88:91], v[44:47], a[120:123], v[88:91]
  buffer_load_dwordx4 v13, s[12:15], s98 offen offset:1536 lds
  v_mfma_f32_16x16x32_bf16 v[92:95], v[44:47], a[124:127], v[92:95]
  s_waitcnt lgkmcnt(6)
  ds_read_b128 a[64:67], v9 offset:16384
  v_mfma_f32_16x16x32_bf16 v[96:99], v[32:35], a[112:115], v[96:99]
  ds_read_b64_tr_b16 v[44:45], v2 offset:20608
  v_add_f32 v168, v168, v24
  v_mfma_f32_16x16x32_bf16 v[100:103], v[32:35], a[116:119], v[100:103]
  ds_read_b64_tr_b16 v[46:47], v2 offset:21120
  v_add_f32 v169, v169, v25
  v_mfma_f32_16x16x32_bf16 v[104:107], v[32:35], a[120:123], v[104:107]
  s_waitcnt lgkmcnt(6)
  ds_read_b128 a[68:71], v9 offset:18432
  v_mfma_f32_16x16x32_bf16 v[108:111], v[32:35], a[124:127], v[108:111]
  ds_read_b128 a[72:75], v9 offset:20480
  v_add_f32 v170, v170, v26
  v_mfma_f32_16x16x32_bf16 v[48:51], v[36:39], a[128:131], v[48:51]
  ds_read_b64_tr_b16 v[32:33], v2 offset:20616
  v_add_f32 v171, v171, v27
  v_mfma_f32_16x16x32_bf16 v[52:55], v[36:39], a[132:135], v[52:55]
  ds_read_b64_tr_b16 v[34:35], v2 offset:21128
  v_add_f32 v172, v172, v24
  v_mfma_f32_16x16x32_bf16 v[56:59], v[36:39], a[136:139], v[56:59]
  buffer_load_dwordx4 v13, s[12:15], s99 offen offset:2560 lds
  v_mfma_f32_16x16x32_bf16 v[60:63], v[36:39], a[140:143], v[60:63]
  s_waitcnt lgkmcnt(7)
  ds_read_b128 a[76:79], v9 offset:22528
  v_mfma_f32_16x16x32_bf16 v[64:67], v[40:43], a[128:131], v[64:67]
  ds_read_b64_tr_b16 v[36:37], v1 offset:24736
  v_add_f32 v173, v173, v25
  v_mfma_f32_16x16x32_bf16 v[68:71], v[40:43], a[132:135], v[68:71]
  ds_read_b64_tr_b16 v[38:39], v1 offset:25248
  v_add_f32 v174, v174, v26
  v_mfma_f32_16x16x32_bf16 v[72:75], v[40:43], a[136:139], v[72:75]
  s_waitcnt lgkmcnt(7)
  ds_read_b128 v[20:23], v15 offset:512
  v_mfma_f32_16x16x32_bf16 v[76:79], v[40:43], a[140:143], v[76:79]
  v_add_f32 v175, v175, v27
  v_mfma_f32_16x16x32_bf16 v[80:83], v[44:47], a[128:131], v[80:83]
  ds_read_b64_tr_b16 v[40:41], v1 offset:24744
  s_waitcnt vmcnt(9)
  v_mfma_f32_16x16x32_bf16 v[84:87], v[44:47], a[132:135], v[84:87]
  ds_read_b64_tr_b16 v[42:43], v1 offset:25256
  s_waitcnt lgkmcnt(2)
  v_mfma_f32_16x16x32_bf16 v[88:91], v[44:47], a[136:139], v[88:91]
  ds_read_b128 a[80:83], v8 offset:0
  v_add_f32 v176, v176, v20
  v_mfma_f32_16x16x32_bf16 v[92:95], v[44:47], a[140:143], v[92:95]
  ds_read_b128 v[24:27], v15 offset:576
  v_add_f32 v177, v177, v21
  v_mfma_f32_16x16x32_bf16 v[96:99], v[32:35], a[128:131], v[96:99]
  ds_read_b64_tr_b16 v[44:45], v2 offset:24736
  v_add_f32 v178, v178, v22
  v_mfma_f32_16x16x32_bf16 v[100:103], v[32:35], a[132:135], v[100:103]
  ds_read_b64_tr_b16 v[46:47], v2 offset:25248
  v_add_f32 v179, v179, v23
  v_mfma_f32_16x16x32_bf16 v[104:107], v[32:35], a[136:139], v[104:107]
  s_barrier
  s_add_u32 s50, s35, 1331200
  s_add_u32 m0, s36, 12384
  v_mfma_f32_16x16x32_bf16 v[108:111], v[32:35], a[140:143], v[108:111]
  buffer_load_dwordx4 v4, s[8:11], s50 offen lds
  v_mfma_f32_16x16x32_bf16 v[48:51], v[36:39], a[144:147], v[48:51]
  ds_read_b64_tr_b16 v[32:33], v2 offset:24744
  s_add_u32 s51, s35, 692352
  v_mfma_f32_16x16x32_bf16 v[52:55], v[36:39], a[148:151], v[52:55]
  ds_read_b64_tr_b16 v[34:35], v2 offset:25256
  s_add_u32 m0, s36, 16512
  v_mfma_f32_16x16x32_bf16 v[56:59], v[36:39], a[152:155], v[56:59]
  buffer_load_dwordx4 v4, s[8:11], s51 offen lds
  v_mfma_f32_16x16x32_bf16 v[60:63], v[36:39], a[156:159], v[60:63]
  s_waitcnt lgkmcnt(6)
  v_add_f32 v180, v180, v20
  v_add_f32 v181, v181, v21
  v_mfma_f32_16x16x32_bf16 v[64:67], v[40:43], a[144:147], v[64:67]
  ds_read_b64_tr_b16 v[36:37], v1 offset:28864
  s_waitcnt vmcnt(8)
  v_mfma_f32_16x16x32_bf16 v[68:71], v[40:43], a[148:151], v[68:71]
  ds_read_b64_tr_b16 v[38:39], v1 offset:29376
  v_add_f32 v182, v182, v22
  v_mfma_f32_16x16x32_bf16 v[72:75], v[40:43], a[152:155], v[72:75]
  s_waitcnt lgkmcnt(4)
  ds_read_b128 a[84:87], v8 offset:2048
  v_mfma_f32_16x16x32_bf16 v[76:79], v[40:43], a[156:159], v[76:79]
  v_add_f32 v183, v183, v23
  v_add_f32 v184, v184, v20
  v_mfma_f32_16x16x32_bf16 v[80:83], v[44:47], a[144:147], v[80:83]
  ds_read_b64_tr_b16 v[40:41], v1 offset:28872
  v_add_f32 v185, v185, v21
  v_mfma_f32_16x16x32_bf16 v[84:87], v[44:47], a[148:151], v[84:87]
  ds_read_b64_tr_b16 v[42:43], v1 offset:29384
  v_add_f32 v186, v186, v22
  v_mfma_f32_16x16x32_bf16 v[88:91], v[44:47], a[152:155], v[88:91]
  s_waitcnt lgkmcnt(5)
  v_add_f32 v187, v187, v23
  v_add_f32 v188, v188, v20
  v_mfma_f32_16x16x32_bf16 v[92:95], v[44:47], a[156:159], v[92:95]
  v_add_f32 v189, v189, v21
  v_add_f32 v190, v190, v22
  v_mfma_f32_16x16x32_bf16 v[96:99], v[32:35], a[144:147], v[96:99]
  ds_read_b64_tr_b16 v[44:45], v2 offset:28864
  v_add_f32 v191, v191, v23
  v_mfma_f32_16x16x32_bf16 v[100:103], v[32:35], a[148:151], v[100:103]
  ds_read_b64_tr_b16 v[46:47], v2 offset:29376
  v_add_f32 v192, v192, v24
  v_mfma_f32_16x16x32_bf16 v[104:107], v[32:35], a[152:155], v[104:107]
  s_waitcnt lgkmcnt(5)
  ds_read_b128 v[20:23], v15 offset:640
  v_mfma_f32_16x16x32_bf16 v[108:111], v[32:35], a[156:159], v[108:111]
  v_add_f32 v193, v193, v25
  v_add_f32 v194, v194, v26
  v_mfma_f32_16x16x32_bf16 v[48:51], v[36:39], a[160:163], v[48:51]
  ds_read_b64_tr_b16 v[32:33], v2 offset:28872
  v_add_f32 v195, v195, v27
  v_mfma_f32_16x16x32_bf16 v[52:55], v[36:39], a[164:167], v[52:55]
  ds_read_b64_tr_b16 v[34:35], v2 offset:29384
  v_add_f32 v196, v196, v24
  v_mfma_f32_16x16x32_bf16 v[56:59], v[36:39], a[168:171], v[56:59]
  s_waitcnt lgkmcnt(5)
  v_add_f32 v197, v197, v25
  v_add_f32 v198, v198, v26
  v_mfma_f32_16x16x32_bf16 v[60:63], v[36:39], a[172:175], v[60:63]
  v_add_f32 v199, v199, v27
  v_add_f32 v200, v200, v24
  v_mfma_f32_16x16x32_bf16 v[64:67], v[40:43], a[160:163], v[64:67]
  ds_read_b64_tr_b16 v[36:37], v1 offset:32992
  s_waitcnt vmcnt(4)
  v_mfma_f32_16x16x32_bf16 v[68:71], v[40:43], a[164:167], v[68:71]
  ds_read_b64_tr_b16 v[38:39], v1 offset:33504
  v_add_f32 v201, v201, v25
  v_mfma_f32_16x16x32_bf16 v[72:75], v[40:43], a[168:171], v[72:75]
  s_waitcnt lgkmcnt(5)
  ds_read_b128 a[88:91], v8 offset:4096
  v_mfma_f32_16x16x32_bf16 v[76:79], v[40:43], a[172:175], v[76:79]
  v_add_f32 v202, v202, v26
  v_add_f32 v203, v203, v27
  v_mfma_f32_16x16x32_bf16 v[80:83], v[44:47], a[160:163], v[80:83]
  ds_read_b64_tr_b16 v[40:41], v1 offset:33000
  v_add_f32 v204, v204, v24
  v_mfma_f32_16x16x32_bf16 v[84:87], v[44:47], a[164:167], v[84:87]
  ds_read_b64_tr_b16 v[42:43], v1 offset:33512
  v_add_f32 v205, v205, v25
  v_mfma_f32_16x16x32_bf16 v[88:91], v[44:47], a[168:171], v[88:91]
  s_waitcnt lgkmcnt(5)
  v_add_f32 v206, v206, v26
  v_add_f32 v207, v207, v27
  v_mfma_f32_16x16x32_bf16 v[92:95], v[44:47], a[172:175], v[92:95]
  ds_read_b128 v[24:27], v15 offset:704
  v_add_f32 v208, v208, v20
  v_mfma_f32_16x16x32_bf16 v[96:99], v[32:35], a[160:163], v[96:99]
  ds_read_b64_tr_b16 v[44:45], v2 offset:32992
  v_add_f32 v209, v209, v21
  v_mfma_f32_16x16x32_bf16 v[100:103], v[32:35], a[164:167], v[100:103]
  ds_read_b64_tr_b16 v[46:47], v2 offset:33504
  v_add_f32 v210, v210, v22
  v_mfma_f32_16x16x32_bf16 v[104:107], v[32:35], a[168:171], v[104:107]
  s_waitcnt lgkmcnt(6)
  v_add_f32 v211, v211, v23
  v_add_f32 v212, v212, v20
  v_mfma_f32_16x16x32_bf16 v[108:111], v[32:35], a[172:175], v[108:111]
  v_add_f32 v213, v213, v21
  v_add_f32 v214, v214, v22
  v_mfma_f32_16x16x32_bf16 v[48:51], v[36:39], a[176:179], v[48:51]
  ds_read_b64_tr_b16 v[32:33], v2 offset:33000
  s_waitcnt vmcnt(2)
  v_mfma_f32_16x16x32_bf16 v[52:55], v[36:39], a[180:183], v[52:55]
  ds_read_b64_tr_b16 v[34:35], v2 offset:33512
  v_add_u32 v13, s35, v13
  v_mfma_f32_16x16x32_bf16 v[56:59], v[36:39], a[184:187], v[56:59]
  s_add_u32 m0, s45, 8192
  ds_read_b128 a[92:95], v8 offset:6144
  v_mfma_f32_16x16x32_bf16 v[60:63], v[36:39], a[188:191], v[60:63]
  s_waitcnt lgkmcnt(6)
  ds_read_b128 a[96:99], v9 offset:0
  v_mfma_f32_16x16x32_bf16 v[64:67], v[40:43], a[176:179], v[64:67]
  ds_read_b64_tr_b16 v[36:37], v1 offset:37120
  v_add_f32 v215, v215, v23
  v_mfma_f32_16x16x32_bf16 v[68:71], v[40:43], a[180:183], v[68:71]
  ds_read_b64_tr_b16 v[38:39], v1 offset:37632
  v_add_f32 v216, v216, v20
  v_mfma_f32_16x16x32_bf16 v[72:75], v[40:43], a[184:187], v[72:75]
  buffer_load_dwordx4 v13, s[12:15], s92 offen offset:0 lds
  v_mfma_f32_16x16x32_bf16 v[76:79], v[40:43], a[188:191], v[76:79]
  s_waitcnt lgkmcnt(6)
  ds_read_b128 a[100:103], v9 offset:2048
  v_mfma_f32_16x16x32_bf16 v[80:83], v[44:47], a[176:179], v[80:83]
  ds_read_b64_tr_b16 v[40:41], v1 offset:37128
  v_add_f32 v217, v217, v21
  v_mfma_f32_16x16x32_bf16 v[84:87], v[44:47], a[180:183], v[84:87]
  ds_read_b64_tr_b16 v[42:43], v1 offset:37640
  v_add_f32 v218, v218, v22
  v_mfma_f32_16x16x32_bf16 v[88:91], v[44:47], a[184:187], v[88:91]
  buffer_load_dwordx4 v13, s[12:15], s93 offen offset:1024 lds
  v_mfma_f32_16x16x32_bf16 v[92:95], v[44:47], a[188:191], v[92:95]
  s_waitcnt lgkmcnt(7)
  ds_read_b128 a[104:107], v9 offset:4096
  v_mfma_f32_16x16x32_bf16 v[96:99], v[32:35], a[176:179], v[96:99]
  ds_read_b64_tr_b16 v[44:45], v2 offset:37120
  s_add_u32 m0, s45, 10240
  v_mfma_f32_16x16x32_bf16 v[100:103], v[32:35], a[180:183], v[100:103]
  ds_read_b64_tr_b16 v[46:47], v2 offset:37632
  s_waitcnt lgkmcnt(6)
  v_mfma_f32_16x16x32_bf16 v[104:107], v[32:35], a[184:187], v[104:107]
  s_barrier
  s_add_u32 s50, s35, 745600
  v_add_f32 v219, v219, v23
  v_mfma_f32_16x16x32_bf16 v[108:111], v[32:35], a[188:191], v[108:111]
  buffer_load_dwordx4 v13, s[12:15], s94 offen offset:0 lds
  v_mfma_f32_16x16x32_bf16 v[48:51], v[36:39], a[192:195], v[48:51]
  ds_read_b64_tr_b16 v[32:33], v2 offset:37128
  v_add_f32 v220, v220, v20
  v_mfma_f32_16x16x32_bf16 v[52:55], v[36:39], a[196:199], v[52:55]
  ds_read_b64_tr_b16 v[34:35], v2 offset:37640
  v_add_f32 v221, v221, v21
  v_mfma_f32_16x16x32_bf16 v[56:59], v[36:39], a[200:203], v[56:59]
  buffer_load_dwordx4 v13, s[12:15], s95 offen offset:1024 lds
  v_mfma_f32_16x16x32_bf16 v[60:63], v[36:39], a[204:207], v[60:63]
  s_waitcnt lgkmcnt(5)
  s_add_u32 m0, s36, 20640
  v_add_f32 v222, v222, v22
  v_mfma_f32_16x16x32_bf16 v[64:67], v[40:43], a[192:195], v[64:67]
  ds_read_b64_tr_b16 v[36:37], v1 offset:41248
  v_add_f32 v223, v223, v23
  v_mfma_f32_16x16x32_bf16 v[68:71], v[40:43], a[196:199], v[68:71]
  ds_read_b64_tr_b16 v[38:39], v1 offset:41760
  v_add_f32 v224, v224, v24
  v_mfma_f32_16x16x32_bf16 v[72:75], v[40:43], a[200:203], v[72:75]
  buffer_load_dwordx4 v4, s[8:11], s50 offen lds
  v_mfma_f32_16x16x32_bf16 v[76:79], v[40:43], a[204:207], v[76:79]
  s_waitcnt lgkmcnt(4)
  s_add_u32 s51, s35, 798848
  s_add_u32 m0, s36, 24768
  v_mfma_f32_16x16x32_bf16 v[80:83], v[44:47], a[192:195], v[80:83]
  ds_read_b64_tr_b16 v[40:41], v1 offset:41256
  v_add_f32 v225, v225, v25
  v_mfma_f32_16x16x32_bf16 v[84:87], v[44:47], a[196:199], v[84:87]
  ds_read_b64_tr_b16 v[42:43], v1 offset:41768
  v_add_f32 v226, v226, v26
  v_mfma_f32_16x16x32_bf16 v[88:91], v[44:47], a[200:203], v[88:91]
  buffer_load_dwordx4 v4, s[8:11], s51 offen lds
  v_mfma_f32_16x16x32_bf16 v[92:95], v[44:47], a[204:207], v[92:95]
  s_waitcnt lgkmcnt(4)
  s_add_u32 m0, s45, 12288
  s_add_u32 s50, s35, 852096
  v_mfma_f32_16x16x32_bf16 v[96:99], v[32:35], a[192:195], v[96:99]
  ds_read_b64_tr_b16 v[44:45], v2 offset:41248
  v_add_f32 v227, v227, v27
  v_mfma_f32_16x16x32_bf16 v[100:103], v[32:35], a[196:199], v[100:103]
  ds_read_b64_tr_b16 v[46:47], v2 offset:41760
  v_add_f32 v228, v228, v24
  v_mfma_f32_16x16x32_bf16 v[104:107], v[32:35], a[200:203], v[104:107]
  buffer_load_dwordx4 v13, s[12:15], s96 offen offset:0 lds
  v_mfma_f32_16x16x32_bf16 v[108:111], v[32:35], a[204:207], v[108:111]
  s_waitcnt lgkmcnt(4)
  ds_read_b128 a[108:111], v9 offset:6144
  v_mfma_f32_16x16x32_bf16 v[48:51], v[36:39], a[0:3], v[48:51]
  ds_read_b64_tr_b16 v[32:33], v2 offset:41256
  v_add_f32 v229, v229, v25
  v_mfma_f32_16x16x32_bf16 v[52:55], v[36:39], a[4:7], v[52:55]
  ds_read_b64_tr_b16 v[34:35], v2 offset:41768
  v_add_f32 v230, v230, v26
  v_mfma_f32_16x16x32_bf16 v[56:59], v[36:39], a[8:11], v[56:59]
  buffer_load_dwordx4 v13, s[12:15], s97 offen offset:1024 lds
  v_mfma_f32_16x16x32_bf16 v[60:63], v[36:39], a[12:15], v[60:63]
  s_waitcnt lgkmcnt(5)
  s_add_u32 m0, s36, 28896
  v_add_f32 v231, v231, v27
  v_mfma_f32_16x16x32_bf16 v[64:67], v[40:43], a[0:3], v[64:67]
  ds_read_b64_tr_b16 v[36:37], v1 offset:45376
  v_add_f32 v232, v232, v24
  v_mfma_f32_16x16x32_bf16 v[68:71], v[40:43], a[4:7], v[68:71]
  ds_read_b64_tr_b16 v[38:39], v1 offset:45888
  v_add_f32 v233, v233, v25
  v_mfma_f32_16x16x32_bf16 v[72:75], v[40:43], a[8:11], v[72:75]
  buffer_load_dwordx4 v4, s[8:11], s50 offen lds
  v_mfma_f32_16x16x32_bf16 v[76:79], v[40:43], a[12:15], v[76:79]
  s_waitcnt lgkmcnt(5)
  s_add_u32 m0, s45, 14336
  v_add_f32 v234, v234, v26
  v_mfma_f32_16x16x32_bf16 v[80:83], v[44:47], a[0:3], v[80:83]
  ds_read_b64_tr_b16 v[40:41], v1 offset:45384
  v_add_f32 v235, v235, v27
  v_mfma_f32_16x16x32_bf16 v[84:87], v[44:47], a[4:7], v[84:87]
  ds_read_b64_tr_b16 v[42:43], v1 offset:45896
  v_add_f32 v236, v236, v24
  v_mfma_f32_16x16x32_bf16 v[88:91], v[44:47], a[8:11], v[88:91]
  buffer_load_dwordx4 v13, s[12:15], s98 offen offset:0 lds
  v_mfma_f32_16x16x32_bf16 v[92:95], v[44:47], a[12:15], v[92:95]
  s_waitcnt lgkmcnt(4)
  ds_read_b128 v[20:23], v15 offset:768
  v_mfma_f32_16x16x32_bf16 v[96:99], v[32:35], a[0:3], v[96:99]
  ds_read_b64_tr_b16 v[44:45], v2 offset:45376
  v_add_f32 v237, v237, v25
  v_mfma_f32_16x16x32_bf16 v[100:103], v[32:35], a[4:7], v[100:103]
  ds_read_b64_tr_b16 v[46:47], v2 offset:45888
  v_add_f32 v238, v238, v26
  v_mfma_f32_16x16x32_bf16 v[104:107], v[32:35], a[8:11], v[104:107]
  buffer_load_dwordx4 v13, s[12:15], s99 offen offset:1024 lds
  v_mfma_f32_16x16x32_bf16 v[108:111], v[32:35], a[12:15], v[108:111]
  s_waitcnt lgkmcnt(5)
  v_add_f32 v239, v239, v27
  s_waitcnt lgkmcnt(2)
  v_mfma_f32_16x16x32_bf16 v[48:51], v[36:39], a[16:19], v[48:51]
  ds_read_b64_tr_b16 v[32:33], v2 offset:45384
  v_add_f32 v240, v240, v20
  v_mfma_f32_16x16x32_bf16 v[52:55], v[36:39], a[20:23], v[52:55]
  ds_read_b64_tr_b16 v[34:35], v2 offset:45896
  v_add_f32 v241, v241, v21
  v_mfma_f32_16x16x32_bf16 v[56:59], v[36:39], a[24:27], v[56:59]
  v_add_f32 v242, v242, v22
  v_add_f32 v243, v243, v23
  v_mfma_f32_16x16x32_bf16 v[60:63], v[36:39], a[28:31], v[60:63]
  v_add_f32 v244, v244, v20
  v_add_f32 v245, v245, v21
  v_mfma_f32_16x16x32_bf16 v[64:67], v[40:43], a[16:19], v[64:67]
  ds_read_b64_tr_b16 v[36:37], v1 offset:49504
  v_add_f32 v246, v246, v22
  v_mfma_f32_16x16x32_bf16 v[68:71], v[40:43], a[20:23], v[68:71]
  ds_read_b64_tr_b16 v[38:39], v1 offset:50016
  v_add_f32 v247, v247, v23
  v_mfma_f32_16x16x32_bf16 v[72:75], v[40:43], a[24:27], v[72:75]
  s_waitcnt lgkmcnt(4)
  v_add_f32 v248, v248, v20
  v_add_f32 v249, v249, v21
  v_mfma_f32_16x16x32_bf16 v[76:79], v[40:43], a[28:31], v[76:79]
  v_add_f32 v250, v250, v22
  v_add_f32 v251, v251, v23
  v_mfma_f32_16x16x32_bf16 v[80:83], v[44:47], a[16:19], v[80:83]
  ds_read_b64_tr_b16 v[40:41], v1 offset:49512
  v_add_f32 v252, v252, v20
  v_mfma_f32_16x16x32_bf16 v[84:87], v[44:47], a[20:23], v[84:87]
  ds_read_b64_tr_b16 v[42:43], v1 offset:50024
  v_add_f32 v253, v253, v21
  v_mfma_f32_16x16x32_bf16 v[88:91], v[44:47], a[24:27], v[88:91]
  s_waitcnt lgkmcnt(4)
  v_add_f32 v254, v254, v22
  v_add_f32 v255, v255, v23
  v_mfma_f32_16x16x32_bf16 v[92:95], v[44:47], a[28:31], v[92:95]
  v_mfma_f32_16x16x32_bf16 v[96:99], v[32:35], a[16:19], v[96:99]
  ds_read_b64_tr_b16 v[44:45], v2 offset:49504
  v_mfma_f32_16x16x32_bf16 v[100:103], v[32:35], a[20:23], v[100:103]
  ds_read_b64_tr_b16 v[46:47], v2 offset:50016
  s_waitcnt lgkmcnt(4)
  v_mfma_f32_16x16x32_bf16 v[104:107], v[32:35], a[24:27], v[104:107]
  s_barrier
  s_add_u32 s51, s35, 905344
  s_add_u32 m0, s36, 33024
  v_mfma_f32_16x16x32_bf16 v[108:111], v[32:35], a[28:31], v[108:111]
  buffer_load_dwordx4 v4, s[8:11], s51 offen lds
  v_mfma_f32_16x16x32_bf16 v[48:51], v[36:39], a[32:35], v[48:51]
  ds_read_b64_tr_b16 v[32:33], v2 offset:49512
  s_add_u32 s50, s35, 958592
  v_mfma_f32_16x16x32_bf16 v[52:55], v[36:39], a[36:39], v[52:55]
  ds_read_b64_tr_b16 v[34:35], v2 offset:50024
  s_waitcnt lgkmcnt(4)
  v_mfma_f32_16x16x32_bf16 v[56:59], v[36:39], a[40:43], v[56:59]
  s_add_u32 m0, s36, 37152
  v_mfma_f32_16x16x32_bf16 v[60:63], v[36:39], a[44:47], v[60:63]
  buffer_load_dwordx4 v4, s[8:11], s50 offen lds
  v_mfma_f32_16x16x32_bf16 v[64:67], v[40:43], a[32:35], v[64:67]
  ds_read_b64_tr_b16 v[36:37], v1 offset:0
  s_add_u32 s51, s35, 1011840
  v_mfma_f32_16x16x32_bf16 v[68:71], v[40:43], a[36:39], v[68:71]
  ds_read_b64_tr_b16 v[38:39], v1 offset:512
  s_waitcnt lgkmcnt(4)
  v_mfma_f32_16x16x32_bf16 v[72:75], v[40:43], a[40:43], v[72:75]
  s_add_u32 m0, s36, 41280
  v_mfma_f32_16x16x32_bf16 v[76:79], v[40:43], a[44:47], v[76:79]
  buffer_load_dwordx4 v4, s[8:11], s51 offen lds
  v_mfma_f32_16x16x32_bf16 v[80:83], v[44:47], a[32:35], v[80:83]
  ds_read_b64_tr_b16 v[40:41], v1 offset:8
  v_mfma_f32_16x16x32_bf16 v[84:87], v[44:47], a[36:39], v[84:87]
  ds_read_b64_tr_b16 v[42:43], v1 offset:520
  s_waitcnt lgkmcnt(4)
  v_mfma_f32_16x16x32_bf16 v[88:91], v[44:47], a[40:43], v[88:91]
  v_mfma_f32_16x16x32_bf16 v[92:95], v[44:47], a[44:47], v[92:95]
  v_mfma_f32_16x16x32_bf16 v[96:99], v[32:35], a[32:35], v[96:99]
  ds_read_b64_tr_b16 v[44:45], v2 offset:0
  v_mfma_f32_16x16x32_bf16 v[100:103], v[32:35], a[36:39], v[100:103]
  ds_read_b64_tr_b16 v[46:47], v2 offset:512
  s_waitcnt lgkmcnt(4)
  v_mfma_f32_16x16x32_bf16 v[104:107], v[32:35], a[40:43], v[104:107]
  v_mfma_f32_16x16x32_bf16 v[108:111], v[32:35], a[44:47], v[108:111]
  v_mfma_f32_16x16x32_bf16 v[48:51], v[36:39], a[48:51], v[48:51]
  ds_read_b64_tr_b16 v[32:33], v2 offset:8
  v_mfma_f32_16x16x32_bf16 v[52:55], v[36:39], a[52:55], v[52:55]
  ds_read_b64_tr_b16 v[34:35], v2 offset:520
  s_waitcnt lgkmcnt(4)
  v_mfma_f32_16x16x32_bf16 v[56:59], v[36:39], a[56:59], v[56:59]
  v_mfma_f32_16x16x32_bf16 v[60:63], v[36:39], a[60:63], v[60:63]
  v_mfma_f32_16x16x32_bf16 v[64:67], v[40:43], a[48:51], v[64:67]
  ds_read_b64_tr_b16 v[36:37], v1 offset:4128
  v_mfma_f32_16x16x32_bf16 v[68:71], v[40:43], a[52:55], v[68:71]
  ds_read_b64_tr_b16 v[38:39], v1 offset:4640
  s_waitcnt lgkmcnt(4)
  v_mfma_f32_16x16x32_bf16 v[72:75], v[40:43], a[56:59], v[72:75]
  v_mfma_f32_16x16x32_bf16 v[76:79], v[40:43], a[60:63], v[76:79]
  v_mfma_f32_16x16x32_bf16 v[80:83], v[44:47], a[48:51], v[80:83]
  ds_read_b64_tr_b16 v[40:41], v1 offset:4136
  v_mfma_f32_16x16x32_bf16 v[84:87], v[44:47], a[52:55], v[84:87]
  ds_read_b64_tr_b16 v[42:43], v1 offset:4648
  s_waitcnt lgkmcnt(4)
  v_mfma_f32_16x16x32_bf16 v[88:91], v[44:47], a[56:59], v[88:91]
  v_mfma_f32_16x16x32_bf16 v[92:95], v[44:47], a[60:63], v[92:95]
  v_mfma_f32_16x16x32_bf16 v[96:99], v[32:35], a[48:51], v[96:99]
  ds_read_b64_tr_b16 v[44:45], v2 offset:4128
  v_mfma_f32_16x16x32_bf16 v[100:103], v[32:35], a[52:55], v[100:103]
  ds_read_b64_tr_b16 v[46:47], v2 offset:4640
  s_waitcnt lgkmcnt(4)
  v_mfma_f32_16x16x32_bf16 v[104:107], v[32:35], a[56:59], v[104:107]
  v_mfma_f32_16x16x32_bf16 v[108:111], v[32:35], a[60:63], v[108:111]
  v_mfma_f32_16x16x32_bf16 v[48:51], v[36:39], a[64:67], v[48:51]
  ds_read_b64_tr_b16 v[32:33], v2 offset:4136
  v_mfma_f32_16x16x32_bf16 v[52:55], v[36:39], a[68:71], v[52:55]
  ds_read_b64_tr_b16 v[34:35], v2 offset:4648
  s_waitcnt lgkmcnt(4)
  v_mfma_f32_16x16x32_bf16 v[56:59], v[36:39], a[72:75], v[56:59]
  v_mfma_f32_16x16x32_bf16 v[60:63], v[36:39], a[76:79], v[60:63]
  v_mfma_f32_16x16x32_bf16 v[64:67], v[40:43], a[64:67], v[64:67]
  ds_read_b64_tr_b16 v[36:37], v1 offset:8256
  v_mfma_f32_16x16x32_bf16 v[68:71], v[40:43], a[68:71], v[68:71]
  ds_read_b64_tr_b16 v[38:39], v1 offset:8768
  s_waitcnt lgkmcnt(4)
  v_mfma_f32_16x16x32_bf16 v[72:75], v[40:43], a[72:75], v[72:75]
  v_mfma_f32_16x16x32_bf16 v[76:79], v[40:43], a[76:79], v[76:79]
  v_mfma_f32_16x16x32_bf16 v[80:83], v[44:47], a[64:67], v[80:83]
  ds_read_b64_tr_b16 v[40:41], v1 offset:8264
  v_mfma_f32_16x16x32_bf16 v[84:87], v[44:47], a[68:71], v[84:87]
  ds_read_b64_tr_b16 v[42:43], v1 offset:8776
  s_waitcnt lgkmcnt(4)
  v_mfma_f32_16x16x32_bf16 v[88:91], v[44:47], a[72:75], v[88:91]
  v_mfma_f32_16x16x32_bf16 v[92:95], v[44:47], a[76:79], v[92:95]
  v_mfma_f32_16x16x32_bf16 v[96:99], v[32:35], a[64:67], v[96:99]
  ds_read_b64_tr_b16 v[44:45], v2 offset:8256
  v_mfma_f32_16x16x32_bf16 v[100:103], v[32:35], a[68:71], v[100:103]
  ds_read_b64_tr_b16 v[46:47], v2 offset:8768
  s_waitcnt vmcnt(9) lgkmcnt(4)
  v_mfma_f32_16x16x32_bf16 v[104:107], v[32:35], a[72:75], v[104:107]
  s_barrier
  s_add_u32 s50, s35, 1065088
  s_add_u32 m0, s36, 45408
  v_mfma_f32_16x16x32_bf16 v[108:111], v[32:35], a[76:79], v[108:111]
  buffer_load_dwordx4 v4, s[8:11], s50 offen lds
  v_mfma_f32_16x16x32_bf16 v[48:51], v[36:39], a[80:83], v[48:51]
  ds_read_b64_tr_b16 v[32:33], v2 offset:8264
  s_add_u32 s51, s35, 1118336
  v_mfma_f32_16x16x32_bf16 v[52:55], v[36:39], a[84:87], v[52:55]
  ds_read_b64_tr_b16 v[34:35], v2 offset:8776
  s_waitcnt lgkmcnt(4)
  v_mfma_f32_16x16x32_bf16 v[56:59], v[36:39], a[88:91], v[56:59]
  s_add_u32 m0, s36, 49536
  v_mfma_f32_16x16x32_bf16 v[60:63], v[36:39], a[92:95], v[60:63]
  buffer_load_dwordx4 v4, s[8:11], s51 offen lds
  v_mfma_f32_16x16x32_bf16 v[64:67], v[40:43], a[80:83], v[64:67]
  ds_read_b64_tr_b16 v[36:37], v1 offset:12384
  s_add_u32 s50, s35, 1171584
  v_mfma_f32_16x16x32_bf16 v[68:71], v[40:43], a[84:87], v[68:71]
  ds_read_b64_tr_b16 v[38:39], v1 offset:12896
  s_waitcnt lgkmcnt(4)
  v_mfma_f32_16x16x32_bf16 v[72:75], v[40:43], a[88:91], v[72:75]
  s_add_u32 m0, s36, 0
  s_add_u32 s53, s41, s38
  s_add_u32 s53, s53, 0
  v_mfma_f32_16x16x32_bf16 v[76:79], v[40:43], a[92:95], v[76:79]
  buffer_load_dwordx4 v4, s[8:11], s50 offen lds
  v_mfma_f32_16x16x32_bf16 v[80:83], v[44:47], a[80:83], v[80:83]
  ds_read_b64_tr_b16 v[40:41], v1 offset:12392
  s_add_u32 m0, s45, 24576
  v_mfma_f32_16x16x32_bf16 v[84:87], v[44:47], a[84:87], v[84:87]
  ds_read_b64_tr_b16 v[42:43], v1 offset:12904
  s_waitcnt lgkmcnt(4)
  v_mfma_f32_16x16x32_bf16 v[88:91], v[44:47], a[88:91], v[88:91]
  buffer_load_dwordx4 v14, s[12:15], s53 offen lds
  v_mfma_f32_16x16x32_bf16 v[92:95], v[44:47], a[92:95], v[92:95]
  s_add_u32 s51, s35, 1224832
  s_add_u32 m0, s36, 4128
  s_add_u32 s52, s41, s38
  v_mfma_f32_16x16x32_bf16 v[96:99], v[32:35], a[80:83], v[96:99]
  ds_read_b64_tr_b16 v[44:45], v2 offset:12384
  s_add_u32 s52, s52, 53248
  v_mfma_f32_16x16x32_bf16 v[100:103], v[32:35], a[84:87], v[100:103]
  ds_read_b64_tr_b16 v[46:47], v2 offset:12896
  s_waitcnt lgkmcnt(4)
  v_mfma_f32_16x16x32_bf16 v[104:107], v[32:35], a[88:91], v[104:107]
  buffer_load_dwordx4 v4, s[8:11], s51 offen lds
  v_mfma_f32_16x16x32_bf16 v[108:111], v[32:35], a[92:95], v[108:111]
  v_mfma_f32_16x16x32_bf16 v[48:51], v[36:39], a[96:99], v[48:51]
  ds_read_b64_tr_b16 v[32:33], v2 offset:12392
  v_mfma_f32_16x16x32_bf16 v[52:55], v[36:39], a[100:103], v[52:55]
  ds_read_b64_tr_b16 v[34:35], v2 offset:12904
  s_waitcnt lgkmcnt(4)
  v_mfma_f32_16x16x32_bf16 v[56:59], v[36:39], a[104:107], v[56:59]
  v_mfma_f32_16x16x32_bf16 v[60:63], v[36:39], a[108:111], v[60:63]
  v_mfma_f32_16x16x32_bf16 v[64:67], v[40:43], a[96:99], v[64:67]
  ds_read_b64_tr_b16 v[36:37], v1 offset:16512
  v_mfma_f32_16x16x32_bf16 v[68:71], v[40:43], a[100:103], v[68:71]
  ds_read_b64_tr_b16 v[38:39], v1 offset:17024
  s_waitcnt lgkmcnt(4)
  v_mfma_f32_16x16x32_bf16 v[72:75], v[40:43], a[104:107], v[72:75]
  v_mfma_f32_16x16x32_bf16 v[76:79], v[40:43], a[108:111], v[76:79]
  v_mfma_f32_16x16x32_bf16 v[80:83], v[44:47], a[96:99], v[80:83]
  ds_read_b64_tr_b16 v[40:41], v1 offset:16520
  v_mfma_f32_16x16x32_bf16 v[84:87], v[44:47], a[100:103], v[84:87]
  ds_read_b64_tr_b16 v[42:43], v1 offset:17032
  s_waitcnt lgkmcnt(4)
  v_mfma_f32_16x16x32_bf16 v[88:91], v[44:47], a[104:107], v[88:91]
  s_add_u32 m0, s45, 25600
  v_mfma_f32_16x16x32_bf16 v[92:95], v[44:47], a[108:111], v[92:95]
  buffer_load_dwordx4 v14, s[12:15], s52 offen lds
  v_mfma_f32_16x16x32_bf16 v[96:99], v[32:35], a[96:99], v[96:99]
  ds_read_b64_tr_b16 v[44:45], v2 offset:16512
  v_mfma_f32_16x16x32_bf16 v[100:103], v[32:35], a[100:103], v[100:103]
  ds_read_b64_tr_b16 v[46:47], v2 offset:17024
  s_waitcnt lgkmcnt(4)
  v_mfma_f32_16x16x32_bf16 v[104:107], v[32:35], a[104:107], v[104:107]
  ds_read_b128 v[20:23], v8 offset:8192
  v_mfma_f32_16x16x32_bf16 v[108:111], v[32:35], a[108:111], v[108:111]
  ds_read_b128 v[24:27], v8 offset:10240
  s_add_u32 s77, s42, 0
  v_mfma_f32_16x16x32_bf16 v[112:115], v[36:39], a[112:115], v[112:115]
  ds_read_b64_tr_b16 v[32:33], v2 offset:16520
  v_mfma_f32_16x16x32_bf16 v[116:119], v[36:39], a[116:119], v[116:119]
  ds_read_b64_tr_b16 v[34:35], v2 offset:17032
  s_waitcnt lgkmcnt(6)
  v_mfma_f32_16x16x32_bf16 v[120:123], v[36:39], a[120:123], v[120:123]
  v_mfma_f32_16x16x32_bf16 v[124:127], v[36:39], a[124:127], v[124:127]
  v_mfma_f32_16x16x32_bf16 v[128:131], v[40:43], a[112:115], v[128:131]
  ds_read_b64_tr_b16 v[36:37], v1 offset:20640
  s_waitcnt lgkmcnt(4)
  v_mfma_f32_16x16x32_bf16 v[132:135], v[40:43], a[116:119], v[132:135]
  ds_read_b64_tr_b16 v[38:39], v1 offset:21152
  v_lshlrev_b32 v28, 16, v20
  v_mfma_f32_16x16x32_bf16 v[136:139], v[40:43], a[120:123], v[136:139]
  v_and_b32 v20, s44, v20
  v_mul_f32 v28, v28, v48
  v_mfma_f32_16x16x32_bf16 v[140:143], v[40:43], a[124:127], v[140:143]
  v_mul_f32 v20, v20, v49
  v_cvt_pk_bf16_f32 v20, v28, v20
  v_mfma_f32_16x16x32_bf16 v[144:147], v[44:47], a[112:115], v[144:147]
  ds_read_b64_tr_b16 v[40:41], v1 offset:20648
  v_lshlrev_b32 v29, 16, v21
  v_mfma_f32_16x16x32_bf16 v[148:151], v[44:47], a[116:119], v[148:151]
  ds_read_b64_tr_b16 v[42:43], v1 offset:21160
  v_and_b32 v21, s44, v21
  v_mfma_f32_16x16x32_bf16 v[152:155], v[44:47], a[120:123], v[152:155]
  v_mul_f32 v29, v29, v50
  v_mul_f32 v21, v21, v51
  v_mfma_f32_16x16x32_bf16 v[156:159], v[44:47], a[124:127], v[156:159]
  s_waitcnt lgkmcnt(4)
  v_cvt_pk_bf16_f32 v21, v29, v21
  v_lshlrev_b32 v28, 16, v22
  v_mfma_f32_16x16x32_bf16 v[160:163], v[32:35], a[112:115], v[160:163]
  ds_read_b64_tr_b16 v[44:45], v2 offset:20640
  v_and_b32 v22, s44, v22
  v_mfma_f32_16x16x32_bf16 v[164:167], v[32:35], a[116:119], v[164:167]
  ds_read_b64_tr_b16 v[46:47], v2 offset:21152
  s_waitcnt vmcnt(8) lgkmcnt(4)
  v_mfma_f32_16x16x32_bf16 v[168:171], v[32:35], a[120:123], v[168:171]
  s_barrier
  s_add_u32 s50, s35, 1278080
  s_add_u32 m0, s36, 8256
  v_mfma_f32_16x16x32_bf16 v[172:175], v[32:35], a[124:127], v[172:175]
  buffer_load_dwordx4 v4, s[8:11], s50 offen lds
  v_mfma_f32_16x16x32_bf16 v[112:115], v[36:39], a[128:131], v[112:115]
  ds_read_b64_tr_b16 v[32:33], v2 offset:20648
  s_add_u32 s51, s35, 1331328
  v_mfma_f32_16x16x32_bf16 v[116:119], v[36:39], a[132:135], v[116:119]
  ds_read_b64_tr_b16 v[34:35], v2 offset:21160
  s_add_u32 m0, s36, 12384
  v_mfma_f32_16x16x32_bf16 v[120:123], v[36:39], a[136:139], v[120:123]
  buffer_load_dwordx4 v4, s[8:11], s51 offen lds
  v_mfma_f32_16x16x32_bf16 v[124:127], v[36:39], a[140:143], v[124:127]
  s_waitcnt lgkmcnt(4)
  s_add_u32 s50, s35, 692480
  s_add_u32 m0, s36, 16512
  v_mfma_f32_16x16x32_bf16 v[128:131], v[40:43], a[128:131], v[128:131]
  ds_read_b64_tr_b16 v[36:37], v1 offset:24768
  v_mul_f32 v28, v28, v64
  v_mfma_f32_16x16x32_bf16 v[132:135], v[40:43], a[132:135], v[132:135]
  ds_read_b64_tr_b16 v[38:39], v1 offset:25280
  v_mul_f32 v22, v22, v65
  v_mfma_f32_16x16x32_bf16 v[136:139], v[40:43], a[136:139], v[136:139]
  buffer_load_dwordx4 v4, s[8:11], s50 offen lds
  v_mfma_f32_16x16x32_bf16 v[140:143], v[40:43], a[140:143], v[140:143]
  s_waitcnt lgkmcnt(4)
  v_cvt_pk_bf16_f32 v22, v28, v22
  v_lshlrev_b32 v29, 16, v23
  v_mfma_f32_16x16x32_bf16 v[144:147], v[44:47], a[128:131], v[144:147]
  ds_read_b64_tr_b16 v[40:41], v1 offset:24776
  v_and_b32 v23, s44, v23
  v_mfma_f32_16x16x32_bf16 v[148:151], v[44:47], a[132:135], v[148:151]
  ds_read_b64_tr_b16 v[42:43], v1 offset:25288
  v_mul_f32 v29, v29, v66
  v_mfma_f32_16x16x32_bf16 v[152:155], v[44:47], a[136:139], v[152:155]
  v_mul_f32 v23, v23, v67
  v_cvt_pk_bf16_f32 v23, v29, v23
  v_mfma_f32_16x16x32_bf16 v[156:159], v[44:47], a[140:143], v[156:159]
  s_waitcnt lgkmcnt(4)
  v_lshlrev_b32 v28, 16, v24
  v_and_b32 v24, s44, v24
  v_mfma_f32_16x16x32_bf16 v[160:163], v[32:35], a[128:131], v[160:163]
  ds_read_b64_tr_b16 v[44:45], v2 offset:24768
  s_add_u32 m0, s45, 16256
  v_mfma_f32_16x16x32_bf16 v[164:167], v[32:35], a[132:135], v[164:167]
  ds_read_b64_tr_b16 v[46:47], v2 offset:25280
  v_mul_f32 v28, v28, v52
  v_mfma_f32_16x16x32_bf16 v[168:171], v[32:35], a[136:139], v[168:171]
  buffer_store_dwordx4 v[20:23], v11, s[20:23], s77 offen offset:0 sc1
  v_mfma_f32_16x16x32_bf16 v[172:175], v[32:35], a[140:143], v[172:175]
  s_waitcnt lgkmcnt(4)
  ds_read_b128 v[20:23], v8 offset:12288
  v_mfma_f32_16x16x32_bf16 v[112:115], v[36:39], a[144:147], v[112:115]
  ds_read_b64_tr_b16 v[32:33], v2 offset:24776
  s_add_u32 s84, s42, 0
  v_mfma_f32_16x16x32_bf16 v[116:119], v[36:39], a[148:151], v[116:119]
  ds_read_b64_tr_b16 v[34:35], v2 offset:25288
  v_mul_f32 v24, v24, v53
  v_mfma_f32_16x16x32_bf16 v[120:123], v[36:39], a[152:155], v[120:123]
  buffer_load_dwordx4 v13, s[12:15], s92 offen offset:128 lds
  v_mfma_f32_16x16x32_bf16 v[124:127], v[36:39], a[156:159], v[124:127]
  s_waitcnt lgkmcnt(5)
  v_cvt_pk_bf16_f32 v24, v28, v24
  v_lshlrev_b32 v29, 16, v25
  v_mfma_f32_16x16x32_bf16 v[128:131], v[40:43], a[144:147], v[128:131]
  ds_read_b64_tr_b16 v[36:37], v1 offset:28896
  s_add_u32 s54, s72, 24576
  v_mfma_f32_16x16x32_bf16 v[132:135], v[40:43], a[148:151], v[132:135]
  ds_read_b64_tr_b16 v[38:39], v1 offset:29408
  v_and_b32 v25, s44, v25
  v_mfma_f32_16x16x32_bf16 v[136:139], v[40:43], a[152:155], v[136:139]
  buffer_load_dwordx4 v13, s[12:15], s93 offen offset:1152 lds
  v_mfma_f32_16x16x32_bf16 v[140:143], v[40:43], a[156:159], v[140:143]
  s_waitcnt lgkmcnt(5)
  v_mul_f32 v29, v29, v54
  v_mul_f32 v25, v25, v55
  v_mfma_f32_16x16x32_bf16 v[144:147], v[44:47], a[144:147], v[144:147]
  ds_read_b64_tr_b16 v[40:41], v1 offset:28904
  s_add_u32 m0, s45, 18304
  v_mfma_f32_16x16x32_bf16 v[148:151], v[44:47], a[148:151], v[148:151]
  ds_read_b64_tr_b16 v[42:43], v1 offset:29416
  v_cvt_pk_bf16_f32 v25, v29, v25
  v_mfma_f32_16x16x32_bf16 v[152:155], v[44:47], a[152:155], v[152:155]
  buffer_load_dwordx4 v13, s[12:15], s94 offen offset:128 lds
  v_mfma_f32_16x16x32_bf16 v[156:159], v[44:47], a[156:159], v[156:159]
  s_waitcnt lgkmcnt(4)
  v_lshlrev_b32 v28, 16, v26
  v_and_b32 v26, s44, v26
  v_mfma_f32_16x16x32_bf16 v[160:163], v[32:35], a[144:147], v[160:163]
  ds_read_b64_tr_b16 v[44:45], v2 offset:28896
  v_mul_f32 v28, v28, v68
  v_mfma_f32_16x16x32_bf16 v[164:167], v[32:35], a[148:151], v[164:167]
  ds_read_b64_tr_b16 v[46:47], v2 offset:29408
  v_mul_f32 v26, v26, v69
  v_mfma_f32_16x16x32_bf16 v[168:171], v[32:35], a[152:155], v[168:171]
  buffer_load_dword v14, off, s[64:67], s54
  v_cvt_pk_bf16_f32 v26, v28, v26
  v_mfma_f32_16x16x32_bf16 v[172:175], v[32:35], a[156:159], v[172:175]
  s_waitcnt lgkmcnt(4)
  v_lshlrev_b32 v29, 16, v27
  v_and_b32 v27, s44, v27
  v_mfma_f32_16x16x32_bf16 v[112:115], v[36:39], a[160:163], v[112:115]
  ds_read_b64_tr_b16 v[32:33], v2 offset:28904
  v_mul_f32 v29, v29, v70
  v_mfma_f32_16x16x32_bf16 v[116:119], v[36:39], a[164:167], v[116:119]
  ds_read_b64_tr_b16 v[34:35], v2 offset:29416
  v_mul_f32 v27, v27, v71
  v_mfma_f32_16x16x32_bf16 v[120:123], v[36:39], a[168:171], v[120:123]
  buffer_load_dwordx4 v13, s[12:15], s95 offen offset:1152 lds
  v_mfma_f32_16x16x32_bf16 v[124:127], v[36:39], a[172:175], v[124:127]
  s_waitcnt lgkmcnt(4)
  v_cvt_pk_bf16_f32 v27, v29, v27
  v_lshlrev_b32 v28, 16, v20
  v_mfma_f32_16x16x32_bf16 v[128:131], v[40:43], a[160:163], v[128:131]
  ds_read_b64_tr_b16 v[36:37], v1 offset:33024
  s_add_u32 m0, s45, 20352
  v_mfma_f32_16x16x32_bf16 v[132:135], v[40:43], a[164:167], v[132:135]
  ds_read_b64_tr_b16 v[38:39], v1 offset:33536
  v_and_b32 v20, s44, v20
  v_mfma_f32_16x16x32_bf16 v[136:139], v[40:43], a[168:171], v[136:139]
  buffer_store_dwordx4 v[24:27], v11, s[20:23], s84 offen offset:1024 sc1
  v_mfma_f32_16x16x32_bf16 v[140:143], v[40:43], a[172:175], v[140:143]
  s_waitcnt lgkmcnt(4)
  ds_read_b128 v[24:27], v8 offset:14336
  v_mfma_f32_16x16x32_bf16 v[144:147], v[44:47], a[160:163], v[144:147]
  ds_read_b64_tr_b16 v[40:41], v1 offset:33032
  s_add_u32 s77, s42, 0
  v_mfma_f32_16x16x32_bf16 v[148:151], v[44:47], a[164:167], v[148:151]
  ds_read_b64_tr_b16 v[42:43], v1 offset:33544
  v_mul_f32 v28, v28, v56
  v_mfma_f32_16x16x32_bf16 v[152:155], v[44:47], a[168:171], v[152:155]
  buffer_load_dwordx4 v13, s[12:15], s96 offen offset:128 lds
  v_mfma_f32_16x16x32_bf16 v[156:159], v[44:47], a[172:175], v[156:159]
  s_waitcnt lgkmcnt(5)
  v_mul_f32 v20, v20, v57
  v_cvt_pk_bf16_f32 v20, v28, v20
  v_mfma_f32_16x16x32_bf16 v[160:163], v[32:35], a[160:163], v[160:163]
  ds_read_b64_tr_b16 v[44:45], v2 offset:33024
  v_lshlrev_b32 v29, 16, v21
  v_mfma_f32_16x16x32_bf16 v[164:167], v[32:35], a[164:167], v[164:167]
  ds_read_b64_tr_b16 v[46:47], v2 offset:33536
  s_waitcnt vmcnt(16) lgkmcnt(5)
  v_mfma_f32_16x16x32_bf16 v[168:171], v[32:35], a[168:171], v[168:171]
  s_barrier
  s_add_u32 s51, s35, 745728
  v_and_b32 v21, s44, v21
  v_mfma_f32_16x16x32_bf16 v[172:175], v[32:35], a[172:175], v[172:175]
  buffer_load_dwordx4 v13, s[12:15], s97 offen offset:1152 lds
  v_mfma_f32_16x16x32_bf16 v[112:115], v[36:39], a[176:179], v[112:115]
  ds_read_b64_tr_b16 v[32:33], v2 offset:33032
  s_add_u32 m0, s36, 20640
  v_mfma_f32_16x16x32_bf16 v[116:119], v[36:39], a[180:183], v[116:119]
  ds_read_b64_tr_b16 v[34:35], v2 offset:33544
  v_mul_f32 v29, v29, v58
  v_mfma_f32_16x16x32_bf16 v[120:123], v[36:39], a[184:187], v[120:123]
  buffer_load_dwordx4 v4, s[8:11], s51 offen lds
  v_mfma_f32_16x16x32_bf16 v[124:127], v[36:39], a[188:191], v[124:127]
  s_waitcnt lgkmcnt(4)
  s_add_u32 m0, s45, 22400
  s_add_u32 s50, s35, 798976
  v_mfma_f32_16x16x32_bf16 v[128:131], v[40:43], a[176:179], v[128:131]
  ds_read_b64_tr_b16 v[36:37], v1 offset:37152
  v_mul_f32 v21, v21, v59
  v_mfma_f32_16x16x32_bf16 v[132:135], v[40:43], a[180:183], v[132:135]
  ds_read_b64_tr_b16 v[38:39], v1 offset:37664
  v_cvt_pk_bf16_f32 v21, v29, v21
  v_mfma_f32_16x16x32_bf16 v[136:139], v[40:43], a[184:187], v[136:139]
  buffer_load_dwordx4 v13, s[12:15], s98 offen offset:128 lds
  v_mfma_f32_16x16x32_bf16 v[140:143], v[40:43], a[188:191], v[140:143]
  s_waitcnt lgkmcnt(4)
  v_lshlrev_b32 v28, 16, v22
  v_and_b32 v22, s44, v22
  v_mfma_f32_16x16x32_bf16 v[144:147], v[44:47], a[176:179], v[144:147]
  ds_read_b64_tr_b16 v[40:41], v1 offset:37160
  v_mul_f32 v28, v28, v72
  v_mfma_f32_16x16x32_bf16 v[148:151], v[44:47], a[180:183], v[148:151]
  ds_read_b64_tr_b16 v[42:43], v1 offset:37672
  v_mul_f32 v22, v22, v73
  v_mfma_f32_16x16x32_bf16 v[152:155], v[44:47], a[184:187], v[152:155]
  buffer_load_dwordx4 v13, s[12:15], s99 offen offset:1152 lds
  v_mfma_f32_16x16x32_bf16 v[156:159], v[44:47], a[188:191], v[156:159]
  s_waitcnt lgkmcnt(4)
  s_add_u32 m0, s36, 24768
  v_cvt_pk_bf16_f32 v22, v28, v22
  v_mfma_f32_16x16x32_bf16 v[160:163], v[32:35], a[176:179], v[160:163]
  ds_read_b64_tr_b16 v[44:45], v2 offset:37152
  v_lshlrev_b32 v29, 16, v23
  v_mfma_f32_16x16x32_bf16 v[164:167], v[32:35], a[180:183], v[164:167]
  ds_read_b64_tr_b16 v[46:47], v2 offset:37664
  v_and_b32 v23, s44, v23
  v_mfma_f32_16x16x32_bf16 v[168:171], v[32:35], a[184:187], v[168:171]
  buffer_load_dwordx4 v4, s[8:11], s50 offen lds
  v_mfma_f32_16x16x32_bf16 v[172:175], v[32:35], a[188:191], v[172:175]
  s_waitcnt lgkmcnt(4)
  s_add_u32 s51, s35, 852224
  s_add_u32 m0, s36, 28896
  v_mfma_f32_16x16x32_bf16 v[112:115], v[36:39], a[192:195], v[112:115]
  ds_read_b64_tr_b16 v[32:33], v2 offset:37160
  v_mul_f32 v29, v29, v74
  v_mfma_f32_16x16x32_bf16 v[116:119], v[36:39], a[196:199], v[116:119]
  ds_read_b64_tr_b16 v[34:35], v2 offset:37672
  v_mul_f32 v23, v23, v75
  v_mfma_f32_16x16x32_bf16 v[120:123], v[36:39], a[200:203], v[120:123]
  buffer_load_dwordx4 v4, s[8:11], s51 offen lds
  v_mfma_f32_16x16x32_bf16 v[124:127], v[36:39], a[204:207], v[124:127]
  s_waitcnt lgkmcnt(4)
  v_cvt_pk_bf16_f32 v23, v29, v23
  v_lshlrev_b32 v28, 16, v24
  v_mfma_f32_16x16x32_bf16 v[128:131], v[40:43], a[192:195], v[128:131]
  ds_read_b64_tr_b16 v[36:37], v1 offset:41280
  v_and_b32 v24, s44, v24
  v_mfma_f32_16x16x32_bf16 v[132:135], v[40:43], a[196:199], v[132:135]
  ds_read_b64_tr_b16 v[38:39], v1 offset:41792
  v_mul_f32 v28, v28, v60
  v_mfma_f32_16x16x32_bf16 v[136:139], v[40:43], a[200:203], v[136:139]
  buffer_store_dwordx4 v[20:23], v11, s[20:23], s77 offen offset:2048 sc1
  v_mfma_f32_16x16x32_bf16 v[140:143], v[40:43], a[204:207], v[140:143]
  s_waitcnt lgkmcnt(4)
  ds_read_b128 v[20:23], v9 offset:8192
  v_mfma_f32_16x16x32_bf16 v[144:147], v[44:47], a[192:195], v[144:147]
  ds_read_b64_tr_b16 v[40:41], v1 offset:41288
  s_add_u32 s84, s42, 0
  v_mfma_f32_16x16x32_bf16 v[148:151], v[44:47], a[196:199], v[148:151]
  ds_read_b64_tr_b16 v[42:43], v1 offset:41800
  v_mul_f32 v24, v24, v61
  v_mfma_f32_16x16x32_bf16 v[152:155], v[44:47], a[200:203], v[152:155]
  v_cvt_pk_bf16_f32 v24, v28, v24
  v_lshlrev_b32 v29, 16, v25
  v_mfma_f32_16x16x32_bf16 v[156:159], v[44:47], a[204:207], v[156:159]
  s_waitcnt lgkmcnt(5)
  v_and_b32 v25, s44, v25
  v_mul_f32 v29, v29, v62
  v_mfma_f32_16x16x32_bf16 v[160:163], v[32:35], a[192:195], v[160:163]
  ds_read_b64_tr_b16 v[44:45], v2 offset:41280
  v_mul_f32 v25, v25, v63
  v_mfma_f32_16x16x32_bf16 v[164:167], v[32:35], a[196:199], v[164:167]
  ds_read_b64_tr_b16 v[46:47], v2 offset:41792
  v_cvt_pk_bf16_f32 v25, v29, v25
  v_mfma_f32_16x16x32_bf16 v[168:171], v[32:35], a[200:203], v[168:171]
  v_lshlrev_b32 v28, 16, v26
  v_and_b32 v26, s44, v26
  v_mfma_f32_16x16x32_bf16 v[172:175], v[32:35], a[204:207], v[172:175]
  s_waitcnt lgkmcnt(5)
  v_mul_f32 v28, v28, v76
  v_mul_f32 v26, v26, v77
  v_mfma_f32_16x16x32_bf16 v[112:115], v[36:39], a[0:3], v[112:115]
  ds_read_b64_tr_b16 v[32:33], v2 offset:41288
  v_cvt_pk_bf16_f32 v26, v28, v26
  v_mfma_f32_16x16x32_bf16 v[116:119], v[36:39], a[4:7], v[116:119]
  ds_read_b64_tr_b16 v[34:35], v2 offset:41800
  v_lshlrev_b32 v29, 16, v27
  v_mfma_f32_16x16x32_bf16 v[120:123], v[36:39], a[8:11], v[120:123]
  v_and_b32 v27, s44, v27
  v_mul_f32 v29, v29, v78
  v_mfma_f32_16x16x32_bf16 v[124:127], v[36:39], a[12:15], v[124:127]
  s_waitcnt lgkmcnt(4)
  v_mul_f32 v27, v27, v79
  v_cvt_pk_bf16_f32 v27, v29, v27
  v_mfma_f32_16x16x32_bf16 v[128:131], v[40:43], a[0:3], v[128:131]
  ds_read_b64_tr_b16 v[36:37], v1 offset:45408
  v_lshlrev_b32 v28, 16, v20
  v_mfma_f32_16x16x32_bf16 v[132:135], v[40:43], a[4:7], v[132:135]
  ds_read_b64_tr_b16 v[38:39], v1 offset:45920
  v_and_b32 v20, s44, v20
  v_mfma_f32_16x16x32_bf16 v[136:139], v[40:43], a[8:11], v[136:139]
  buffer_store_dwordx4 v[24:27], v11, s[20:23], s84 offen offset:3072 sc1
  v_mfma_f32_16x16x32_bf16 v[140:143], v[40:43], a[12:15], v[140:143]
  s_waitcnt lgkmcnt(4)
  ds_read_b128 v[24:27], v9 offset:10240
  v_mfma_f32_16x16x32_bf16 v[144:147], v[44:47], a[0:3], v[144:147]
  ds_read_b64_tr_b16 v[40:41], v1 offset:45416
  s_add_u32 s77, s42, 4096
  v_mfma_f32_16x16x32_bf16 v[148:151], v[44:47], a[4:7], v[148:151]
  ds_read_b64_tr_b16 v[42:43], v1 offset:45928
  v_mul_f32 v28, v28, v80
  v_mfma_f32_16x16x32_bf16 v[152:155], v[44:47], a[8:11], v[152:155]
  v_mul_f32 v20, v20, v81
  v_cvt_pk_bf16_f32 v20, v28, v20
  v_mfma_f32_16x16x32_bf16 v[156:159], v[44:47], a[12:15], v[156:159]
  s_waitcnt lgkmcnt(5)
  v_lshlrev_b32 v29, 16, v21
  v_and_b32 v21, s44, v21
  v_mfma_f32_16x16x32_bf16 v[160:163], v[32:35], a[0:3], v[160:163]
  ds_read_b64_tr_b16 v[44:45], v2 offset:45408
  v_mul_f32 v29, v29, v82
  v_mfma_f32_16x16x32_bf16 v[164:167], v[32:35], a[4:7], v[164:167]
  ds_read_b64_tr_b16 v[46:47], v2 offset:45920
  s_waitcnt vmcnt(20) lgkmcnt(5)
  v_mfma_f32_16x16x32_bf16 v[168:171], v[32:35], a[8:11], v[168:171]
  s_barrier
  s_add_u32 s50, s35, 905472
  s_add_u32 m0, s36, 33024
  v_mfma_f32_16x16x32_bf16 v[172:175], v[32:35], a[12:15], v[172:175]
  buffer_load_dwordx4 v4, s[8:11], s50 offen lds
  v_mfma_f32_16x16x32_bf16 v[112:115], v[36:39], a[16:19], v[112:115]
  ds_read_b64_tr_b16 v[32:33], v2 offset:45416
  s_add_u32 s51, s35, 958720
  v_mfma_f32_16x16x32_bf16 v[116:119], v[36:39], a[20:23], v[116:119]
  ds_read_b64_tr_b16 v[34:35], v2 offset:45928
  s_add_u32 m0, s36, 37152
  v_mfma_f32_16x16x32_bf16 v[120:123], v[36:39], a[24:27], v[120:123]
  buffer_load_dwordx4 v4, s[8:11], s51 offen lds
  v_mfma_f32_16x16x32_bf16 v[124:127], v[36:39], a[28:31], v[124:127]
  s_waitcnt lgkmcnt(4)
  s_add_u32 s50, s35, 1011968
  s_add_u32 m0, s36, 41280
  v_mfma_f32_16x16x32_bf16 v[128:131], v[40:43], a[16:19], v[128:131]
  ds_read_b64_tr_b16 v[36:37], v1 offset:49536
  v_mul_f32 v21, v21, v83
  v_mfma_f32_16x16x32_bf16 v[132:135], v[40:43], a[20:23], v[132:135]
  ds_read_b64_tr_b16 v[38:39], v1 offset:50048
  v_cvt_pk_bf16_f32 v21, v29, v21
  v_mfma_f32_16x16x32_bf16 v[136:139], v[40:43], a[24:27], v[136:139]
  buffer_load_dwordx4 v4, s[8:11], s50 offen lds
  v_mfma_f32_16x16x32_bf16 v[140:143], v[40:43], a[28:31], v[140:143]
  s_waitcnt lgkmcnt(4)
  v_lshlrev_b32 v28, 16, v22
  v_and_b32 v22, s44, v22
  v_mfma_f32_16x16x32_bf16 v[144:147], v[44:47], a[16:19], v[144:147]
  ds_read_b64_tr_b16 v[40:41], v1 offset:49544
  v_mul_f32 v28, v28, v96
  v_mfma_f32_16x16x32_bf16 v[148:151], v[44:47], a[20:23], v[148:151]
  ds_read_b64_tr_b16 v[42:43], v1 offset:50056
  v_mul_f32 v22, v22, v97
  v_mfma_f32_16x16x32_bf16 v[152:155], v[44:47], a[24:27], v[152:155]
  v_cvt_pk_bf16_f32 v22, v28, v22
  v_lshlrev_b32 v29, 16, v23
  v_mfma_f32_16x16x32_bf16 v[156:159], v[44:47], a[28:31], v[156:159]
  s_waitcnt lgkmcnt(4)
  v_and_b32 v23, s44, v23
  v_mul_f32 v29, v29, v98
  v_mfma_f32_16x16x32_bf16 v[160:163], v[32:35], a[16:19], v[160:163]
  ds_read_b64_tr_b16 v[44:45], v2 offset:49536
  v_mul_f32 v23, v23, v99
  v_mfma_f32_16x16x32_bf16 v[164:167], v[32:35], a[20:23], v[164:167]
  ds_read_b64_tr_b16 v[46:47], v2 offset:50048
  v_cvt_pk_bf16_f32 v23, v29, v23
  v_mfma_f32_16x16x32_bf16 v[168:171], v[32:35], a[24:27], v[168:171]
  buffer_store_dwordx4 v[20:23], v11, s[20:23], s77 offen offset:0 sc1
  v_mfma_f32_16x16x32_bf16 v[172:175], v[32:35], a[28:31], v[172:175]
  s_waitcnt lgkmcnt(4)
  ds_read_b128 v[20:23], v9 offset:12288
  v_mfma_f32_16x16x32_bf16 v[112:115], v[36:39], a[32:35], v[112:115]
  ds_read_b64_tr_b16 v[32:33], v2 offset:49544
  s_add_u32 s84, s42, 4096
  v_mfma_f32_16x16x32_bf16 v[116:119], v[36:39], a[36:39], v[116:119]
  ds_read_b64_tr_b16 v[34:35], v2 offset:50056
  v_lshlrev_b32 v28, 16, v24
  v_mfma_f32_16x16x32_bf16 v[120:123], v[36:39], a[40:43], v[120:123]
  v_and_b32 v24, s44, v24
  v_mul_f32 v28, v28, v84
  v_mfma_f32_16x16x32_bf16 v[124:127], v[36:39], a[44:47], v[124:127]
  s_waitcnt lgkmcnt(5)
  v_mul_f32 v24, v24, v85
  v_cvt_pk_bf16_f32 v24, v28, v24
  v_mfma_f32_16x16x32_bf16 v[128:131], v[40:43], a[32:35], v[128:131]
  ds_read_b64_tr_b16 v[36:37], v1 offset:0
  v_lshlrev_b32 v29, 16, v25
  v_mfma_f32_16x16x32_bf16 v[132:135], v[40:43], a[36:39], v[132:135]
  ds_read_b64_tr_b16 v[38:39], v1 offset:512
  v_and_b32 v25, s44, v25
  v_mfma_f32_16x16x32_bf16 v[136:139], v[40:43], a[40:43], v[136:139]
  v_mul_f32 v29, v29, v86
  v_mul_f32 v25, v25, v87
  v_mfma_f32_16x16x32_bf16 v[140:143], v[40:43], a[44:47], v[140:143]
  s_waitcnt lgkmcnt(5)
  v_cvt_pk_bf16_f32 v25, v29, v25
  v_lshlrev_b32 v28, 16, v26
  v_mfma_f32_16x16x32_bf16 v[144:147], v[44:47], a[32:35], v[144:147]
  ds_read_b64_tr_b16 v[40:41], v1 offset:8
  v_and_b32 v26, s44, v26
  v_mfma_f32_16x16x32_bf16 v[148:151], v[44:47], a[36:39], v[148:151]
  ds_read_b64_tr_b16 v[42:43], v1 offset:520
  v_mul_f32 v28, v28, v100
  v_mfma_f32_16x16x32_bf16 v[152:155], v[44:47], a[40:43], v[152:155]
  v_mul_f32 v26, v26, v101
  v_cvt_pk_bf16_f32 v26, v28, v26
  v_mfma_f32_16x16x32_bf16 v[156:159], v[44:47], a[44:47], v[156:159]
  s_waitcnt lgkmcnt(4)
  v_lshlrev_b32 v29, 16, v27
  v_and_b32 v27, s44, v27
  v_mfma_f32_16x16x32_bf16 v[160:163], v[32:35], a[32:35], v[160:163]
  ds_read_b64_tr_b16 v[44:45], v2 offset:0
  v_mul_f32 v29, v29, v102
  v_mfma_f32_16x16x32_bf16 v[164:167], v[32:35], a[36:39], v[164:167]
  ds_read_b64_tr_b16 v[46:47], v2 offset:512
  v_mul_f32 v27, v27, v103
  v_mfma_f32_16x16x32_bf16 v[168:171], v[32:35], a[40:43], v[168:171]
  v_cvt_pk_bf16_f32 v27, v29, v27
  v_lshlrev_b32 v28, 16, v20
  v_mfma_f32_16x16x32_bf16 v[172:175], v[32:35], a[44:47], v[172:175]
  s_waitcnt lgkmcnt(4)
  v_and_b32 v20, s44, v20
  v_mul_f32 v28, v28, v88
  v_mfma_f32_16x16x32_bf16 v[112:115], v[36:39], a[48:51], v[112:115]
  ds_read_b64_tr_b16 v[32:33], v2 offset:8
  v_mul_f32 v20, v20, v89
  v_mfma_f32_16x16x32_bf16 v[116:119], v[36:39], a[52:55], v[116:119]
  ds_read_b64_tr_b16 v[34:35], v2 offset:520
  v_cvt_pk_bf16_f32 v20, v28, v20
  v_mfma_f32_16x16x32_bf16 v[120:123], v[36:39], a[56:59], v[120:123]
  buffer_store_dwordx4 v[24:27], v11, s[20:23], s84 offen offset:1024 sc1
  v_mfma_f32_16x16x32_bf16 v[124:127], v[36:39], a[60:63], v[124:127]
  s_waitcnt lgkmcnt(4)
  ds_read_b128 v[24:27], v9 offset:14336
  v_mfma_f32_16x16x32_bf16 v[128:131], v[40:43], a[48:51], v[128:131]
  ds_read_b64_tr_b16 v[36:37], v1 offset:4128
  s_add_u32 s77, s42, 4096
  v_mfma_f32_16x16x32_bf16 v[132:135], v[40:43], a[52:55], v[132:135]
  ds_read_b64_tr_b16 v[38:39], v1 offset:4640
  v_lshlrev_b32 v29, 16, v21
  v_mfma_f32_16x16x32_bf16 v[136:139], v[40:43], a[56:59], v[136:139]
  v_and_b32 v21, s44, v21
  v_mul_f32 v29, v29, v90
  v_mfma_f32_16x16x32_bf16 v[140:143], v[40:43], a[60:63], v[140:143]
  s_waitcnt lgkmcnt(5)
  v_mul_f32 v21, v21, v91
  v_cvt_pk_bf16_f32 v21, v29, v21
  v_mfma_f32_16x16x32_bf16 v[144:147], v[44:47], a[48:51], v[144:147]
  ds_read_b64_tr_b16 v[40:41], v1 offset:4136
  v_lshlrev_b32 v28, 16, v22
  v_mfma_f32_16x16x32_bf16 v[148:151], v[44:47], a[52:55], v[148:151]
  ds_read_b64_tr_b16 v[42:43], v1 offset:4648
  v_and_b32 v22, s44, v22
  v_mfma_f32_16x16x32_bf16 v[152:155], v[44:47], a[56:59], v[152:155]
  v_mul_f32 v28, v28, v104
  v_mul_f32 v22, v22, v105
  v_mfma_f32_16x16x32_bf16 v[156:159], v[44:47], a[60:63], v[156:159]
  s_waitcnt lgkmcnt(5)
  v_cvt_pk_bf16_f32 v22, v28, v22
  v_lshlrev_b32 v29, 16, v23
  v_mfma_f32_16x16x32_bf16 v[160:163], v[32:35], a[48:51], v[160:163]
  ds_read_b64_tr_b16 v[44:45], v2 offset:4128
  v_and_b32 v23, s44, v23
  v_mfma_f32_16x16x32_bf16 v[164:167], v[32:35], a[52:55], v[164:167]
  ds_read_b64_tr_b16 v[46:47], v2 offset:4640
  s_waitcnt vmcnt(21) lgkmcnt(4)
  v_mfma_f32_16x16x32_bf16 v[168:171], v[32:35], a[56:59], v[168:171]
  s_barrier
  s_add_u32 s51, s35, 1065216
  s_add_u32 m0, s36, 45408
  v_mfma_f32_16x16x32_bf16 v[172:175], v[32:35], a[60:63], v[172:175]
  buffer_load_dwordx4 v4, s[8:11], s51 offen lds
  v_mfma_f32_16x16x32_bf16 v[112:115], v[36:39], a[64:67], v[112:115]
  ds_read_b64_tr_b16 v[32:33], v2 offset:4136
  s_add_u32 s50, s35, 1118464
  v_mfma_f32_16x16x32_bf16 v[116:119], v[36:39], a[68:71], v[116:119]
  ds_read_b64_tr_b16 v[34:35], v2 offset:4648
  s_add_u32 m0, s36, 49536
  v_mfma_f32_16x16x32_bf16 v[120:123], v[36:39], a[72:75], v[120:123]
  buffer_load_dwordx4 v4, s[8:11], s50 offen lds
  v_mfma_f32_16x16x32_bf16 v[124:127], v[36:39], a[76:79], v[124:127]
  s_waitcnt lgkmcnt(4)
  s_add_u32 s51, s35, 1171712
  s_add_u32 m0, s36, 0
  v_mfma_f32_16x16x32_bf16 v[128:131], v[40:43], a[64:67], v[128:131]
  ds_read_b64_tr_b16 v[36:37], v1 offset:8256
  v_mul_f32 v29, v29, v106
  v_mfma_f32_16x16x32_bf16 v[132:135], v[40:43], a[68:71], v[132:135]
  ds_read_b64_tr_b16 v[38:39], v1 offset:8768
  v_mul_f32 v23, v23, v107
  v_mfma_f32_16x16x32_bf16 v[136:139], v[40:43], a[72:75], v[136:139]
  buffer_load_dwordx4 v4, s[8:11], s51 offen lds
  v_mfma_f32_16x16x32_bf16 v[140:143], v[40:43], a[76:79], v[140:143]
  s_waitcnt lgkmcnt(4)
  s_add_u32 m0, s45, -256
  v_cvt_pk_bf16_f32 v23, v29, v23
  v_mfma_f32_16x16x32_bf16 v[144:147], v[44:47], a[64:67], v[144:147]
  ds_read_b64_tr_b16 v[40:41], v1 offset:8264
  v_lshlrev_b32 v28, 16, v24
  v_mfma_f32_16x16x32_bf16 v[148:151], v[44:47], a[68:71], v[148:151]
  ds_read_b64_tr_b16 v[42:43], v1 offset:8776
  v_and_b32 v24, s44, v24
  v_mfma_f32_16x16x32_bf16 v[152:155], v[44:47], a[72:75], v[152:155]
  buffer_store_dwordx4 v[20:23], v11, s[20:23], s77 offen offset:2048 sc1
  v_mfma_f32_16x16x32_bf16 v[156:159], v[44:47], a[76:79], v[156:159]
  s_waitcnt lgkmcnt(4)
  s_add_u32 s84, s42, 4096
  v_mul_f32 v28, v28, v92
  v_mfma_f32_16x16x32_bf16 v[160:163], v[32:35], a[64:67], v[160:163]
  ds_read_b64_tr_b16 v[44:45], v2 offset:8256
  s_waitcnt vmcnt(9)
  v_mfma_f32_16x16x32_bf16 v[164:167], v[32:35], a[68:71], v[164:167]
  ds_read_b64_tr_b16 v[46:47], v2 offset:8768
  v_add_u32 v17, 1, v30
  v_mfma_f32_16x16x32_bf16 v[168:171], v[32:35], a[72:75], v[168:171]
  buffer_store_dword v17, v16, s[20:23], 0 offen sc1
  v_mfma_f32_16x16x32_bf16 v[172:175], v[32:35], a[76:79], v[172:175]
  s_waitcnt lgkmcnt(4)
  v_mul_f32 v24, v24, v93
  v_cvt_pk_bf16_f32 v24, v28, v24
  v_mfma_f32_16x16x32_bf16 v[112:115], v[36:39], a[80:83], v[112:115]
  ds_read_b64_tr_b16 v[32:33], v2 offset:8264
  v_lshlrev_b32 v29, 16, v25
  v_mfma_f32_16x16x32_bf16 v[116:119], v[36:39], a[84:87], v[116:119]
  ds_read_b64_tr_b16 v[34:35], v2 offset:8776
  v_and_b32 v25, s44, v25
  v_mfma_f32_16x16x32_bf16 v[120:123], v[36:39], a[88:91], v[120:123]
  buffer_load_dwordx4 v13, s[12:15], s92 offen offset:256 lds
  v_mfma_f32_16x16x32_bf16 v[124:127], v[36:39], a[92:95], v[124:127]
  s_waitcnt lgkmcnt(4)
  v_mul_f32 v29, v29, v94
  v_mul_f32 v25, v25, v95
  v_mfma_f32_16x16x32_bf16 v[128:131], v[40:43], a[80:83], v[128:131]
  ds_read_b64_tr_b16 v[36:37], v1 offset:12384
  v_cvt_pk_bf16_f32 v25, v29, v25
  v_mfma_f32_16x16x32_bf16 v[132:135], v[40:43], a[84:87], v[132:135]
  ds_read_b64_tr_b16 v[38:39], v1 offset:12896
  v_lshlrev_b32 v28, 16, v26
  v_mfma_f32_16x16x32_bf16 v[136:139], v[40:43], a[88:91], v[136:139]
  buffer_load_dwordx4 v13, s[12:15], s93 offen offset:1280 lds
  v_mfma_f32_16x16x32_bf16 v[140:143], v[40:43], a[92:95], v[140:143]
  s_waitcnt lgkmcnt(4)
  s_add_u32 m0, s45, 1792
  v_and_b32 v26, s44, v26
  v_mfma_f32_16x16x32_bf16 v[144:147], v[44:47], a[80:83], v[144:147]
  ds_read_b64_tr_b16 v[40:41], v1 offset:12392
  v_mul_f32 v28, v28, v108
  v_mfma_f32_16x16x32_bf16 v[148:151], v[44:47], a[84:87], v[148:151]
  ds_read_b64_tr_b16 v[42:43], v1 offset:12904
  v_mul_f32 v26, v26, v109
  v_mfma_f32_16x16x32_bf16 v[152:155], v[44:47], a[88:91], v[152:155]
  buffer_load_dwordx4 v13, s[12:15], s94 offen offset:256 lds
  v_mfma_f32_16x16x32_bf16 v[156:159], v[44:47], a[92:95], v[156:159]
  s_waitcnt lgkmcnt(4)
  v_cvt_pk_bf16_f32 v26, v28, v26
  v_lshlrev_b32 v29, 16, v27
  v_mfma_f32_16x16x32_bf16 v[160:163], v[32:35], a[80:83], v[160:163]
  ds_read_b64_tr_b16 v[44:45], v2 offset:12384
  v_and_b32 v27, s44, v27
  v_mfma_f32_16x16x32_bf16 v[164:167], v[32:35], a[84:87], v[164:167]
  ds_read_b64_tr_b16 v[46:47], v2 offset:12896
  v_mul_f32 v29, v29, v110
  v_mfma_f32_16x16x32_bf16 v[168:171], v[32:35], a[88:91], v[168:171]
  buffer_load_dwordx4 v13, s[12:15], s95 offen offset:1280 lds
  v_mfma_f32_16x16x32_bf16 v[172:175], v[32:35], a[92:95], v[172:175]
  s_waitcnt lgkmcnt(4)
  s_add_u32 m0, s45, 3840
  v_mul_f32 v27, v27, v111
  v_mfma_f32_16x16x32_bf16 v[112:115], v[36:39], a[96:99], v[112:115]
  ds_read_b64_tr_b16 v[32:33], v2 offset:12392
  v_cvt_pk_bf16_f32 v27, v29, v27
  v_mfma_f32_16x16x32_bf16 v[116:119], v[36:39], a[100:103], v[116:119]
  ds_read_b64_tr_b16 v[34:35], v2 offset:12904
  s_waitcnt lgkmcnt(4)
  v_mfma_f32_16x16x32_bf16 v[120:123], v[36:39], a[104:107], v[120:123]
  buffer_store_dwordx4 v[24:27], v11, s[20:23], s84 offen offset:3072 sc1
  v_mfma_f32_16x16x32_bf16 v[124:127], v[36:39], a[108:111], v[124:127]
  buffer_load_dwordx4 v13, s[12:15], s96 offen offset:256 lds
  v_mfma_f32_16x16x32_bf16 v[128:131], v[40:43], a[96:99], v[128:131]
  ds_read_b64_tr_b16 v[36:37], v1 offset:16512
  v_mfma_f32_16x16x32_bf16 v[132:135], v[40:43], a[100:103], v[132:135]
  ds_read_b64_tr_b16 v[38:39], v1 offset:17024
  s_waitcnt lgkmcnt(4)
  v_mfma_f32_16x16x32_bf16 v[136:139], v[40:43], a[104:107], v[136:139]
  buffer_load_dwordx4 v13, s[12:15], s97 offen offset:1280 lds
  v_mfma_f32_16x16x32_bf16 v[140:143], v[40:43], a[108:111], v[140:143]
  v_mfma_f32_16x16x32_bf16 v[144:147], v[44:47], a[96:99], v[144:147]
  ds_read_b64_tr_b16 v[40:41], v1 offset:16520
  v_mfma_f32_16x16x32_bf16 v[148:151], v[44:47], a[100:103], v[148:151]
  ds_read_b64_tr_b16 v[42:43], v1 offset:17032
  s_waitcnt lgkmcnt(4)
  v_mfma_f32_16x16x32_bf16 v[152:155], v[44:47], a[104:107], v[152:155]
  s_add_u32 m0, s45, 5888
  v_mfma_f32_16x16x32_bf16 v[156:159], v[44:47], a[108:111], v[156:159]
  buffer_load_dwordx4 v13, s[12:15], s98 offen offset:256 lds
  v_mfma_f32_16x16x32_bf16 v[160:163], v[32:35], a[96:99], v[160:163]
  ds_read_b64_tr_b16 v[44:45], v2 offset:16512
  v_mfma_f32_16x16x32_bf16 v[164:167], v[32:35], a[100:103], v[164:167]
  ds_read_b64_tr_b16 v[46:47], v2 offset:17024
  s_waitcnt lgkmcnt(4)
  v_mfma_f32_16x16x32_bf16 v[168:171], v[32:35], a[104:107], v[168:171]
  s_barrier
  s_add_u32 s50, s35, 1224960
  v_mfma_f32_16x16x32_bf16 v[172:175], v[32:35], a[108:111], v[172:175]
  ds_read_b128 v[20:23], v8 offset:16384
  v_mfma_f32_16x16x32_bf16 v[176:179], v[36:39], a[112:115], v[176:179]
  ds_read_b64_tr_b16 v[32:33], v2 offset:16520
  v_mfma_f32_16x16x32_bf16 v[180:183], v[36:39], a[116:119], v[180:183]
  ds_read_b64_tr_b16 v[34:35], v2 offset:17032
  s_waitcnt lgkmcnt(5)
  v_mfma_f32_16x16x32_bf16 v[184:187], v[36:39], a[120:123], v[184:187]
  buffer_load_dwordx4 v13, s[12:15], s99 offen offset:1280 lds
  v_mfma_f32_16x16x32_bf16 v[188:191], v[36:39], a[124:127], v[188:191]
  s_add_u32 m0, s36, 4128
  ds_read_b128 v[24:27], v8 offset:18432
  v_mfma_f32_16x16x32_bf16 v[192:195], v[40:43], a[112:115], v[192:195]
  ds_read_b64_tr_b16 v[36:37], v1 offset:20640
  s_add_u32 s77, s42, 8192
  v_mfma_f32_16x16x32_bf16 v[196:199], v[40:43], a[116:119], v[196:199]
  ds_read_b64_tr_b16 v[38:39], v1 offset:21152
  s_waitcnt lgkmcnt(5)
  v_mfma_f32_16x16x32_bf16 v[200:203], v[40:43], a[120:123], v[200:203]
  buffer_load_dwordx4 v4, s[8:11], s50 offen lds
  v_mfma_f32_16x16x32_bf16 v[204:207], v[40:43], a[124:127], v[204:207]
  s_add_u32 s51, s35, 1278208
  s_add_u32 m0, s36, 8256
  v_lshlrev_b32 v28, 16, v20
  v_mfma_f32_16x16x32_bf16 v[208:211], v[44:47], a[112:115], v[208:211]
  ds_read_b64_tr_b16 v[40:41], v1 offset:20648
  v_and_b32 v20, s44, v20
  v_mfma_f32_16x16x32_bf16 v[212:215], v[44:47], a[116:119], v[212:215]
  ds_read_b64_tr_b16 v[42:43], v1 offset:21160
  v_mul_f32 v28, v28, v112
  v_mfma_f32_16x16x32_bf16 v[216:219], v[44:47], a[120:123], v[216:219]
  buffer_load_dwordx4 v4, s[8:11], s51 offen lds
  v_mfma_f32_16x16x32_bf16 v[220:223], v[44:47], a[124:127], v[220:223]
  s_waitcnt lgkmcnt(5)
  s_add_u32 s50, s35, 1331456
  s_add_u32 m0, s36, 12384
  v_mfma_f32_16x16x32_bf16 v[224:227], v[32:35], a[112:115], v[224:227]
  ds_read_b64_tr_b16 v[44:45], v2 offset:20640
  v_mul_f32 v20, v20, v113
  v_mfma_f32_16x16x32_bf16 v[228:231], v[32:35], a[116:119], v[228:231]
  ds_read_b64_tr_b16 v[46:47], v2 offset:21152
  v_cvt_pk_bf16_f32 v20, v28, v20
  v_mfma_f32_16x16x32_bf16 v[232:235], v[32:35], a[120:123], v[232:235]
  buffer_load_dwordx4 v4, s[8:11], s50 offen lds
  v_mfma_f32_16x16x32_bf16 v[236:239], v[32:35], a[124:127], v[236:239]
  s_waitcnt lgkmcnt(4)
  v_lshlrev_b32 v29, 16, v21
  v_and_b32 v21, s44, v21
  v_mfma_f32_16x16x32_bf16 v[176:179], v[36:39], a[128:131], v[176:179]
  ds_read_b64_tr_b16 v[32:33], v2 offset:20648
  v_mul_f32 v29, v29, v114
  v_mfma_f32_16x16x32_bf16 v[180:183], v[36:39], a[132:135], v[180:183]
  ds_read_b64_tr_b16 v[34:35], v2 offset:21160
  v_mul_f32 v21, v21, v115
  v_mfma_f32_16x16x32_bf16 v[184:187], v[36:39], a[136:139], v[184:187]
  v_cvt_pk_bf16_f32 v21, v29, v21
  v_lshlrev_b32 v28, 16, v22
  v_mfma_f32_16x16x32_bf16 v[188:191], v[36:39], a[140:143], v[188:191]
  s_waitcnt lgkmcnt(4)
  v_and_b32 v22, s44, v22
  v_mul_f32 v28, v28, v128
  v_mfma_f32_16x16x32_bf16 v[192:195], v[40:43], a[128:131], v[192:195]
  ds_read_b64_tr_b16 v[36:37], v1 offset:24768
  v_mul_f32 v22, v22, v129
  v_mfma_f32_16x16x32_bf16 v[196:199], v[40:43], a[132:135], v[196:199]
  ds_read_b64_tr_b16 v[38:39], v1 offset:25280
  v_cvt_pk_bf16_f32 v22, v28, v22
  v_mfma_f32_16x16x32_bf16 v[200:203], v[40:43], a[136:139], v[200:203]
  v_lshlrev_b32 v29, 16, v23
  v_and_b32 v23, s44, v23
  v_mfma_f32_16x16x32_bf16 v[204:207], v[40:43], a[140:143], v[204:207]
  s_waitcnt lgkmcnt(4)
  v_mul_f32 v29, v29, v130
  v_mul_f32 v23, v23, v131
  v_mfma_f32_16x16x32_bf16 v[208:211], v[44:47], a[128:131], v[208:211]
  ds_read_b64_tr_b16 v[40:41], v1 offset:24776
  v_cvt_pk_bf16_f32 v23, v29, v23
  v_mfma_f32_16x16x32_bf16 v[212:215], v[44:47], a[132:135], v[212:215]
  ds_read_b64_tr_b16 v[42:43], v1 offset:25288
  v_lshlrev_b32 v28, 16, v24
  v_mfma_f32_16x16x32_bf16 v[216:219], v[44:47], a[136:139], v[216:219]
  buffer_store_dwordx4 v[20:23], v11, s[20:23], s77 offen offset:0 sc1
  v_mfma_f32_16x16x32_bf16 v[220:223], v[44:47], a[140:143], v[220:223]
  s_waitcnt lgkmcnt(4)
  ds_read_b128 v[20:23], v8 offset:20480
  v_mfma_f32_16x16x32_bf16 v[224:227], v[32:35], a[128:131], v[224:227]
  ds_read_b64_tr_b16 v[44:45], v2 offset:24768
  s_add_u32 s84, s42, 8192
  v_mfma_f32_16x16x32_bf16 v[228:231], v[32:35], a[132:135], v[228:231]
  ds_read_b64_tr_b16 v[46:47], v2 offset:25280
  v_and_b32 v24, s44, v24
  v_mfma_f32_16x16x32_bf16 v[232:235], v[32:35], a[136:139], v[232:235]
  v_mul_f32 v28, v28, v116
  v_mul_f32 v24, v24, v117
  v_mfma_f32_16x16x32_bf16 v[236:239], v[32:35], a[140:143], v[236:239]
  s_waitcnt lgkmcnt(5)
  v_cvt_pk_bf16_f32 v24, v28, v24
  v_lshlrev_b32 v29, 16, v25
  v_mfma_f32_16x16x32_bf16 v[176:179], v[36:39], a[144:147], v[176:179]
  ds_read_b64_tr_b16 v[32:33], v2 offset:24776
  v_and_b32 v25, s44, v25
  v_mfma_f32_16x16x32_bf16 v[180:183], v[36:39], a[148:151], v[180:183]
  ds_read_b64_tr_b16 v[34:35], v2 offset:25288
  v_mul_f32 v29, v29, v118
  v_mfma_f32_16x16x32_bf16 v[184:187], v[36:39], a[152:155], v[184:187]
  v_mul_f32 v25, v25, v119
  v_cvt_pk_bf16_f32 v25, v29, v25
  v_mfma_f32_16x16x32_bf16 v[188:191], v[36:39], a[156:159], v[188:191]
  s_waitcnt lgkmcnt(5)
  v_lshlrev_b32 v28, 16, v26
  v_and_b32 v26, s44, v26
  v_mfma_f32_16x16x32_bf16 v[192:195], v[40:43], a[144:147], v[192:195]
  ds_read_b64_tr_b16 v[36:37], v1 offset:28896
  v_mul_f32 v28, v28, v132
  v_mfma_f32_16x16x32_bf16 v[196:199], v[40:43], a[148:151], v[196:199]
  ds_read_b64_tr_b16 v[38:39], v1 offset:29408
  v_mul_f32 v26, v26, v133
  v_mfma_f32_16x16x32_bf16 v[200:203], v[40:43], a[152:155], v[200:203]
  v_cvt_pk_bf16_f32 v26, v28, v26
  v_lshlrev_b32 v29, 16, v27
  v_mfma_f32_16x16x32_bf16 v[204:207], v[40:43], a[156:159], v[204:207]
  s_waitcnt lgkmcnt(4)
  v_and_b32 v27, s44, v27
  v_mul_f32 v29, v29, v134
  v_mfma_f32_16x16x32_bf16 v[208:211], v[44:47], a[144:147], v[208:211]
  ds_read_b64_tr_b16 v[40:41], v1 offset:28904
  v_mul_f32 v27, v27, v135
  v_mfma_f32_16x16x32_bf16 v[212:215], v[44:47], a[148:151], v[212:215]
  ds_read_b64_tr_b16 v[42:43], v1 offset:29416
  v_cvt_pk_bf16_f32 v27, v29, v27
  v_mfma_f32_16x16x32_bf16 v[216:219], v[44:47], a[152:155], v[216:219]
  buffer_store_dwordx4 v[24:27], v11, s[20:23], s84 offen offset:1024 sc1
  v_mfma_f32_16x16x32_bf16 v[220:223], v[44:47], a[156:159], v[220:223]
  s_waitcnt lgkmcnt(4)
  ds_read_b128 v[24:27], v8 offset:22528
  v_mfma_f32_16x16x32_bf16 v[224:227], v[32:35], a[144:147], v[224:227]
  ds_read_b64_tr_b16 v[44:45], v2 offset:28896
  s_add_u32 s77, s42, 8192
  v_mfma_f32_16x16x32_bf16 v[228:231], v[32:35], a[148:151], v[228:231]
  ds_read_b64_tr_b16 v[46:47], v2 offset:29408
  s_waitcnt vmcnt(21) lgkmcnt(5)
  v_mfma_f32_16x16x32_bf16 v[232:235], v[32:35], a[152:155], v[232:235]
  s_barrier
  s_lshr_b32 s51, 0x100f0e0d, s37
  s_and_b32 s51, s51, 0xff
  v_mfma_f32_16x16x32_bf16 v[236:239], v[32:35], a[156:159], v[236:239]
  s_mul_i32 s51, s51, 53248
  s_add_u32 s51, s51, s38
  s_add_u32 m0, s39, 16512
  v_mfma_f32_16x16x32_bf16 v[176:179], v[36:39], a[160:163], v[176:179]
  ds_read_b64_tr_b16 v[32:33], v2 offset:28904
  v_lshlrev_b32 v28, 16, v20
  v_mfma_f32_16x16x32_bf16 v[180:183], v[36:39], a[164:167], v[180:183]
  ds_read_b64_tr_b16 v[34:35], v2 offset:29416
  v_and_b32 v20, s44, v20
  v_mfma_f32_16x16x32_bf16 v[184:187], v[36:39], a[168:171], v[184:187]
  buffer_load_dwordx4 v6, s[8:11], s51 offen lds
  v_mfma_f32_16x16x32_bf16 v[188:191], v[36:39], a[172:175], v[188:191]
  s_waitcnt lgkmcnt(5)
  s_lshr_b32 s50, 0x14131211, s37
  s_and_b32 s50, s50, 0xff
  v_mfma_f32_16x16x32_bf16 v[192:195], v[40:43], a[160:163], v[192:195]
  ds_read_b64_tr_b16 v[36:37], v1 offset:33024
  s_mul_i32 s50, s50, 53248
  v_mfma_f32_16x16x32_bf16 v[196:199], v[40:43], a[164:167], v[196:199]
  ds_read_b64_tr_b16 v[38:39], v1 offset:33536
  s_add_u32 s50, s50, s38
  v_mfma_f32_16x16x32_bf16 v[200:203], v[40:43], a[168:171], v[200:203]
  s_add_u32 m0, s39, 20608
  v_mul_f32 v28, v28, v120
  v_mul_f32 v20, v20, v121
  v_mfma_f32_16x16x32_bf16 v[204:207], v[40:43], a[172:175], v[204:207]
  s_waitcnt lgkmcnt(4)
  v_cvt_pk_bf16_f32 v20, v28, v20
  v_lshlrev_b32 v29, 16, v21
  v_mfma_f32_16x16x32_bf16 v[208:211], v[44:47], a[160:163], v[208:211]
  ds_read_b64_tr_b16 v[40:41], v1 offset:33032
  s_waitcnt vmcnt(10)
  v_mfma_f32_16x16x32_bf16 v[212:215], v[44:47], a[164:167], v[212:215]
  ds_read_b64_tr_b16 v[42:43], v1 offset:33544
  v_add_u32 v17, 2, v30
  v_mfma_f32_16x16x32_bf16 v[216:219], v[44:47], a[168:171], v[216:219]
  buffer_store_dword v17, v16, s[20:23], 0 offen sc1
  v_mfma_f32_16x16x32_bf16 v[220:223], v[44:47], a[172:175], v[220:223]
  s_waitcnt lgkmcnt(4)
  v_and_b32 v21, s44, v21
  v_mul_f32 v29, v29, v122
  v_mfma_f32_16x16x32_bf16 v[224:227], v[32:35], a[160:163], v[224:227]
  ds_read_b64_tr_b16 v[44:45], v2 offset:33024
  v_mul_f32 v21, v21, v123
  v_mfma_f32_16x16x32_bf16 v[228:231], v[32:35], a[164:167], v[228:231]
  ds_read_b64_tr_b16 v[46:47], v2 offset:33536
  v_cvt_pk_bf16_f32 v21, v29, v21
  v_mfma_f32_16x16x32_bf16 v[232:235], v[32:35], a[168:171], v[232:235]
  buffer_load_dwordx4 v6, s[8:11], s50 offen lds
  v_mfma_f32_16x16x32_bf16 v[236:239], v[32:35], a[172:175], v[236:239]
  s_waitcnt lgkmcnt(4)
  s_lshr_b32 s51, 0x18171615, s37
  s_and_b32 s51, s51, 0xff
  v_mfma_f32_16x16x32_bf16 v[176:179], v[36:39], a[176:179], v[176:179]
  ds_read_b64_tr_b16 v[32:33], v2 offset:33032
  s_mul_i32 s51, s51, 53248
  v_mfma_f32_16x16x32_bf16 v[180:183], v[36:39], a[180:183], v[180:183]
  ds_read_b64_tr_b16 v[34:35], v2 offset:33544
  s_add_u32 s51, s51, s38
  v_mfma_f32_16x16x32_bf16 v[184:187], v[36:39], a[184:187], v[184:187]
  v_lshlrev_b32 v28, 16, v22
  v_and_b32 v22, s44, v22
  v_mfma_f32_16x16x32_bf16 v[188:191], v[36:39], a[188:191], v[188:191]
  s_waitcnt lgkmcnt(4)
  v_mul_f32 v28, v28, v136
  v_mul_f32 v22, v22, v137
  v_mfma_f32_16x16x32_bf16 v[192:195], v[40:43], a[176:179], v[192:195]
  ds_read_b64_tr_b16 v[36:37], v1 offset:37152
  v_cvt_pk_bf16_f32 v22, v28, v22
  v_mfma_f32_16x16x32_bf16 v[196:199], v[40:43], a[180:183], v[196:199]
  ds_read_b64_tr_b16 v[38:39], v1 offset:37664
  s_add_u32 m0, s39, 24704
  v_mfma_f32_16x16x32_bf16 v[200:203], v[40:43], a[184:187], v[200:203]
  buffer_load_dwordx4 v6, s[8:11], s51 offen lds
  v_mfma_f32_16x16x32_bf16 v[204:207], v[40:43], a[188:191], v[204:207]
  s_waitcnt lgkmcnt(4)
  v_lshlrev_b32 v29, 16, v23
  v_and_b32 v23, s44, v23
  v_mfma_f32_16x16x32_bf16 v[208:211], v[44:47], a[176:179], v[208:211]
  ds_read_b64_tr_b16 v[40:41], v1 offset:37160
  v_mul_f32 v29, v29, v138
  v_mfma_f32_16x16x32_bf16 v[212:215], v[44:47], a[180:183], v[212:215]
  ds_read_b64_tr_b16 v[42:43], v1 offset:37672
  v_mul_f32 v23, v23, v139
  v_mfma_f32_16x16x32_bf16 v[216:219], v[44:47], a[184:187], v[216:219]
  v_cvt_pk_bf16_f32 v23, v29, v23
  v_lshlrev_b32 v28, 16, v24
  v_mfma_f32_16x16x32_bf16 v[220:223], v[44:47], a[188:191], v[220:223]
  s_waitcnt lgkmcnt(4)
  v_and_b32 v24, s44, v24
  v_mul_f32 v28, v28, v124
  v_mfma_f32_16x16x32_bf16 v[224:227], v[32:35], a[176:179], v[224:227]
  ds_read_b64_tr_b16 v[44:45], v2 offset:37152
  v_mul_f32 v24, v24, v125
  v_mfma_f32_16x16x32_bf16 v[228:231], v[32:35], a[180:183], v[228:231]
  ds_read_b64_tr_b16 v[46:47], v2 offset:37664
  v_cvt_pk_bf16_f32 v24, v28, v24
  v_mfma_f32_16x16x32_bf16 v[232:235], v[32:35], a[184:187], v[232:235]
  buffer_store_dwordx4 v[20:23], v11, s[20:23], s77 offen offset:2048 sc1
  v_mfma_f32_16x16x32_bf16 v[236:239], v[32:35], a[188:191], v[236:239]
  s_waitcnt lgkmcnt(4)
  ds_read_b128 v[20:23], v9 offset:16384
  v_mfma_f32_16x16x32_bf16 v[176:179], v[36:39], a[192:195], v[176:179]
  ds_read_b64_tr_b16 v[32:33], v2 offset:37160
  s_add_u32 s84, s42, 8192
  v_mfma_f32_16x16x32_bf16 v[180:183], v[36:39], a[196:199], v[180:183]
  ds_read_b64_tr_b16 v[34:35], v2 offset:37672
  v_lshlrev_b32 v29, 16, v25
  v_mfma_f32_16x16x32_bf16 v[184:187], v[36:39], a[200:203], v[184:187]
  v_and_b32 v25, s44, v25
  v_mul_f32 v29, v29, v126
  v_mfma_f32_16x16x32_bf16 v[188:191], v[36:39], a[204:207], v[188:191]
  s_waitcnt lgkmcnt(5)
  v_mul_f32 v25, v25, v127
  v_cvt_pk_bf16_f32 v25, v29, v25
  v_mfma_f32_16x16x32_bf16 v[192:195], v[40:43], a[192:195], v[192:195]
  ds_read_b64_tr_b16 v[36:37], v1 offset:41280
  v_lshlrev_b32 v28, 16, v26
  v_mfma_f32_16x16x32_bf16 v[196:199], v[40:43], a[196:199], v[196:199]
  ds_read_b64_tr_b16 v[38:39], v1 offset:41792
  v_and_b32 v26, s44, v26
  v_mfma_f32_16x16x32_bf16 v[200:203], v[40:43], a[200:203], v[200:203]
  v_mul_f32 v28, v28, v140
  v_mul_f32 v26, v26, v141
  v_mfma_f32_16x16x32_bf16 v[204:207], v[40:43], a[204:207], v[204:207]
  s_waitcnt lgkmcnt(5)
  v_cvt_pk_bf16_f32 v26, v28, v26
  v_lshlrev_b32 v29, 16, v27
  v_mfma_f32_16x16x32_bf16 v[208:211], v[44:47], a[192:195], v[208:211]
  ds_read_b64_tr_b16 v[40:41], v1 offset:41288
  v_and_b32 v27, s44, v27
  v_mfma_f32_16x16x32_bf16 v[212:215], v[44:47], a[196:199], v[212:215]
  ds_read_b64_tr_b16 v[42:43], v1 offset:41800
  v_mul_f32 v29, v29, v142
  v_mfma_f32_16x16x32_bf16 v[216:219], v[44:47], a[200:203], v[216:219]
  v_mul_f32 v27, v27, v143
  v_cvt_pk_bf16_f32 v27, v29, v27
  v_mfma_f32_16x16x32_bf16 v[220:223], v[44:47], a[204:207], v[220:223]
  s_waitcnt lgkmcnt(4)
  v_lshlrev_b32 v28, 16, v20
  v_and_b32 v20, s44, v20
  v_mfma_f32_16x16x32_bf16 v[224:227], v[32:35], a[192:195], v[224:227]
  ds_read_b64_tr_b16 v[44:45], v2 offset:41280
  v_mul_f32 v28, v28, v144
  v_mfma_f32_16x16x32_bf16 v[228:231], v[32:35], a[196:199], v[228:231]
  ds_read_b64_tr_b16 v[46:47], v2 offset:41792
  s_waitcnt lgkmcnt(4)
  v_mfma_f32_16x16x32_bf16 v[232:235], v[32:35], a[200:203], v[232:235]
  s_barrier
  s_lshr_b32 s50, 0x19191919, s37
  s_and_b32 s50, s50, 0xff
  v_mfma_f32_16x16x32_bf16 v[236:239], v[32:35], a[204:207], v[236:239]
  buffer_store_dwordx4 v[24:27], v11, s[20:23], s84 offen offset:3072 sc1
  v_mfma_f32_16x16x32_bf16 v[176:179], v[36:39], a[0:3], v[176:179]
  ds_read_b64_tr_b16 v[32:33], v2 offset:41288
  s_mul_i32 s50, s50, 53248
  v_mfma_f32_16x16x32_bf16 v[180:183], v[36:39], a[4:7], v[180:183]
  ds_read_b64_tr_b16 v[34:35], v2 offset:41800
  s_add_u32 s50, s50, s38
  v_mfma_f32_16x16x32_bf16 v[184:187], v[36:39], a[8:11], v[184:187]
  buffer_load_dword v19, v18, s[20:23], 0 offen sc1
  v_mul_f32 v20, v20, v145
  v_mfma_f32_16x16x32_bf16 v[188:191], v[36:39], a[12:15], v[188:191]
  s_waitcnt lgkmcnt(4)
  s_add_u32 m0, s39, 28800
  v_cvt_pk_bf16_f32 v20, v28, v20
  v_mfma_f32_16x16x32_bf16 v[192:195], v[40:43], a[0:3], v[192:195]
  ds_read_b64_tr_b16 v[36:37], v1 offset:45408
  v_lshlrev_b32 v29, 16, v21
  v_mfma_f32_16x16x32_bf16 v[196:199], v[40:43], a[4:7], v[196:199]
  ds_read_b64_tr_b16 v[38:39], v1 offset:45920
  v_and_b32 v21, s44, v21
  v_mfma_f32_16x16x32_bf16 v[200:203], v[40:43], a[8:11], v[200:203]
  buffer_load_dwordx4 v6, s[8:11], s50 offen lds
  v_mfma_f32_16x16x32_bf16 v[204:207], v[40:43], a[12:15], v[204:207]
  s_waitcnt lgkmcnt(4)
  s_add_u32 s51, s35, 1384448
  v_mul_f32 v29, v29, v146
  v_mfma_f32_16x16x32_bf16 v[208:211], v[44:47], a[0:3], v[208:211]
  ds_read_b64_tr_b16 v[40:41], v1 offset:45416
  v_mul_f32 v21, v21, v147
  v_mfma_f32_16x16x32_bf16 v[212:215], v[44:47], a[4:7], v[212:215]
  ds_read_b64_tr_b16 v[42:43], v1 offset:45928
  v_cvt_pk_bf16_f32 v21, v29, v21
  v_mfma_f32_16x16x32_bf16 v[216:219], v[44:47], a[8:11], v[216:219]
  ds_read_b128 v[24:27], v9 offset:18432
  s_add_u32 s77, s42, 12288
  v_mfma_f32_16x16x32_bf16 v[220:223], v[44:47], a[12:15], v[220:223]
  s_waitcnt lgkmcnt(5)
  v_lshlrev_b32 v28, 16, v22
  v_and_b32 v22, s44, v22
  v_mfma_f32_16x16x32_bf16 v[224:227], v[32:35], a[0:3], v[224:227]
  ds_read_b64_tr_b16 v[44:45], v2 offset:45408
  v_mul_f32 v28, v28, v160
  v_mfma_f32_16x16x32_bf16 v[228:231], v[32:35], a[4:7], v[228:231]
  ds_read_b64_tr_b16 v[46:47], v2 offset:45920
  v_mul_f32 v22, v22, v161
  v_mfma_f32_16x16x32_bf16 v[232:235], v[32:35], a[8:11], v[232:235]
  v_cvt_pk_bf16_f32 v22, v28, v22
  v_lshlrev_b32 v29, 16, v23
  v_mfma_f32_16x16x32_bf16 v[236:239], v[32:35], a[12:15], v[236:239]
  s_waitcnt lgkmcnt(5)
  v_and_b32 v23, s44, v23
  v_mul_f32 v29, v29, v162
  v_mfma_f32_16x16x32_bf16 v[176:179], v[36:39], a[16:19], v[176:179]
  ds_read_b64_tr_b16 v[32:33], v2 offset:45416
  v_mul_f32 v23, v23, v163
  v_mfma_f32_16x16x32_bf16 v[180:183], v[36:39], a[20:23], v[180:183]
  ds_read_b64_tr_b16 v[34:35], v2 offset:45928
  v_cvt_pk_bf16_f32 v23, v29, v23
  v_mfma_f32_16x16x32_bf16 v[184:187], v[36:39], a[24:27], v[184:187]
  buffer_store_dwordx4 v[20:23], v11, s[20:23], s77 offen offset:0 sc1
  v_mfma_f32_16x16x32_bf16 v[188:191], v[36:39], a[28:31], v[188:191]
  s_waitcnt lgkmcnt(5)
  ds_read_b128 v[20:23], v9 offset:20480
  v_mfma_f32_16x16x32_bf16 v[192:195], v[40:43], a[16:19], v[192:195]
  ds_read_b64_tr_b16 v[36:37], v1 offset:49536
  s_add_u32 s84, s42, 12288
  v_mfma_f32_16x16x32_bf16 v[196:199], v[40:43], a[20:23], v[196:199]
  ds_read_b64_tr_b16 v[38:39], v1 offset:50048
  s_waitcnt lgkmcnt(7)
  v_mfma_f32_16x16x32_bf16 v[200:203], v[40:43], a[24:27], v[200:203]
  v_lshlrev_b32 v28, 16, v24
  v_and_b32 v24, s44, v24
  v_mfma_f32_16x16x32_bf16 v[204:207], v[40:43], a[28:31], v[204:207]
  s_waitcnt lgkmcnt(5)
  v_mul_f32 v28, v28, v148
  v_mul_f32 v24, v24, v149
  v_mfma_f32_16x16x32_bf16 v[208:211], v[44:47], a[16:19], v[208:211]
  ds_read_b64_tr_b16 v[40:41], v1 offset:49544
  s_add_u32 m0, s36, 32896
  v_mfma_f32_16x16x32_bf16 v[212:215], v[44:47], a[20:23], v[212:215]
  ds_read_b64_tr_b16 v[42:43], v1 offset:50056
  v_cvt_pk_bf16_f32 v24, v28, v24
  v_mfma_f32_16x16x32_bf16 v[216:219], v[44:47], a[24:27], v[216:219]
  buffer_load_dwordx4 v4, s[8:11], s51 offen lds
  v_mfma_f32_16x16x32_bf16 v[220:223], v[44:47], a[28:31], v[220:223]
  s_waitcnt lgkmcnt(5)
  s_add_u32 s50, s35, 1703936
  v_lshlrev_b32 v29, 16, v25
  v_mfma_f32_16x16x32_bf16 v[224:227], v[32:35], a[16:19], v[224:227]
  ds_read_b64_tr_b16 v[44:45], v2 offset:49536
  v_and_b32 v25, s44, v25
  v_mfma_f32_16x16x32_bf16 v[228:231], v[32:35], a[20:23], v[228:231]
  ds_read_b64_tr_b16 v[46:47], v2 offset:50048
  s_add_u32 m0, s36, 37024
  v_mfma_f32_16x16x32_bf16 v[232:235], v[32:35], a[24:27], v[232:235]
  buffer_load_dwordx4 v4, s[8:11], s50 offen lds
  v_mfma_f32_16x16x32_bf16 v[236:239], v[32:35], a[28:31], v[236:239]
  s_waitcnt lgkmcnt(4)
  v_mul_f32 v29, v29, v150
  v_mul_f32 v25, v25, v151
  v_mfma_f32_16x16x32_bf16 v[176:179], v[36:39], a[32:35], v[176:179]
  ds_read_b64_tr_b16 v[32:33], v2 offset:49544
  v_cvt_pk_bf16_f32 v25, v29, v25
  v_mfma_f32_16x16x32_bf16 v[180:183], v[36:39], a[36:39], v[180:183]
  ds_read_b64_tr_b16 v[34:35], v2 offset:50056
  v_lshlrev_b32 v28, 16, v26
  v_mfma_f32_16x16x32_bf16 v[184:187], v[36:39], a[40:43], v[184:187]
  v_and_b32 v26, s44, v26
  v_mul_f32 v28, v28, v164
  v_mfma_f32_16x16x32_bf16 v[188:191], v[36:39], a[44:47], v[188:191]
  s_waitcnt lgkmcnt(4)
  v_mul_f32 v26, v26, v165
  v_cvt_pk_bf16_f32 v26, v28, v26
  v_mfma_f32_16x16x32_bf16 v[192:195], v[40:43], a[32:35], v[192:195]
  ds_read_b64_tr_b16 v[36:37], v1 offset:0
  v_lshlrev_b32 v29, 16, v27
  v_mfma_f32_16x16x32_bf16 v[196:199], v[40:43], a[36:39], v[196:199]
  ds_read_b64_tr_b16 v[38:39], v1 offset:512
  v_and_b32 v27, s44, v27
  v_mfma_f32_16x16x32_bf16 v[200:203], v[40:43], a[40:43], v[200:203]
  v_mul_f32 v29, v29, v166
  v_mul_f32 v27, v27, v167
  v_mfma_f32_16x16x32_bf16 v[204:207], v[40:43], a[44:47], v[204:207]
  s_waitcnt lgkmcnt(4)
  v_cvt_pk_bf16_f32 v27, v29, v27
  v_lshlrev_b32 v28, 16, v20
  v_mfma_f32_16x16x32_bf16 v[208:211], v[44:47], a[32:35], v[208:211]
  ds_read_b64_tr_b16 v[40:41], v1 offset:8
  s_waitcnt vmcnt(4)
  v_mfma_f32_16x16x32_bf16 v[212:215], v[44:47], a[36:39], v[212:215]
  ds_read_b64_tr_b16 v[42:43], v1 offset:520
  v_sub_u32 v19, v19, v30
  v_mfma_f32_16x16x32_bf16 v[216:219], v[44:47], a[40:43], v[216:219]
  buffer_store_dwordx4 v[24:27], v11, s[20:23], s84 offen offset:1024 sc1
  v_mfma_f32_16x16x32_bf16 v[220:223], v[44:47], a[44:47], v[220:223]
  s_waitcnt lgkmcnt(4)
  v_cmp_gt_u32 vcc, 1, v19
  s_nop 0
  v_mfma_f32_16x16x32_bf16 v[224:227], v[32:35], a[32:35], v[224:227]
  ds_read_b64_tr_b16 v[44:45], v2 offset:0
  s_cbranch_vccnz Lslow1
Lback1:
  v_mfma_f32_16x16x32_bf16 v[228:231], v[32:35], a[36:39], v[228:231]
  ds_read_b64_tr_b16 v[46:47], v2 offset:512
  s_waitcnt lgkmcnt(4)
  v_mfma_f32_16x16x32_bf16 v[232:235], v[32:35], a[40:43], v[232:235]
  s_barrier
  s_add_u32 s51, s35, 2023424
  s_add_u32 m0, s36, 41152
  v_mfma_f32_16x16x32_bf16 v[236:239], v[32:35], a[44:47], v[236:239]
  buffer_load_dwordx4 v4, s[8:11], s51 offen lds
  v_mfma_f32_16x16x32_bf16 v[176:179], v[36:39], a[48:51], v[176:179]
  ds_read_b64_tr_b16 v[32:33], v2 offset:8
  s_add_u32 s50, s35, 1384576
  v_mfma_f32_16x16x32_bf16 v[180:183], v[36:39], a[52:55], v[180:183]
  ds_read_b64_tr_b16 v[34:35], v2 offset:520
  s_add_u32 m0, s36, 45280
  v_mfma_f32_16x16x32_bf16 v[184:187], v[36:39], a[56:59], v[184:187]
  buffer_load_dwordx4 v4, s[8:11], s50 offen lds
  v_mfma_f32_16x16x32_bf16 v[188:191], v[36:39], a[60:63], v[188:191]
  s_waitcnt lgkmcnt(4)
  s_add_u32 s51, s35, 1704064
  s_add_u32 m0, s36, 49408
  v_mfma_f32_16x16x32_bf16 v[192:195], v[40:43], a[48:51], v[192:195]
  ds_read_b64_tr_b16 v[36:37], v1 offset:4128
  s_add_u32 s57, s40, 0
  v_mfma_f32_16x16x32_bf16 v[196:199], v[40:43], a[52:55], v[196:199]
  ds_read_b64_tr_b16 v[38:39], v1 offset:4640
  v_and_b32 v20, s44, v20
  v_mfma_f32_16x16x32_bf16 v[200:203], v[40:43], a[56:59], v[200:203]
  buffer_load_dwordx4 a[208:211], v11, s[20:23], s57 offen offset:0 sc1
  v_mul_f32 v28, v28, v152
  v_mfma_f32_16x16x32_bf16 v[204:207], v[40:43], a[60:63], v[204:207]
  s_waitcnt lgkmcnt(4)
  ds_read_b128 v[24:27], v9 offset:22528
  v_mfma_f32_16x16x32_bf16 v[208:211], v[44:47], a[48:51], v[208:211]
  ds_read_b64_tr_b16 v[40:41], v1 offset:4136
  s_add_u32 s77, s42, 12288
  v_mfma_f32_16x16x32_bf16 v[212:215], v[44:47], a[52:55], v[212:215]
  ds_read_b64_tr_b16 v[42:43], v1 offset:4648
  v_mul_f32 v20, v20, v153
  v_mfma_f32_16x16x32_bf16 v[216:219], v[44:47], a[56:59], v[216:219]
  buffer_load_dwordx4 a[212:215], v11, s[20:23], s57 offen offset:1024 sc1
  v_cvt_pk_bf16_f32 v20, v28, v20
  v_mfma_f32_16x16x32_bf16 v[220:223], v[44:47], a[60:63], v[220:223]
  s_waitcnt lgkmcnt(5)
  v_lshlrev_b32 v29, 16, v21
  v_and_b32 v21, s44, v21
  v_mfma_f32_16x16x32_bf16 v[224:227], v[32:35], a[48:51], v[224:227]
  ds_read_b64_tr_b16 v[44:45], v2 offset:4128
  v_mul_f32 v29, v29, v154
  v_mfma_f32_16x16x32_bf16 v[228:231], v[32:35], a[52:55], v[228:231]
  ds_read_b64_tr_b16 v[46:47], v2 offset:4640
  v_mul_f32 v21, v21, v155
  v_mfma_f32_16x16x32_bf16 v[232:235], v[32:35], a[56:59], v[232:235]
  buffer_load_dwordx4 a[216:219], v11, s[20:23], s57 offen offset:2048 sc1
  v_cvt_pk_bf16_f32 v21, v29, v21
  v_mfma_f32_16x16x32_bf16 v[236:239], v[32:35], a[60:63], v[236:239]
  s_waitcnt lgkmcnt(5)
  v_lshlrev_b32 v28, 16, v22
  v_and_b32 v22, s44, v22
  v_mfma_f32_16x16x32_bf16 v[176:179], v[36:39], a[64:67], v[176:179]
  ds_read_b64_tr_b16 v[32:33], v2 offset:4136
  v_mul_f32 v28, v28, v168
  v_mfma_f32_16x16x32_bf16 v[180:183], v[36:39], a[68:71], v[180:183]
  ds_read_b64_tr_b16 v[34:35], v2 offset:4648
  v_mul_f32 v22, v22, v169
  v_mfma_f32_16x16x32_bf16 v[184:187], v[36:39], a[72:75], v[184:187]
  buffer_load_dwordx4 a[220:223], v11, s[20:23], s57 offen offset:3072 sc1
  v_cvt_pk_bf16_f32 v22, v28, v22
  v_mfma_f32_16x16x32_bf16 v[188:191], v[36:39], a[76:79], v[188:191]
  s_waitcnt lgkmcnt(4)
  s_add_u32 s57, s40, 24576
  v_lshlrev_b32 v29, 16, v23
  v_mfma_f32_16x16x32_bf16 v[192:195], v[40:43], a[64:67], v[192:195]
  ds_read_b64_tr_b16 v[36:37], v1 offset:8256
  v_and_b32 v23, s44, v23
  v_mfma_f32_16x16x32_bf16 v[196:199], v[40:43], a[68:71], v[196:199]
  ds_read_b64_tr_b16 v[38:39], v1 offset:8768
  v_mul_f32 v29, v29, v170
  v_mfma_f32_16x16x32_bf16 v[200:203], v[40:43], a[72:75], v[200:203]
  buffer_load_dwordx4 v4, s[8:11], s51 offen lds
  v_mfma_f32_16x16x32_bf16 v[204:207], v[40:43], a[76:79], v[204:207]
  s_waitcnt lgkmcnt(4)
  v_mul_f32 v23, v23, v171
  v_cvt_pk_bf16_f32 v23, v29, v23
  v_mfma_f32_16x16x32_bf16 v[208:211], v[44:47], a[64:67], v[208:211]
  ds_read_b64_tr_b16 v[40:41], v1 offset:8264
  v_lshlrev_b32 v28, 16, v24
  v_mfma_f32_16x16x32_bf16 v[212:215], v[44:47], a[68:71], v[212:215]
  ds_read_b64_tr_b16 v[42:43], v1 offset:8776
  v_and_b32 v24, s44, v24
  v_mfma_f32_16x16x32_bf16 v[216:219], v[44:47], a[72:75], v[216:219]
  buffer_store_dwordx4 v[20:23], v11, s[20:23], s77 offen offset:2048 sc1
  v_mfma_f32_16x16x32_bf16 v[220:223], v[44:47], a[76:79], v[220:223]
  s_waitcnt lgkmcnt(4)
  s_add_u32 s84, s42, 12288
  v_mul_f32 v28, v28, v156
  v_mfma_f32_16x16x32_bf16 v[224:227], v[32:35], a[64:67], v[224:227]
  ds_read_b64_tr_b16 v[44:45], v2 offset:8256
  v_mul_f32 v24, v24, v157
  v_mfma_f32_16x16x32_bf16 v[228:231], v[32:35], a[68:71], v[228:231]
  ds_read_b64_tr_b16 v[46:47], v2 offset:8768
  v_cvt_pk_bf16_f32 v24, v28, v24
  v_mfma_f32_16x16x32_bf16 v[232:235], v[32:35], a[72:75], v[232:235]
  buffer_load_dwordx4 a[224:227], v11, s[20:23], s57 offen offset:0 sc1
  v_lshlrev_b32 v29, 16, v25
  v_mfma_f32_16x16x32_bf16 v[236:239], v[32:35], a[76:79], v[236:239]
  s_waitcnt lgkmcnt(4)
  v_and_b32 v25, s44, v25
  v_mul_f32 v29, v29, v158
  v_mfma_f32_16x16x32_bf16 v[176:179], v[36:39], a[80:83], v[176:179]
  ds_read_b64_tr_b16 v[32:33], v2 offset:8264
  v_mul_f32 v25, v25, v159
  v_mfma_f32_16x16x32_bf16 v[180:183], v[36:39], a[84:87], v[180:183]
  ds_read_b64_tr_b16 v[34:35], v2 offset:8776
  v_cvt_pk_bf16_f32 v25, v29, v25
  v_mfma_f32_16x16x32_bf16 v[184:187], v[36:39], a[88:91], v[184:187]
  buffer_load_dwordx4 a[228:231], v11, s[20:23], s57 offen offset:1024 sc1
  v_lshlrev_b32 v28, 16, v26
  v_mfma_f32_16x16x32_bf16 v[188:191], v[36:39], a[92:95], v[188:191]
  s_waitcnt lgkmcnt(4)
  v_and_b32 v26, s44, v26
  v_mul_f32 v28, v28, v172
  v_mfma_f32_16x16x32_bf16 v[192:195], v[40:43], a[80:83], v[192:195]
  ds_read_b64_tr_b16 v[36:37], v1 offset:12384
  v_mul_f32 v26, v26, v173
  v_mfma_f32_16x16x32_bf16 v[196:199], v[40:43], a[84:87], v[196:199]
  ds_read_b64_tr_b16 v[38:39], v1 offset:12896
  v_cvt_pk_bf16_f32 v26, v28, v26
  v_mfma_f32_16x16x32_bf16 v[200:203], v[40:43], a[88:91], v[200:203]
  buffer_load_dwordx4 a[232:235], v11, s[20:23], s57 offen offset:2048 sc1
  v_lshlrev_b32 v29, 16, v27
  v_mfma_f32_16x16x32_bf16 v[204:207], v[40:43], a[92:95], v[204:207]
  s_waitcnt lgkmcnt(4)
  v_and_b32 v27, s44, v27
  v_mul_f32 v29, v29, v174
  v_mfma_f32_16x16x32_bf16 v[208:211], v[44:47], a[80:83], v[208:211]
  ds_read_b64_tr_b16 v[40:41], v1 offset:12392
  v_mul_f32 v27, v27, v175
  v_mfma_f32_16x16x32_bf16 v[212:215], v[44:47], a[84:87], v[212:215]
  ds_read_b64_tr_b16 v[42:43], v1 offset:12904
  v_cvt_pk_bf16_f32 v27, v29, v27
  v_mfma_f32_16x16x32_bf16 v[216:219], v[44:47], a[88:91], v[216:219]
  buffer_store_dwordx4 v[24:27], v11, s[20:23], s84 offen offset:3072 sc1
  v_mfma_f32_16x16x32_bf16 v[220:223], v[44:47], a[92:95], v[220:223]
  s_waitcnt lgkmcnt(4)
  v_mfma_f32_16x16x32_bf16 v[224:227], v[32:35], a[80:83], v[224:227]
  ds_read_b64_tr_b16 v[44:45], v2 offset:12384
  v_mfma_f32_16x16x32_bf16 v[228:231], v[32:35], a[84:87], v[228:231]
  ds_read_b64_tr_b16 v[46:47], v2 offset:12896
  s_waitcnt lgkmcnt(4)
  v_mfma_f32_16x16x32_bf16 v[232:235], v[32:35], a[88:91], v[232:235]
  s_barrier
  s_add_u32 s50, s35, 2023552
  s_add_u32 m0, s36, 0
  v_mfma_f32_16x16x32_bf16 v[236:239], v[32:35], a[92:95], v[236:239]
  buffer_load_dwordx4 a[236:239], v11, s[20:23], s57 offen offset:3072 sc1
  v_mfma_f32_16x16x32_bf16 v[176:179], v[36:39], a[96:99], v[176:179]
  ds_read_b64_tr_b16 v[32:33], v2 offset:12392
  s_add_u32 s57, s40, 49152
  v_mfma_f32_16x16x32_bf16 v[180:183], v[36:39], a[100:103], v[180:183]
  ds_read_b64_tr_b16 v[34:35], v2 offset:12904
  s_waitcnt lgkmcnt(4)
  v_mfma_f32_16x16x32_bf16 v[184:187], v[36:39], a[104:107], v[184:187]
  buffer_load_dwordx4 a[240:243], v11, s[20:23], s57 offen offset:0 sc1
  v_mfma_f32_16x16x32_bf16 v[188:191], v[36:39], a[108:111], v[188:191]
  v_mfma_f32_16x16x32_bf16 v[192:195], v[40:43], a[96:99], v[192:195]
  ds_read_b64_tr_b16 v[36:37], v3 offset:16512
  v_mfma_f32_16x16x32_bf16 v[196:199], v[40:43], a[100:103], v[196:199]
  ds_read_b64_tr_b16 v[38:39], v3 offset:16768
  s_waitcnt lgkmcnt(4)
  v_mfma_f32_16x16x32_bf16 v[200:203], v[40:43], a[104:107], v[200:203]
  buffer_load_dwordx4 a[244:247], v11, s[20:23], s57 offen offset:1024 sc1
  v_mfma_f32_16x16x32_bf16 v[204:207], v[40:43], a[108:111], v[204:207]
  v_mfma_f32_16x16x32_bf16 v[208:211], v[44:47], a[96:99], v[208:211]
  ds_read_b64_tr_b16 v[40:41], v3 offset:17536
  v_mfma_f32_16x16x32_bf16 v[212:215], v[44:47], a[100:103], v[212:215]
  ds_read_b64_tr_b16 v[42:43], v3 offset:17792
  s_waitcnt lgkmcnt(4)
  v_mfma_f32_16x16x32_bf16 v[216:219], v[44:47], a[104:107], v[216:219]
  buffer_load_dwordx4 a[248:251], v11, s[20:23], s57 offen offset:2048 sc1
  v_mfma_f32_16x16x32_bf16 v[220:223], v[44:47], a[108:111], v[220:223]
  v_mfma_f32_16x16x32_bf16 v[224:227], v[32:35], a[96:99], v[224:227]
  ds_read_b64_tr_b16 v[44:45], v3 offset:18560
  v_mfma_f32_16x16x32_bf16 v[228:231], v[32:35], a[100:103], v[228:231]
  ds_read_b64_tr_b16 v[46:47], v3 offset:18816
  s_waitcnt lgkmcnt(4)
  v_mfma_f32_16x16x32_bf16 v[232:235], v[32:35], a[104:107], v[232:235]
  ds_read_b128 v[20:23], v8 offset:0
  v_mfma_f32_16x16x32_bf16 v[236:239], v[32:35], a[108:111], v[236:239]
  buffer_load_dwordx4 a[252:255], v11, s[20:23], s57 offen offset:3072 sc1
  v_mfma_f32_16x16x32_bf16 v[240:243], v[36:39], a[112:115], v[240:243]
  ds_read_b64_tr_b16 v[32:33], v3 offset:19584
  v_mfma_f32_16x16x32_bf16 v[244:247], v[36:39], a[116:119], v[244:247]
  ds_read_b64_tr_b16 v[34:35], v3 offset:19840
  s_waitcnt lgkmcnt(5)
  v_mfma_f32_16x16x32_bf16 v[248:251], v[36:39], a[120:123], v[248:251]
  ds_read_b128 v[24:27], v8 offset:2048
  s_add_u32 s77, s42, 16384
  v_mfma_f32_16x16x32_bf16 v[252:255], v[36:39], a[124:127], v[252:255]
  buffer_load_dword v19, v18, s[20:23], 0 offen sc1
  v_mfma_f32_16x16x32_bf16 v[240:243], v[40:43], a[128:131], v[240:243]
  ds_read_b64_tr_b16 v[36:37], v3 offset:20608
  s_add_u32 s57, s40, 73728
  v_mfma_f32_16x16x32_bf16 v[244:247], v[40:43], a[132:135], v[244:247]
  ds_read_b64_tr_b16 v[38:39], v3 offset:20864
  s_waitcnt lgkmcnt(5)
  v_mfma_f32_16x16x32_bf16 v[248:251], v[40:43], a[136:139], v[248:251]
  buffer_load_dwordx4 v4, s[8:11], s50 offen lds
  v_mfma_f32_16x16x32_bf16 v[252:255], v[40:43], a[140:143], v[252:255]
  s_add_u32 s51, s35, 2342912
  v_lshlrev_b32 v28, 16, v20
  v_and_b32 v20, s44, v20
  v_mfma_f32_16x16x32_bf16 v[240:243], v[44:47], a[144:147], v[240:243]
  ds_read_b64_tr_b16 v[40:41], v3 offset:21632
  v_mul_f32 v28, v28, v176
  v_mfma_f32_16x16x32_bf16 v[244:247], v[44:47], a[148:151], v[244:247]
  ds_read_b64_tr_b16 v[42:43], v3 offset:21888
  s_add_u32 m0, s36, 4128
  v_mfma_f32_16x16x32_bf16 v[248:251], v[44:47], a[152:155], v[248:251]
  buffer_load_dwordx4 v4, s[8:11], s51 offen lds
  v_mfma_f32_16x16x32_bf16 v[252:255], v[44:47], a[156:159], v[252:255]
  s_waitcnt lgkmcnt(5)
  s_add_u32 s50, s35, 1437696
  v_mul_f32 v20, v20, v177
  v_mfma_f32_16x16x32_bf16 v[240:243], v[32:35], a[160:163], v[240:243]
  ds_read_b64_tr_b16 v[44:45], v3 offset:22656
  v_cvt_pk_bf16_f32 v20, v28, v20
  v_mfma_f32_16x16x32_bf16 v[244:247], v[32:35], a[164:167], v[244:247]
  ds_read_b64_tr_b16 v[46:47], v3 offset:22912
  v_lshlrev_b32 v29, 16, v21
  v_mfma_f32_16x16x32_bf16 v[248:251], v[32:35], a[168:171], v[248:251]
  s_add_u32 m0, s36, 8256
  v_and_b32 v21, s44, v21
  v_mul_f32 v29, v29, v178
  v_mfma_f32_16x16x32_bf16 v[252:255], v[32:35], a[172:175], v[252:255]
  s_waitcnt lgkmcnt(4)
  v_mul_f32 v21, v21, v179
  v_cvt_pk_bf16_f32 v21, v29, v21
  v_mfma_f32_16x16x32_bf16 v[240:243], v[36:39], a[176:179], v[240:243]
  ds_read_b64_tr_b16 v[32:33], v3 offset:23680
  v_lshlrev_b32 v28, 16, v22
  v_mfma_f32_16x16x32_bf16 v[244:247], v[36:39], a[180:183], v[244:247]
  ds_read_b64_tr_b16 v[34:35], v3 offset:23936
  v_and_b32 v22, s44, v22
  v_mfma_f32_16x16x32_bf16 v[248:251], v[36:39], a[184:187], v[248:251]
  buffer_load_dwordx4 v4, s[8:11], s50 offen lds
  v_mfma_f32_16x16x32_bf16 v[252:255], v[36:39], a[188:191], v[252:255]
  s_waitcnt lgkmcnt(4)
  v_mul_f32 v28, v28, v192
  v_mul_f32 v22, v22, v193
  v_mfma_f32_16x16x32_bf16 v[240:243], v[40:43], a[192:195], v[240:243]
  ds_read_b64_tr_b16 v[36:37], v3 offset:24704
  s_add_u32 s54, s72, 32768
  v_mfma_f32_16x16x32_bf16 v[244:247], v[40:43], a[196:199], v[244:247]
  ds_read_b64_tr_b16 v[38:39], v3 offset:24960
  v_cvt_pk_bf16_f32 v22, v28, v22
  v_mfma_f32_16x16x32_bf16 v[248:251], v[40:43], a[200:203], v[248:251]
  buffer_load_dwordx4 a[112:115], v11, s[20:23], s57 offen offset:0 sc1
  v_lshlrev_b32 v29, 16, v23
  v_mfma_f32_16x16x32_bf16 v[252:255], v[40:43], a[204:207], v[252:255]
  s_waitcnt lgkmcnt(4)
  v_and_b32 v23, s44, v23
  v_mul_f32 v29, v29, v194
  v_mfma_f32_16x16x32_bf16 v[240:243], v[44:47], a[0:3], v[240:243]
  ds_read_b64_tr_b16 v[40:41], v3 offset:25728
  v_mul_f32 v23, v23, v195
  v_mfma_f32_16x16x32_bf16 v[244:247], v[44:47], a[4:7], v[244:247]
  ds_read_b64_tr_b16 v[42:43], v3 offset:25984
  v_cvt_pk_bf16_f32 v23, v29, v23
  v_mfma_f32_16x16x32_bf16 v[248:251], v[44:47], a[8:11], v[248:251]
  buffer_store_dwordx4 v[20:23], v11, s[20:23], s77 offen offset:0 sc1
  v_mfma_f32_16x16x32_bf16 v[252:255], v[44:47], a[12:15], v[252:255]
  s_waitcnt lgkmcnt(4)
  ds_read_b128 v[20:23], v8 offset:4096
  v_mfma_f32_16x16x32_bf16 v[240:243], v[32:35], a[16:19], v[240:243]
  ds_read_b64_tr_b16 v[44:45], v3 offset:26752
  s_add_u32 s84, s42, 16384
  v_mfma_f32_16x16x32_bf16 v[244:247], v[32:35], a[20:23], v[244:247]
  ds_read_b64_tr_b16 v[46:47], v3 offset:27008
  s_waitcnt vmcnt(22) lgkmcnt(5)
  v_mfma_f32_16x16x32_bf16 v[248:251], v[32:35], a[24:27], v[248:251]
  s_barrier
  s_add_u32 s51, s35, 1757184
  s_add_u32 m0, s36, 12384
  v_mfma_f32_16x16x32_bf16 v[252:255], v[32:35], a[28:31], v[252:255]
  buffer_load_dwordx4 a[116:119], v11, s[20:23], s57 offen offset:1024 sc1
  v_lshlrev_b32 v28, 16, v24
  v_mfma_f32_16x16x32_bf16 v[240:243], v[36:39], a[32:35], v[240:243]
  ds_read_b64_tr_b16 v[32:33], v3 offset:27776
  v_and_b32 v24, s44, v24
  v_mfma_f32_16x16x32_bf16 v[244:247], v[36:39], a[36:39], v[244:247]
  ds_read_b64_tr_b16 v[34:35], v3 offset:28032
  v_mul_f32 v28, v28, v180
  v_mfma_f32_16x16x32_bf16 v[248:251], v[36:39], a[40:43], v[248:251]
  buffer_load_dwordx4 a[120:123], v11, s[20:23], s57 offen offset:2048 sc1
  v_mul_f32 v24, v24, v181
  v_mfma_f32_16x16x32_bf16 v[252:255], v[36:39], a[44:47], v[252:255]
  s_waitcnt lgkmcnt(5)
  v_cvt_pk_bf16_f32 v24, v28, v24
  v_lshlrev_b32 v29, 16, v25
  v_mfma_f32_16x16x32_bf16 v[240:243], v[40:43], a[48:51], v[240:243]
  ds_read_b64_tr_b16 v[36:37], v3 offset:28800
  v_and_b32 v25, s44, v25
  v_mfma_f32_16x16x32_bf16 v[244:247], v[40:43], a[52:55], v[244:247]
  ds_read_b64_tr_b16 v[38:39], v3 offset:29056
  v_mul_f32 v29, v29, v182
  v_mfma_f32_16x16x32_bf16 v[248:251], v[40:43], a[56:59], v[248:251]
  buffer_load_dwordx4 a[124:127], v11, s[20:23], s57 offen offset:3072 sc1
  v_mul_f32 v25, v25, v183
  v_mfma_f32_16x16x32_bf16 v[252:255], v[40:43], a[60:63], v[252:255]
  s_waitcnt lgkmcnt(4)
  v_cvt_pk_bf16_f32 v25, v29, v25
  v_lshlrev_b32 v28, 16, v26
  v_mfma_f32_16x16x32_bf16 v[240:243], v[44:47], a[64:67], v[240:243]
  ds_read_b64_tr_b16 v[40:41], v1 offset:32896
  s_waitcnt vmcnt(8)
  v_mfma_f32_16x16x32_bf16 v[244:247], v[44:47], a[68:71], v[244:247]
  ds_read_b64_tr_b16 v[42:43], v1 offset:33408
  v_add_u32 v17, 3, v30
  v_mfma_f32_16x16x32_bf16 v[248:251], v[44:47], a[72:75], v[248:251]
  buffer_store_dword v17, v16, s[20:23], 0 offen sc1
  v_mfma_f32_16x16x32_bf16 v[252:255], v[44:47], a[76:79], v[252:255]
  s_waitcnt lgkmcnt(4)
  v_sub_u32 v19, v19, v30
  v_cmp_gt_u32 vcc, 2, v19
  v_mfma_f32_16x16x32_bf16 v[240:243], v[32:35], a[80:83], v[240:243]
  ds_read_b64_tr_b16 v[44:45], v1 offset:32904
  s_nop 0
  v_mfma_f32_16x16x32_bf16 v[244:247], v[32:35], a[84:87], v[244:247]
  ds_read_b64_tr_b16 v[46:47], v1 offset:33416
  s_cbranch_vccnz Lslow2
Lback2:
  v_mfma_f32_16x16x32_bf16 v[248:251], v[32:35], a[88:91], v[248:251]
  buffer_load_dwordx4 v4, s[8:11], s51 offen lds
  v_mfma_f32_16x16x32_bf16 v[252:255], v[32:35], a[92:95], v[252:255]
  s_waitcnt lgkmcnt(4)
  s_add_u32 s50, s35, 2343040
  s_add_u32 m0, s36, 16512
  v_mfma_f32_16x16x32_bf16 v[240:243], v[36:39], a[96:99], v[240:243]
  ds_read_b64_tr_b16 v[32:33], v2 offset:32896
  s_add_u32 s56, s40, 4096
  v_mfma_f32_16x16x32_bf16 v[244:247], v[36:39], a[100:103], v[244:247]
  ds_read_b64_tr_b16 v[34:35], v2 offset:33408
  v_and_b32 v26, s44, v26
  v_mfma_f32_16x16x32_bf16 v[248:251], v[36:39], a[104:107], v[248:251]
  buffer_load_dwordx4 a[128:131], v11, s[20:23], s56 offen offset:0 sc1
  v_mul_f32 v28, v28, v196
  v_mfma_f32_16x16x32_bf16 v[252:255], v[36:39], a[108:111], v[252:255]
  s_waitcnt lgkmcnt(4)
  v_mul_f32 v26, v26, v197
  v_cvt_pk_bf16_f32 v26, v28, v26
  v_mfma_f32_16x16x32_bf16 v[48:51], v[40:43], a[208:211], v[48:51]
  ds_read_b64_tr_b16 v[36:37], v2 offset:32904
  v_lshlrev_b32 v29, 16, v27
  v_mfma_f32_16x16x32_bf16 v[52:55], v[40:43], a[212:215], v[52:55]
  ds_read_b64_tr_b16 v[38:39], v2 offset:33416
  v_and_b32 v27, s44, v27
  v_mfma_f32_16x16x32_bf16 v[56:59], v[40:43], a[216:219], v[56:59]
  buffer_load_dwordx4 a[132:135], v11, s[20:23], s56 offen offset:1024 sc1
  v_mul_f32 v29, v29, v198
  v_mfma_f32_16x16x32_bf16 v[60:63], v[40:43], a[220:223], v[60:63]
  s_waitcnt lgkmcnt(4)
  v_mul_f32 v27, v27, v199
  v_cvt_pk_bf16_f32 v27, v29, v27
  v_mfma_f32_16x16x32_bf16 v[64:67], v[44:47], a[208:211], v[64:67]
  ds_read_b64_tr_b16 v[40:41], v1 offset:37024
  v_lshlrev_b32 v28, 16, v20
  v_mfma_f32_16x16x32_bf16 v[68:71], v[44:47], a[212:215], v[68:71]
  ds_read_b64_tr_b16 v[42:43], v1 offset:37536
  v_and_b32 v20, s44, v20
  v_mfma_f32_16x16x32_bf16 v[72:75], v[44:47], a[216:219], v[72:75]
  buffer_store_dwordx4 v[24:27], v11, s[20:23], s84 offen offset:1024 sc1
  v_mfma_f32_16x16x32_bf16 v[76:79], v[44:47], a[220:223], v[76:79]
  s_waitcnt lgkmcnt(4)
  ds_read_b128 v[24:27], v8 offset:6144
  v_mfma_f32_16x16x32_bf16 v[80:83], v[32:35], a[208:211], v[80:83]
  ds_read_b64_tr_b16 v[44:45], v1 offset:37032
  s_add_u32 s77, s42, 16384
  v_mfma_f32_16x16x32_bf16 v[84:87], v[32:35], a[212:215], v[84:87]
  ds_read_b64_tr_b16 v[46:47], v1 offset:37544
  v_mul_f32 v28, v28, v184
  v_mfma_f32_16x16x32_bf16 v[88:91], v[32:35], a[216:219], v[88:91]
  buffer_load_dwordx4 a[136:139], v11, s[20:23], s56 offen offset:2048 sc1
  v_mul_f32 v20, v20, v185
  v_mfma_f32_16x16x32_bf16 v[92:95], v[32:35], a[220:223], v[92:95]
  s_waitcnt lgkmcnt(5)
  v_cvt_pk_bf16_f32 v20, v28, v20
  v_lshlrev_b32 v29, 16, v21
  v_mfma_f32_16x16x32_bf16 v[96:99], v[36:39], a[208:211], v[96:99]
  ds_read_b64_tr_b16 v[32:33], v2 offset:37024
  v_and_b32 v21, s44, v21
  v_mfma_f32_16x16x32_bf16 v[100:103], v[36:39], a[212:215], v[100:103]
  ds_read_b64_tr_b16 v[34:35], v2 offset:37536
  v_mul_f32 v29, v29, v186
  v_mfma_f32_16x16x32_bf16 v[104:107], v[36:39], a[216:219], v[104:107]
  buffer_load_dwordx4 a[140:143], v11, s[20:23], s56 offen offset:3072 sc1
  v_mul_f32 v21, v21, v187
  v_mfma_f32_16x16x32_bf16 v[108:111], v[36:39], a[220:223], v[108:111]
  s_waitcnt lgkmcnt(5)
  s_add_u32 s56, s40, 28672
  v_cvt_pk_bf16_f32 v21, v29, v21
  v_mfma_f32_16x16x32_bf16 v[48:51], v[40:43], a[224:227], v[48:51]
  ds_read_b64_tr_b16 v[36:37], v2 offset:37032
  v_lshlrev_b32 v28, 16, v22
  v_mfma_f32_16x16x32_bf16 v[52:55], v[40:43], a[228:231], v[52:55]
  ds_read_b64_tr_b16 v[38:39], v2 offset:37544
  v_and_b32 v22, s44, v22
  v_mfma_f32_16x16x32_bf16 v[56:59], v[40:43], a[232:235], v[56:59]
  buffer_load_dwordx4 v4, s[8:11], s50 offen lds
  v_mfma_f32_16x16x32_bf16 v[60:63], v[40:43], a[236:239], v[60:63]
  s_waitcnt lgkmcnt(4)
  v_mul_f32 v28, v28, v200
  v_mul_f32 v22, v22, v201
  v_mfma_f32_16x16x32_bf16 v[64:67], v[44:47], a[224:227], v[64:67]
  ds_read_b64_tr_b16 v[40:41], v1 offset:41152
  v_cvt_pk_bf16_f32 v22, v28, v22
  v_mfma_f32_16x16x32_bf16 v[68:71], v[44:47], a[228:231], v[68:71]
  ds_read_b64_tr_b16 v[42:43], v1 offset:41664
  v_lshlrev_b32 v29, 16, v23
  v_mfma_f32_16x16x32_bf16 v[72:75], v[44:47], a[232:235], v[72:75]
  buffer_load_dwordx4 a[144:147], v11, s[20:23], s56 offen offset:0 sc1
  v_and_b32 v23, s44, v23
  v_mfma_f32_16x16x32_bf16 v[76:79], v[44:47], a[236:239], v[76:79]
  s_waitcnt lgkmcnt(4)
  v_mul_f32 v29, v29, v202
  v_mul_f32 v23, v23, v203
  v_mfma_f32_16x16x32_bf16 v[80:83], v[32:35], a[224:227], v[80:83]
  ds_read_b64_tr_b16 v[44:45], v1 offset:41160
  v_cvt_pk_bf16_f32 v23, v29, v23
  v_mfma_f32_16x16x32_bf16 v[84:87], v[32:35], a[228:231], v[84:87]
  ds_read_b64_tr_b16 v[46:47], v1 offset:41672
  s_waitcnt vmcnt(16) lgkmcnt(4)
  v_mfma_f32_16x16x32_bf16 v[88:91], v[32:35], a[232:235], v[88:91]
  s_barrier
  s_add_u32 s51, s35, 1437824
  s_add_u32 m0, s36, 20640
  v_mfma_f32_16x16x32_bf16 v[92:95], v[32:35], a[236:239], v[92:95]
  buffer_store_dwordx4 v[20:23], v11, s[20:23], s77 offen offset:2048 sc1
  v_mfma_f32_16x16x32_bf16 v[96:99], v[36:39], a[224:227], v[96:99]
  ds_read_b64_tr_b16 v[32:33], v2 offset:41152
  v_lshlrev_b32 v28, 16, v24
  v_mfma_f32_16x16x32_bf16 v[100:103], v[36:39], a[228:231], v[100:103]
  ds_read_b64_tr_b16 v[34:35], v2 offset:41664
  v_and_b32 v24, s44, v24
  v_mfma_f32_16x16x32_bf16 v[104:107], v[36:39], a[232:235], v[104:107]
  ds_read_b128 v[20:23], v9 offset:0
  s_add_u32 s84, s42, 16384
  v_mfma_f32_16x16x32_bf16 v[108:111], v[36:39], a[236:239], v[108:111]
  s_waitcnt lgkmcnt(5)
  v_mul_f32 v28, v28, v188
  v_mul_f32 v24, v24, v189
  v_mfma_f32_16x16x32_bf16 v[48:51], v[40:43], a[240:243], v[48:51]
  ds_read_b64_tr_b16 v[36:37], v2 offset:41160
  v_cvt_pk_bf16_f32 v24, v28, v24
  v_mfma_f32_16x16x32_bf16 v[52:55], v[40:43], a[244:247], v[52:55]
  ds_read_b64_tr_b16 v[38:39], v2 offset:41672
  v_lshlrev_b32 v29, 16, v25
  v_mfma_f32_16x16x32_bf16 v[56:59], v[40:43], a[248:251], v[56:59]
  buffer_load_dwordx4 a[148:151], v11, s[20:23], s56 offen offset:1024 sc1
  v_and_b32 v25, s44, v25
  v_mfma_f32_16x16x32_bf16 v[60:63], v[40:43], a[252:255], v[60:63]
  s_waitcnt lgkmcnt(5)
  v_mul_f32 v29, v29, v190
  v_mul_f32 v25, v25, v191
  v_mfma_f32_16x16x32_bf16 v[64:67], v[44:47], a[240:243], v[64:67]
  ds_read_b64_tr_b16 v[40:41], v1 offset:45280
  v_cvt_pk_bf16_f32 v25, v29, v25
  v_mfma_f32_16x16x32_bf16 v[68:71], v[44:47], a[244:247], v[68:71]
  ds_read_b64_tr_b16 v[42:43], v1 offset:45792
  v_lshlrev_b32 v28, 16, v26
  v_mfma_f32_16x16x32_bf16 v[72:75], v[44:47], a[248:251], v[72:75]
  buffer_load_dwordx4 a[152:155], v11, s[20:23], s56 offen offset:2048 sc1
  v_and_b32 v26, s44, v26
  v_mfma_f32_16x16x32_bf16 v[76:79], v[44:47], a[252:255], v[76:79]
  s_waitcnt lgkmcnt(5)
  v_mul_f32 v28, v28, v204
  v_mul_f32 v26, v26, v205
  v_mfma_f32_16x16x32_bf16 v[80:83], v[32:35], a[240:243], v[80:83]
  ds_read_b64_tr_b16 v[44:45], v1 offset:45288
  v_cvt_pk_bf16_f32 v26, v28, v26
  v_mfma_f32_16x16x32_bf16 v[84:87], v[32:35], a[244:247], v[84:87]
  ds_read_b64_tr_b16 v[46:47], v1 offset:45800
  v_lshlrev_b32 v29, 16, v27
  v_mfma_f32_16x16x32_bf16 v[88:91], v[32:35], a[248:251], v[88:91]
  buffer_load_dwordx4 a[156:159], v11, s[20:23], s56 offen offset:3072 sc1
  v_and_b32 v27, s44, v27
  v_mfma_f32_16x16x32_bf16 v[92:95], v[32:35], a[252:255], v[92:95]
  s_waitcnt lgkmcnt(4)
  v_mul_f32 v29, v29, v206
  v_mul_f32 v27, v27, v207
  v_mfma_f32_16x16x32_bf16 v[96:99], v[36:39], a[240:243], v[96:99]
  ds_read_b64_tr_b16 v[32:33], v2 offset:45280
  v_cvt_pk_bf16_f32 v27, v29, v27
  v_mfma_f32_16x16x32_bf16 v[100:103], v[36:39], a[244:247], v[100:103]
  ds_read_b64_tr_b16 v[34:35], v2 offset:45792
  v_lshlrev_b32 v28, 16, v20
  v_mfma_f32_16x16x32_bf16 v[104:107], v[36:39], a[248:251], v[104:107]
  buffer_store_dwordx4 v[24:27], v11, s[20:23], s84 offen offset:3072 sc1
  v_mfma_f32_16x16x32_bf16 v[108:111], v[36:39], a[252:255], v[108:111]
  s_waitcnt lgkmcnt(4)
  ds_read_b128 v[24:27], v9 offset:2048
  v_mfma_f32_16x16x32_bf16 v[112:115], v[40:43], a[208:211], v[112:115]
  ds_read_b64_tr_b16 v[36:37], v2 offset:45288
  s_add_u32 s77, s42, 20480
  v_mfma_f32_16x16x32_bf16 v[116:119], v[40:43], a[212:215], v[116:119]
  ds_read_b64_tr_b16 v[38:39], v2 offset:45800
  v_and_b32 v20, s44, v20
  v_mfma_f32_16x16x32_bf16 v[120:123], v[40:43], a[216:219], v[120:123]
  buffer_load_dword v14, off, s[64:67], s54
  v_mul_f32 v28, v28, v208
  v_mfma_f32_16x16x32_bf16 v[124:127], v[40:43], a[220:223], v[124:127]
  s_waitcnt lgkmcnt(5)
  v_mul_f32 v20, v20, v209
  v_cvt_pk_bf16_f32 v20, v28, v20
  v_mfma_f32_16x16x32_bf16 v[128:131], v[44:47], a[208:211], v[128:131]
  ds_read_b64_tr_b16 v[40:41], v1 offset:49408
  v_lshlrev_b32 v29, 16, v21
  v_mfma_f32_16x16x32_bf16 v[132:135], v[44:47], a[212:215], v[132:135]
  ds_read_b64_tr_b16 v[42:43], v1 offset:49920
  v_and_b32 v21, s44, v21
  v_mfma_f32_16x16x32_bf16 v[136:139], v[44:47], a[216:219], v[136:139]
  buffer_load_dwordx4 v4, s[8:11], s51 offen lds
  v_mfma_f32_16x16x32_bf16 v[140:143], v[44:47], a[220:223], v[140:143]
  s_waitcnt lgkmcnt(5)
  s_add_u32 s50, s35, 1757312
  s_add_u32 m0, s36, 24768
  v_mfma_f32_16x16x32_bf16 v[144:147], v[32:35], a[208:211], v[144:147]
  ds_read_b64_tr_b16 v[44:45], v1 offset:49416
  v_mul_f32 v29, v29, v210
  v_mfma_f32_16x16x32_bf16 v[148:151], v[32:35], a[212:215], v[148:151]
  ds_read_b64_tr_b16 v[46:47], v1 offset:49928
  v_mul_f32 v21, v21, v211
  v_mfma_f32_16x16x32_bf16 v[152:155], v[32:35], a[216:219], v[152:155]
  buffer_load_dwordx4 v4, s[8:11], s50 offen lds
  v_mfma_f32_16x16x32_bf16 v[156:159], v[32:35], a[220:223], v[156:159]
  s_waitcnt lgkmcnt(4)
  s_add_u32 s51, s35, 1384704
  s_add_u32 m0, s36, 28896
  v_mfma_f32_16x16x32_bf16 v[160:163], v[36:39], a[208:211], v[160:163]
  ds_read_b64_tr_b16 v[32:33], v2 offset:49408
  v_cvt_pk_bf16_f32 v21, v29, v21
  v_mfma_f32_16x16x32_bf16 v[164:167], v[36:39], a[212:215], v[164:167]
  ds_read_b64_tr_b16 v[34:35], v2 offset:49920
  v_lshlrev_b32 v28, 16, v22
  v_mfma_f32_16x16x32_bf16 v[168:171], v[36:39], a[216:219], v[168:171]
  buffer_load_dwordx4 v4, s[8:11], s51 offen lds
  v_mfma_f32_16x16x32_bf16 v[172:175], v[36:39], a[220:223], v[172:175]
  s_waitcnt lgkmcnt(4)
  s_add_u32 s50, s35, 1704192
  s_add_u32 m0, s36, 33024
  v_mfma_f32_16x16x32_bf16 v[112:115], v[40:43], a[224:227], v[112:115]
  ds_read_b64_tr_b16 v[36:37], v2 offset:49416
  v_and_b32 v22, s44, v22
  v_mfma_f32_16x16x32_bf16 v[116:119], v[40:43], a[228:231], v[116:119]
  ds_read_b64_tr_b16 v[38:39], v2 offset:49928
  v_mul_f32 v28, v28, v224
  v_mfma_f32_16x16x32_bf16 v[120:123], v[40:43], a[232:235], v[120:123]
  buffer_load_dwordx4 v4, s[8:11], s50 offen lds
  v_mfma_f32_16x16x32_bf16 v[124:127], v[40:43], a[236:239], v[124:127]
  s_waitcnt lgkmcnt(4)
  v_mul_f32 v22, v22, v225
  v_cvt_pk_bf16_f32 v22, v28, v22
  v_mfma_f32_16x16x32_bf16 v[128:131], v[44:47], a[224:227], v[128:131]
  ds_read_b64_tr_b16 v[40:41], v1 offset:0
  v_lshlrev_b32 v29, 16, v23
  v_mfma_f32_16x16x32_bf16 v[132:135], v[44:47], a[228:231], v[132:135]
  ds_read_b64_tr_b16 v[42:43], v1 offset:512
  v_and_b32 v23, s44, v23
  v_mfma_f32_16x16x32_bf16 v[136:139], v[44:47], a[232:235], v[136:139]
  v_mul_f32 v29, v29, v226
  v_mul_f32 v23, v23, v227
  v_mfma_f32_16x16x32_bf16 v[140:143], v[44:47], a[236:239], v[140:143]
  s_waitcnt lgkmcnt(4)
  v_cvt_pk_bf16_f32 v23, v29, v23
  v_lshlrev_b32 v28, 16, v24
  v_mfma_f32_16x16x32_bf16 v[144:147], v[32:35], a[224:227], v[144:147]
  ds_read_b64_tr_b16 v[44:45], v1 offset:8
  v_and_b32 v24, s44, v24
  v_mfma_f32_16x16x32_bf16 v[148:151], v[32:35], a[228:231], v[148:151]
  ds_read_b64_tr_b16 v[46:47], v1 offset:520
  s_waitcnt vmcnt(17) lgkmcnt(4)
  v_mfma_f32_16x16x32_bf16 v[152:155], v[32:35], a[232:235], v[152:155]
  s_barrier
  s_add_u32 s51, s35, 2023680
  s_add_u32 m0, s36, 37152
  v_mfma_f32_16x16x32_bf16 v[156:159], v[32:35], a[236:239], v[156:159]
  buffer_store_dwordx4 v[20:23], v11, s[20:23], s77 offen offset:0 sc1
  v_mfma_f32_16x16x32_bf16 v[160:163], v[36:39], a[224:227], v[160:163]
  ds_read_b64_tr_b16 v[32:33], v2 offset:0
  v_mul_f32 v28, v28, v212
  v_mfma_f32_16x16x32_bf16 v[164:167], v[36:39], a[228:231], v[164:167]
  ds_read_b64_tr_b16 v[34:35], v2 offset:512
  v_mul_f32 v24, v24, v213
  v_mfma_f32_16x16x32_bf16 v[168:171], v[36:39], a[232:235], v[168:171]
  buffer_load_dwordx4 v4, s[8:11], s51 offen lds
  v_mfma_f32_16x16x32_bf16 v[172:175], v[36:39], a[236:239], v[172:175]
  s_waitcnt lgkmcnt(4)
  s_add_u32 s50, s35, 2343168
  s_add_u32 m0, s36, 41280
  v_mfma_f32_16x16x32_bf16 v[112:115], v[40:43], a[240:243], v[112:115]
  ds_read_b64_tr_b16 v[36:37], v2 offset:8
  v_cvt_pk_bf16_f32 v24, v28, v24
  v_mfma_f32_16x16x32_bf16 v[116:119], v[40:43], a[244:247], v[116:119]
  ds_read_b64_tr_b16 v[38:39], v2 offset:520
  v_lshlrev_b32 v29, 16, v25
  v_mfma_f32_16x16x32_bf16 v[120:123], v[40:43], a[248:251], v[120:123]
  buffer_load_dwordx4 v4, s[8:11], s50 offen lds
  v_mfma_f32_16x16x32_bf16 v[124:127], v[40:43], a[252:255], v[124:127]
  s_waitcnt lgkmcnt(4)
  s_add_u32 s51, s35, 1437952
  s_add_u32 m0, s36, 45408
  v_mfma_f32_16x16x32_bf16 v[128:131], v[44:47], a[240:243], v[128:131]
  ds_read_b64_tr_b16 v[40:41], v1 offset:4128
  v_and_b32 v25, s44, v25
  v_mfma_f32_16x16x32_bf16 v[132:135], v[44:47], a[244:247], v[132:135]
  ds_read_b64_tr_b16 v[42:43], v1 offset:4640
  v_mul_f32 v29, v29, v214
  v_mfma_f32_16x16x32_bf16 v[136:139], v[44:47], a[248:251], v[136:139]
  buffer_load_dwordx4 v4, s[8:11], s51 offen lds
  v_mfma_f32_16x16x32_bf16 v[140:143], v[44:47], a[252:255], v[140:143]
  s_waitcnt lgkmcnt(4)
  s_add_u32 s50, s35, 1757440
  s_add_u32 m0, s36, 49536
  v_mfma_f32_16x16x32_bf16 v[144:147], v[32:35], a[240:243], v[144:147]
  ds_read_b64_tr_b16 v[44:45], v1 offset:4136
  v_mul_f32 v25, v25, v215
  v_mfma_f32_16x16x32_bf16 v[148:151], v[32:35], a[244:247], v[148:151]
  ds_read_b64_tr_b16 v[46:47], v1 offset:4648
  v_cvt_pk_bf16_f32 v25, v29, v25
  v_mfma_f32_16x16x32_bf16 v[152:155], v[32:35], a[248:251], v[152:155]
  buffer_load_dwordx4 v4, s[8:11], s50 offen lds
  v_mfma_f32_16x16x32_bf16 v[156:159], v[32:35], a[252:255], v[156:159]
  s_waitcnt lgkmcnt(4)
  ds_read_b128 v[20:23], v9 offset:4096
  v_mfma_f32_16x16x32_bf16 v[160:163], v[36:39], a[240:243], v[160:163]
  ds_read_b64_tr_b16 v[32:33], v2 offset:4128
  s_add_u32 s84, s42, 20480
  v_mfma_f32_16x16x32_bf16 v[164:167], v[36:39], a[244:247], v[164:167]
  ds_read_b64_tr_b16 v[34:35], v2 offset:4640
  v_lshlrev_b32 v28, 16, v26
  v_mfma_f32_16x16x32_bf16 v[168:171], v[36:39], a[248:251], v[168:171]
  v_and_b32 v26, s44, v26
  v_mul_f32 v28, v28, v228
  v_mfma_f32_16x16x32_bf16 v[172:175], v[36:39], a[252:255], v[172:175]
  s_waitcnt lgkmcnt(5)
  v_mul_f32 v26, v26, v229
  v_cvt_pk_bf16_f32 v26, v28, v26
  v_mfma_f32_16x16x32_bf16 v[48:51], v[40:43], a[112:115], v[48:51]
  ds_read_b64_tr_b16 v[36:37], v2 offset:4136
  v_lshlrev_b32 v29, 16, v27
  v_mfma_f32_16x16x32_bf16 v[52:55], v[40:43], a[116:119], v[52:55]
  ds_read_b64_tr_b16 v[38:39], v2 offset:4648
  v_and_b32 v27, s44, v27
  v_mfma_f32_16x16x32_bf16 v[56:59], v[40:43], a[120:123], v[56:59]
  v_mul_f32 v29, v29, v230
  v_mul_f32 v27, v27, v231
  v_mfma_f32_16x16x32_bf16 v[60:63], v[40:43], a[124:127], v[60:63]
  s_waitcnt lgkmcnt(5)
  v_cvt_pk_bf16_f32 v27, v29, v27
  s_waitcnt lgkmcnt(4)
  v_mfma_f32_16x16x32_bf16 v[64:67], v[44:47], a[112:115], v[64:67]
  ds_read_b64_tr_b16 v[40:41], v1 offset:8256
  v_lshlrev_b32 v28, 16, v20
  v_mfma_f32_16x16x32_bf16 v[68:71], v[44:47], a[116:119], v[68:71]
  ds_read_b64_tr_b16 v[42:43], v1 offset:8768
  v_and_b32 v20, s44, v20
  v_mfma_f32_16x16x32_bf16 v[72:75], v[44:47], a[120:123], v[72:75]
  buffer_store_dwordx4 v[24:27], v11, s[20:23], s84 offen offset:1024 sc1
  v_mfma_f32_16x16x32_bf16 v[76:79], v[44:47], a[124:127], v[76:79]
  s_waitcnt lgkmcnt(4)
  ds_read_b128 v[24:27], v9 offset:6144
  v_mfma_f32_16x16x32_bf16 v[80:83], v[32:35], a[112:115], v[80:83]
  ds_read_b64_tr_b16 v[44:45], v1 offset:8264
  s_add_u32 s77, s42, 20480
  v_mfma_f32_16x16x32_bf16 v[84:87], v[32:35], a[116:119], v[84:87]
  ds_read_b64_tr_b16 v[46:47], v1 offset:8776
  v_mul_f32 v28, v28, v216
  v_mfma_f32_16x16x32_bf16 v[88:91], v[32:35], a[120:123], v[88:91]
  v_mul_f32 v20, v20, v217
  v_cvt_pk_bf16_f32 v20, v28, v20
  v_mfma_f32_16x16x32_bf16 v[92:95], v[32:35], a[124:127], v[92:95]
  s_waitcnt lgkmcnt(5)
  v_lshlrev_b32 v29, 16, v21
  v_and_b32 v21, s44, v21
  v_mfma_f32_16x16x32_bf16 v[96:99], v[36:39], a[112:115], v[96:99]
  ds_read_b64_tr_b16 v[32:33], v2 offset:8256
  v_mul_f32 v29, v29, v218
  v_mfma_f32_16x16x32_bf16 v[100:103], v[36:39], a[116:119], v[100:103]
  ds_read_b64_tr_b16 v[34:35], v2 offset:8768
  v_mul_f32 v21, v21, v219
  v_mfma_f32_16x16x32_bf16 v[104:107], v[36:39], a[120:123], v[104:107]
  v_cvt_pk_bf16_f32 v21, v29, v21
  v_lshlrev_b32 v28, 16, v22
  v_mfma_f32_16x16x32_bf16 v[108:111], v[36:39], a[124:127], v[108:111]
  s_waitcnt vmcnt(18) lgkmcnt(5)
  v_and_b32 v22, s44, v22
  v_mul_f32 v28, v28, v232
  v_mfma_f32_16x16x32_bf16 v[48:51], v[40:43], a[128:131], v[48:51]
  ds_read_b64_tr_b16 v[36:37], v2 offset:8264
  v_mul_f32 v22, v22, v233
  v_mfma_f32_16x16x32_bf16 v[52:55], v[40:43], a[132:135], v[52:55]
  ds_read_b64_tr_b16 v[38:39], v2 offset:8776
  v_cvt_pk_bf16_f32 v22, v28, v22
  v_mfma_f32_16x16x32_bf16 v[56:59], v[40:43], a[136:139], v[56:59]
  v_lshlrev_b32 v29, 16, v23
  v_and_b32 v23, s44, v23
  v_mfma_f32_16x16x32_bf16 v[60:63], v[40:43], a[140:143], v[60:63]
  s_waitcnt lgkmcnt(4)
  v_mul_f32 v29, v29, v234
  v_mul_f32 v23, v23, v235
  v_mfma_f32_16x16x32_bf16 v[64:67], v[44:47], a[128:131], v[64:67]
  ds_read_b64_tr_b16 v[40:41], v1 offset:12384
  v_cvt_pk_bf16_f32 v23, v29, v23
  v_mfma_f32_16x16x32_bf16 v[68:71], v[44:47], a[132:135], v[68:71]
  ds_read_b64_tr_b16 v[42:43], v1 offset:12896
  v_lshlrev_b32 v28, 16, v24
  v_mfma_f32_16x16x32_bf16 v[72:75], v[44:47], a[136:139], v[72:75]
  buffer_store_dwordx4 v[20:23], v11, s[20:23], s77 offen offset:2048 sc1
  v_mfma_f32_16x16x32_bf16 v[76:79], v[44:47], a[140:143], v[76:79]
  s_waitcnt lgkmcnt(4)
  s_add_u32 s84, s42, 20480
  v_and_b32 v24, s44, v24
  v_mfma_f32_16x16x32_bf16 v[80:83], v[32:35], a[128:131], v[80:83]
  ds_read_b64_tr_b16 v[44:45], v1 offset:12392
  v_mul_f32 v28, v28, v220
  v_mfma_f32_16x16x32_bf16 v[84:87], v[32:35], a[132:135], v[84:87]
  ds_read_b64_tr_b16 v[46:47], v1 offset:12904
  s_waitcnt vmcnt(9) lgkmcnt(4)
  v_mfma_f32_16x16x32_bf16 v[88:91], v[32:35], a[136:139], v[88:91]
  s_barrier
  s_lshr_b32 s51, 0x2c26201a, s37
  s_and_b32 s51, s51, 0xff
  v_mfma_f32_16x16x32_bf16 v[92:95], v[32:35], a[140:143], v[92:95]
  s_mul_i32 s51, s51, 53248
  s_add_u32 s51, s51, s38
  s_add_u32 m0, s39, 0
  v_mfma_f32_16x16x32_bf16 v[96:99], v[36:39], a[128:131], v[96:99]
  ds_read_b64_tr_b16 v[32:33], v2 offset:12384
  v_mul_f32 v24, v24, v221
  v_mfma_f32_16x16x32_bf16 v[100:103], v[36:39], a[132:135], v[100:103]
  ds_read_b64_tr_b16 v[34:35], v2 offset:12896
  v_cvt_pk_bf16_f32 v24, v28, v24
  v_mfma_f32_16x16x32_bf16 v[104:107], v[36:39], a[136:139], v[104:107]
  buffer_load_dwordx4 v6, s[8:11], s51 offen lds
  v_mfma_f32_16x16x32_bf16 v[108:111], v[36:39], a[140:143], v[108:111]
  s_waitcnt lgkmcnt(4)
  s_lshr_b32 s50, 0x2121211b, s37
  s_and_b32 s50, s50, 0xff
  v_mfma_f32_16x16x32_bf16 v[48:51], v[40:43], a[144:147], v[48:51]
  ds_read_b64_tr_b16 v[36:37], v2 offset:12392
  s_mul_i32 s50, s50, 53248
  v_mfma_f32_16x16x32_bf16 v[52:55], v[40:43], a[148:151], v[52:55]
  ds_read_b64_tr_b16 v[38:39], v2 offset:12904
  s_add_u32 s50, s50, s38
  v_mfma_f32_16x16x32_bf16 v[56:59], v[40:43], a[152:155], v[56:59]
  s_add_u32 m0, s39, 4096
  v_lshlrev_b32 v29, 16, v25
  v_and_b32 v25, s44, v25
  v_mfma_f32_16x16x32_bf16 v[60:63], v[40:43], a[156:159], v[60:63]
  s_waitcnt lgkmcnt(4)
  v_mul_f32 v29, v29, v222
  v_mul_f32 v25, v25, v223
  v_mfma_f32_16x16x32_bf16 v[64:67], v[44:47], a[144:147], v[64:67]
  ds_read_b64_tr_b16 v[40:41], v1 offset:16512
  v_cvt_pk_bf16_f32 v25, v29, v25
  v_mfma_f32_16x16x32_bf16 v[68:71], v[44:47], a[148:151], v[68:71]
  ds_read_b64_tr_b16 v[42:43], v1 offset:17024
  v_lshlrev_b32 v28, 16, v26
  v_mfma_f32_16x16x32_bf16 v[72:75], v[44:47], a[152:155], v[72:75]
  buffer_load_dwordx4 v6, s[8:11], s50 offen lds
  v_mfma_f32_16x16x32_bf16 v[76:79], v[44:47], a[156:159], v[76:79]
  s_waitcnt lgkmcnt(4)
  s_add_u32 s51, s35, 2076672
  v_and_b32 v26, s44, v26
  v_mfma_f32_16x16x32_bf16 v[80:83], v[32:35], a[144:147], v[80:83]
  ds_read_b64_tr_b16 v[44:45], v1 offset:16520
  v_mul_f32 v28, v28, v236
  v_mfma_f32_16x16x32_bf16 v[84:87], v[32:35], a[148:151], v[84:87]
  ds_read_b64_tr_b16 v[46:47], v1 offset:17032
  v_mul_f32 v26, v26, v237
  v_mfma_f32_16x16x32_bf16 v[88:91], v[32:35], a[152:155], v[88:91]
  v_cvt_pk_bf16_f32 v26, v28, v26
  v_lshlrev_b32 v29, 16, v27
  v_mfma_f32_16x16x32_bf16 v[92:95], v[32:35], a[156:159], v[92:95]
  s_waitcnt lgkmcnt(4)
  v_and_b32 v27, s44, v27
  v_mul_f32 v29, v29, v238
  v_mfma_f32_16x16x32_bf16 v[96:99], v[36:39], a[144:147], v[96:99]
  ds_read_b64_tr_b16 v[32:33], v2 offset:16512
  v_mul_f32 v27, v27, v239
  v_mfma_f32_16x16x32_bf16 v[100:103], v[36:39], a[148:151], v[100:103]
  ds_read_b64_tr_b16 v[34:35], v2 offset:17024
  v_cvt_pk_bf16_f32 v27, v29, v27
  v_mfma_f32_16x16x32_bf16 v[104:107], v[36:39], a[152:155], v[104:107]
  buffer_store_dwordx4 v[24:27], v11, s[20:23], s84 offen offset:3072 sc1
  v_mfma_f32_16x16x32_bf16 v[108:111], v[36:39], a[156:159], v[108:111]
  s_waitcnt lgkmcnt(4)
  ds_read_b64 v[20:21], v10 offset:0
  v_mfma_f32_16x16x32_bf16 v[112:115], v[40:43], a[112:115], v[112:115]
  ds_read_b64_tr_b16 v[36:37], v2 offset:16520
  s_waitcnt lgkmcnt(1)
  v_mfma_f32_16x16x32_bf16 v[116:119], v[40:43], a[116:119], v[116:119]
  ds_read_b64_tr_b16 v[38:39], v2 offset:17032
  v_lshlrev_b32 v28, 16, v20
  v_mfma_f32_16x16x32_bf16 v[120:123], v[40:43], a[120:123], v[120:123]
  ds_read_b64 v[24:25], v10 offset:512
  s_add_u32 s77, s43, 0
  v_mfma_f32_16x16x32_bf16 v[124:127], v[40:43], a[124:127], v[124:127]
  v_and_b32 v20, s44, v20
  v_mul_f32 v28, v28, v240
  v_mfma_f32_16x16x32_bf16 v[128:131], v[44:47], a[112:115], v[128:131]
  ds_read_b64_tr_b16 v[40:41], v1 offset:20640
  s_add_u32 m0, s36, 8192
  v_mfma_f32_16x16x32_bf16 v[132:135], v[44:47], a[116:119], v[132:135]
  ds_read_b64_tr_b16 v[42:43], v1 offset:21152
  v_mul_f32 v20, v20, v241
  v_mfma_f32_16x16x32_bf16 v[136:139], v[44:47], a[120:123], v[136:139]
  buffer_load_dwordx4 v4, s[8:11], s51 offen lds
  v_mfma_f32_16x16x32_bf16 v[140:143], v[44:47], a[124:127], v[140:143]
  v_cvt_pk_bf16_f32 v20, v28, v20
  v_lshlrev_b32 v29, 16, v21
  v_mfma_f32_16x16x32_bf16 v[144:147], v[32:35], a[112:115], v[144:147]
  ds_read_b64_tr_b16 v[44:45], v1 offset:20648
  v_and_b32 v21, s44, v21
  v_mfma_f32_16x16x32_bf16 v[148:151], v[32:35], a[116:119], v[148:151]
  ds_read_b64_tr_b16 v[46:47], v1 offset:21160
  v_mul_f32 v29, v29, v242
  v_mfma_f32_16x16x32_bf16 v[152:155], v[32:35], a[120:123], v[152:155]
  v_mul_f32 v21, v21, v243
  v_cvt_pk_bf16_f32 v21, v29, v21
  v_mfma_f32_16x16x32_bf16 v[156:159], v[32:35], a[124:127], v[156:159]
  s_waitcnt lgkmcnt(5)
  s_waitcnt lgkmcnt(4)
  v_lshlrev_b32 v28, 16, v24
  v_mfma_f32_16x16x32_bf16 v[160:163], v[36:39], a[112:115], v[160:163]
  ds_read_b64_tr_b16 v[32:33], v2 offset:20640
  v_and_b32 v24, s44, v24
  v_mfma_f32_16x16x32_bf16 v[164:167], v[36:39], a[116:119], v[164:167]
  ds_read_b64_tr_b16 v[34:35], v2 offset:21152
  v_mul_f32 v28, v28, v244
  v_mfma_f32_16x16x32_bf16 v[168:171], v[36:39], a[120:123], v[168:171]
  buffer_store_dwordx2 v[20:21], v12, s[20:23], s77 offen offset:0 sc1
  v_mfma_f32_16x16x32_bf16 v[172:175], v[36:39], a[124:127], v[172:175]
  s_waitcnt lgkmcnt(4)
  ds_read_b64 v[20:21], v10 offset:1024
  v_mfma_f32_16x16x32_bf16 v[112:115], v[40:43], a[128:131], v[112:115]
  ds_read_b64_tr_b16 v[36:37], v2 offset:20648
  s_add_u32 s84, s43, 0
  v_mfma_f32_16x16x32_bf16 v[116:119], v[40:43], a[132:135], v[116:119]
  ds_read_b64_tr_b16 v[38:39], v2 offset:21160
  v_mul_f32 v24, v24, v245
  v_mfma_f32_16x16x32_bf16 v[120:123], v[40:43], a[136:139], v[120:123]
  buffer_load_dword v19, v18, s[20:23], 0 offen sc1
  v_cvt_pk_bf16_f32 v24, v28, v24
  v_mfma_f32_16x16x32_bf16 v[124:127], v[40:43], a[140:143], v[124:127]
  s_waitcnt lgkmcnt(5)
  v_lshlrev_b32 v29, 16, v25
  v_and_b32 v25, s44, v25
  v_mfma_f32_16x16x32_bf16 v[128:131], v[44:47], a[128:131], v[128:131]
  ds_read_b64_tr_b16 v[40:41], v1 offset:24768
  v_mul_f32 v29, v29, v246
  v_mfma_f32_16x16x32_bf16 v[132:135], v[44:47], a[132:135], v[132:135]
  ds_read_b64_tr_b16 v[42:43], v1 offset:25280
  v_mul_f32 v25, v25, v247
  v_mfma_f32_16x16x32_bf16 v[136:139], v[44:47], a[136:139], v[136:139]
  v_cvt_pk_bf16_f32 v25, v29, v25
  s_waitcnt lgkmcnt(4)
  v_mfma_f32_16x16x32_bf16 v[140:143], v[44:47], a[140:143], v[140:143]
  buffer_store_dwordx2 v[24:25], v12, s[20:23], s84 offen offset:512 sc1
  v_mfma_f32_16x16x32_bf16 v[144:147], v[32:35], a[128:131], v[144:147]
  ds_read_b64_tr_b16 v[44:45], v1 offset:24776
  v_lshlrev_b32 v28, 16, v20
  v_mfma_f32_16x16x32_bf16 v[148:151], v[32:35], a[132:135], v[148:151]
  ds_read_b64_tr_b16 v[46:47], v1 offset:25288
  s_waitcnt vmcnt(12) lgkmcnt(4)
  v_mfma_f32_16x16x32_bf16 v[152:155], v[32:35], a[136:139], v[152:155]
  s_barrier
  s_add_u32 s50, s35, 2396160
  s_add_u32 m0, s36, 12320
  v_mfma_f32_16x16x32_bf16 v[156:159], v[32:35], a[140:143], v[156:159]
  buffer_load_dwordx4 v4, s[8:11], s50 offen lds
  v_mfma_f32_16x16x32_bf16 v[160:163], v[36:39], a[128:131], v[160:163]
  ds_read_b64_tr_b16 v[32:33], v2 offset:24768
  s_add_u32 s51, s35, 1490944
  v_mfma_f32_16x16x32_bf16 v[164:167], v[36:39], a[132:135], v[164:167]
  ds_read_b64_tr_b16 v[34:35], v2 offset:25280
  s_add_u32 m0, s36, 16448
  v_mfma_f32_16x16x32_bf16 v[168:171], v[36:39], a[136:139], v[168:171]
  buffer_load_dwordx4 v4, s[8:11], s51 offen lds
  v_mfma_f32_16x16x32_bf16 v[172:175], v[36:39], a[140:143], v[172:175]
  s_waitcnt lgkmcnt(4)
  s_add_u32 s50, s35, 1810432
  s_add_u32 m0, s36, 20576
  v_mfma_f32_16x16x32_bf16 v[112:115], v[40:43], a[144:147], v[112:115]
  ds_read_b64_tr_b16 v[36:37], v2 offset:24776
  v_and_b32 v20, s44, v20
  v_mfma_f32_16x16x32_bf16 v[116:119], v[40:43], a[148:151], v[116:119]
  ds_read_b64_tr_b16 v[38:39], v2 offset:25288
  v_mul_f32 v28, v28, v248
  v_mfma_f32_16x16x32_bf16 v[120:123], v[40:43], a[152:155], v[120:123]
  buffer_load_dwordx4 v4, s[8:11], s50 offen lds
  v_mfma_f32_16x16x32_bf16 v[124:127], v[40:43], a[156:159], v[124:127]
  s_waitcnt lgkmcnt(4)
  ds_read_b64 v[24:25], v10 offset:1536
  v_mfma_f32_16x16x32_bf16 v[128:131], v[44:47], a[144:147], v[128:131]
  ds_read_b64_tr_b16 v[40:41], v1 offset:28896
  s_add_u32 s77, s43, 0
  v_mfma_f32_16x16x32_bf16 v[132:135], v[44:47], a[148:151], v[132:135]
  ds_read_b64_tr_b16 v[42:43], v1 offset:29408
  v_mul_f32 v20, v20, v249
  v_mfma_f32_16x16x32_bf16 v[136:139], v[44:47], a[152:155], v[136:139]
  v_cvt_pk_bf16_f32 v20, v28, v20
  v_lshlrev_b32 v29, 16, v21
  v_mfma_f32_16x16x32_bf16 v[140:143], v[44:47], a[156:159], v[140:143]
  s_waitcnt lgkmcnt(5)
  v_and_b32 v21, s44, v21
  v_mul_f32 v29, v29, v250
  v_mfma_f32_16x16x32_bf16 v[144:147], v[32:35], a[144:147], v[144:147]
  ds_read_b64_tr_b16 v[44:45], v1 offset:28904
  v_mul_f32 v21, v21, v251
  v_mfma_f32_16x16x32_bf16 v[148:151], v[32:35], a[148:151], v[148:151]
  ds_read_b64_tr_b16 v[46:47], v1 offset:29416
  v_cvt_pk_bf16_f32 v21, v29, v21
  v_mfma_f32_16x16x32_bf16 v[152:155], v[32:35], a[152:155], v[152:155]
  buffer_store_dwordx2 v[20:21], v12, s[20:23], s77 offen offset:1024 sc1
  v_mfma_f32_16x16x32_bf16 v[156:159], v[32:35], a[156:159], v[156:159]
  s_waitcnt lgkmcnt(5)
  s_add_u32 s84, s43, 0
  s_waitcnt lgkmcnt(4)
  v_mfma_f32_16x16x32_bf16 v[160:163], v[36:39], a[144:147], v[160:163]
  ds_read_b64_tr_b16 v[32:33], v2 offset:28896
  v_lshlrev_b32 v28, 16, v24
  v_mfma_f32_16x16x32_bf16 v[164:167], v[36:39], a[148:151], v[164:167]
  ds_read_b64_tr_b16 v[34:35], v2 offset:29408
  v_and_b32 v24, s44, v24
  v_mfma_f32_16x16x32_bf16 v[168:171], v[36:39], a[152:155], v[168:171]
  v_mul_f32 v28, v28, v252
  v_mul_f32 v24, v24, v253
  v_mfma_f32_16x16x32_bf16 v[172:175], v[36:39], a[156:159], v[172:175]
  s_waitcnt lgkmcnt(4)
  v_cvt_pk_bf16_f32 v24, v28, v24
  v_lshlrev_b32 v29, 16, v25
  v_mfma_f32_16x16x32_bf16 v[176:179], v[40:43], a[208:211], v[176:179]
  ds_read_b64_tr_b16 v[36:37], v2 offset:28904
  s_add_u32 s56, s40, 53248
  v_mfma_f32_16x16x32_bf16 v[180:183], v[40:43], a[212:215], v[180:183]
  ds_read_b64_tr_b16 v[38:39], v2 offset:29416
  v_and_b32 v25, s44, v25
  v_mfma_f32_16x16x32_bf16 v[184:187], v[40:43], a[216:219], v[184:187]
  buffer_load_dwordx4 a[48:51], v11, s[20:23], s56 offen offset:0 sc1
  v_mul_f32 v29, v29, v254
  v_mfma_f32_16x16x32_bf16 v[188:191], v[40:43], a[220:223], v[188:191]
  s_waitcnt lgkmcnt(4)
  v_mul_f32 v25, v25, v255
  v_cvt_pk_bf16_f32 v25, v29, v25
  v_mfma_f32_16x16x32_bf16 v[192:195], v[44:47], a[208:211], v[192:195]
  ds_read_b64_tr_b16 v[40:41], v1 offset:33024
  v_mfma_f32_16x16x32_bf16 v[196:199], v[44:47], a[212:215], v[196:199]
  ds_read_b64_tr_b16 v[42:43], v1 offset:33536
  s_waitcnt lgkmcnt(4)
  v_mfma_f32_16x16x32_bf16 v[200:203], v[44:47], a[216:219], v[200:203]
  buffer_store_dwordx2 v[24:25], v12, s[20:23], s84 offen offset:1536 sc1
  v_mfma_f32_16x16x32_bf16 v[204:207], v[44:47], a[220:223], v[204:207]
  buffer_load_dwordx4 a[52:55], v11, s[20:23], s56 offen offset:1024 sc1
  v_mfma_f32_16x16x32_bf16 v[208:211], v[32:35], a[208:211], v[208:211]
  ds_read_b64_tr_b16 v[44:45], v1 offset:33032
  v_mfma_f32_16x16x32_bf16 v[212:215], v[32:35], a[212:215], v[212:215]
  ds_read_b64_tr_b16 v[46:47], v1 offset:33544
  s_waitcnt lgkmcnt(4)
  v_mfma_f32_16x16x32_bf16 v[216:219], v[32:35], a[216:219], v[216:219]
  buffer_load_dwordx4 a[56:59], v11, s[20:23], s56 offen offset:2048 sc1
  v_mfma_f32_16x16x32_bf16 v[220:223], v[32:35], a[220:223], v[220:223]
  v_mfma_f32_16x16x32_bf16 v[224:227], v[36:39], a[208:211], v[224:227]
  ds_read_b64_tr_b16 v[32:33], v2 offset:33024
  v_mfma_f32_16x16x32_bf16 v[228:231], v[36:39], a[212:215], v[228:231]
  ds_read_b64_tr_b16 v[34:35], v2 offset:33536
  s_waitcnt lgkmcnt(4)
  v_mfma_f32_16x16x32_bf16 v[232:235], v[36:39], a[216:219], v[232:235]
  buffer_load_dwordx4 a[60:63], v11, s[20:23], s56 offen offset:3072 sc1
  v_mfma_f32_16x16x32_bf16 v[236:239], v[36:39], a[220:223], v[236:239]
  v_mfma_f32_16x16x32_bf16 v[176:179], v[40:43], a[224:227], v[176:179]
  ds_read_b64_tr_b16 v[36:37], v2 offset:33032
  s_add_u32 s56, s40, 77824
  v_mfma_f32_16x16x32_bf16 v[180:183], v[40:43], a[228:231], v[180:183]
  ds_read_b64_tr_b16 v[38:39], v2 offset:33544
  s_waitcnt lgkmcnt(4)
  v_mfma_f32_16x16x32_bf16 v[184:187], v[40:43], a[232:235], v[184:187]
  buffer_load_dwordx4 a[64:67], v11, s[20:23], s56 offen offset:0 sc1
  v_mfma_f32_16x16x32_bf16 v[188:191], v[40:43], a[236:239], v[188:191]
  v_mfma_f32_16x16x32_bf16 v[192:195], v[44:47], a[224:227], v[192:195]
  ds_read_b64_tr_b16 v[40:41], v1 offset:37152
  v_mfma_f32_16x16x32_bf16 v[196:199], v[44:47], a[228:231], v[196:199]
  ds_read_b64_tr_b16 v[42:43], v1 offset:37664
  s_waitcnt lgkmcnt(4)
  v_mfma_f32_16x16x32_bf16 v[200:203], v[44:47], a[232:235], v[200:203]
  buffer_load_dwordx4 a[68:71], v11, s[20:23], s56 offen offset:1024 sc1
  v_mfma_f32_16x16x32_bf16 v[204:207], v[44:47], a[236:239], v[204:207]
  v_mfma_f32_16x16x32_bf16 v[208:211], v[32:35], a[224:227], v[208:211]
  ds_read_b64_tr_b16 v[44:45], v1 offset:37160
  v_mfma_f32_16x16x32_bf16 v[212:215], v[32:35], a[228:231], v[212:215]
  ds_read_b64_tr_b16 v[46:47], v1 offset:37672
  s_waitcnt vmcnt(20) lgkmcnt(4)
  v_mfma_f32_16x16x32_bf16 v[216:219], v[32:35], a[232:235], v[216:219]
  s_barrier
  s_add_u32 s51, s35, 2076800
  s_add_u32 m0, s36, 24704
  v_mfma_f32_16x16x32_bf16 v[220:223], v[32:35], a[236:239], v[220:223]
  buffer_load_dwordx4 v4, s[8:11], s51 offen lds
  v_mfma_f32_16x16x32_bf16 v[224:227], v[36:39], a[224:227], v[224:227]
  ds_read_b64_tr_b16 v[32:33], v2 offset:37152
  s_add_u32 s50, s35, 2396288
  v_mfma_f32_16x16x32_bf16 v[228:231], v[36:39], a[228:231], v[228:231]
  ds_read_b64_tr_b16 v[34:35], v2 offset:37664
  s_waitcnt lgkmcnt(4)
  v_mfma_f32_16x16x32_bf16 v[232:235], v[36:39], a[232:235], v[232:235]
  s_add_u32 m0, s36, 28832
  v_mfma_f32_16x16x32_bf16 v[236:239], v[36:39], a[236:239], v[236:239]
  buffer_load_dwordx4 v4, s[8:11], s50 offen lds
  v_mfma_f32_16x16x32_bf16 v[176:179], v[40:43], a[240:243], v[176:179]
  ds_read_b64_tr_b16 v[36:37], v2 offset:37160
  s_add_u32 s51, s35, 1491072
  v_mfma_f32_16x16x32_bf16 v[180:183], v[40:43], a[244:247], v[180:183]
  ds_read_b64_tr_b16 v[38:39], v2 offset:37672
  s_waitcnt lgkmcnt(4)
  v_mfma_f32_16x16x32_bf16 v[184:187], v[40:43], a[248:251], v[184:187]
  s_add_u32 m0, s36, 32960
  v_mfma_f32_16x16x32_bf16 v[188:191], v[40:43], a[252:255], v[188:191]
  buffer_load_dwordx4 v4, s[8:11], s51 offen lds
  v_mfma_f32_16x16x32_bf16 v[192:195], v[44:47], a[240:243], v[192:195]
  ds_read_b64_tr_b16 v[40:41], v1 offset:41280
  v_mfma_f32_16x16x32_bf16 v[196:199], v[44:47], a[244:247], v[196:199]
  ds_read_b64_tr_b16 v[42:43], v1 offset:41792
  s_waitcnt lgkmcnt(4)
  v_mfma_f32_16x16x32_bf16 v[200:203], v[44:47], a[248:251], v[200:203]
  buffer_load_dwordx4 a[72:75], v11, s[20:23], s56 offen offset:2048 sc1
  v_mfma_f32_16x16x32_bf16 v[204:207], v[44:47], a[252:255], v[204:207]
  v_mfma_f32_16x16x32_bf16 v[208:211], v[32:35], a[240:243], v[208:211]
  ds_read_b64_tr_b16 v[44:45], v1 offset:41288
  v_mfma_f32_16x16x32_bf16 v[212:215], v[32:35], a[244:247], v[212:215]
  ds_read_b64_tr_b16 v[46:47], v1 offset:41800
  s_waitcnt lgkmcnt(4)
  v_mfma_f32_16x16x32_bf16 v[216:219], v[32:35], a[248:251], v[216:219]
  buffer_load_dwordx4 a[76:79], v11, s[20:23], s56 offen offset:3072 sc1
  v_mfma_f32_16x16x32_bf16 v[220:223], v[32:35], a[252:255], v[220:223]
  s_waitcnt vmcnt(17)
  v_sub_u32 v19, v19, v30
  v_cmp_gt_u32 vcc, 3, v19
  v_mfma_f32_16x16x32_bf16 v[224:227], v[36:39], a[240:243], v[224:227]
  ds_read_b64_tr_b16 v[32:33], v2 offset:41280
  s_nop 0
  v_mfma_f32_16x16x32_bf16 v[228:231], v[36:39], a[244:247], v[228:231]
  ds_read_b64_tr_b16 v[34:35], v2 offset:41792
  s_waitcnt lgkmcnt(4)
  v_mfma_f32_16x16x32_bf16 v[232:235], v[36:39], a[248:251], v[232:235]
  s_cbranch_vccnz Lslow3
Lback3:
  s_add_u32 s57, s40, 8192
  v_mfma_f32_16x16x32_bf16 v[236:239], v[36:39], a[252:255], v[236:239]
  buffer_load_dwordx4 a[80:83], v11, s[20:23], s57 offen offset:0 sc1
  v_mfma_f32_16x16x32_bf16 v[176:179], v[40:43], a[112:115], v[176:179]
  ds_read_b64_tr_b16 v[36:37], v2 offset:41288
  v_mfma_f32_16x16x32_bf16 v[180:183], v[40:43], a[116:119], v[180:183]
  ds_read_b64_tr_b16 v[38:39], v2 offset:41800
  s_waitcnt lgkmcnt(4)
  v_mfma_f32_16x16x32_bf16 v[184:187], v[40:43], a[120:123], v[184:187]
  v_mfma_f32_16x16x32_bf16 v[188:191], v[40:43], a[124:127], v[188:191]
  buffer_load_dwordx4 a[84:87], v11, s[20:23], s57 offen offset:1024 sc1
  v_mfma_f32_16x16x32_bf16 v[192:195], v[44:47], a[112:115], v[192:195]
  ds_read_b64_tr_b16 v[40:41], v1 offset:45408
  v_mfma_f32_16x16x32_bf16 v[196:199], v[44:47], a[116:119], v[196:199]
  ds_read_b64_tr_b16 v[42:43], v1 offset:45920
  s_waitcnt lgkmcnt(4)
  v_mfma_f32_16x16x32_bf16 v[200:203], v[44:47], a[120:123], v[200:203]
  v_mfma_f32_16x16x32_bf16 v[204:207], v[44:47], a[124:127], v[204:207]
  v_mfma_f32_16x16x32_bf16 v[208:211], v[32:35], a[112:115], v[208:211]
  ds_read_b64_tr_b16 v[44:45], v1 offset:45416
  v_mfma_f32_16x16x32_bf16 v[212:215], v[32:35], a[116:119], v[212:215]
  ds_read_b64_tr_b16 v[46:47], v1 offset:45928
  s_waitcnt lgkmcnt(4)
  v_mfma_f32_16x16x32_bf16 v[216:219], v[32:35], a[120:123], v[216:219]
  buffer_load_dwordx4 a[88:91], v11, s[20:23], s57 offen offset:2048 sc1
  v_mfma_f32_16x16x32_bf16 v[220:223], v[32:35], a[124:127], v[220:223]
  v_mfma_f32_16x16x32_bf16 v[224:227], v[36:39], a[112:115], v[224:227]
  ds_read_b64_tr_b16 v[32:33], v2 offset:45408
  v_mfma_f32_16x16x32_bf16 v[228:231], v[36:39], a[116:119], v[228:231]
  ds_read_b64_tr_b16 v[34:35], v2 offset:45920
  s_waitcnt lgkmcnt(4)
  v_mfma_f32_16x16x32_bf16 v[232:235], v[36:39], a[120:123], v[232:235]
  buffer_load_dwordx4 a[92:95], v11, s[20:23], s57 offen offset:3072 sc1
  v_mfma_f32_16x16x32_bf16 v[236:239], v[36:39], a[124:127], v[236:239]
  s_add_u32 s57, s40, 32768
  v_mfma_f32_16x16x32_bf16 v[176:179], v[40:43], a[128:131], v[176:179]
  ds_read_b64_tr_b16 v[36:37], v2 offset:45416
  v_mfma_f32_16x16x32_bf16 v[180:183], v[40:43], a[132:135], v[180:183]
  ds_read_b64_tr_b16 v[38:39], v2 offset:45928
  s_waitcnt lgkmcnt(4)
  v_mfma_f32_16x16x32_bf16 v[184:187], v[40:43], a[136:139], v[184:187]
  buffer_load_dwordx4 a[96:99], v11, s[20:23], s57 offen offset:0 sc1
  v_mfma_f32_16x16x32_bf16 v[188:191], v[40:43], a[140:143], v[188:191]
  v_mfma_f32_16x16x32_bf16 v[192:195], v[44:47], a[128:131], v[192:195]
  ds_read_b64_tr_b16 v[40:41], v1 offset:49536
  v_mfma_f32_16x16x32_bf16 v[196:199], v[44:47], a[132:135], v[196:199]
  ds_read_b64_tr_b16 v[42:43], v1 offset:50048
  s_waitcnt lgkmcnt(4)
  v_mfma_f32_16x16x32_bf16 v[200:203], v[44:47], a[136:139], v[200:203]
  buffer_load_dwordx4 a[100:103], v11, s[20:23], s57 offen offset:1024 sc1
  v_mfma_f32_16x16x32_bf16 v[204:207], v[44:47], a[140:143], v[204:207]
  v_mfma_f32_16x16x32_bf16 v[208:211], v[32:35], a[128:131], v[208:211]
  ds_read_b64_tr_b16 v[44:45], v1 offset:49544
  v_mfma_f32_16x16x32_bf16 v[212:215], v[32:35], a[132:135], v[212:215]
  ds_read_b64_tr_b16 v[46:47], v1 offset:50056
  s_waitcnt lgkmcnt(4)
  v_mfma_f32_16x16x32_bf16 v[216:219], v[32:35], a[136:139], v[216:219]
  s_barrier
  s_add_u32 s50, s35, 1810560
  s_add_u32 m0, s36, 37088
  v_mfma_f32_16x16x32_bf16 v[220:223], v[32:35], a[140:143], v[220:223]
  buffer_load_dwordx4 v4, s[8:11], s50 offen lds
  v_mfma_f32_16x16x32_bf16 v[224:227], v[36:39], a[128:131], v[224:227]
  ds_read_b64_tr_b16 v[32:33], v2 offset:49536
  s_waitcnt vmcnt(17)
  v_mfma_f32_16x16x32_bf16 v[228:231], v[36:39], a[132:135], v[228:231]
  ds_read_b64_tr_b16 v[34:35], v2 offset:50048
  s_waitcnt lgkmcnt(4)
  v_mfma_f32_16x16x32_bf16 v[232:235], v[36:39], a[136:139], v[232:235]
  buffer_load_dwordx4 a[104:107], v11, s[20:23], s57 offen offset:2048 sc1
  v_add_u32 v17, 4, v30
  v_mfma_f32_16x16x32_bf16 v[236:239], v[36:39], a[140:143], v[236:239]
  buffer_store_dword v17, v16, s[20:23], 0 offen sc1
  v_mfma_f32_16x16x32_bf16 v[176:179], v[40:43], a[144:147], v[176:179]
  ds_read_b64_tr_b16 v[36:37], v2 offset:49544
  s_add_u32 s51, s35, 2076928
  v_mfma_f32_16x16x32_bf16 v[180:183], v[40:43], a[148:151], v[180:183]
  ds_read_b64_tr_b16 v[38:39], v2 offset:50056
  s_waitcnt lgkmcnt(4)
  v_mfma_f32_16x16x32_bf16 v[184:187], v[40:43], a[152:155], v[184:187]
  s_add_u32 m0, s36, 41216
  v_mfma_f32_16x16x32_bf16 v[188:191], v[40:43], a[156:159], v[188:191]
  buffer_load_dwordx4 v4, s[8:11], s51 offen lds
  v_mfma_f32_16x16x32_bf16 v[192:195], v[44:47], a[144:147], v[192:195]
  ds_read_b64_tr_b16 v[40:41], v3 offset:0
  s_add_u32 s50, s35, 2396416
  v_mfma_f32_16x16x32_bf16 v[196:199], v[44:47], a[148:151], v[196:199]
  ds_read_b64_tr_b16 v[42:43], v3 offset:256
  s_waitcnt lgkmcnt(4)
  v_mfma_f32_16x16x32_bf16 v[200:203], v[44:47], a[152:155], v[200:203]
  s_add_u32 m0, s36, 45344
  v_mfma_f32_16x16x32_bf16 v[204:207], v[44:47], a[156:159], v[204:207]
  buffer_load_dwordx4 v4, s[8:11], s50 offen lds
  v_mfma_f32_16x16x32_bf16 v[208:211], v[32:35], a[144:147], v[208:211]
  ds_read_b64_tr_b16 v[44:45], v3 offset:1024
  v_mfma_f32_16x16x32_bf16 v[212:215], v[32:35], a[148:151], v[212:215]
  ds_read_b64_tr_b16 v[46:47], v3 offset:1280
  s_waitcnt lgkmcnt(4)
  v_mfma_f32_16x16x32_bf16 v[216:219], v[32:35], a[152:155], v[216:219]
  buffer_load_dwordx4 a[108:111], v11, s[20:23], s57 offen offset:3072 sc1
  v_mfma_f32_16x16x32_bf16 v[220:223], v[32:35], a[156:159], v[220:223]
  v_mfma_f32_16x16x32_bf16 v[224:227], v[36:39], a[144:147], v[224:227]
  ds_read_b64_tr_b16 v[32:33], v3 offset:2048
  v_mfma_f32_16x16x32_bf16 v[228:231], v[36:39], a[148:151], v[228:231]
  ds_read_b64_tr_b16 v[34:35], v3 offset:2304
  s_waitcnt lgkmcnt(4)
  v_mfma_f32_16x16x32_bf16 v[232:235], v[36:39], a[152:155], v[232:235]
  v_mfma_f32_16x16x32_bf16 v[236:239], v[36:39], a[156:159], v[236:239]
  v_mfma_f32_16x16x32_bf16 v[240:243], v[40:43], a[208:211], v[240:243]
  ds_read_b64_tr_b16 v[36:37], v3 offset:3072
  v_mfma_f32_16x16x32_bf16 v[244:247], v[40:43], a[212:215], v[244:247]
  ds_read_b64_tr_b16 v[38:39], v3 offset:3328
  s_waitcnt lgkmcnt(4)
  v_mfma_f32_16x16x32_bf16 v[248:251], v[40:43], a[216:219], v[248:251]
  v_mfma_f32_16x16x32_bf16 v[252:255], v[40:43], a[220:223], v[252:255]
  v_mfma_f32_16x16x32_bf16 v[240:243], v[44:47], a[224:227], v[240:243]
  ds_read_b64_tr_b16 v[40:41], v3 offset:4096
  v_mfma_f32_16x16x32_bf16 v[244:247], v[44:47], a[228:231], v[244:247]
  ds_read_b64_tr_b16 v[42:43], v3 offset:4352
  s_waitcnt lgkmcnt(4)
  v_mfma_f32_16x16x32_bf16 v[248:251], v[44:47], a[232:235], v[248:251]
  v_mfma_f32_16x16x32_bf16 v[252:255], v[44:47], a[236:239], v[252:255]
  v_mfma_f32_16x16x32_bf16 v[240:243], v[32:35], a[240:243], v[240:243]
  ds_read_b64_tr_b16 v[44:45], v3 offset:5120
  v_mfma_f32_16x16x32_bf16 v[244:247], v[32:35], a[244:247], v[244:247]
  ds_read_b64_tr_b16 v[46:47], v3 offset:5376
  s_waitcnt lgkmcnt(4)
  v_mfma_f32_16x16x32_bf16 v[248:251], v[32:35], a[248:251], v[248:251]
  v_mfma_f32_16x16x32_bf16 v[252:255], v[32:35], a[252:255], v[252:255]
  v_mfma_f32_16x16x32_bf16 v[240:243], v[36:39], a[112:115], v[240:243]
  ds_read_b64_tr_b16 v[32:33], v1 offset:8192
  v_mfma_f32_16x16x32_bf16 v[244:247], v[36:39], a[116:119], v[244:247]
  ds_read_b64_tr_b16 v[34:35], v1 offset:8704
  s_waitcnt lgkmcnt(4)
  v_mfma_f32_16x16x32_bf16 v[248:251], v[36:39], a[120:123], v[248:251]
  v_mfma_f32_16x16x32_bf16 v[252:255], v[36:39], a[124:127], v[252:255]
  v_mfma_f32_16x16x32_bf16 v[240:243], v[40:43], a[128:131], v[240:243]
  ds_read_b64_tr_b16 v[36:37], v1 offset:8200
  v_mfma_f32_16x16x32_bf16 v[244:247], v[40:43], a[132:135], v[244:247]
  ds_read_b64_tr_b16 v[38:39], v1 offset:8712
  s_waitcnt lgkmcnt(4)
  v_mfma_f32_16x16x32_bf16 v[248:251], v[40:43], a[136:139], v[248:251]
  v_mfma_f32_16x16x32_bf16 v[252:255], v[40:43], a[140:143], v[252:255]
  v_mfma_f32_16x16x32_bf16 v[240:243], v[44:47], a[144:147], v[240:243]
  ds_read_b64_tr_b16 v[40:41], v2 offset:8192
  v_mfma_f32_16x16x32_bf16 v[244:247], v[44:47], a[148:151], v[244:247]
  ds_read_b64_tr_b16 v[42:43], v2 offset:8704
  s_waitcnt vmcnt(19) lgkmcnt(4)
  v_mfma_f32_16x16x32_bf16 v[248:251], v[44:47], a[152:155], v[248:251]
  v_mfma_f32_16x16x32_bf16 v[252:255], v[44:47], a[156:159], v[252:255]
  v_mfma_f32_16x16x32_bf16 v[48:51], v[32:35], a[48:51], v[48:51]
  ds_read_b64_tr_b16 v[44:45], v2 offset:8200
  v_mfma_f32_16x16x32_bf16 v[52:55], v[32:35], a[52:55], v[52:55]
  ds_read_b64_tr_b16 v[46:47], v2 offset:8712
  s_waitcnt lgkmcnt(4)
  v_mfma_f32_16x16x32_bf16 v[56:59], v[32:35], a[56:59], v[56:59]
  s_barrier
  s_add_u32 s51, s35, 1491200
  s_add_u32 m0, s36, 49472
  v_mfma_f32_16x16x32_bf16 v[60:63], v[32:35], a[60:63], v[60:63]
  buffer_load_dwordx4 v4, s[8:11], s51 offen lds
  v_mfma_f32_16x16x32_bf16 v[64:67], v[36:39], a[48:51], v[64:67]
  ds_read_b64_tr_b16 v[32:33], v1 offset:12320
  s_add_u32 s50, s35, 1810688
  v_mfma_f32_16x16x32_bf16 v[68:71], v[36:39], a[52:55], v[68:71]
  ds_read_b64_tr_b16 v[34:35], v1 offset:12832
  s_waitcnt lgkmcnt(4)
  v_mfma_f32_16x16x32_bf16 v[72:75], v[36:39], a[56:59], v[72:75]
  s_add_u32 m0, s36, 0
  v_mfma_f32_16x16x32_bf16 v[76:79], v[36:39], a[60:63], v[76:79]
  buffer_load_dwordx4 v4, s[8:11], s50 offen lds
  v_mfma_f32_16x16x32_bf16 v[80:83], v[40:43], a[48:51], v[80:83]
  ds_read_b64_tr_b16 v[36:37], v1 offset:12328
  v_mfma_f32_16x16x32_bf16 v[84:87], v[40:43], a[52:55], v[84:87]
  ds_read_b64_tr_b16 v[38:39], v1 offset:12840
  s_waitcnt lgkmcnt(4)
  v_mfma_f32_16x16x32_bf16 v[88:91], v[40:43], a[56:59], v[88:91]
  v_mfma_f32_16x16x32_bf16 v[92:95], v[40:43], a[60:63], v[92:95]
  v_mfma_f32_16x16x32_bf16 v[96:99], v[44:47], a[48:51], v[96:99]
  ds_read_b64_tr_b16 v[40:41], v2 offset:12320
  v_mfma_f32_16x16x32_bf16 v[100:103], v[44:47], a[52:55], v[100:103]
  ds_read_b64_tr_b16 v[42:43], v2 offset:12832
  s_waitcnt vmcnt(14) lgkmcnt(4)
  v_mfma_f32_16x16x32_bf16 v[104:107], v[44:47], a[56:59], v[104:107]
  v_mfma_f32_16x16x32_bf16 v[108:111], v[44:47], a[60:63], v[108:111]
  v_mfma_f32_16x16x32_bf16 v[48:51], v[32:35], a[64:67], v[48:51]
  ds_read_b64_tr_b16 v[44:45], v2 offset:12328
  s_add_u32 s54, s72, 40960
  v_mfma_f32_16x16x32_bf16 v[52:55], v[32:35], a[68:71], v[52:55]
  ds_read_b64_tr_b16 v[46:47], v2 offset:12840
  s_waitcnt lgkmcnt(4)
  v_mfma_f32_16x16x32_bf16 v[56:59], v[32:35], a[72:75], v[56:59]
  buffer_load_dword v14, off, s[64:67], s54
  v_mfma_f32_16x16x32_bf16 v[60:63], v[32:35], a[76:79], v[60:63]
  v_mfma_f32_16x16x32_bf16 v[64:67], v[36:39], a[64:67], v[64:67]
  ds_read_b64_tr_b16 v[32:33], v1 offset:16448
  v_mfma_f32_16x16x32_bf16 v[68:71], v[36:39], a[68:71], v[68:71]
  ds_read_b64_tr_b16 v[34:35], v1 offset:16960
  s_waitcnt lgkmcnt(4)
  v_mfma_f32_16x16x32_bf16 v[72:75], v[36:39], a[72:75], v[72:75]
  v_mfma_f32_16x16x32_bf16 v[76:79], v[36:39], a[76:79], v[76:79]
  v_mfma_f32_16x16x32_bf16 v[80:83], v[40:43], a[64:67], v[80:83]
  ds_read_b64_tr_b16 v[36:37], v1 offset:16456
  v_mfma_f32_16x16x32_bf16 v[84:87], v[40:43], a[68:71], v[84:87]
  ds_read_b64_tr_b16 v[38:39], v1 offset:16968
  s_waitcnt lgkmcnt(4)
  v_mfma_f32_16x16x32_bf16 v[88:91], v[40:43], a[72:75], v[88:91]
  v_mfma_f32_16x16x32_bf16 v[92:95], v[40:43], a[76:79], v[92:95]
  v_mfma_f32_16x16x32_bf16 v[96:99], v[44:47], a[64:67], v[96:99]
  ds_read_b64_tr_b16 v[40:41], v2 offset:16448
  v_mfma_f32_16x16x32_bf16 v[100:103], v[44:47], a[68:71], v[100:103]
  ds_read_b64_tr_b16 v[42:43], v2 offset:16960
  s_waitcnt vmcnt(11) lgkmcnt(4)
  v_mfma_f32_16x16x32_bf16 v[104:107], v[44:47], a[72:75], v[104:107]
  v_mfma_f32_16x16x32_bf16 v[108:111], v[44:47], a[76:79], v[108:111]
  v_mfma_f32_16x16x32_bf16 v[48:51], v[32:35], a[80:83], v[48:51]
  ds_read_b64_tr_b16 v[44:45], v2 offset:16456
  v_mfma_f32_16x16x32_bf16 v[52:55], v[32:35], a[84:87], v[52:55]
  ds_read_b64_tr_b16 v[46:47], v2 offset:16968
  s_waitcnt lgkmcnt(4)
  v_mfma_f32_16x16x32_bf16 v[56:59], v[32:35], a[88:91], v[56:59]
  v_mfma_f32_16x16x32_bf16 v[60:63], v[32:35], a[92:95], v[60:63]
  v_mfma_f32_16x16x32_bf16 v[64:67], v[36:39], a[80:83], v[64:67]
  ds_read_b64_tr_b16 v[32:33], v1 offset:20576
  v_mfma_f32_16x16x32_bf16 v[68:71], v[36:39], a[84:87], v[68:71]
  ds_read_b64_tr_b16 v[34:35], v1 offset:21088
  s_waitcnt lgkmcnt(4)
  v_mfma_f32_16x16x32_bf16 v[72:75], v[36:39], a[88:91], v[72:75]
  v_mfma_f32_16x16x32_bf16 v[76:79], v[36:39], a[92:95], v[76:79]
  v_mfma_f32_16x16x32_bf16 v[80:83], v[40:43], a[80:83], v[80:83]
  ds_read_b64_tr_b16 v[36:37], v1 offset:20584
  v_mfma_f32_16x16x32_bf16 v[84:87], v[40:43], a[84:87], v[84:87]
  ds_read_b64_tr_b16 v[38:39], v1 offset:21096
  s_waitcnt lgkmcnt(4)
  v_mfma_f32_16x16x32_bf16 v[88:91], v[40:43], a[88:91], v[88:91]
  v_mfma_f32_16x16x32_bf16 v[92:95], v[40:43], a[92:95], v[92:95]
  v_mfma_f32_16x16x32_bf16 v[96:99], v[44:47], a[80:83], v[96:99]
  ds_read_b64_tr_b16 v[40:41], v2 offset:20576
  v_mfma_f32_16x16x32_bf16 v[100:103], v[44:47], a[84:87], v[100:103]
  ds_read_b64_tr_b16 v[42:43], v2 offset:21088
  s_waitcnt vmcnt(3) lgkmcnt(4)
  v_mfma_f32_16x16x32_bf16 v[104:107], v[44:47], a[88:91], v[104:107]
  v_mfma_f32_16x16x32_bf16 v[108:111], v[44:47], a[92:95], v[108:111]
  v_mfma_f32_16x16x32_bf16 v[48:51], v[32:35], a[96:99], v[48:51]
  ds_read_b64_tr_b16 v[44:45], v2 offset:20584
  v_mfma_f32_16x16x32_bf16 v[52:55], v[32:35], a[100:103], v[52:55]
  ds_read_b64_tr_b16 v[46:47], v2 offset:21096
  s_waitcnt lgkmcnt(4)
  v_mfma_f32_16x16x32_bf16 v[56:59], v[32:35], a[104:107], v[56:59]
  s_barrier
  s_lshr_b32 s51, 0x221c2d27, s37
  s_and_b32 s51, s51, 0xff
  v_mfma_f32_16x16x32_bf16 v[60:63], v[32:35], a[108:111], v[60:63]
  s_mul_i32 s51, s51, 53248
  s_add_u32 s51, s51, s38
  s_add_u32 m0, s39, 4128
  v_mfma_f32_16x16x32_bf16 v[64:67], v[36:39], a[96:99], v[64:67]
  ds_read_b64_tr_b16 v[32:33], v1 offset:24704
  v_mfma_f32_16x16x32_bf16 v[68:71], v[36:39], a[100:103], v[68:71]
  ds_read_b64_tr_b16 v[34:35], v1 offset:25216
  s_waitcnt lgkmcnt(4)
  v_mfma_f32_16x16x32_bf16 v[72:75], v[36:39], a[104:107], v[72:75]
  buffer_load_dwordx4 v6, s[8:11], s51 offen lds
  v_mfma_f32_16x16x32_bf16 v[76:79], v[36:39], a[108:111], v[76:79]
  s_add_u32 s50, s35, 2129920
  s_add_u32 m0, s36, 8224
  v_mfma_f32_16x16x32_bf16 v[80:83], v[40:43], a[96:99], v[80:83]
  ds_read_b64_tr_b16 v[36:37], v1 offset:24712
  v_mfma_f32_16x16x32_bf16 v[84:87], v[40:43], a[100:103], v[84:87]
  ds_read_b64_tr_b16 v[38:39], v1 offset:25224
  s_waitcnt lgkmcnt(4)
  v_mfma_f32_16x16x32_bf16 v[88:91], v[40:43], a[104:107], v[88:91]
  buffer_load_dwordx4 v4, s[8:11], s50 offen lds
  v_mfma_f32_16x16x32_bf16 v[92:95], v[40:43], a[108:111], v[92:95]
  s_add_u32 s51, s35, 2449408
  s_add_u32 m0, s36, 12352
  v_mfma_f32_16x16x32_bf16 v[96:99], v[44:47], a[96:99], v[96:99]
  ds_read_b64_tr_b16 v[40:41], v2 offset:24704
  v_mfma_f32_16x16x32_bf16 v[100:103], v[44:47], a[100:103], v[100:103]
  ds_read_b64_tr_b16 v[42:43], v2 offset:25216
  s_waitcnt lgkmcnt(4)
  v_mfma_f32_16x16x32_bf16 v[104:107], v[44:47], a[104:107], v[104:107]
  buffer_load_dwordx4 v4, s[8:11], s51 offen lds
  v_mfma_f32_16x16x32_bf16 v[108:111], v[44:47], a[108:111], v[108:111]
  ds_read_b128 v[20:23], v15 offset:832
  v_mfma_f32_16x16x32_bf16 v[112:115], v[32:35], a[48:51], v[112:115]
  ds_read_b64_tr_b16 v[44:45], v2 offset:24712
  s_add_u32 s57, s40, 57344
  v_mfma_f32_16x16x32_bf16 v[116:119], v[32:35], a[52:55], v[116:119]
  ds_read_b64_tr_b16 v[46:47], v2 offset:25224
  s_waitcnt lgkmcnt(5)
  v_mfma_f32_16x16x32_bf16 v[120:123], v[32:35], a[56:59], v[120:123]
  ds_read_b128 v[24:27], v15 offset:896
  v_mfma_f32_16x16x32_bf16 v[124:127], v[32:35], a[60:63], v[124:127]
  v_mfma_f32_16x16x32_bf16 v[128:131], v[36:39], a[48:51], v[128:131]
  ds_read_b64_tr_b16 v[32:33], v1 offset:28832
  s_waitcnt lgkmcnt(4)
  v_mfma_f32_16x16x32_bf16 v[132:135], v[36:39], a[52:55], v[132:135]
  ds_read_b64_tr_b16 v[34:35], v1 offset:29344
  v_add_f32 v48, v48, v20
  v_mfma_f32_16x16x32_bf16 v[136:139], v[36:39], a[56:59], v[136:139]
  v_add_f32 v49, v49, v21
  v_add_f32 v50, v50, v22
  v_mfma_f32_16x16x32_bf16 v[140:143], v[36:39], a[60:63], v[140:143]
  v_add_f32 v51, v51, v23
  v_add_f32 v52, v52, v20
  v_mfma_f32_16x16x32_bf16 v[144:147], v[40:43], a[48:51], v[144:147]
  ds_read_b64_tr_b16 v[36:37], v1 offset:28840
  v_add_f32 v53, v53, v21
  v_mfma_f32_16x16x32_bf16 v[148:151], v[40:43], a[52:55], v[148:151]
  ds_read_b64_tr_b16 v[38:39], v1 offset:29352
  v_add_f32 v54, v54, v22
  v_mfma_f32_16x16x32_bf16 v[152:155], v[40:43], a[56:59], v[152:155]
  buffer_load_dwordx4 a[208:211], v11, s[20:23], s57 offen offset:0 sc1
  v_add_f32 v55, v55, v23
  v_mfma_f32_16x16x32_bf16 v[156:159], v[40:43], a[60:63], v[156:159]
  s_waitcnt lgkmcnt(5)
  v_add_f32 v56, v56, v20
  v_add_f32 v57, v57, v21
  v_mfma_f32_16x16x32_bf16 v[160:163], v[44:47], a[48:51], v[160:163]
  ds_read_b64_tr_b16 v[40:41], v2 offset:28832
  v_add_f32 v58, v58, v22
  v_mfma_f32_16x16x32_bf16 v[164:167], v[44:47], a[52:55], v[164:167]
  ds_read_b64_tr_b16 v[42:43], v2 offset:29344
  v_add_f32 v59, v59, v23
  v_mfma_f32_16x16x32_bf16 v[168:171], v[44:47], a[56:59], v[168:171]
  buffer_load_dwordx4 a[212:215], v11, s[20:23], s57 offen offset:1024 sc1
  v_add_f32 v60, v60, v20
  v_mfma_f32_16x16x32_bf16 v[172:175], v[44:47], a[60:63], v[172:175]
  s_waitcnt lgkmcnt(4)
  v_add_f32 v61, v61, v21
  v_add_f32 v62, v62, v22
  v_mfma_f32_16x16x32_bf16 v[112:115], v[32:35], a[64:67], v[112:115]
  ds_read_b64_tr_b16 v[44:45], v2 offset:28840
  v_add_f32 v63, v63, v23
  v_mfma_f32_16x16x32_bf16 v[116:119], v[32:35], a[68:71], v[116:119]
  ds_read_b64_tr_b16 v[46:47], v2 offset:29352
  v_add_f32 v64, v64, v24
  v_mfma_f32_16x16x32_bf16 v[120:123], v[32:35], a[72:75], v[120:123]
  ds_read_b128 v[20:23], v15 offset:960
  v_add_f32 v65, v65, v25
  v_mfma_f32_16x16x32_bf16 v[124:127], v[32:35], a[76:79], v[124:127]
  s_waitcnt lgkmcnt(5)
  v_add_f32 v66, v66, v26
  v_add_f32 v67, v67, v27
  v_mfma_f32_16x16x32_bf16 v[128:131], v[36:39], a[64:67], v[128:131]
  ds_read_b64_tr_b16 v[32:33], v1 offset:32960
  v_add_f32 v68, v68, v24
  v_mfma_f32_16x16x32_bf16 v[132:135], v[36:39], a[68:71], v[132:135]
  ds_read_b64_tr_b16 v[34:35], v1 offset:33472
  v_add_f32 v69, v69, v25
  v_mfma_f32_16x16x32_bf16 v[136:139], v[36:39], a[72:75], v[136:139]
  buffer_load_dwordx4 a[216:219], v11, s[20:23], s57 offen offset:2048 sc1
  v_add_f32 v70, v70, v26
  v_mfma_f32_16x16x32_bf16 v[140:143], v[36:39], a[76:79], v[140:143]
  s_waitcnt lgkmcnt(5)
  v_add_f32 v71, v71, v27
  v_add_f32 v72, v72, v24
  v_mfma_f32_16x16x32_bf16 v[144:147], v[40:43], a[64:67], v[144:147]
  ds_read_b64_tr_b16 v[36:37], v1 offset:32968
  v_add_f32 v73, v73, v25
  v_mfma_f32_16x16x32_bf16 v[148:151], v[40:43], a[68:71], v[148:151]
  ds_read_b64_tr_b16 v[38:39], v1 offset:33480
  v_add_f32 v74, v74, v26
  v_mfma_f32_16x16x32_bf16 v[152:155], v[40:43], a[72:75], v[152:155]
  buffer_load_dwordx4 a[220:223], v11, s[20:23], s57 offen offset:3072 sc1
  v_add_f32 v75, v75, v27
  v_mfma_f32_16x16x32_bf16 v[156:159], v[40:43], a[76:79], v[156:159]
  s_waitcnt lgkmcnt(5)
  s_add_u32 s57, s40, 81920
  v_add_f32 v76, v76, v24
  v_mfma_f32_16x16x32_bf16 v[160:163], v[44:47], a[64:67], v[160:163]
  ds_read_b64_tr_b16 v[40:41], v2 offset:32960
  v_add_f32 v77, v77, v25
  v_mfma_f32_16x16x32_bf16 v[164:167], v[44:47], a[68:71], v[164:167]
  ds_read_b64_tr_b16 v[42:43], v2 offset:33472
  v_add_f32 v78, v78, v26
  v_mfma_f32_16x16x32_bf16 v[168:171], v[44:47], a[72:75], v[168:171]
  buffer_load_dwordx4 a[224:227], v11, s[20:23], s57 offen offset:0 sc1
  v_add_f32 v79, v79, v27
  v_mfma_f32_16x16x32_bf16 v[172:175], v[44:47], a[76:79], v[172:175]
  s_waitcnt lgkmcnt(4)
  ds_read_b128 v[24:27], v15 offset:1024
  v_mfma_f32_16x16x32_bf16 v[112:115], v[32:35], a[80:83], v[112:115]
  ds_read_b64_tr_b16 v[44:45], v2 offset:32968
  v_add_f32 v80, v80, v20
  v_mfma_f32_16x16x32_bf16 v[116:119], v[32:35], a[84:87], v[116:119]
  ds_read_b64_tr_b16 v[46:47], v2 offset:33480
  s_waitcnt lgkmcnt(5)
  v_mfma_f32_16x16x32_bf16 v[120:123], v[32:35], a[88:91], v[120:123]
  s_barrier
  s_add_u32 s50, s35, 1544192
  s_add_u32 m0, s36, 16480
  v_mfma_f32_16x16x32_bf16 v[124:127], v[32:35], a[92:95], v[124:127]
  buffer_load_dwordx4 v4, s[8:11], s50 offen lds
  v_mfma_f32_16x16x32_bf16 v[128:131], v[36:39], a[80:83], v[128:131]
  ds_read_b64_tr_b16 v[32:33], v1 offset:37088
  s_add_u32 s51, s35, 2130048
  v_mfma_f32_16x16x32_bf16 v[132:135], v[36:39], a[84:87], v[132:135]
  ds_read_b64_tr_b16 v[34:35], v1 offset:37600
  s_add_u32 m0, s36, 20608
  v_mfma_f32_16x16x32_bf16 v[136:139], v[36:39], a[88:91], v[136:139]
  buffer_load_dwordx4 v4, s[8:11], s51 offen lds
  v_mfma_f32_16x16x32_bf16 v[140:143], v[36:39], a[92:95], v[140:143]
  s_waitcnt lgkmcnt(5)
  s_add_u32 s50, s35, 2449536
  s_add_u32 m0, s36, 24736
  v_mfma_f32_16x16x32_bf16 v[144:147], v[40:43], a[80:83], v[144:147]
  ds_read_b64_tr_b16 v[36:37], v1 offset:37096
  v_add_f32 v81, v81, v21
  v_mfma_f32_16x16x32_bf16 v[148:151], v[40:43], a[84:87], v[148:151]
  ds_read_b64_tr_b16 v[38:39], v1 offset:37608
  v_add_f32 v82, v82, v22
  v_mfma_f32_16x16x32_bf16 v[152:155], v[40:43], a[88:91], v[152:155]
  buffer_load_dwordx4 v4, s[8:11], s50 offen lds
  v_mfma_f32_16x16x32_bf16 v[156:159], v[40:43], a[92:95], v[156:159]
  s_waitcnt lgkmcnt(4)
  v_add_f32 v83, v83, v23
  v_add_f32 v84, v84, v20
  v_mfma_f32_16x16x32_bf16 v[160:163], v[44:47], a[80:83], v[160:163]
  ds_read_b64_tr_b16 v[40:41], v2 offset:37088
  v_add_f32 v85, v85, v21
  v_mfma_f32_16x16x32_bf16 v[164:167], v[44:47], a[84:87], v[164:167]
  ds_read_b64_tr_b16 v[42:43], v2 offset:37600
  v_add_f32 v86, v86, v22
  v_mfma_f32_16x16x32_bf16 v[168:171], v[44:47], a[88:91], v[168:171]
  buffer_load_dwordx4 a[228:231], v11, s[20:23], s57 offen offset:1024 sc1
  v_add_f32 v87, v87, v23
  v_mfma_f32_16x16x32_bf16 v[172:175], v[44:47], a[92:95], v[172:175]
  s_waitcnt lgkmcnt(4)
  v_add_f32 v88, v88, v20
  v_add_f32 v89, v89, v21
  v_mfma_f32_16x16x32_bf16 v[112:115], v[32:35], a[96:99], v[112:115]
  ds_read_b64_tr_b16 v[44:45], v2 offset:37096
  v_add_f32 v90, v90, v22
  v_mfma_f32_16x16x32_bf16 v[116:119], v[32:35], a[100:103], v[116:119]
  ds_read_b64_tr_b16 v[46:47], v2 offset:37608
  v_add_f32 v91, v91, v23
  v_mfma_f32_16x16x32_bf16 v[120:123], v[32:35], a[104:107], v[120:123]
  buffer_load_dwordx4 a[232:235], v11, s[20:23], s57 offen offset:2048 sc1
  v_add_f32 v92, v92, v20
  v_mfma_f32_16x16x32_bf16 v[124:127], v[32:35], a[108:111], v[124:127]
  s_waitcnt lgkmcnt(4)
  v_add_f32 v93, v93, v21
  v_add_f32 v94, v94, v22
  v_mfma_f32_16x16x32_bf16 v[128:131], v[36:39], a[96:99], v[128:131]
  ds_read_b64_tr_b16 v[32:33], v1 offset:41216
  v_add_f32 v95, v95, v23
  v_mfma_f32_16x16x32_bf16 v[132:135], v[36:39], a[100:103], v[132:135]
  ds_read_b64_tr_b16 v[34:35], v1 offset:41728
  v_add_f32 v96, v96, v24
  v_mfma_f32_16x16x32_bf16 v[136:139], v[36:39], a[104:107], v[136:139]
  v_add_f32 v97, v97, v25
  v_add_f32 v98, v98, v26
  v_mfma_f32_16x16x32_bf16 v[140:143], v[36:39], a[108:111], v[140:143]
  s_waitcnt lgkmcnt(4)
  v_add_f32 v99, v99, v27
  v_add_f32 v100, v100, v24
  v_mfma_f32_16x16x32_bf16 v[144:147], v[40:43], a[96:99], v[144:147]
  ds_read_b64_tr_b16 v[36:37], v1 offset:41224
  v_add_f32 v101, v101, v25
  v_mfma_f32_16x16x32_bf16 v[148:151], v[40:43], a[100:103], v[148:151]
  ds_read_b64_tr_b16 v[38:39], v1 offset:41736
  v_add_f32 v102, v102, v26
  v_mfma_f32_16x16x32_bf16 v[152:155], v[40:43], a[104:107], v[152:155]
  buffer_load_dwordx4 a[236:239], v11, s[20:23], s57 offen offset:3072 sc1
  v_add_f32 v103, v103, v27
  v_mfma_f32_16x16x32_bf16 v[156:159], v[40:43], a[108:111], v[156:159]
  s_waitcnt lgkmcnt(4)
  s_add_u32 s56, s40, 12288
  v_add_f32 v104, v104, v24
  v_mfma_f32_16x16x32_bf16 v[160:163], v[44:47], a[96:99], v[160:163]
  ds_read_b64_tr_b16 v[40:41], v2 offset:41216
  v_add_f32 v105, v105, v25
  v_mfma_f32_16x16x32_bf16 v[164:167], v[44:47], a[100:103], v[164:167]
  ds_read_b64_tr_b16 v[42:43], v2 offset:41728
  v_add_f32 v106, v106, v26
  v_mfma_f32_16x16x32_bf16 v[168:171], v[44:47], a[104:107], v[168:171]
  buffer_load_dwordx4 a[240:243], v11, s[20:23], s56 offen offset:0 sc1
  v_add_f32 v107, v107, v27
  v_mfma_f32_16x16x32_bf16 v[172:175], v[44:47], a[108:111], v[172:175]
  s_waitcnt lgkmcnt(4)
  ds_read_b128 v[20:23], v15 offset:1088
  v_mfma_f32_16x16x32_bf16 v[176:179], v[32:35], a[48:51], v[176:179]
  ds_read_b64_tr_b16 v[44:45], v2 offset:41224
  v_add_f32 v108, v108, v24
  v_mfma_f32_16x16x32_bf16 v[180:183], v[32:35], a[52:55], v[180:183]
  ds_read_b64_tr_b16 v[46:47], v2 offset:41736
  v_add_f32 v109, v109, v25
  v_mfma_f32_16x16x32_bf16 v[184:187], v[32:35], a[56:59], v[184:187]
  buffer_load_dwordx4 a[244:247], v11, s[20:23], s56 offen offset:1024 sc1
  v_add_f32 v110, v110, v26
  v_mfma_f32_16x16x32_bf16 v[188:191], v[32:35], a[60:63], v[188:191]
  s_waitcnt lgkmcnt(5)
  v_add_f32 v111, v111, v27
  v_mfma_f32_16x16x32_bf16 v[192:195], v[36:39], a[48:51], v[192:195]
  ds_read_b64_tr_b16 v[32:33], v1 offset:45344
  s_waitcnt lgkmcnt(3)
  v_mfma_f32_16x16x32_bf16 v[196:199], v[36:39], a[52:55], v[196:199]
  ds_read_b64_tr_b16 v[34:35], v1 offset:45856
  v_add_f32 v112, v112, v20
  v_mfma_f32_16x16x32_bf16 v[200:203], v[36:39], a[56:59], v[200:203]
  buffer_load_dwordx4 a[248:251], v11, s[20:23], s56 offen offset:2048 sc1
  v_add_f32 v113, v113, v21
  v_mfma_f32_16x16x32_bf16 v[204:207], v[36:39], a[60:63], v[204:207]
  ds_read_b128 v[24:27], v15 offset:1152
  v_add_f32 v114, v114, v22
  v_mfma_f32_16x16x32_bf16 v[208:211], v[40:43], a[48:51], v[208:211]
  ds_read_b64_tr_b16 v[36:37], v1 offset:45352
  v_add_f32 v115, v115, v23
  v_mfma_f32_16x16x32_bf16 v[212:215], v[40:43], a[52:55], v[212:215]
  ds_read_b64_tr_b16 v[38:39], v1 offset:45864
  v_add_f32 v116, v116, v20
  v_mfma_f32_16x16x32_bf16 v[216:219], v[40:43], a[56:59], v[216:219]
  buffer_load_dwordx4 a[252:255], v11, s[20:23], s56 offen offset:3072 sc1
  v_add_f32 v117, v117, v21
  v_mfma_f32_16x16x32_bf16 v[220:223], v[40:43], a[60:63], v[220:223]
  s_waitcnt lgkmcnt(5)
  v_add_f32 v118, v118, v22
  v_add_f32 v119, v119, v23
  v_mfma_f32_16x16x32_bf16 v[224:227], v[44:47], a[48:51], v[224:227]
  ds_read_b64_tr_b16 v[40:41], v2 offset:45344
  v_add_f32 v120, v120, v20
  v_mfma_f32_16x16x32_bf16 v[228:231], v[44:47], a[52:55], v[228:231]
  ds_read_b64_tr_b16 v[42:43], v2 offset:45856
  v_add_f32 v121, v121, v21
  v_mfma_f32_16x16x32_bf16 v[232:235], v[44:47], a[56:59], v[232:235]
  s_waitcnt lgkmcnt(5)
  v_add_f32 v122, v122, v22
  v_add_f32 v123, v123, v23
  v_mfma_f32_16x16x32_bf16 v[236:239], v[44:47], a[60:63], v[236:239]
  v_add_f32 v124, v124, v20
  v_add_f32 v125, v125, v21
  v_mfma_f32_16x16x32_bf16 v[176:179], v[32:35], a[64:67], v[176:179]
  ds_read_b64_tr_b16 v[44:45], v2 offset:45352
  v_add_f32 v126, v126, v22
  v_mfma_f32_16x16x32_bf16 v[180:183], v[32:35], a[68:71], v[180:183]
  ds_read_b64_tr_b16 v[46:47], v2 offset:45864
  s_waitcnt vmcnt(17) lgkmcnt(4)
  v_mfma_f32_16x16x32_bf16 v[184:187], v[32:35], a[72:75], v[184:187]
  s_barrier
  s_add_u32 s51, s35, 1544320
  s_add_u32 m0, s36, 28864
  v_mfma_f32_16x16x32_bf16 v[188:191], v[32:35], a[76:79], v[188:191]
  buffer_load_dwordx4 v4, s[8:11], s51 offen lds
  v_mfma_f32_16x16x32_bf16 v[192:195], v[36:39], a[64:67], v[192:195]
  ds_read_b64_tr_b16 v[32:33], v1 offset:49472
  s_add_u32 s50, s35, 2130176
  v_mfma_f32_16x16x32_bf16 v[196:199], v[36:39], a[68:71], v[196:199]
  ds_read_b64_tr_b16 v[34:35], v1 offset:49984
  s_add_u32 m0, s36, 32992
  v_mfma_f32_16x16x32_bf16 v[200:203], v[36:39], a[72:75], v[200:203]
  buffer_load_dword v19, v18, s[20:23], 0 offen sc1
  v_add_f32 v127, v127, v23
  v_mfma_f32_16x16x32_bf16 v[204:207], v[36:39], a[76:79], v[204:207]
  s_waitcnt lgkmcnt(4)
  ds_read_b128 v[20:23], v15 offset:1216
  v_mfma_f32_16x16x32_bf16 v[208:211], v[40:43], a[64:67], v[208:211]
  ds_read_b64_tr_b16 v[36:37], v1 offset:49480
  v_add_f32 v128, v128, v24
  v_mfma_f32_16x16x32_bf16 v[212:215], v[40:43], a[68:71], v[212:215]
  ds_read_b64_tr_b16 v[38:39], v1 offset:49992
  v_add_f32 v129, v129, v25
  v_mfma_f32_16x16x32_bf16 v[216:219], v[40:43], a[72:75], v[216:219]
  buffer_load_dwordx4 v4, s[8:11], s50 offen lds
  v_mfma_f32_16x16x32_bf16 v[220:223], v[40:43], a[76:79], v[220:223]
  s_waitcnt lgkmcnt(5)
  s_add_u32 s51, s35, 2449664
  s_add_u32 m0, s36, 37120
  v_mfma_f32_16x16x32_bf16 v[224:227], v[44:47], a[64:67], v[224:227]
  ds_read_b64_tr_b16 v[40:41], v2 offset:49472
  v_add_f32 v130, v130, v26
  v_mfma_f32_16x16x32_bf16 v[228:231], v[44:47], a[68:71], v[228:231]
  ds_read_b64_tr_b16 v[42:43], v2 offset:49984
  v_add_f32 v131, v131, v27
  v_mfma_f32_16x16x32_bf16 v[232:235], v[44:47], a[72:75], v[232:235]
  buffer_load_dwordx4 v4, s[8:11], s51 offen lds
  v_mfma_f32_16x16x32_bf16 v[236:239], v[44:47], a[76:79], v[236:239]
  s_waitcnt lgkmcnt(5)
  v_add_f32 v132, v132, v24
  v_add_f32 v133, v133, v25
  v_mfma_f32_16x16x32_bf16 v[176:179], v[32:35], a[80:83], v[176:179]
  ds_read_b64_tr_b16 v[44:45], v2 offset:49480
  v_add_f32 v134, v134, v26
  v_mfma_f32_16x16x32_bf16 v[180:183], v[32:35], a[84:87], v[180:183]
  ds_read_b64_tr_b16 v[46:47], v2 offset:49992
  v_add_f32 v135, v135, v27
  v_mfma_f32_16x16x32_bf16 v[184:187], v[32:35], a[88:91], v[184:187]
  s_waitcnt lgkmcnt(4)
  v_add_f32 v136, v136, v24
  v_add_f32 v137, v137, v25
  v_mfma_f32_16x16x32_bf16 v[188:191], v[32:35], a[92:95], v[188:191]
  v_add_f32 v138, v138, v26
  v_add_f32 v139, v139, v27
  v_mfma_f32_16x16x32_bf16 v[192:195], v[36:39], a[80:83], v[192:195]
  ds_read_b64_tr_b16 v[32:33], v1 offset:0
  s_add_u32 s56, s40, 36864
  v_mfma_f32_16x16x32_bf16 v[196:199], v[36:39], a[84:87], v[196:199]
  ds_read_b64_tr_b16 v[34:35], v1 offset:512
  v_add_f32 v140, v140, v24
  v_mfma_f32_16x16x32_bf16 v[200:203], v[36:39], a[88:91], v[200:203]
  buffer_load_dwordx4 a[112:115], v11, s[20:23], s56 offen offset:0 sc1
  v_add_f32 v141, v141, v25
  v_mfma_f32_16x16x32_bf16 v[204:207], v[36:39], a[92:95], v[204:207]
  s_waitcnt lgkmcnt(4)
  v_add_f32 v142, v142, v26
  v_add_f32 v143, v143, v27
  v_mfma_f32_16x16x32_bf16 v[208:211], v[40:43], a[80:83], v[208:211]
  ds_read_b64_tr_b16 v[36:37], v1 offset:8
  v_add_f32 v144, v144, v20
  v_mfma_f32_16x16x32_bf16 v[212:215], v[40:43], a[84:87], v[212:215]
  ds_read_b64_tr_b16 v[38:39], v1 offset:520
  v_add_f32 v145, v145, v21
  v_mfma_f32_16x16x32_bf16 v[216:219], v[40:43], a[88:91], v[216:219]
  buffer_load_dwordx4 a[116:119], v11, s[20:23], s56 offen offset:1024 sc1
  v_add_f32 v146, v146, v22
  v_mfma_f32_16x16x32_bf16 v[220:223], v[40:43], a[92:95], v[220:223]
  s_waitcnt lgkmcnt(4)
  ds_read_b128 v[24:27], v15 offset:1280
  v_mfma_f32_16x16x32_bf16 v[224:227], v[44:47], a[80:83], v[224:227]
  ds_read_b64_tr_b16 v[40:41], v2 offset:0
  v_add_f32 v147, v147, v23
  v_mfma_f32_16x16x32_bf16 v[228:231], v[44:47], a[84:87], v[228:231]
  ds_read_b64_tr_b16 v[42:43], v2 offset:512
  v_add_f32 v148, v148, v20
  v_mfma_f32_16x16x32_bf16 v[232:235], v[44:47], a[88:91], v[232:235]
  buffer_load_dwordx4 a[120:123], v11, s[20:23], s56 offen offset:2048 sc1
  v_add_f32 v149, v149, v21
  v_mfma_f32_16x16x32_bf16 v[236:239], v[44:47], a[92:95], v[236:239]
  s_waitcnt lgkmcnt(5)
  v_add_f32 v150, v150, v22
  v_add_f32 v151, v151, v23
  v_mfma_f32_16x16x32_bf16 v[176:179], v[32:35], a[96:99], v[176:179]
  ds_read_b64_tr_b16 v[44:45], v2 offset:8
  v_add_f32 v152, v152, v20
  v_mfma_f32_16x16x32_bf16 v[180:183], v[32:35], a[100:103], v[180:183]
  ds_read_b64_tr_b16 v[46:47], v2 offset:520
  v_add_f32 v153, v153, v21
  v_mfma_f32_16x16x32_bf16 v[184:187], v[32:35], a[104:107], v[184:187]
  buffer_load_dwordx4 a[124:127], v11, s[20:23], s56 offen offset:3072 sc1
  v_add_f32 v154, v154, v22
  v_mfma_f32_16x16x32_bf16 v[188:191], v[32:35], a[108:111], v[188:191]
  s_waitcnt lgkmcnt(5)
  v_add_f32 v155, v155, v23
  v_add_f32 v156, v156, v20
  v_mfma_f32_16x16x32_bf16 v[192:195], v[36:39], a[96:99], v[192:195]
  ds_read_b64_tr_b16 v[32:33], v3 offset:4128
  s_add_u32 s56, s40, 61440
  v_mfma_f32_16x16x32_bf16 v[196:199], v[36:39], a[100:103], v[196:199]
  ds_read_b64_tr_b16 v[34:35], v3 offset:4384
  v_add_f32 v157, v157, v21
  v_mfma_f32_16x16x32_bf16 v[200:203], v[36:39], a[104:107], v[200:203]
  buffer_load_dwordx4 a[128:131], v11, s[20:23], s56 offen offset:0 sc1
  v_add_f32 v158, v158, v22
  v_mfma_f32_16x16x32_bf16 v[204:207], v[36:39], a[108:111], v[204:207]
  s_waitcnt lgkmcnt(4)
  v_add_f32 v159, v159, v23
  v_add_f32 v160, v160, v24
  v_mfma_f32_16x16x32_bf16 v[208:211], v[40:43], a[96:99], v[208:211]
  ds_read_b64_tr_b16 v[36:37], v3 offset:5152
  v_add_f32 v161, v161, v25
  v_mfma_f32_16x16x32_bf16 v[212:215], v[40:43], a[100:103], v[212:215]
  ds_read_b64_tr_b16 v[38:39], v3 offset:5408
  v_add_f32 v162, v162, v26
  v_mfma_f32_16x16x32_bf16 v[216:219], v[40:43], a[104:107], v[216:219]
  buffer_load_dwordx4 a[132:135], v11, s[20:23], s56 offen offset:1024 sc1
  v_add_f32 v163, v163, v27
  v_mfma_f32_16x16x32_bf16 v[220:223], v[40:43], a[108:111], v[220:223]
  s_waitcnt lgkmcnt(4)
  v_add_f32 v164, v164, v24
  v_add_f32 v165, v165, v25
  v_mfma_f32_16x16x32_bf16 v[224:227], v[44:47], a[96:99], v[224:227]
  ds_read_b64_tr_b16 v[40:41], v3 offset:6176
  v_add_f32 v166, v166, v26
  v_mfma_f32_16x16x32_bf16 v[228:231], v[44:47], a[100:103], v[228:231]
  ds_read_b64_tr_b16 v[42:43], v3 offset:6432
  v_add_f32 v167, v167, v27
  v_mfma_f32_16x16x32_bf16 v[232:235], v[44:47], a[104:107], v[232:235]
  buffer_load_dwordx4 a[136:139], v11, s[20:23], s56 offen offset:2048 sc1
  v_add_f32 v168, v168, v24
  v_mfma_f32_16x16x32_bf16 v[236:239], v[44:47], a[108:111], v[236:239]
  s_waitcnt lgkmcnt(4)
  ds_read_b128 v[20:23], v15 offset:1344
  v_mfma_f32_16x16x32_bf16 v[240:243], v[32:35], a[48:51], v[240:243]
  ds_read_b64_tr_b16 v[44:45], v3 offset:7200
  v_add_f32 v169, v169, v25
  v_mfma_f32_16x16x32_bf16 v[244:247], v[32:35], a[52:55], v[244:247]
  ds_read_b64_tr_b16 v[46:47], v3 offset:7456
  s_waitcnt vmcnt(20) lgkmcnt(5)
  v_mfma_f32_16x16x32_bf16 v[248:251], v[32:35], a[56:59], v[248:251]
  s_barrier
  s_add_u32 s50, s35, 1544448
  s_add_u32 m0, s36, 41248
  v_mfma_f32_16x16x32_bf16 v[252:255], v[32:35], a[60:63], v[252:255]
  buffer_load_dwordx4 v4, s[8:11], s50 offen lds
  v_mfma_f32_16x16x32_bf16 v[240:243], v[36:39], a[64:67], v[240:243]
  ds_read_b64_tr_b16 v[32:33], v1 offset:8224
  s_lshr_b32 s51, 0x1d1d2e28, s37
  v_mfma_f32_16x16x32_bf16 v[244:247], v[36:39], a[68:71], v[244:247]
  ds_read_b64_tr_b16 v[34:35], v1 offset:8736
  s_and_b32 s51, s51, 0xff
  v_mfma_f32_16x16x32_bf16 v[248:251], v[36:39], a[72:75], v[248:251]
  buffer_load_dwordx4 a[140:143], v11, s[20:23], s56 offen offset:3072 sc1
  v_add_f32 v170, v170, v26
  v_mfma_f32_16x16x32_bf16 v[252:255], v[36:39], a[76:79], v[252:255]
  s_waitcnt lgkmcnt(5)
  s_mul_i32 s51, s51, 53248
  s_add_u32 s51, s51, s38
  v_mfma_f32_16x16x32_bf16 v[240:243], v[40:43], a[80:83], v[240:243]
  ds_read_b64_tr_b16 v[36:37], v1 offset:8232
  s_add_u32 m0, s39, 45376
  v_mfma_f32_16x16x32_bf16 v[244:247], v[40:43], a[84:87], v[244:247]
  ds_read_b64_tr_b16 v[38:39], v1 offset:8744
  s_add_u32 s56, s40, 86016
  v_mfma_f32_16x16x32_bf16 v[248:251], v[40:43], a[88:91], v[248:251]
  buffer_load_dwordx4 v6, s[8:11], s51 offen lds
  v_mfma_f32_16x16x32_bf16 v[252:255], v[40:43], a[92:95], v[252:255]
  s_waitcnt lgkmcnt(4)
  s_add_u32 s50, s35, 1863680
  v_add_f32 v171, v171, v27
  v_mfma_f32_16x16x32_bf16 v[240:243], v[44:47], a[96:99], v[240:243]
  ds_read_b64_tr_b16 v[40:41], v2 offset:8224
  v_add_f32 v172, v172, v24
  v_mfma_f32_16x16x32_bf16 v[244:247], v[44:47], a[100:103], v[244:247]
  ds_read_b64_tr_b16 v[42:43], v2 offset:8736
  v_add_f32 v173, v173, v25
  v_mfma_f32_16x16x32_bf16 v[248:251], v[44:47], a[104:107], v[248:251]
  s_add_u32 m0, s36, 49472
  v_add_f32 v174, v174, v26
  v_add_f32 v175, v175, v27
  v_mfma_f32_16x16x32_bf16 v[252:255], v[44:47], a[108:111], v[252:255]
  s_waitcnt lgkmcnt(4)
  ds_read_b128 v[24:27], v15 offset:1408
  v_mfma_f32_16x16x32_bf16 v[48:51], v[32:35], a[208:211], v[48:51]
  ds_read_b64_tr_b16 v[44:45], v2 offset:8232
  v_add_f32 v176, v176, v20
  v_mfma_f32_16x16x32_bf16 v[52:55], v[32:35], a[212:215], v[52:55]
  ds_read_b64_tr_b16 v[46:47], v2 offset:8744
  v_add_f32 v177, v177, v21
  v_mfma_f32_16x16x32_bf16 v[56:59], v[32:35], a[216:219], v[56:59]
  buffer_load_dwordx4 v4, s[8:11], s50 offen lds
  v_mfma_f32_16x16x32_bf16 v[60:63], v[32:35], a[220:223], v[60:63]
  s_waitcnt lgkmcnt(5)
  s_add_u32 s51, s35, 2183168
  s_add_u32 m0, s36, 0
  v_mfma_f32_16x16x32_bf16 v[64:67], v[36:39], a[208:211], v[64:67]
  ds_read_b64_tr_b16 v[32:33], v1 offset:12352
  v_add_f32 v178, v178, v22
  v_mfma_f32_16x16x32_bf16 v[68:71], v[36:39], a[212:215], v[68:71]
  ds_read_b64_tr_b16 v[34:35], v1 offset:12864
  v_add_f32 v179, v179, v23
  v_mfma_f32_16x16x32_bf16 v[72:75], v[36:39], a[216:219], v[72:75]
  buffer_load_dwordx4 v4, s[8:11], s51 offen lds
  v_mfma_f32_16x16x32_bf16 v[76:79], v[36:39], a[220:223], v[76:79]
  s_waitcnt lgkmcnt(5)
  v_add_f32 v180, v180, v20
  v_add_f32 v181, v181, v21
  v_mfma_f32_16x16x32_bf16 v[80:83], v[40:43], a[208:211], v[80:83]
  ds_read_b64_tr_b16 v[36:37], v1 offset:12360
  v_add_f32 v182, v182, v22
  v_mfma_f32_16x16x32_bf16 v[84:87], v[40:43], a[212:215], v[84:87]
  ds_read_b64_tr_b16 v[38:39], v1 offset:12872
  v_add_f32 v183, v183, v23
  v_mfma_f32_16x16x32_bf16 v[88:91], v[40:43], a[216:219], v[88:91]
  v_add_f32 v184, v184, v20
  v_add_f32 v185, v185, v21
  v_mfma_f32_16x16x32_bf16 v[92:95], v[40:43], a[220:223], v[92:95]
  s_waitcnt lgkmcnt(4)
  v_add_f32 v186, v186, v22
  v_add_f32 v187, v187, v23
  v_mfma_f32_16x16x32_bf16 v[96:99], v[44:47], a[208:211], v[96:99]
  ds_read_b64_tr_b16 v[40:41], v2 offset:12352
  v_add_f32 v188, v188, v20
  v_mfma_f32_16x16x32_bf16 v[100:103], v[44:47], a[212:215], v[100:103]
  ds_read_b64_tr_b16 v[42:43], v2 offset:12864
  v_add_f32 v189, v189, v21
  v_mfma_f32_16x16x32_bf16 v[104:107], v[44:47], a[216:219], v[104:107]
  v_add_f32 v190, v190, v22
  v_add_f32 v191, v191, v23
  v_mfma_f32_16x16x32_bf16 v[108:111], v[44:47], a[220:223], v[108:111]
  s_waitcnt vmcnt(20) lgkmcnt(4)
  ds_read_b128 v[20:23], v15 offset:1472
  v_mfma_f32_16x16x32_bf16 v[48:51], v[32:35], a[224:227], v[48:51]
  ds_read_b64_tr_b16 v[44:45], v2 offset:12360
  v_add_f32 v192, v192, v24
  v_mfma_f32_16x16x32_bf16 v[52:55], v[32:35], a[228:231], v[52:55]
  ds_read_b64_tr_b16 v[46:47], v2 offset:12872
  v_add_f32 v193, v193, v25
  v_mfma_f32_16x16x32_bf16 v[56:59], v[32:35], a[232:235], v[56:59]
  buffer_load_dwordx4 a[144:147], v11, s[20:23], s56 offen offset:0 sc1
  v_add_f32 v194, v194, v26
  v_mfma_f32_16x16x32_bf16 v[60:63], v[32:35], a[236:239], v[60:63]
  s_waitcnt lgkmcnt(5)
  v_add_f32 v195, v195, v27
  v_add_f32 v196, v196, v24
  v_mfma_f32_16x16x32_bf16 v[64:67], v[36:39], a[224:227], v[64:67]
  ds_read_b64_tr_b16 v[32:33], v1 offset:16480
  v_add_f32 v197, v197, v25
  v_mfma_f32_16x16x32_bf16 v[68:71], v[36:39], a[228:231], v[68:71]
  ds_read_b64_tr_b16 v[34:35], v1 offset:16992
  v_add_f32 v198, v198, v26
  v_mfma_f32_16x16x32_bf16 v[72:75], v[36:39], a[232:235], v[72:75]
  v_add_f32 v199, v199, v27
  v_add_f32 v200, v200, v24
  v_mfma_f32_16x16x32_bf16 v[76:79], v[36:39], a[236:239], v[76:79]
  s_waitcnt lgkmcnt(5)
  v_add_f32 v201, v201, v25
  v_add_f32 v202, v202, v26
  v_mfma_f32_16x16x32_bf16 v[80:83], v[40:43], a[224:227], v[80:83]
  ds_read_b64_tr_b16 v[36:37], v1 offset:16488
  v_add_f32 v203, v203, v27
  v_mfma_f32_16x16x32_bf16 v[84:87], v[40:43], a[228:231], v[84:87]
  ds_read_b64_tr_b16 v[38:39], v1 offset:17000
  v_add_f32 v204, v204, v24
  v_mfma_f32_16x16x32_bf16 v[88:91], v[40:43], a[232:235], v[88:91]
  buffer_load_dwordx4 a[148:151], v11, s[20:23], s56 offen offset:1024 sc1
  v_add_f32 v205, v205, v25
  v_mfma_f32_16x16x32_bf16 v[92:95], v[40:43], a[236:239], v[92:95]
  s_waitcnt lgkmcnt(4)
  v_add_f32 v206, v206, v26
  v_add_f32 v207, v207, v27
  v_mfma_f32_16x16x32_bf16 v[96:99], v[44:47], a[224:227], v[96:99]
  ds_read_b64_tr_b16 v[40:41], v2 offset:16480
  v_add_f32 v208, v208, v20
  v_mfma_f32_16x16x32_bf16 v[100:103], v[44:47], a[228:231], v[100:103]
  ds_read_b64_tr_b16 v[42:43], v2 offset:16992
  v_add_f32 v209, v209, v21
  v_mfma_f32_16x16x32_bf16 v[104:107], v[44:47], a[232:235], v[104:107]
  buffer_load_dwordx4 a[152:155], v11, s[20:23], s56 offen offset:2048 sc1
  v_add_f32 v210, v210, v22
  v_mfma_f32_16x16x32_bf16 v[108:111], v[44:47], a[236:239], v[108:111]
  s_waitcnt vmcnt(19) lgkmcnt(4)
  ds_read_b128 v[24:27], v15 offset:1536
  v_mfma_f32_16x16x32_bf16 v[48:51], v[32:35], a[240:243], v[48:51]
  ds_read_b64_tr_b16 v[44:45], v2 offset:16488
  v_add_f32 v211, v211, v23
  v_mfma_f32_16x16x32_bf16 v[52:55], v[32:35], a[244:247], v[52:55]
  ds_read_b64_tr_b16 v[46:47], v2 offset:17000
  s_waitcnt vmcnt(18) lgkmcnt(5)
  v_mfma_f32_16x16x32_bf16 v[56:59], v[32:35], a[248:251], v[56:59]
  s_barrier
  s_add_u32 s50, s35, 2502656
  s_add_u32 m0, s36, 4128
  v_mfma_f32_16x16x32_bf16 v[60:63], v[32:35], a[252:255], v[60:63]
  buffer_load_dwordx4 v4, s[8:11], s50 offen lds
  v_mfma_f32_16x16x32_bf16 v[64:67], v[36:39], a[240:243], v[64:67]
  ds_read_b64_tr_b16 v[32:33], v1 offset:20608
  s_add_u32 s51, s35, 1597440
  v_mfma_f32_16x16x32_bf16 v[68:71], v[36:39], a[244:247], v[68:71]
  ds_read_b64_tr_b16 v[34:35], v1 offset:21120
  s_add_u32 m0, s36, 8256
  v_mfma_f32_16x16x32_bf16 v[72:75], v[36:39], a[248:251], v[72:75]
  buffer_load_dwordx4 v4, s[8:11], s51 offen lds
  v_mfma_f32_16x16x32_bf16 v[76:79], v[36:39], a[252:255], v[76:79]
  s_waitcnt lgkmcnt(5)
  v_add_f32 v212, v212, v20
  v_add_f32 v213, v213, v21
  v_mfma_f32_16x16x32_bf16 v[80:83], v[40:43], a[240:243], v[80:83]
  ds_read_b64_tr_b16 v[36:37], v1 offset:20616
  v_add_f32 v214, v214, v22
  v_mfma_f32_16x16x32_bf16 v[84:87], v[40:43], a[244:247], v[84:87]
  ds_read_b64_tr_b16 v[38:39], v1 offset:21128
  v_add_f32 v215, v215, v23
  v_mfma_f32_16x16x32_bf16 v[88:91], v[40:43], a[248:251], v[88:91]
  buffer_load_dwordx4 a[156:159], v11, s[20:23], s56 offen offset:3072 sc1
  v_add_f32 v216, v216, v20
  v_mfma_f32_16x16x32_bf16 v[92:95], v[40:43], a[252:255], v[92:95]
  s_waitcnt lgkmcnt(4)
  s_waitcnt vmcnt(20)
  v_sub_u32 v19, v19, v30
  v_mfma_f32_16x16x32_bf16 v[96:99], v[44:47], a[240:243], v[96:99]
  ds_read_b64_tr_b16 v[40:41], v2 offset:20608
  v_cmp_gt_u32 vcc, 4, v19
  v_mfma_f32_16x16x32_bf16 v[100:103], v[44:47], a[244:247], v[100:103]
  ds_read_b64_tr_b16 v[42:43], v2 offset:21120
  s_nop 0
  v_mfma_f32_16x16x32_bf16 v[104:107], v[44:47], a[248:251], v[104:107]
  s_waitcnt lgkmcnt(4)
  s_cbranch_vccnz Lslow4
Lback4:
  s_add_u32 s57, s40, 16384
  v_mfma_f32_16x16x32_bf16 v[108:111], v[44:47], a[252:255], v[108:111]
  buffer_load_dwordx4 a[160:163], v11, s[20:23], s57 offen offset:0 sc1
  v_add_f32 v217, v217, v21
  v_mfma_f32_16x16x32_bf16 v[112:115], v[32:35], a[208:211], v[112:115]
  ds_read_b64_tr_b16 v[44:45], v2 offset:20616
  v_add_f32 v218, v218, v22
  v_mfma_f32_16x16x32_bf16 v[116:119], v[32:35], a[212:215], v[116:119]
  ds_read_b64_tr_b16 v[46:47], v2 offset:21128
  v_add_f32 v219, v219, v23
  v_mfma_f32_16x16x32_bf16 v[120:123], v[32:35], a[216:219], v[120:123]
  buffer_load_dwordx4 a[164:167], v11, s[20:23], s57 offen offset:1024 sc1
  v_add_f32 v220, v220, v20
  v_mfma_f32_16x16x32_bf16 v[124:127], v[32:35], a[220:223], v[124:127]
  s_waitcnt lgkmcnt(4)
  v_add_f32 v221, v221, v21
  v_add_f32 v222, v222, v22
  v_mfma_f32_16x16x32_bf16 v[128:131], v[36:39], a[208:211], v[128:131]
  ds_read_b64_tr_b16 v[32:33], v1 offset:24736
  v_add_f32 v223, v223, v23
  v_mfma_f32_16x16x32_bf16 v[132:135], v[36:39], a[212:215], v[132:135]
  ds_read_b64_tr_b16 v[34:35], v1 offset:25248
  v_add_f32 v224, v224, v24
  v_mfma_f32_16x16x32_bf16 v[136:139], v[36:39], a[216:219], v[136:139]
  buffer_load_dwordx4 a[168:171], v11, s[20:23], s57 offen offset:2048 sc1
  v_add_f32 v225, v225, v25
  v_mfma_f32_16x16x32_bf16 v[140:143], v[36:39], a[220:223], v[140:143]
  s_waitcnt lgkmcnt(4)
  ds_read_b128 v[20:23], v15 offset:1600
  v_mfma_f32_16x16x32_bf16 v[144:147], v[40:43], a[208:211], v[144:147]
  ds_read_b64_tr_b16 v[36:37], v1 offset:24744
  v_add_f32 v226, v226, v26
  v_mfma_f32_16x16x32_bf16 v[148:151], v[40:43], a[212:215], v[148:151]
  ds_read_b64_tr_b16 v[38:39], v1 offset:25256
  v_add_f32 v227, v227, v27
  v_mfma_f32_16x16x32_bf16 v[152:155], v[40:43], a[216:219], v[152:155]
  v_add_f32 v228, v228, v24
  v_add_f32 v229, v229, v25
  v_mfma_f32_16x16x32_bf16 v[156:159], v[40:43], a[220:223], v[156:159]
  s_waitcnt lgkmcnt(5)
  v_add_f32 v230, v230, v26
  v_add_f32 v231, v231, v27
  v_mfma_f32_16x16x32_bf16 v[160:163], v[44:47], a[208:211], v[160:163]
  ds_read_b64_tr_b16 v[40:41], v2 offset:24736
  v_add_f32 v232, v232, v24
  v_mfma_f32_16x16x32_bf16 v[164:167], v[44:47], a[212:215], v[164:167]
  ds_read_b64_tr_b16 v[42:43], v2 offset:25248
  v_add_f32 v233, v233, v25
  v_mfma_f32_16x16x32_bf16 v[168:171], v[44:47], a[216:219], v[168:171]
  buffer_load_dwordx4 a[172:175], v11, s[20:23], s57 offen offset:3072 sc1
  v_add_f32 v234, v234, v26
  v_mfma_f32_16x16x32_bf16 v[172:175], v[44:47], a[220:223], v[172:175]
  s_waitcnt lgkmcnt(5)
  s_add_u32 s57, s40, 40960
  v_add_f32 v235, v235, v27
  v_mfma_f32_16x16x32_bf16 v[112:115], v[32:35], a[224:227], v[112:115]
  ds_read_b64_tr_b16 v[44:45], v2 offset:24744
  v_add_f32 v236, v236, v24
  v_mfma_f32_16x16x32_bf16 v[116:119], v[32:35], a[228:231], v[116:119]
  ds_read_b64_tr_b16 v[46:47], v2 offset:25256
  v_add_f32 v237, v237, v25
  v_mfma_f32_16x16x32_bf16 v[120:123], v[32:35], a[232:235], v[120:123]
  buffer_load_dwordx4 a[176:179], v11, s[20:23], s57 offen offset:0 sc1
  v_add_f32 v238, v238, v26
  v_mfma_f32_16x16x32_bf16 v[124:127], v[32:35], a[236:239], v[124:127]
  s_waitcnt lgkmcnt(4)
  v_add_f32 v239, v239, v27
  v_add_f32 v240, v240, v20
  v_mfma_f32_16x16x32_bf16 v[128:131], v[36:39], a[224:227], v[128:131]
  ds_read_b64_tr_b16 v[32:33], v1 offset:28864
  v_add_f32 v241, v241, v21
  v_mfma_f32_16x16x32_bf16 v[132:135], v[36:39], a[228:231], v[132:135]
  ds_read_b64_tr_b16 v[34:35], v1 offset:29376
  v_add_f32 v242, v242, v22
  v_mfma_f32_16x16x32_bf16 v[136:139], v[36:39], a[232:235], v[136:139]
  buffer_load_dwordx4 a[180:183], v11, s[20:23], s57 offen offset:1024 sc1
  v_add_f32 v243, v243, v23
  v_mfma_f32_16x16x32_bf16 v[140:143], v[36:39], a[236:239], v[140:143]
  s_waitcnt lgkmcnt(4)
  v_add_f32 v244, v244, v20
  v_add_f32 v245, v245, v21
  v_mfma_f32_16x16x32_bf16 v[144:147], v[40:43], a[224:227], v[144:147]
  ds_read_b64_tr_b16 v[36:37], v1 offset:28872
  v_add_f32 v246, v246, v22
  v_mfma_f32_16x16x32_bf16 v[148:151], v[40:43], a[228:231], v[148:151]
  ds_read_b64_tr_b16 v[38:39], v1 offset:29384
  v_add_f32 v247, v247, v23
  v_mfma_f32_16x16x32_bf16 v[152:155], v[40:43], a[232:235], v[152:155]
  buffer_load_dwordx4 a[184:187], v11, s[20:23], s57 offen offset:2048 sc1
  v_add_f32 v248, v248, v20
  v_mfma_f32_16x16x32_bf16 v[156:159], v[40:43], a[236:239], v[156:159]
  s_waitcnt lgkmcnt(4)
  v_add_f32 v249, v249, v21
  v_add_f32 v250, v250, v22
  v_mfma_f32_16x16x32_bf16 v[160:163], v[44:47], a[224:227], v[160:163]
  ds_read_b64_tr_b16 v[40:41], v2 offset:28864
  v_add_f32 v251, v251, v23
  v_mfma_f32_16x16x32_bf16 v[164:167], v[44:47], a[228:231], v[164:167]
  ds_read_b64_tr_b16 v[42:43], v2 offset:29376
  v_add_f32 v252, v252, v20
  v_mfma_f32_16x16x32_bf16 v[168:171], v[44:47], a[232:235], v[168:171]
  buffer_load_dwordx4 a[188:191], v11, s[20:23], s57 offen offset:3072 sc1
  v_add_f32 v253, v253, v21
  v_mfma_f32_16x16x32_bf16 v[172:175], v[44:47], a[236:239], v[172:175]
  s_waitcnt lgkmcnt(4)
  s_add_u32 s57, s40, 65536
  v_add_f32 v254, v254, v22
  v_mfma_f32_16x16x32_bf16 v[112:115], v[32:35], a[240:243], v[112:115]
  ds_read_b64_tr_b16 v[44:45], v2 offset:28872
  v_add_f32 v255, v255, v23
  v_mfma_f32_16x16x32_bf16 v[116:119], v[32:35], a[244:247], v[116:119]
  ds_read_b64_tr_b16 v[46:47], v2 offset:29384
  s_waitcnt vmcnt(18) lgkmcnt(4)
  v_mfma_f32_16x16x32_bf16 v[120:123], v[32:35], a[248:251], v[120:123]
  s_barrier
  s_add_u32 s50, s35, 1916928
  s_add_u32 m0, s36, 12384
  v_mfma_f32_16x16x32_bf16 v[124:127], v[32:35], a[252:255], v[124:127]
  buffer_load_dwordx4 v4, s[8:11], s50 offen lds
  v_mfma_f32_16x16x32_bf16 v[128:131], v[36:39], a[240:243], v[128:131]
  ds_read_b64_tr_b16 v[32:33], v1 offset:32992
  s_add_u32 s51, s35, 2236416
  v_mfma_f32_16x16x32_bf16 v[132:135], v[36:39], a[244:247], v[132:135]
  ds_read_b64_tr_b16 v[34:35], v1 offset:33504
  s_waitcnt lgkmcnt(4)
  v_mfma_f32_16x16x32_bf16 v[136:139], v[36:39], a[248:251], v[136:139]
  s_add_u32 m0, s36, 16512
  v_mfma_f32_16x16x32_bf16 v[140:143], v[36:39], a[252:255], v[140:143]
  buffer_load_dwordx4 v4, s[8:11], s51 offen lds
  v_mfma_f32_16x16x32_bf16 v[144:147], v[40:43], a[240:243], v[144:147]
  ds_read_b64_tr_b16 v[36:37], v1 offset:33000
  s_add_u32 s50, s35, 2555904
  v_mfma_f32_16x16x32_bf16 v[148:151], v[40:43], a[244:247], v[148:151]
  ds_read_b64_tr_b16 v[38:39], v1 offset:33512
  s_waitcnt lgkmcnt(4)
  v_mfma_f32_16x16x32_bf16 v[152:155], v[40:43], a[248:251], v[152:155]
  s_add_u32 m0, s36, 20640
  v_mfma_f32_16x16x32_bf16 v[156:159], v[40:43], a[252:255], v[156:159]
  buffer_load_dwordx4 v4, s[8:11], s50 offen lds
  v_mfma_f32_16x16x32_bf16 v[160:163], v[44:47], a[240:243], v[160:163]
  ds_read_b64_tr_b16 v[40:41], v2 offset:32992
  v_mfma_f32_16x16x32_bf16 v[164:167], v[44:47], a[244:247], v[164:167]
  ds_read_b64_tr_b16 v[42:43], v2 offset:33504
  s_waitcnt lgkmcnt(4)
  v_mfma_f32_16x16x32_bf16 v[168:171], v[44:47], a[248:251], v[168:171]
  v_mfma_f32_16x16x32_bf16 v[172:175], v[44:47], a[252:255], v[172:175]
  buffer_load_dwordx4 a[192:195], v11, s[20:23], s57 offen offset:0 sc1
  v_mfma_f32_16x16x32_bf16 v[176:179], v[32:35], a[208:211], v[176:179]
  ds_read_b64_tr_b16 v[44:45], v2 offset:33000
  v_mfma_f32_16x16x32_bf16 v[180:183], v[32:35], a[212:215], v[180:183]
  ds_read_b64_tr_b16 v[46:47], v2 offset:33512
  s_waitcnt lgkmcnt(4)
  v_mfma_f32_16x16x32_bf16 v[184:187], v[32:35], a[216:219], v[184:187]
  v_mfma_f32_16x16x32_bf16 v[188:191], v[32:35], a[220:223], v[188:191]
  buffer_load_dwordx4 a[196:199], v11, s[20:23], s57 offen offset:1024 sc1
  v_mfma_f32_16x16x32_bf16 v[192:195], v[36:39], a[208:211], v[192:195]
  ds_read_b64_tr_b16 v[32:33], v1 offset:37120
  v_mfma_f32_16x16x32_bf16 v[196:199], v[36:39], a[212:215], v[196:199]
  ds_read_b64_tr_b16 v[34:35], v1 offset:37632
  s_waitcnt lgkmcnt(4)
  v_mfma_f32_16x16x32_bf16 v[200:203], v[36:39], a[216:219], v[200:203]
  v_mfma_f32_16x16x32_bf16 v[204:207], v[36:39], a[220:223], v[204:207]
  v_mfma_f32_16x16x32_bf16 v[208:211], v[40:43], a[208:211], v[208:211]
  ds_read_b64_tr_b16 v[36:37], v1 offset:37128
  v_mfma_f32_16x16x32_bf16 v[212:215], v[40:43], a[212:215], v[212:215]
  ds_read_b64_tr_b16 v[38:39], v1 offset:37640
  s_waitcnt lgkmcnt(4)
  v_mfma_f32_16x16x32_bf16 v[216:219], v[40:43], a[216:219], v[216:219]
  buffer_load_dwordx4 a[200:203], v11, s[20:23], s57 offen offset:2048 sc1
  v_mfma_f32_16x16x32_bf16 v[220:223], v[40:43], a[220:223], v[220:223]
  v_mfma_f32_16x16x32_bf16 v[224:227], v[44:47], a[208:211], v[224:227]
  ds_read_b64_tr_b16 v[40:41], v2 offset:37120
  v_mfma_f32_16x16x32_bf16 v[228:231], v[44:47], a[212:215], v[228:231]
  ds_read_b64_tr_b16 v[42:43], v2 offset:37632
  s_waitcnt lgkmcnt(4)
  v_mfma_f32_16x16x32_bf16 v[232:235], v[44:47], a[216:219], v[232:235]
  buffer_load_dwordx4 a[204:207], v11, s[20:23], s57 offen offset:3072 sc1
  v_mfma_f32_16x16x32_bf16 v[236:239], v[44:47], a[220:223], v[236:239]
  s_add_u32 s57, s40, 90112
  v_mfma_f32_16x16x32_bf16 v[176:179], v[32:35], a[224:227], v[176:179]
  ds_read_b64_tr_b16 v[44:45], v2 offset:37128
  v_mfma_f32_16x16x32_bf16 v[180:183], v[32:35], a[228:231], v[180:183]
  ds_read_b64_tr_b16 v[46:47], v2 offset:37640
  s_waitcnt lgkmcnt(4)
  v_mfma_f32_16x16x32_bf16 v[184:187], v[32:35], a[232:235], v[184:187]
  buffer_load_dwordx4 a[0:3], v11, s[20:23], s57 offen offset:0 sc1
  v_mfma_f32_16x16x32_bf16 v[188:191], v[32:35], a[236:239], v[188:191]
  v_mfma_f32_16x16x32_bf16 v[192:195], v[36:39], a[224:227], v[192:195]
  ds_read_b64_tr_b16 v[32:33], v1 offset:41248
  v_mfma_f32_16x16x32_bf16 v[196:199], v[36:39], a[228:231], v[196:199]
  ds_read_b64_tr_b16 v[34:35], v1 offset:41760
  s_waitcnt lgkmcnt(4)
  v_mfma_f32_16x16x32_bf16 v[200:203], v[36:39], a[232:235], v[200:203]
  buffer_load_dwordx4 a[4:7], v11, s[20:23], s57 offen offset:1024 sc1
  v_mfma_f32_16x16x32_bf16 v[204:207], v[36:39], a[236:239], v[204:207]
  v_mfma_f32_16x16x32_bf16 v[208:211], v[40:43], a[224:227], v[208:211]
  ds_read_b64_tr_b16 v[36:37], v1 offset:41256
  v_mfma_f32_16x16x32_bf16 v[212:215], v[40:43], a[228:231], v[212:215]
  ds_read_b64_tr_b16 v[38:39], v1 offset:41768
  s_waitcnt lgkmcnt(4)
  v_mfma_f32_16x16x32_bf16 v[216:219], v[40:43], a[232:235], v[216:219]
  buffer_load_dwordx4 a[8:11], v11, s[20:23], s57 offen offset:2048 sc1
  v_mfma_f32_16x16x32_bf16 v[220:223], v[40:43], a[236:239], v[220:223]
  v_mfma_f32_16x16x32_bf16 v[224:227], v[44:47], a[224:227], v[224:227]
  ds_read_b64_tr_b16 v[40:41], v2 offset:41248
  v_mfma_f32_16x16x32_bf16 v[228:231], v[44:47], a[228:231], v[228:231]
  ds_read_b64_tr_b16 v[42:43], v2 offset:41760
  s_waitcnt lgkmcnt(4)
  v_mfma_f32_16x16x32_bf16 v[232:235], v[44:47], a[232:235], v[232:235]
  buffer_load_dwordx4 a[12:15], v11, s[20:23], s57 offen offset:3072 sc1
  v_mfma_f32_16x16x32_bf16 v[236:239], v[44:47], a[236:239], v[236:239]
  s_add_u32 s56, s40, 20480
  v_mfma_f32_16x16x32_bf16 v[176:179], v[32:35], a[240:243], v[176:179]
  ds_read_b64_tr_b16 v[44:45], v2 offset:41256
  v_mfma_f32_16x16x32_bf16 v[180:183], v[32:35], a[244:247], v[180:183]
  ds_read_b64_tr_b16 v[46:47], v2 offset:41768
  s_waitcnt vmcnt(21) lgkmcnt(4)
  v_mfma_f32_16x16x32_bf16 v[184:187], v[32:35], a[248:251], v[184:187]
  s_barrier
  s_add_u32 s51, s35, 1650688
  s_add_u32 m0, s36, 24768
  v_mfma_f32_16x16x32_bf16 v[188:191], v[32:35], a[252:255], v[188:191]
  buffer_load_dwordx4 v4, s[8:11], s51 offen lds
  v_mfma_f32_16x16x32_bf16 v[192:195], v[36:39], a[240:243], v[192:195]
  ds_read_b64_tr_b16 v[32:33], v3 offset:45376
  s_add_u32 s50, s35, 1970176
  v_mfma_f32_16x16x32_bf16 v[196:199], v[36:39], a[244:247], v[196:199]
  ds_read_b64_tr_b16 v[34:35], v3 offset:45632
  s_waitcnt lgkmcnt(4)
  v_mfma_f32_16x16x32_bf16 v[200:203], v[36:39], a[248:251], v[200:203]
  s_add_u32 m0, s36, 28896
  v_mfma_f32_16x16x32_bf16 v[204:207], v[36:39], a[252:255], v[204:207]
  buffer_load_dwordx4 v4, s[8:11], s50 offen lds
  v_mfma_f32_16x16x32_bf16 v[208:211], v[40:43], a[240:243], v[208:211]
  ds_read_b64_tr_b16 v[36:37], v3 offset:46400
  s_add_u32 s51, s35, 2289664
  v_mfma_f32_16x16x32_bf16 v[212:215], v[40:43], a[244:247], v[212:215]
  ds_read_b64_tr_b16 v[38:39], v3 offset:46656
  s_waitcnt lgkmcnt(4)
  v_mfma_f32_16x16x32_bf16 v[216:219], v[40:43], a[248:251], v[216:219]
  s_add_u32 m0, s36, 33024
  v_mfma_f32_16x16x32_bf16 v[220:223], v[40:43], a[252:255], v[220:223]
  buffer_load_dwordx4 v4, s[8:11], s51 offen lds
  v_mfma_f32_16x16x32_bf16 v[224:227], v[44:47], a[240:243], v[224:227]
  ds_read_b64_tr_b16 v[40:41], v3 offset:47424
  v_mfma_f32_16x16x32_bf16 v[228:231], v[44:47], a[244:247], v[228:231]
  ds_read_b64_tr_b16 v[42:43], v3 offset:47680
  s_waitcnt lgkmcnt(4)
  v_mfma_f32_16x16x32_bf16 v[232:235], v[44:47], a[248:251], v[232:235]
  v_mfma_f32_16x16x32_bf16 v[236:239], v[44:47], a[252:255], v[236:239]
  v_mfma_f32_16x16x32_bf16 v[240:243], v[32:35], a[208:211], v[240:243]
  ds_read_b64_tr_b16 v[44:45], v1 offset:49472
  v_mfma_f32_16x16x32_bf16 v[244:247], v[32:35], a[212:215], v[244:247]
  ds_read_b64_tr_b16 v[46:47], v1 offset:49984
  s_waitcnt lgkmcnt(4)
  v_mfma_f32_16x16x32_bf16 v[248:251], v[32:35], a[216:219], v[248:251]
  buffer_load_dwordx4 a[16:19], v11, s[20:23], s56 offen offset:0 sc1
  v_mfma_f32_16x16x32_bf16 v[252:255], v[32:35], a[220:223], v[252:255]
  v_mfma_f32_16x16x32_bf16 v[240:243], v[36:39], a[224:227], v[240:243]
  ds_read_b64_tr_b16 v[32:33], v1 offset:49480
  v_mfma_f32_16x16x32_bf16 v[244:247], v[36:39], a[228:231], v[244:247]
  ds_read_b64_tr_b16 v[34:35], v1 offset:49992
  s_waitcnt lgkmcnt(4)
  v_mfma_f32_16x16x32_bf16 v[248:251], v[36:39], a[232:235], v[248:251]
  buffer_load_dwordx4 a[20:23], v11, s[20:23], s56 offen offset:1024 sc1
  v_mfma_f32_16x16x32_bf16 v[252:255], v[36:39], a[236:239], v[252:255]
  v_mfma_f32_16x16x32_bf16 v[240:243], v[40:43], a[240:243], v[240:243]
  ds_read_b64_tr_b16 v[36:37], v2 offset:49472
  v_mfma_f32_16x16x32_bf16 v[244:247], v[40:43], a[244:247], v[244:247]
  ds_read_b64_tr_b16 v[38:39], v2 offset:49984
  s_waitcnt lgkmcnt(4)
  v_mfma_f32_16x16x32_bf16 v[248:251], v[40:43], a[248:251], v[248:251]
  buffer_load_dwordx4 a[24:27], v11, s[20:23], s56 offen offset:2048 sc1
  v_mfma_f32_16x16x32_bf16 v[252:255], v[40:43], a[252:255], v[252:255]
  v_mfma_f32_16x16x32_bf16 v[48:51], v[44:47], a[112:115], v[48:51]
  ds_read_b64_tr_b16 v[40:41], v2 offset:49480
  v_mfma_f32_16x16x32_bf16 v[52:55], v[44:47], a[116:119], v[52:55]
  ds_read_b64_tr_b16 v[42:43], v2 offset:49992
  s_waitcnt lgkmcnt(4)
  v_mfma_f32_16x16x32_bf16 v[56:59], v[44:47], a[120:123], v[56:59]
  buffer_load_dwordx4 a[28:31], v11, s[20:23], s56 offen offset:3072 sc1
  v_mfma_f32_16x16x32_bf16 v[60:63], v[44:47], a[124:127], v[60:63]
  s_add_u32 s56, s40, 45056
  v_mfma_f32_16x16x32_bf16 v[64:67], v[32:35], a[112:115], v[64:67]
  ds_read_b64_tr_b16 v[44:45], v1 offset:0
  v_mfma_f32_16x16x32_bf16 v[68:71], v[32:35], a[116:119], v[68:71]
  ds_read_b64_tr_b16 v[46:47], v1 offset:512
  s_waitcnt lgkmcnt(4)
  v_mfma_f32_16x16x32_bf16 v[72:75], v[32:35], a[120:123], v[72:75]
  buffer_load_dwordx4 a[32:35], v11, s[20:23], s56 offen offset:0 sc1
  v_mfma_f32_16x16x32_bf16 v[76:79], v[32:35], a[124:127], v[76:79]
  v_mfma_f32_16x16x32_bf16 v[80:83], v[36:39], a[112:115], v[80:83]
  ds_read_b64_tr_b16 v[32:33], v1 offset:8
  v_mfma_f32_16x16x32_bf16 v[84:87], v[36:39], a[116:119], v[84:87]
  ds_read_b64_tr_b16 v[34:35], v1 offset:520
  s_waitcnt lgkmcnt(4)
  v_mfma_f32_16x16x32_bf16 v[88:91], v[36:39], a[120:123], v[88:91]
  v_mfma_f32_16x16x32_bf16 v[92:95], v[36:39], a[124:127], v[92:95]
  buffer_load_dwordx4 a[36:39], v11, s[20:23], s56 offen offset:1024 sc1
  v_mfma_f32_16x16x32_bf16 v[96:99], v[40:43], a[112:115], v[96:99]
  ds_read_b64_tr_b16 v[36:37], v2 offset:0
  v_mfma_f32_16x16x32_bf16 v[100:103], v[40:43], a[116:119], v[100:103]
  ds_read_b64_tr_b16 v[38:39], v2 offset:512
  s_waitcnt lgkmcnt(4)
  v_mfma_f32_16x16x32_bf16 v[104:107], v[40:43], a[120:123], v[104:107]
  v_mfma_f32_16x16x32_bf16 v[108:111], v[40:43], a[124:127], v[108:111]
  buffer_load_dwordx4 a[40:43], v11, s[20:23], s56 offen offset:2048 sc1
  v_mfma_f32_16x16x32_bf16 v[48:51], v[44:47], a[128:131], v[48:51]
  ds_read_b64_tr_b16 v[40:41], v2 offset:8
  v_mfma_f32_16x16x32_bf16 v[52:55], v[44:47], a[132:135], v[52:55]
  ds_read_b64_tr_b16 v[42:43], v2 offset:520
  s_waitcnt lgkmcnt(4)
  v_mfma_f32_16x16x32_bf16 v[56:59], v[44:47], a[136:139], v[56:59]
  v_mfma_f32_16x16x32_bf16 v[60:63], v[44:47], a[140:143], v[60:63]
  v_mfma_f32_16x16x32_bf16 v[64:67], v[32:35], a[128:131], v[64:67]
  ds_read_b64_tr_b16 v[44:45], v1 offset:4128
  v_mfma_f32_16x16x32_bf16 v[68:71], v[32:35], a[132:135], v[68:71]
  ds_read_b64_tr_b16 v[46:47], v1 offset:4640
  s_waitcnt vmcnt(19) lgkmcnt(4)
  v_mfma_f32_16x16x32_bf16 v[72:75], v[32:35], a[136:139], v[72:75]
  s_barrier
  s_add_u32 s50, s35, 2609152
  s_add_u32 m0, s36, 37152
  v_mfma_f32_16x16x32_bf16 v[76:79], v[32:35], a[140:143], v[76:79]
  buffer_load_dwordx4 v4, s[8:11], s50 offen lds
  v_mfma_f32_16x16x32_bf16 v[80:83], v[36:39], a[128:131], v[80:83]
  ds_read_b64_tr_b16 v[32:33], v1 offset:4136
  s_add_u32 s51, s35, 2662400
  v_mfma_f32_16x16x32_bf16 v[84:87], v[36:39], a[132:135], v[84:87]
  ds_read_b64_tr_b16 v[34:35], v1 offset:4648
  s_waitcnt lgkmcnt(4)
  v_mfma_f32_16x16x32_bf16 v[88:91], v[36:39], a[136:139], v[88:91]
  s_add_u32 m0, s36, 41280
  v_mfma_f32_16x16x32_bf16 v[92:95], v[36:39], a[140:143], v[92:95]
  buffer_load_dwordx4 v5, s[8:11], s51 offen lds
  v_mfma_f32_16x16x32_bf16 v[96:99], v[40:43], a[128:131], v[96:99]
  ds_read_b64_tr_b16 v[36:37], v2 offset:4128
  s_add_u32 s50, s35, 2715648
  v_mfma_f32_16x16x32_bf16 v[100:103], v[40:43], a[132:135], v[100:103]
  ds_read_b64_tr_b16 v[38:39], v2 offset:4640
  s_waitcnt lgkmcnt(4)
  v_mfma_f32_16x16x32_bf16 v[104:107], v[40:43], a[136:139], v[104:107]
  s_add_u32 m0, s36, 45408
  v_mfma_f32_16x16x32_bf16 v[108:111], v[40:43], a[140:143], v[108:111]
  buffer_load_dwordx4 v5, s[8:11], s50 offen lds
  v_mfma_f32_16x16x32_bf16 v[48:51], v[44:47], a[144:147], v[48:51]
  ds_read_b64_tr_b16 v[40:41], v2 offset:4136
  s_add_u32 s51, s35, 1863808
  v_mfma_f32_16x16x32_bf16 v[52:55], v[44:47], a[148:151], v[52:55]
  ds_read_b64_tr_b16 v[42:43], v2 offset:4648
  s_waitcnt lgkmcnt(4)
  v_mfma_f32_16x16x32_bf16 v[56:59], v[44:47], a[152:155], v[56:59]
  s_add_u32 m0, s36, 49536
  v_mfma_f32_16x16x32_bf16 v[60:63], v[44:47], a[156:159], v[60:63]
  buffer_load_dwordx4 v4, s[8:11], s51 offen lds
  v_mfma_f32_16x16x32_bf16 v[64:67], v[32:35], a[144:147], v[64:67]
  ds_read_b64_tr_b16 v[44:45], v1 offset:8256
  v_mfma_f32_16x16x32_bf16 v[68:71], v[32:35], a[148:151], v[68:71]
  ds_read_b64_tr_b16 v[46:47], v1 offset:8768
  s_waitcnt lgkmcnt(4)
  v_mfma_f32_16x16x32_bf16 v[72:75], v[32:35], a[152:155], v[72:75]
  buffer_load_dwordx4 a[44:47], v11, s[20:23], s56 offen offset:3072 sc1
  v_mfma_f32_16x16x32_bf16 v[76:79], v[32:35], a[156:159], v[76:79]
  s_add_u32 s56, s40, 69632
  v_mfma_f32_16x16x32_bf16 v[80:83], v[36:39], a[144:147], v[80:83]
  ds_read_b64_tr_b16 v[32:33], v1 offset:8264
  v_mfma_f32_16x16x32_bf16 v[84:87], v[36:39], a[148:151], v[84:87]
  ds_read_b64_tr_b16 v[34:35], v1 offset:8776
  s_waitcnt lgkmcnt(4)
  v_mfma_f32_16x16x32_bf16 v[88:91], v[36:39], a[152:155], v[88:91]
  buffer_load_dwordx4 a[48:51], v11, s[20:23], s56 offen offset:0 sc1
  v_mfma_f32_16x16x32_bf16 v[92:95], v[36:39], a[156:159], v[92:95]
  v_mfma_f32_16x16x32_bf16 v[96:99], v[40:43], a[144:147], v[96:99]
  ds_read_b64_tr_b16 v[36:37], v2 offset:8256
  v_mfma_f32_16x16x32_bf16 v[100:103], v[40:43], a[148:151], v[100:103]
  ds_read_b64_tr_b16 v[38:39], v2 offset:8768
  s_waitcnt lgkmcnt(4)
  v_mfma_f32_16x16x32_bf16 v[104:107], v[40:43], a[152:155], v[104:107]
  v_mfma_f32_16x16x32_bf16 v[108:111], v[40:43], a[156:159], v[108:111]
  buffer_load_dwordx4 a[52:55], v11, s[20:23], s56 offen offset:1024 sc1
  v_mfma_f32_16x16x32_bf16 v[48:51], v[44:47], a[160:163], v[48:51]
  ds_read_b64_tr_b16 v[40:41], v2 offset:8264
  v_mfma_f32_16x16x32_bf16 v[52:55], v[44:47], a[164:167], v[52:55]
  ds_read_b64_tr_b16 v[42:43], v2 offset:8776
  s_waitcnt lgkmcnt(4)
  v_mfma_f32_16x16x32_bf16 v[56:59], v[44:47], a[168:171], v[56:59]
  v_mfma_f32_16x16x32_bf16 v[60:63], v[44:47], a[172:175], v[60:63]
  buffer_load_dwordx4 a[56:59], v11, s[20:23], s56 offen offset:2048 sc1
  v_mfma_f32_16x16x32_bf16 v[64:67], v[32:35], a[160:163], v[64:67]
  ds_read_b64_tr_b16 v[44:45], v1 offset:12384
  v_mfma_f32_16x16x32_bf16 v[68:71], v[32:35], a[164:167], v[68:71]
  ds_read_b64_tr_b16 v[46:47], v1 offset:12896
  s_waitcnt lgkmcnt(4)
  v_mfma_f32_16x16x32_bf16 v[72:75], v[32:35], a[168:171], v[72:75]
  v_mfma_f32_16x16x32_bf16 v[76:79], v[32:35], a[172:175], v[76:79]
  v_mfma_f32_16x16x32_bf16 v[80:83], v[36:39], a[160:163], v[80:83]
  ds_read_b64_tr_b16 v[32:33], v1 offset:12392
  v_mfma_f32_16x16x32_bf16 v[84:87], v[36:39], a[164:167], v[84:87]
  ds_read_b64_tr_b16 v[34:35], v1 offset:12904
  s_waitcnt lgkmcnt(4)
  v_mfma_f32_16x16x32_bf16 v[88:91], v[36:39], a[168:171], v[88:91]
  buffer_load_dwordx4 a[60:63], v11, s[20:23], s56 offen offset:3072 sc1
  v_mfma_f32_16x16x32_bf16 v[92:95], v[36:39], a[172:175], v[92:95]
  s_add_u32 s56, s40, 94208
  v_mfma_f32_16x16x32_bf16 v[96:99], v[40:43], a[160:163], v[96:99]
  ds_read_b64_tr_b16 v[36:37], v2 offset:12384
  v_mfma_f32_16x16x32_bf16 v[100:103], v[40:43], a[164:167], v[100:103]
  ds_read_b64_tr_b16 v[38:39], v2 offset:12896
  s_waitcnt lgkmcnt(4)
  v_mfma_f32_16x16x32_bf16 v[104:107], v[40:43], a[168:171], v[104:107]
  buffer_load_dwordx4 a[64:67], v11, s[20:23], s56 offen offset:0 sc1
  v_mfma_f32_16x16x32_bf16 v[108:111], v[40:43], a[172:175], v[108:111]
  v_mfma_f32_16x16x32_bf16 v[48:51], v[44:47], a[176:179], v[48:51]
  ds_read_b64_tr_b16 v[40:41], v2 offset:12392
  v_mfma_f32_16x16x32_bf16 v[52:55], v[44:47], a[180:183], v[52:55]
  ds_read_b64_tr_b16 v[42:43], v2 offset:12904
  s_waitcnt lgkmcnt(4)
  v_mfma_f32_16x16x32_bf16 v[56:59], v[44:47], a[184:187], v[56:59]
  buffer_load_dwordx4 a[68:71], v11, s[20:23], s56 offen offset:1024 sc1
  v_mfma_f32_16x16x32_bf16 v[60:63], v[44:47], a[188:191], v[60:63]
  v_mfma_f32_16x16x32_bf16 v[64:67], v[32:35], a[176:179], v[64:67]
  ds_read_b64_tr_b16 v[44:45], v1 offset:16512
  v_mfma_f32_16x16x32_bf16 v[68:71], v[32:35], a[180:183], v[68:71]
  ds_read_b64_tr_b16 v[46:47], v1 offset:17024
  s_waitcnt vmcnt(19) lgkmcnt(4)
  v_mfma_f32_16x16x32_bf16 v[72:75], v[32:35], a[184:187], v[72:75]
  s_barrier
  s_add_u32 s50, s35, 2183296
  s_add_u32 m0, s36, 0
  v_mfma_f32_16x16x32_bf16 v[76:79], v[32:35], a[188:191], v[76:79]
  buffer_load_dwordx4 v4, s[8:11], s50 offen lds
  v_mfma_f32_16x16x32_bf16 v[80:83], v[36:39], a[176:179], v[80:83]
  ds_read_b64_tr_b16 v[32:33], v1 offset:16520
  s_add_u32 s51, s35, 2502784
  v_mfma_f32_16x16x32_bf16 v[84:87], v[36:39], a[180:183], v[84:87]
  ds_read_b64_tr_b16 v[34:35], v1 offset:17032
  s_waitcnt lgkmcnt(4)
  v_mfma_f32_16x16x32_bf16 v[88:91], v[36:39], a[184:187], v[88:91]
  s_add_u32 m0, s36, 4128
  v_mfma_f32_16x16x32_bf16 v[92:95], v[36:39], a[188:191], v[92:95]
  buffer_load_dwordx4 v4, s[8:11], s51 offen lds
  v_mfma_f32_16x16x32_bf16 v[96:99], v[40:43], a[176:179], v[96:99]
  ds_read_b64_tr_b16 v[36:37], v2 offset:16512
  s_add_u32 s50, s35, 1597568
  v_mfma_f32_16x16x32_bf16 v[100:103], v[40:43], a[180:183], v[100:103]
  ds_read_b64_tr_b16 v[38:39], v2 offset:17024
  s_waitcnt lgkmcnt(4)
  v_mfma_f32_16x16x32_bf16 v[104:107], v[40:43], a[184:187], v[104:107]
  s_add_u32 m0, s36, 8256
  v_mfma_f32_16x16x32_bf16 v[108:111], v[40:43], a[188:191], v[108:111]
  buffer_load_dwordx4 v4, s[8:11], s50 offen lds
  v_mfma_f32_16x16x32_bf16 v[48:51], v[44:47], a[192:195], v[48:51]
  ds_read_b64_tr_b16 v[40:41], v2 offset:16520
  v_mfma_f32_16x16x32_bf16 v[52:55], v[44:47], a[196:199], v[52:55]
  ds_read_b64_tr_b16 v[42:43], v2 offset:17032
  s_waitcnt lgkmcnt(4)
  v_mfma_f32_16x16x32_bf16 v[56:59], v[44:47], a[200:203], v[56:59]
  buffer_load_dwordx4 a[72:75], v11, s[20:23], s56 offen offset:2048 sc1
  v_mfma_f32_16x16x32_bf16 v[60:63], v[44:47], a[204:207], v[60:63]
  v_mfma_f32_16x16x32_bf16 v[64:67], v[32:35], a[192:195], v[64:67]
  ds_read_b64_tr_b16 v[44:45], v1 offset:20640
  v_mfma_f32_16x16x32_bf16 v[68:71], v[32:35], a[196:199], v[68:71]
  ds_read_b64_tr_b16 v[46:47], v1 offset:21152
  s_waitcnt lgkmcnt(4)
  v_mfma_f32_16x16x32_bf16 v[72:75], v[32:35], a[200:203], v[72:75]
  buffer_load_dwordx4 a[76:79], v11, s[20:23], s56 offen offset:3072 sc1
  v_mfma_f32_16x16x32_bf16 v[76:79], v[32:35], a[204:207], v[76:79]
  s_add_u32 s57, s40, 98304
  v_mfma_f32_16x16x32_bf16 v[80:83], v[36:39], a[192:195], v[80:83]
  ds_read_b64_tr_b16 v[32:33], v1 offset:20648
  v_mfma_f32_16x16x32_bf16 v[84:87], v[36:39], a[196:199], v[84:87]
  ds_read_b64_tr_b16 v[34:35], v1 offset:21160
  s_waitcnt lgkmcnt(4)
  v_mfma_f32_16x16x32_bf16 v[88:91], v[36:39], a[200:203], v[88:91]
  buffer_load_dwordx2 a[80:81], v12, s[20:23], s57 offen offset:0 sc1
  v_mfma_f32_16x16x32_bf16 v[92:95], v[36:39], a[204:207], v[92:95]
  v_mfma_f32_16x16x32_bf16 v[96:99], v[40:43], a[192:195], v[96:99]
  ds_read_b64_tr_b16 v[36:37], v2 offset:20640
  s_add_u32 s54, s72, 49152
  v_mfma_f32_16x16x32_bf16 v[100:103], v[40:43], a[196:199], v[100:103]
  ds_read_b64_tr_b16 v[38:39], v2 offset:21152
  s_waitcnt lgkmcnt(4)
  v_mfma_f32_16x16x32_bf16 v[104:107], v[40:43], a[200:203], v[104:107]
  buffer_load_dwordx2 a[82:83], v12, s[20:23], s57 offen offset:2048 sc1
  v_mfma_f32_16x16x32_bf16 v[108:111], v[40:43], a[204:207], v[108:111]
  v_mfma_f32_16x16x32_bf16 v[48:51], v[44:47], a[0:3], v[48:51]
  ds_read_b64_tr_b16 v[40:41], v2 offset:20648
  v_mfma_f32_16x16x32_bf16 v[52:55], v[44:47], a[4:7], v[52:55]
  ds_read_b64_tr_b16 v[42:43], v2 offset:21160
  s_waitcnt lgkmcnt(4)
  v_mfma_f32_16x16x32_bf16 v[56:59], v[44:47], a[8:11], v[56:59]
  buffer_load_dwordx2 a[84:85], v12, s[20:23], s57 offen offset:512 sc1
  v_mfma_f32_16x16x32_bf16 v[60:63], v[44:47], a[12:15], v[60:63]
  v_mfma_f32_16x16x32_bf16 v[64:67], v[32:35], a[0:3], v[64:67]
  ds_read_b64_tr_b16 v[44:45], v1 offset:24768
  v_mfma_f32_16x16x32_bf16 v[68:71], v[32:35], a[4:7], v[68:71]
  ds_read_b64_tr_b16 v[46:47], v1 offset:25280
  s_waitcnt lgkmcnt(4)
  v_mfma_f32_16x16x32_bf16 v[72:75], v[32:35], a[8:11], v[72:75]
  buffer_load_dwordx2 a[86:87], v12, s[20:23], s57 offen offset:2560 sc1
  v_mfma_f32_16x16x32_bf16 v[76:79], v[32:35], a[12:15], v[76:79]
  v_mfma_f32_16x16x32_bf16 v[80:83], v[36:39], a[0:3], v[80:83]
  ds_read_b64_tr_b16 v[32:33], v1 offset:24776
  v_mfma_f32_16x16x32_bf16 v[84:87], v[36:39], a[4:7], v[84:87]
  ds_read_b64_tr_b16 v[34:35], v1 offset:25288
  s_waitcnt lgkmcnt(4)
  v_mfma_f32_16x16x32_bf16 v[88:91], v[36:39], a[8:11], v[88:91]
  buffer_load_dwordx2 a[88:89], v12, s[20:23], s57 offen offset:1024 sc1
  v_mfma_f32_16x16x32_bf16 v[92:95], v[36:39], a[12:15], v[92:95]
  v_mfma_f32_16x16x32_bf16 v[96:99], v[40:43], a[0:3], v[96:99]
  ds_read_b64_tr_b16 v[36:37], v2 offset:24768
  v_mfma_f32_16x16x32_bf16 v[100:103], v[40:43], a[4:7], v[100:103]
  ds_read_b64_tr_b16 v[38:39], v2 offset:25280
  s_waitcnt vmcnt(24) lgkmcnt(4)
  v_mfma_f32_16x16x32_bf16 v[104:107], v[40:43], a[8:11], v[104:107]
  buffer_load_dwordx2 a[90:91], v12, s[20:23], s57 offen offset:3072 sc1
  v_mfma_f32_16x16x32_bf16 v[108:111], v[40:43], a[12:15], v[108:111]
  v_mfma_f32_16x16x32_bf16 v[48:51], v[44:47], a[16:19], v[48:51]
  ds_read_b64_tr_b16 v[40:41], v2 offset:24776
  v_mfma_f32_16x16x32_bf16 v[52:55], v[44:47], a[20:23], v[52:55]
  ds_read_b64_tr_b16 v[42:43], v2 offset:25288
  s_waitcnt lgkmcnt(4)
  v_mfma_f32_16x16x32_bf16 v[56:59], v[44:47], a[24:27], v[56:59]
  buffer_load_dwordx2 a[92:93], v12, s[20:23], s57 offen offset:1536 sc1
  v_mfma_f32_16x16x32_bf16 v[60:63], v[44:47], a[28:31], v[60:63]
  v_mfma_f32_16x16x32_bf16 v[64:67], v[32:35], a[16:19], v[64:67]
  ds_read_b64_tr_b16 v[44:45], v1 offset:28896
  v_mfma_f32_16x16x32_bf16 v[68:71], v[32:35], a[20:23], v[68:71]
  ds_read_b64_tr_b16 v[46:47], v1 offset:29408
  s_waitcnt vmcnt(21) lgkmcnt(4)
  v_mfma_f32_16x16x32_bf16 v[72:75], v[32:35], a[24:27], v[72:75]
  s_barrier
  s_add_u32 s51, s35, 1917056
  s_add_u32 m0, s36, 12384
  v_mfma_f32_16x16x32_bf16 v[76:79], v[32:35], a[28:31], v[76:79]
  buffer_load_dwordx2 a[94:95], v12, s[20:23], s57 offen offset:3584 sc1
  v_mfma_f32_16x16x32_bf16 v[80:83], v[36:39], a[16:19], v[80:83]
  ds_read_b64_tr_b16 v[32:33], v1 offset:28904
  s_add_u32 s56, s40, 102400
  v_mfma_f32_16x16x32_bf16 v[84:87], v[36:39], a[20:23], v[84:87]
  ds_read_b64_tr_b16 v[34:35], v1 offset:29416
  s_waitcnt lgkmcnt(4)
  v_mfma_f32_16x16x32_bf16 v[88:91], v[36:39], a[24:27], v[88:91]
  buffer_load_dwordx2 a[96:97], v12, s[20:23], s56 offen offset:0 sc1
  v_mfma_f32_16x16x32_bf16 v[92:95], v[36:39], a[28:31], v[92:95]
  buffer_load_dwordx4 v4, s[8:11], s51 offen lds
  v_mfma_f32_16x16x32_bf16 v[96:99], v[40:43], a[16:19], v[96:99]
  ds_read_b64_tr_b16 v[36:37], v2 offset:28896
  s_add_u32 s50, s35, 2236544
  v_mfma_f32_16x16x32_bf16 v[100:103], v[40:43], a[20:23], v[100:103]
  ds_read_b64_tr_b16 v[38:39], v2 offset:29408
  s_waitcnt vmcnt(21) lgkmcnt(4)
  v_mfma_f32_16x16x32_bf16 v[104:107], v[40:43], a[24:27], v[104:107]
  s_add_u32 m0, s36, 16512
  v_mfma_f32_16x16x32_bf16 v[108:111], v[40:43], a[28:31], v[108:111]
  buffer_load_dwordx2 a[98:99], v12, s[20:23], s56 offen offset:2048 sc1
  v_mfma_f32_16x16x32_bf16 v[48:51], v[44:47], a[32:35], v[48:51]
  ds_read_b64_tr_b16 v[40:41], v2 offset:28904
  v_mfma_f32_16x16x32_bf16 v[52:55], v[44:47], a[36:39], v[52:55]
  ds_read_b64_tr_b16 v[42:43], v2 offset:29416
  s_waitcnt lgkmcnt(4)
  v_mfma_f32_16x16x32_bf16 v[56:59], v[44:47], a[40:43], v[56:59]
  v_mfma_f32_16x16x32_bf16 v[60:63], v[44:47], a[44:47], v[60:63]
  buffer_load_dwordx2 a[100:101], v12, s[20:23], s56 offen offset:512 sc1
  v_mfma_f32_16x16x32_bf16 v[64:67], v[32:35], a[32:35], v[64:67]
  ds_read_b64_tr_b16 v[44:45], v1 offset:33024
  v_mfma_f32_16x16x32_bf16 v[68:71], v[32:35], a[36:39], v[68:71]
  ds_read_b64_tr_b16 v[46:47], v1 offset:33536
  s_waitcnt lgkmcnt(4)
  v_mfma_f32_16x16x32_bf16 v[72:75], v[32:35], a[40:43], v[72:75]
  v_mfma_f32_16x16x32_bf16 v[76:79], v[32:35], a[44:47], v[76:79]
  v_mfma_f32_16x16x32_bf16 v[80:83], v[36:39], a[32:35], v[80:83]
  ds_read_b64_tr_b16 v[32:33], v1 offset:33032
  v_mfma_f32_16x16x32_bf16 v[84:87], v[36:39], a[36:39], v[84:87]
  ds_read_b64_tr_b16 v[34:35], v1 offset:33544
  s_waitcnt lgkmcnt(4)
  v_mfma_f32_16x16x32_bf16 v[88:91], v[36:39], a[40:43], v[88:91]
  buffer_load_dwordx2 a[102:103], v12, s[20:23], s56 offen offset:2560 sc1
  v_mfma_f32_16x16x32_bf16 v[92:95], v[36:39], a[44:47], v[92:95]
  v_mfma_f32_16x16x32_bf16 v[96:99], v[40:43], a[32:35], v[96:99]
  ds_read_b64_tr_b16 v[36:37], v2 offset:33024
  v_mfma_f32_16x16x32_bf16 v[100:103], v[40:43], a[36:39], v[100:103]
  ds_read_b64_tr_b16 v[38:39], v2 offset:33536
  s_waitcnt vmcnt(20) lgkmcnt(4)
  v_mfma_f32_16x16x32_bf16 v[104:107], v[40:43], a[40:43], v[104:107]
  buffer_load_dwordx2 a[104:105], v12, s[20:23], s56 offen offset:1024 sc1
  v_mfma_f32_16x16x32_bf16 v[108:111], v[40:43], a[44:47], v[108:111]
  v_mfma_f32_16x16x32_bf16 v[48:51], v[44:47], a[48:51], v[48:51]
  ds_read_b64_tr_b16 v[40:41], v2 offset:33032
  v_mfma_f32_16x16x32_bf16 v[52:55], v[44:47], a[52:55], v[52:55]
  ds_read_b64_tr_b16 v[42:43], v2 offset:33544
  s_waitcnt lgkmcnt(4)
  v_mfma_f32_16x16x32_bf16 v[56:59], v[44:47], a[56:59], v[56:59]
  buffer_load_dwordx2 a[106:107], v12, s[20:23], s56 offen offset:3072 sc1
  v_mfma_f32_16x16x32_bf16 v[60:63], v[44:47], a[60:63], v[60:63]
  v_mfma_f32_16x16x32_bf16 v[64:67], v[32:35], a[48:51], v[64:67]
  ds_read_b64_tr_b16 v[44:45], v1 offset:37152
  v_mfma_f32_16x16x32_bf16 v[68:71], v[32:35], a[52:55], v[68:71]
  ds_read_b64_tr_b16 v[46:47], v1 offset:37664
  s_waitcnt lgkmcnt(4)
  v_mfma_f32_16x16x32_bf16 v[72:75], v[32:35], a[56:59], v[72:75]
  buffer_load_dwordx2 a[108:109], v12, s[20:23], s56 offen offset:1536 sc1
  v_mfma_f32_16x16x32_bf16 v[76:79], v[32:35], a[60:63], v[76:79]
  v_mfma_f32_16x16x32_bf16 v[80:83], v[36:39], a[48:51], v[80:83]
  ds_read_b64_tr_b16 v[32:33], v1 offset:37160
  v_mfma_f32_16x16x32_bf16 v[84:87], v[36:39], a[52:55], v[84:87]
  ds_read_b64_tr_b16 v[34:35], v1 offset:37672
  s_waitcnt lgkmcnt(4)
  v_mfma_f32_16x16x32_bf16 v[88:91], v[36:39], a[56:59], v[88:91]
  buffer_load_dwordx2 a[110:111], v12, s[20:23], s56 offen offset:3584 sc1
  v_mfma_f32_16x16x32_bf16 v[92:95], v[36:39], a[60:63], v[92:95]
  v_mfma_f32_16x16x32_bf16 v[96:99], v[40:43], a[48:51], v[96:99]
  ds_read_b64_tr_b16 v[36:37], v2 offset:37152
  v_mfma_f32_16x16x32_bf16 v[100:103], v[40:43], a[52:55], v[100:103]
  ds_read_b64_tr_b16 v[38:39], v2 offset:37664
  s_waitcnt vmcnt(17) lgkmcnt(4)
  v_mfma_f32_16x16x32_bf16 v[104:107], v[40:43], a[56:59], v[104:107]
  buffer_load_dwordx4 v4, s[8:11], s50 offen lds
  v_mfma_f32_16x16x32_bf16 v[108:111], v[40:43], a[60:63], v[108:111]
  s_add_u32 s51, s35, 2556032
  v_mfma_f32_16x16x32_bf16 v[48:51], v[44:47], a[64:67], v[48:51]
  ds_read_b64_tr_b16 v[40:41], v2 offset:37160
  v_mfma_f32_16x16x32_bf16 v[52:55], v[44:47], a[68:71], v[52:55]
  ds_read_b64_tr_b16 v[42:43], v2 offset:37672
  s_waitcnt lgkmcnt(4)
  v_mfma_f32_16x16x32_bf16 v[56:59], v[44:47], a[72:75], v[56:59]
  s_add_u32 m0, s36, 20640
  v_mfma_f32_16x16x32_bf16 v[60:63], v[44:47], a[76:79], v[60:63]
  buffer_load_dwordx4 v4, s[8:11], s51 offen lds
  v_mfma_f32_16x16x32_bf16 v[64:67], v[32:35], a[64:67], v[64:67]
  ds_read_b64_tr_b16 v[44:45], v1 offset:41280
  v_mfma_f32_16x16x32_bf16 v[68:71], v[32:35], a[68:71], v[68:71]
  ds_read_b64_tr_b16 v[46:47], v1 offset:41792
  s_waitcnt lgkmcnt(4)
  v_mfma_f32_16x16x32_bf16 v[72:75], v[32:35], a[72:75], v[72:75]
  s_barrier
  s_add_u32 s50, s35, 1650816
  s_add_u32 m0, s36, 24768
  v_mfma_f32_16x16x32_bf16 v[76:79], v[32:35], a[76:79], v[76:79]
  buffer_load_dword v14, off, s[64:67], s54
  v_mfma_f32_16x16x32_bf16 v[80:83], v[36:39], a[64:67], v[80:83]
  ds_read_b64_tr_b16 v[32:33], v1 offset:41288
  v_mfma_f32_16x16x32_bf16 v[84:87], v[36:39], a[68:71], v[84:87]
  ds_read_b64_tr_b16 v[34:35], v1 offset:41800
  s_waitcnt lgkmcnt(4)
  v_mfma_f32_16x16x32_bf16 v[88:91], v[36:39], a[72:75], v[88:91]
  buffer_load_dwordx4 v4, s[8:11], s50 offen lds
  v_mfma_f32_16x16x32_bf16 v[92:95], v[36:39], a[76:79], v[92:95]
  s_add_u32 s51, s35, 1970304
  v_mfma_f32_16x16x32_bf16 v[96:99], v[40:43], a[64:67], v[96:99]
  ds_read_b64_tr_b16 v[36:37], v2 offset:41280
  s_add_u32 m0, s36, 28896
  v_mfma_f32_16x16x32_bf16 v[100:103], v[40:43], a[68:71], v[100:103]
  ds_read_b64_tr_b16 v[38:39], v2 offset:41792
  s_waitcnt vmcnt(13) lgkmcnt(4)
  v_mfma_f32_16x16x32_bf16 v[104:107], v[40:43], a[72:75], v[104:107]
  buffer_load_dwordx4 v4, s[8:11], s51 offen lds
  v_mfma_f32_16x16x32_bf16 v[108:111], v[40:43], a[76:79], v[108:111]
  s_add_u32 s50, s35, 2289792
  v_mfma_f32_16x16x32_bf16 v[48:51], v[44:47], a[80:83], v[48:51]
  ds_read_b64_tr_b16 v[40:41], v2 offset:41288
  s_add_u32 m0, s36, 33024
  v_mfma_f32_16x16x32_bf16 v[52:55], v[44:47], a[84:87], v[52:55]
  ds_read_b64_tr_b16 v[42:43], v2 offset:41800
  s_waitcnt lgkmcnt(4)
  v_mfma_f32_16x16x32_bf16 v[56:59], v[44:47], a[88:91], v[56:59]
  buffer_load_dwordx4 v4, s[8:11], s50 offen lds
  v_mfma_f32_16x16x32_bf16 v[60:63], v[44:47], a[92:95], v[60:63]
  v_mfma_f32_16x16x32_bf16 v[64:67], v[32:35], a[80:83], v[64:67]
  ds_read_b64_tr_b16 v[44:45], v1 offset:45408
  v_mfma_f32_16x16x32_bf16 v[68:71], v[32:35], a[84:87], v[68:71]
  ds_read_b64_tr_b16 v[46:47], v1 offset:45920
  s_waitcnt lgkmcnt(4)
  v_mfma_f32_16x16x32_bf16 v[72:75], v[32:35], a[88:91], v[72:75]
  v_mfma_f32_16x16x32_bf16 v[76:79], v[32:35], a[92:95], v[76:79]
  v_mfma_f32_16x16x32_bf16 v[80:83], v[36:39], a[80:83], v[80:83]
  ds_read_b64_tr_b16 v[32:33], v1 offset:45416
  v_mfma_f32_16x16x32_bf16 v[84:87], v[36:39], a[84:87], v[84:87]
  ds_read_b64_tr_b16 v[34:35], v1 offset:45928
  s_waitcnt lgkmcnt(4)
  v_mfma_f32_16x16x32_bf16 v[88:91], v[36:39], a[88:91], v[88:91]
  v_mfma_f32_16x16x32_bf16 v[92:95], v[36:39], a[92:95], v[92:95]
  v_mfma_f32_16x16x32_bf16 v[96:99], v[40:43], a[80:83], v[96:99]
  ds_read_b64_tr_b16 v[36:37], v2 offset:45408
  v_mfma_f32_16x16x32_bf16 v[100:103], v[40:43], a[84:87], v[100:103]
  ds_read_b64_tr_b16 v[38:39], v2 offset:45920
  s_waitcnt vmcnt(6) lgkmcnt(4)
  v_mfma_f32_16x16x32_bf16 v[104:107], v[40:43], a[88:91], v[104:107]
  v_mfma_f32_16x16x32_bf16 v[108:111], v[40:43], a[92:95], v[108:111]
  v_mfma_f32_16x16x32_bf16 v[48:51], v[44:47], a[96:99], v[48:51]
  ds_read_b64_tr_b16 v[40:41], v2 offset:45416
  v_mfma_f32_16x16x32_bf16 v[52:55], v[44:47], a[100:103], v[52:55]
  ds_read_b64_tr_b16 v[42:43], v2 offset:45928
  s_waitcnt lgkmcnt(4)
  v_mfma_f32_16x16x32_bf16 v[56:59], v[44:47], a[104:107], v[56:59]
  v_mfma_f32_16x16x32_bf16 v[60:63], v[44:47], a[108:111], v[60:63]
  v_mfma_f32_16x16x32_bf16 v[64:67], v[32:35], a[96:99], v[64:67]
  ds_read_b64_tr_b16 v[44:45], v1 offset:49536
  v_mfma_f32_16x16x32_bf16 v[68:71], v[32:35], a[100:103], v[68:71]
  ds_read_b64_tr_b16 v[46:47], v1 offset:50048
  s_waitcnt lgkmcnt(4)
  v_mfma_f32_16x16x32_bf16 v[72:75], v[32:35], a[104:107], v[72:75]
  v_mfma_f32_16x16x32_bf16 v[76:79], v[32:35], a[108:111], v[76:79]
  v_mfma_f32_16x16x32_bf16 v[80:83], v[36:39], a[96:99], v[80:83]
  ds_read_b64_tr_b16 v[32:33], v1 offset:49544
  v_mfma_f32_16x16x32_bf16 v[84:87], v[36:39], a[100:103], v[84:87]
  ds_read_b64_tr_b16 v[34:35], v1 offset:50056
  s_waitcnt lgkmcnt(4)
  v_mfma_f32_16x16x32_bf16 v[88:91], v[36:39], a[104:107], v[88:91]
  v_mfma_f32_16x16x32_bf16 v[92:95], v[36:39], a[108:111], v[92:95]
  v_mfma_f32_16x16x32_bf16 v[96:99], v[40:43], a[96:99], v[96:99]
  ds_read_b64_tr_b16 v[36:37], v2 offset:49536
  v_mfma_f32_16x16x32_bf16 v[100:103], v[40:43], a[100:103], v[100:103]
  ds_read_b64_tr_b16 v[38:39], v2 offset:50048
  s_waitcnt lgkmcnt(4)
  v_mfma_f32_16x16x32_bf16 v[104:107], v[40:43], a[104:107], v[104:107]
  ds_read_b128 v[20:23], v8 offset:8192
  v_mfma_f32_16x16x32_bf16 v[108:111], v[40:43], a[108:111], v[108:111]
  ds_read_b128 v[24:27], v8 offset:10240
  s_add_u32 s77, s42, 27262976
  v_mfma_f32_16x16x32_bf16 v[112:115], v[44:47], a[112:115], v[112:115]
  ds_read_b64_tr_b16 v[40:41], v2 offset:49544
  v_mfma_f32_16x16x32_bf16 v[116:119], v[44:47], a[116:119], v[116:119]
  ds_read_b64_tr_b16 v[42:43], v2 offset:50056
  s_waitcnt lgkmcnt(6)
  v_mfma_f32_16x16x32_bf16 v[120:123], v[44:47], a[120:123], v[120:123]
  v_mfma_f32_16x16x32_bf16 v[124:127], v[44:47], a[124:127], v[124:127]
  v_mfma_f32_16x16x32_bf16 v[128:131], v[32:35], a[112:115], v[128:131]
  ds_read_b64_tr_b16 v[44:45], v1 offset:0
  s_waitcnt lgkmcnt(4)
  v_mfma_f32_16x16x32_bf16 v[132:135], v[32:35], a[116:119], v[132:135]
  ds_read_b64_tr_b16 v[46:47], v1 offset:512
  v_lshlrev_b32 v28, 16, v20
  v_mfma_f32_16x16x32_bf16 v[136:139], v[32:35], a[120:123], v[136:139]
  s_barrier
  s_add_u32 s51, s35, 2609280
  s_add_u32 m0, s36, 37152
  v_mfma_f32_16x16x32_bf16 v[140:143], v[32:35], a[124:127], v[140:143]
  buffer_load_dwordx4 v4, s[8:11], s51 offen lds
  v_mfma_f32_16x16x32_bf16 v[144:147], v[36:39], a[112:115], v[144:147]
  ds_read_b64_tr_b16 v[32:33], v1 offset:8
  s_add_u32 s50, s35, 2662528
  v_mfma_f32_16x16x32_bf16 v[148:151], v[36:39], a[116:119], v[148:151]
  ds_read_b64_tr_b16 v[34:35], v1 offset:520
  s_add_u32 m0, s36, 41280
  v_mfma_f32_16x16x32_bf16 v[152:155], v[36:39], a[120:123], v[152:155]
  buffer_load_dwordx4 v5, s[8:11], s50 offen lds
  v_mfma_f32_16x16x32_bf16 v[156:159], v[36:39], a[124:127], v[156:159]
  s_waitcnt lgkmcnt(4)
  s_add_u32 s51, s35, 2715776
  s_add_u32 m0, s36, 45408
  v_mfma_f32_16x16x32_bf16 v[160:163], v[40:43], a[112:115], v[160:163]
  ds_read_b64_tr_b16 v[36:37], v2 offset:0
  v_and_b32 v20, s44, v20
  v_mfma_f32_16x16x32_bf16 v[164:167], v[40:43], a[116:119], v[164:167]
  ds_read_b64_tr_b16 v[38:39], v2 offset:512
  v_mul_f32 v28, v28, v48
  v_mfma_f32_16x16x32_bf16 v[168:171], v[40:43], a[120:123], v[168:171]
  buffer_load_dwordx4 v5, s[8:11], s51 offen lds
  v_mfma_f32_16x16x32_bf16 v[172:175], v[40:43], a[124:127], v[172:175]
  s_waitcnt lgkmcnt(4)
  v_mul_f32 v20, v20, v49
  v_cvt_pk_bf16_f32 v20, v28, v20
  v_mfma_f32_16x16x32_bf16 v[112:115], v[44:47], a[128:131], v[112:115]
  ds_read_b64_tr_b16 v[40:41], v2 offset:8
  v_lshlrev_b32 v29, 16, v21
  v_mfma_f32_16x16x32_bf16 v[116:119], v[44:47], a[132:135], v[116:119]
  ds_read_b64_tr_b16 v[42:43], v2 offset:520
  v_and_b32 v21, s44, v21
  v_mfma_f32_16x16x32_bf16 v[120:123], v[44:47], a[136:139], v[120:123]
  v_mul_f32 v29, v29, v50
  v_mul_f32 v21, v21, v51
  v_mfma_f32_16x16x32_bf16 v[124:127], v[44:47], a[140:143], v[124:127]
  s_waitcnt lgkmcnt(4)
  v_cvt_pk_bf16_f32 v21, v29, v21
  v_lshlrev_b32 v28, 16, v22
  v_mfma_f32_16x16x32_bf16 v[128:131], v[32:35], a[128:131], v[128:131]
  ds_read_b64_tr_b16 v[44:45], v1 offset:4128
  v_and_b32 v22, s44, v22
  v_mfma_f32_16x16x32_bf16 v[132:135], v[32:35], a[132:135], v[132:135]
  ds_read_b64_tr_b16 v[46:47], v1 offset:4640
  v_mul_f32 v28, v28, v64
  v_mfma_f32_16x16x32_bf16 v[136:139], v[32:35], a[136:139], v[136:139]
  v_mul_f32 v22, v22, v65
  v_cvt_pk_bf16_f32 v22, v28, v22
  v_mfma_f32_16x16x32_bf16 v[140:143], v[32:35], a[140:143], v[140:143]
  s_waitcnt lgkmcnt(4)
  v_lshlrev_b32 v29, 16, v23
  v_and_b32 v23, s44, v23
  v_mfma_f32_16x16x32_bf16 v[144:147], v[36:39], a[128:131], v[144:147]
  ds_read_b64_tr_b16 v[32:33], v1 offset:4136
  v_mul_f32 v29, v29, v66
  v_mfma_f32_16x16x32_bf16 v[148:151], v[36:39], a[132:135], v[148:151]
  ds_read_b64_tr_b16 v[34:35], v1 offset:4648
  v_mul_f32 v23, v23, v67
  v_mfma_f32_16x16x32_bf16 v[152:155], v[36:39], a[136:139], v[152:155]
  v_cvt_pk_bf16_f32 v23, v29, v23
  v_lshlrev_b32 v28, 16, v24
  v_mfma_f32_16x16x32_bf16 v[156:159], v[36:39], a[140:143], v[156:159]
  s_waitcnt lgkmcnt(4)
  v_and_b32 v24, s44, v24
  v_mul_f32 v28, v28, v52
  v_mfma_f32_16x16x32_bf16 v[160:163], v[40:43], a[128:131], v[160:163]
  ds_read_b64_tr_b16 v[36:37], v2 offset:4128
  v_mul_f32 v24, v24, v53
  v_mfma_f32_16x16x32_bf16 v[164:167], v[40:43], a[132:135], v[164:167]
  ds_read_b64_tr_b16 v[38:39], v2 offset:4640
  v_cvt_pk_bf16_f32 v24, v28, v24
  v_mfma_f32_16x16x32_bf16 v[168:171], v[40:43], a[136:139], v[168:171]
  buffer_store_dwordx4 v[20:23], v11, s[20:23], s77 offen offset:0 sc1
  v_mfma_f32_16x16x32_bf16 v[172:175], v[40:43], a[140:143], v[172:175]
  s_waitcnt lgkmcnt(4)
  ds_read_b128 v[20:23], v8 offset:12288
  v_mfma_f32_16x16x32_bf16 v[112:115], v[44:47], a[144:147], v[112:115]
  ds_read_b64_tr_b16 v[40:41], v2 offset:4136
  s_add_u32 s84, s42, 27262976
  v_mfma_f32_16x16x32_bf16 v[116:119], v[44:47], a[148:151], v[116:119]
  ds_read_b64_tr_b16 v[42:43], v2 offset:4648
  v_lshlrev_b32 v29, 16, v25
  v_mfma_f32_16x16x32_bf16 v[120:123], v[44:47], a[152:155], v[120:123]
  v_and_b32 v25, s44, v25
  v_mul_f32 v29, v29, v54
  v_mfma_f32_16x16x32_bf16 v[124:127], v[44:47], a[156:159], v[124:127]
  s_waitcnt lgkmcnt(5)
  v_mul_f32 v25, v25, v55
  v_cvt_pk_bf16_f32 v25, v29, v25
  v_mfma_f32_16x16x32_bf16 v[128:131], v[32:35], a[144:147], v[128:131]
  ds_read_b64_tr_b16 v[44:45], v1 offset:8256
  v_lshlrev_b32 v28, 16, v26
  v_mfma_f32_16x16x32_bf16 v[132:135], v[32:35], a[148:151], v[132:135]
  ds_read_b64_tr_b16 v[46:47], v1 offset:8768
  v_and_b32 v26, s44, v26
  v_mfma_f32_16x16x32_bf16 v[136:139], v[32:35], a[152:155], v[136:139]
  v_mul_f32 v28, v28, v68
  v_mul_f32 v26, v26, v69
  v_mfma_f32_16x16x32_bf16 v[140:143], v[32:35], a[156:159], v[140:143]
  s_waitcnt lgkmcnt(5)
  v_cvt_pk_bf16_f32 v26, v28, v26
  v_lshlrev_b32 v29, 16, v27
  v_mfma_f32_16x16x32_bf16 v[144:147], v[36:39], a[144:147], v[144:147]
  ds_read_b64_tr_b16 v[32:33], v1 offset:8264
  v_and_b32 v27, s44, v27
  v_mfma_f32_16x16x32_bf16 v[148:151], v[36:39], a[148:151], v[148:151]
  ds_read_b64_tr_b16 v[34:35], v1 offset:8776
  v_mul_f32 v29, v29, v70
  v_mfma_f32_16x16x32_bf16 v[152:155], v[36:39], a[152:155], v[152:155]
  v_mul_f32 v27, v27, v71
  v_cvt_pk_bf16_f32 v27, v29, v27
  v_mfma_f32_16x16x32_bf16 v[156:159], v[36:39], a[156:159], v[156:159]
  s_waitcnt lgkmcnt(4)
  v_lshlrev_b32 v28, 16, v20
  v_and_b32 v20, s44, v20
  v_mfma_f32_16x16x32_bf16 v[160:163], v[40:43], a[144:147], v[160:163]
  ds_read_b64_tr_b16 v[36:37], v2 offset:8256
  v_mul_f32 v28, v28, v56
  v_mfma_f32_16x16x32_bf16 v[164:167], v[40:43], a[148:151], v[164:167]
  ds_read_b64_tr_b16 v[38:39], v2 offset:8768
  v_mul_f32 v20, v20, v57
  v_mfma_f32_16x16x32_bf16 v[168:171], v[40:43], a[152:155], v[168:171]
  buffer_store_dwordx4 v[24:27], v11, s[20:23], s84 offen offset:1024 sc1
  v_mfma_f32_16x16x32_bf16 v[172:175], v[40:43], a[156:159], v[172:175]
  s_waitcnt lgkmcnt(4)
  ds_read_b128 v[24:27], v8 offset:14336
  v_mfma_f32_16x16x32_bf16 v[112:115], v[44:47], a[160:163], v[112:115]
  ds_read_b64_tr_b16 v[40:41], v2 offset:8264
  s_add_u32 s77, s42, 27262976
  v_mfma_f32_16x16x32_bf16 v[116:119], v[44:47], a[164:167], v[116:119]
  ds_read_b64_tr_b16 v[42:43], v2 offset:8776
  v_cvt_pk_bf16_f32 v20, v28, v20
  v_mfma_f32_16x16x32_bf16 v[120:123], v[44:47], a[168:171], v[120:123]
  v_lshlrev_b32 v29, 16, v21
  v_and_b32 v21, s44, v21
  v_mfma_f32_16x16x32_bf16 v[124:127], v[44:47], a[172:175], v[124:127]
  s_waitcnt lgkmcnt(5)
  v_mul_f32 v29, v29, v58
  v_mul_f32 v21, v21, v59
  v_mfma_f32_16x16x32_bf16 v[128:131], v[32:35], a[160:163], v[128:131]
  ds_read_b64_tr_b16 v[44:45], v1 offset:12384
  v_cvt_pk_bf16_f32 v21, v29, v21
  v_mfma_f32_16x16x32_bf16 v[132:135], v[32:35], a[164:167], v[132:135]
  ds_read_b64_tr_b16 v[46:47], v1 offset:12896
  s_waitcnt vmcnt(7) lgkmcnt(5)
  v_mfma_f32_16x16x32_bf16 v[136:139], v[32:35], a[168:171], v[136:139]
  s_barrier
  s_add_u32 s50, s35, 1863936
  s_add_u32 m0, s36, 49536
  v_mfma_f32_16x16x32_bf16 v[140:143], v[32:35], a[172:175], v[140:143]
  buffer_load_dwordx4 v4, s[8:11], s50 offen lds
  v_mfma_f32_16x16x32_bf16 v[144:147], v[36:39], a[160:163], v[144:147]
  ds_read_b64_tr_b16 v[32:33], v1 offset:12392
  s_add_u32 s51, s35, 2183424
  v_mfma_f32_16x16x32_bf16 v[148:151], v[36:39], a[164:167], v[148:151]
  ds_read_b64_tr_b16 v[34:35], v1 offset:12904
  s_add_u32 m0, s36, 0
  v_mfma_f32_16x16x32_bf16 v[152:155], v[36:39], a[168:171], v[152:155]
  buffer_load_dwordx4 v4, s[8:11], s51 offen lds
  v_mfma_f32_16x16x32_bf16 v[156:159], v[36:39], a[172:175], v[156:159]
  s_waitcnt lgkmcnt(4)
  s_add_u32 s50, s35, 2502912
  s_add_u32 m0, s36, 4128
  v_mfma_f32_16x16x32_bf16 v[160:163], v[40:43], a[160:163], v[160:163]
  ds_read_b64_tr_b16 v[36:37], v2 offset:12384
  v_lshlrev_b32 v28, 16, v22
  v_mfma_f32_16x16x32_bf16 v[164:167], v[40:43], a[164:167], v[164:167]
  ds_read_b64_tr_b16 v[38:39], v2 offset:12896
  v_and_b32 v22, s44, v22
  v_mfma_f32_16x16x32_bf16 v[168:171], v[40:43], a[168:171], v[168:171]
  buffer_load_dwordx4 v4, s[8:11], s50 offen lds
  v_mfma_f32_16x16x32_bf16 v[172:175], v[40:43], a[172:175], v[172:175]
  s_waitcnt lgkmcnt(4)
  v_mul_f32 v28, v28, v72
  v_mul_f32 v22, v22, v73
  v_mfma_f32_16x16x32_bf16 v[112:115], v[44:47], a[176:179], v[112:115]
  ds_read_b64_tr_b16 v[40:41], v2 offset:12392
  v_cvt_pk_bf16_f32 v22, v28, v22
  v_mfma_f32_16x16x32_bf16 v[116:119], v[44:47], a[180:183], v[116:119]
  ds_read_b64_tr_b16 v[42:43], v2 offset:12904
  v_lshlrev_b32 v29, 16, v23
  v_mfma_f32_16x16x32_bf16 v[120:123], v[44:47], a[184:187], v[120:123]
  v_and_b32 v23, s44, v23
  v_mul_f32 v29, v29, v74
  v_mfma_f32_16x16x32_bf16 v[124:127], v[44:47], a[188:191], v[124:127]
  s_waitcnt lgkmcnt(4)
  v_mul_f32 v23, v23, v75
  v_cvt_pk_bf16_f32 v23, v29, v23
  v_mfma_f32_16x16x32_bf16 v[128:131], v[32:35], a[176:179], v[128:131]
  ds_read_b64_tr_b16 v[44:45], v1 offset:16512
  v_lshlrev_b32 v28, 16, v24
  v_mfma_f32_16x16x32_bf16 v[132:135], v[32:35], a[180:183], v[132:135]
  ds_read_b64_tr_b16 v[46:47], v1 offset:17024
  v_and_b32 v24, s44, v24
  v_mfma_f32_16x16x32_bf16 v[136:139], v[32:35], a[184:187], v[136:139]
  buffer_store_dwordx4 v[20:23], v11, s[20:23], s77 offen offset:2048 sc1
  v_mfma_f32_16x16x32_bf16 v[140:143], v[32:35], a[188:191], v[140:143]
  s_waitcnt lgkmcnt(4)
  ds_read_b128 v[20:23], v9 offset:8192
  v_mfma_f32_16x16x32_bf16 v[144:147], v[36:39], a[176:179], v[144:147]
  ds_read_b64_tr_b16 v[32:33], v1 offset:16520
  s_add_u32 s84, s42, 27262976
  v_mfma_f32_16x16x32_bf16 v[148:151], v[36:39], a[180:183], v[148:151]
  ds_read_b64_tr_b16 v[34:35], v1 offset:17032
  v_mul_f32 v28, v28, v60
  v_mfma_f32_16x16x32_bf16 v[152:155], v[36:39], a[184:187], v[152:155]
  v_mul_f32 v24, v24, v61
  v_cvt_pk_bf16_f32 v24, v28, v24
  v_mfma_f32_16x16x32_bf16 v[156:159], v[36:39], a[188:191], v[156:159]
  s_waitcnt lgkmcnt(5)
  v_lshlrev_b32 v29, 16, v25
  v_and_b32 v25, s44, v25
  v_mfma_f32_16x16x32_bf16 v[160:163], v[40:43], a[176:179], v[160:163]
  ds_read_b64_tr_b16 v[36:37], v2 offset:16512
  v_mul_f32 v29, v29, v62
  v_mfma_f32_16x16x32_bf16 v[164:167], v[40:43], a[180:183], v[164:167]
  ds_read_b64_tr_b16 v[38:39], v2 offset:17024
  v_mul_f32 v25, v25, v63
  v_mfma_f32_16x16x32_bf16 v[168:171], v[40:43], a[184:187], v[168:171]
  v_cvt_pk_bf16_f32 v25, v29, v25
  v_lshlrev_b32 v28, 16, v26
  v_mfma_f32_16x16x32_bf16 v[172:175], v[40:43], a[188:191], v[172:175]
  s_waitcnt lgkmcnt(5)
  v_and_b32 v26, s44, v26
  v_mul_f32 v28, v28, v76
  v_mfma_f32_16x16x32_bf16 v[112:115], v[44:47], a[192:195], v[112:115]
  ds_read_b64_tr_b16 v[40:41], v2 offset:16520
  v_mul_f32 v26, v26, v77
  v_mfma_f32_16x16x32_bf16 v[116:119], v[44:47], a[196:199], v[116:119]
  ds_read_b64_tr_b16 v[42:43], v2 offset:17032
  v_cvt_pk_bf16_f32 v26, v28, v26
  v_mfma_f32_16x16x32_bf16 v[120:123], v[44:47], a[200:203], v[120:123]
  v_lshlrev_b32 v29, 16, v27
  v_and_b32 v27, s44, v27
  v_mfma_f32_16x16x32_bf16 v[124:127], v[44:47], a[204:207], v[124:127]
  s_waitcnt lgkmcnt(4)
  v_mul_f32 v29, v29, v78
  v_mul_f32 v27, v27, v79
  v_mfma_f32_16x16x32_bf16 v[128:131], v[32:35], a[192:195], v[128:131]
  ds_read_b64_tr_b16 v[44:45], v1 offset:20640
  v_cvt_pk_bf16_f32 v27, v29, v27
  v_mfma_f32_16x16x32_bf16 v[132:135], v[32:35], a[196:199], v[132:135]
  ds_read_b64_tr_b16 v[46:47], v1 offset:21152
  v_lshlrev_b32 v28, 16, v20
  v_mfma_f32_16x16x32_bf16 v[136:139], v[32:35], a[200:203], v[136:139]
  buffer_store_dwordx4 v[24:27], v11, s[20:23], s84 offen offset:3072 sc1
  v_mfma_f32_16x16x32_bf16 v[140:143], v[32:35], a[204:207], v[140:143]
  s_waitcnt lgkmcnt(4)
  ds_read_b128 v[24:27], v9 offset:10240
  v_mfma_f32_16x16x32_bf16 v[144:147], v[36:39], a[192:195], v[144:147]
  ds_read_b64_tr_b16 v[32:33], v1 offset:20648
  s_add_u32 s77, s42, 27267072
  v_mfma_f32_16x16x32_bf16 v[148:151], v[36:39], a[196:199], v[148:151]
  ds_read_b64_tr_b16 v[34:35], v1 offset:21160
  v_and_b32 v20, s44, v20
  v_mfma_f32_16x16x32_bf16 v[152:155], v[36:39], a[200:203], v[152:155]
  v_mul_f32 v28, v28, v80
  v_mul_f32 v20, v20, v81
  v_mfma_f32_16x16x32_bf16 v[156:159], v[36:39], a[204:207], v[156:159]
  s_waitcnt lgkmcnt(5)
  v_cvt_pk_bf16_f32 v20, v28, v20
  v_lshlrev_b32 v29, 16, v21
  v_mfma_f32_16x16x32_bf16 v[160:163], v[40:43], a[192:195], v[160:163]
  ds_read_b64_tr_b16 v[36:37], v2 offset:20640
  v_and_b32 v21, s44, v21
  v_mfma_f32_16x16x32_bf16 v[164:167], v[40:43], a[196:199], v[164:167]
  ds_read_b64_tr_b16 v[38:39], v2 offset:21152
  v_mul_f32 v29, v29, v82
  v_mfma_f32_16x16x32_bf16 v[168:171], v[40:43], a[200:203], v[168:171]
  v_mul_f32 v21, v21, v83
  v_cvt_pk_bf16_f32 v21, v29, v21
  v_mfma_f32_16x16x32_bf16 v[172:175], v[40:43], a[204:207], v[172:175]
  s_waitcnt lgkmcnt(5)
  v_lshlrev_b32 v28, 16, v22
  v_and_b32 v22, s44, v22
  v_mfma_f32_16x16x32_bf16 v[112:115], v[44:47], a[0:3], v[112:115]
  ds_read_b64_tr_b16 v[40:41], v2 offset:20648
  v_mul_f32 v28, v28, v96
  v_mfma_f32_16x16x32_bf16 v[116:119], v[44:47], a[4:7], v[116:119]
  ds_read_b64_tr_b16 v[42:43], v2 offset:21160
  v_mul_f32 v22, v22, v97
  v_mfma_f32_16x16x32_bf16 v[120:123], v[44:47], a[8:11], v[120:123]
  v_cvt_pk_bf16_f32 v22, v28, v22
  v_lshlrev_b32 v29, 16, v23
  v_mfma_f32_16x16x32_bf16 v[124:127], v[44:47], a[12:15], v[124:127]
  s_waitcnt lgkmcnt(4)
  v_and_b32 v23, s44, v23
  v_mul_f32 v29, v29, v98
  v_mfma_f32_16x16x32_bf16 v[128:131], v[32:35], a[0:3], v[128:131]
  ds_read_b64_tr_b16 v[44:45], v1 offset:24768
  v_mul_f32 v23, v23, v99
  v_mfma_f32_16x16x32_bf16 v[132:135], v[32:35], a[4:7], v[132:135]
  ds_read_b64_tr_b16 v[46:47], v1 offset:25280
  s_waitcnt vmcnt(9) lgkmcnt(4)
  v_mfma_f32_16x16x32_bf16 v[136:139], v[32:35], a[8:11], v[136:139]
  s_barrier
  s_add_u32 s51, s35, 1597696
  s_add_u32 m0, s36, 8256
  v_mfma_f32_16x16x32_bf16 v[140:143], v[32:35], a[12:15], v[140:143]
  buffer_load_dwordx4 v4, s[8:11], s51 offen lds
  v_mfma_f32_16x16x32_bf16 v[144:147], v[36:39], a[0:3], v[144:147]
  ds_read_b64_tr_b16 v[32:33], v1 offset:24776
  s_add_u32 s50, s35, 1917184
  v_mfma_f32_16x16x32_bf16 v[148:151], v[36:39], a[4:7], v[148:151]
  ds_read_b64_tr_b16 v[34:35], v1 offset:25288
  s_add_u32 m0, s36, 12384
  v_mfma_f32_16x16x32_bf16 v[152:155], v[36:39], a[8:11], v[152:155]
  buffer_load_dwordx4 v4, s[8:11], s50 offen lds
  v_mfma_f32_16x16x32_bf16 v[156:159], v[36:39], a[12:15], v[156:159]
  s_waitcnt lgkmcnt(4)
  s_add_u32 s51, s35, 2236672
  s_add_u32 m0, s36, 16512
  v_mfma_f32_16x16x32_bf16 v[160:163], v[40:43], a[0:3], v[160:163]
  ds_read_b64_tr_b16 v[36:37], v2 offset:24768
  v_cvt_pk_bf16_f32 v23, v29, v23
  v_mfma_f32_16x16x32_bf16 v[164:167], v[40:43], a[4:7], v[164:167]
  ds_read_b64_tr_b16 v[38:39], v2 offset:25280
  v_lshlrev_b32 v28, 16, v24
  v_mfma_f32_16x16x32_bf16 v[168:171], v[40:43], a[8:11], v[168:171]
  buffer_store_dwordx4 v[20:23], v11, s[20:23], s77 offen offset:0 sc1
  v_mfma_f32_16x16x32_bf16 v[172:175], v[40:43], a[12:15], v[172:175]
  s_waitcnt lgkmcnt(4)
  ds_read_b128 v[20:23], v9 offset:12288
  v_mfma_f32_16x16x32_bf16 v[112:115], v[44:47], a[16:19], v[112:115]
  ds_read_b64_tr_b16 v[40:41], v2 offset:24776
  s_add_u32 s84, s42, 27267072
  v_mfma_f32_16x16x32_bf16 v[116:119], v[44:47], a[20:23], v[116:119]
  ds_read_b64_tr_b16 v[42:43], v2 offset:25288
  v_and_b32 v24, s44, v24
  v_mfma_f32_16x16x32_bf16 v[120:123], v[44:47], a[24:27], v[120:123]
  buffer_load_dwordx4 v4, s[8:11], s51 offen lds
  v_mfma_f32_16x16x32_bf16 v[124:127], v[44:47], a[28:31], v[124:127]
  s_waitcnt lgkmcnt(5)
  v_mul_f32 v28, v28, v84
  v_mul_f32 v24, v24, v85
  v_mfma_f32_16x16x32_bf16 v[128:131], v[32:35], a[16:19], v[128:131]
  ds_read_b64_tr_b16 v[44:45], v1 offset:28896
  v_cvt_pk_bf16_f32 v24, v28, v24
  v_mfma_f32_16x16x32_bf16 v[132:135], v[32:35], a[20:23], v[132:135]
  ds_read_b64_tr_b16 v[46:47], v1 offset:29408
  v_lshlrev_b32 v29, 16, v25
  v_mfma_f32_16x16x32_bf16 v[136:139], v[32:35], a[24:27], v[136:139]
  v_and_b32 v25, s44, v25
  v_mul_f32 v29, v29, v86
  v_mfma_f32_16x16x32_bf16 v[140:143], v[32:35], a[28:31], v[140:143]
  s_waitcnt lgkmcnt(5)
  v_mul_f32 v25, v25, v87
  v_cvt_pk_bf16_f32 v25, v29, v25
  v_mfma_f32_16x16x32_bf16 v[144:147], v[36:39], a[16:19], v[144:147]
  ds_read_b64_tr_b16 v[32:33], v1 offset:28904
  v_lshlrev_b32 v28, 16, v26
  v_mfma_f32_16x16x32_bf16 v[148:151], v[36:39], a[20:23], v[148:151]
  ds_read_b64_tr_b16 v[34:35], v1 offset:29416
  v_and_b32 v26, s44, v26
  v_mfma_f32_16x16x32_bf16 v[152:155], v[36:39], a[24:27], v[152:155]
  v_mul_f32 v28, v28, v100
  v_mul_f32 v26, v26, v101
  v_mfma_f32_16x16x32_bf16 v[156:159], v[36:39], a[28:31], v[156:159]
  s_waitcnt lgkmcnt(4)
  v_cvt_pk_bf16_f32 v26, v28, v26
  v_lshlrev_b32 v29, 16, v27
  v_mfma_f32_16x16x32_bf16 v[160:163], v[40:43], a[16:19], v[160:163]
  ds_read_b64_tr_b16 v[36:37], v2 offset:28896
  v_and_b32 v27, s44, v27
  v_mfma_f32_16x16x32_bf16 v[164:167], v[40:43], a[20:23], v[164:167]
  ds_read_b64_tr_b16 v[38:39], v2 offset:29408
  v_mul_f32 v29, v29, v102
  v_mfma_f32_16x16x32_bf16 v[168:171], v[40:43], a[24:27], v[168:171]
  v_mul_f32 v27, v27, v103
  v_cvt_pk_bf16_f32 v27, v29, v27
  v_mfma_f32_16x16x32_bf16 v[172:175], v[40:43], a[28:31], v[172:175]
  s_waitcnt lgkmcnt(4)
  v_lshlrev_b32 v28, 16, v20
  v_and_b32 v20, s44, v20
  v_mfma_f32_16x16x32_bf16 v[112:115], v[44:47], a[32:35], v[112:115]
  ds_read_b64_tr_b16 v[40:41], v2 offset:28904
  v_mul_f32 v28, v28, v88
  v_mfma_f32_16x16x32_bf16 v[116:119], v[44:47], a[36:39], v[116:119]
  ds_read_b64_tr_b16 v[42:43], v2 offset:29416
  v_mul_f32 v20, v20, v89
  v_mfma_f32_16x16x32_bf16 v[120:123], v[44:47], a[40:43], v[120:123]
  buffer_store_dwordx4 v[24:27], v11, s[20:23], s84 offen offset:1024 sc1
  v_mfma_f32_16x16x32_bf16 v[124:127], v[44:47], a[44:47], v[124:127]
  s_waitcnt lgkmcnt(4)
  ds_read_b128 v[24:27], v9 offset:14336
  v_mfma_f32_16x16x32_bf16 v[128:131], v[32:35], a[32:35], v[128:131]
  ds_read_b64_tr_b16 v[44:45], v1 offset:33024
  s_add_u32 s77, s42, 27267072
  v_mfma_f32_16x16x32_bf16 v[132:135], v[32:35], a[36:39], v[132:135]
  ds_read_b64_tr_b16 v[46:47], v1 offset:33536
  v_cvt_pk_bf16_f32 v20, v28, v20
  v_mfma_f32_16x16x32_bf16 v[136:139], v[32:35], a[40:43], v[136:139]
  v_lshlrev_b32 v29, 16, v21
  v_and_b32 v21, s44, v21
  v_mfma_f32_16x16x32_bf16 v[140:143], v[32:35], a[44:47], v[140:143]
  s_waitcnt lgkmcnt(5)
  v_mul_f32 v29, v29, v90
  v_mul_f32 v21, v21, v91
  v_mfma_f32_16x16x32_bf16 v[144:147], v[36:39], a[32:35], v[144:147]
  ds_read_b64_tr_b16 v[32:33], v1 offset:33032
  v_cvt_pk_bf16_f32 v21, v29, v21
  v_mfma_f32_16x16x32_bf16 v[148:151], v[36:39], a[36:39], v[148:151]
  ds_read_b64_tr_b16 v[34:35], v1 offset:33544
  v_lshlrev_b32 v28, 16, v22
  v_mfma_f32_16x16x32_bf16 v[152:155], v[36:39], a[40:43], v[152:155]
  v_and_b32 v22, s44, v22
  v_mul_f32 v28, v28, v104
  v_mfma_f32_16x16x32_bf16 v[156:159], v[36:39], a[44:47], v[156:159]
  s_waitcnt lgkmcnt(5)
  v_mul_f32 v22, v22, v105
  v_cvt_pk_bf16_f32 v22, v28, v22
  v_mfma_f32_16x16x32_bf16 v[160:163], v[40:43], a[32:35], v[160:163]
  ds_read_b64_tr_b16 v[36:37], v2 offset:33024
  v_lshlrev_b32 v29, 16, v23
  v_mfma_f32_16x16x32_bf16 v[164:167], v[40:43], a[36:39], v[164:167]
  ds_read_b64_tr_b16 v[38:39], v2 offset:33536
  v_and_b32 v23, s44, v23
  v_mfma_f32_16x16x32_bf16 v[168:171], v[40:43], a[40:43], v[168:171]
  v_mul_f32 v29, v29, v106
  v_mul_f32 v23, v23, v107
  v_mfma_f32_16x16x32_bf16 v[172:175], v[40:43], a[44:47], v[172:175]
  s_waitcnt lgkmcnt(4)
  v_cvt_pk_bf16_f32 v23, v29, v23
  v_lshlrev_b32 v28, 16, v24
  v_mfma_f32_16x16x32_bf16 v[112:115], v[44:47], a[48:51], v[112:115]
  ds_read_b64_tr_b16 v[40:41], v2 offset:33032
  v_and_b32 v24, s44, v24
  v_mfma_f32_16x16x32_bf16 v[116:119], v[44:47], a[52:55], v[116:119]
  ds_read_b64_tr_b16 v[42:43], v2 offset:33544
  v_mul_f32 v28, v28, v92
  v_mfma_f32_16x16x32_bf16 v[120:123], v[44:47], a[56:59], v[120:123]
  buffer_store_dwordx4 v[20:23], v11, s[20:23], s77 offen offset:2048 sc1
  v_mfma_f32_16x16x32_bf16 v[124:127], v[44:47], a[60:63], v[124:127]
  s_waitcnt lgkmcnt(4)
  s_add_u32 s84, s42, 27267072
  v_mul_f32 v24, v24, v93
  v_mfma_f32_16x16x32_bf16 v[128:131], v[32:35], a[48:51], v[128:131]
  ds_read_b64_tr_b16 v[44:45], v1 offset:37152
  v_cvt_pk_bf16_f32 v24, v28, v24
  v_mfma_f32_16x16x32_bf16 v[132:135], v[32:35], a[52:55], v[132:135]
  ds_read_b64_tr_b16 v[46:47], v1 offset:37664
  s_waitcnt vmcnt(10) lgkmcnt(4)
  v_mfma_f32_16x16x32_bf16 v[136:139], v[32:35], a[56:59], v[136:139]
  s_barrier
  s_add_u32 s50, s35, 2556160
  s_add_u32 m0, s36, 20640
  v_mfma_f32_16x16x32_bf16 v[140:143], v[32:35], a[60:63], v[140:143]
  buffer_load_dwordx4 v4, s[8:11], s50 offen lds
  v_mfma_f32_16x16x32_bf16 v[144:147], v[36:39], a[48:51], v[144:147]
  ds_read_b64_tr_b16 v[32:33], v1 offset:37160
  s_add_u32 s51, s35, 1650944
  v_mfma_f32_16x16x32_bf16 v[148:151], v[36:39], a[52:55], v[148:151]
  ds_read_b64_tr_b16 v[34:35], v1 offset:37672
  s_add_u32 m0, s36, 24768
  v_mfma_f32_16x16x32_bf16 v[152:155], v[36:39], a[56:59], v[152:155]
  buffer_load_dwordx4 v4, s[8:11], s51 offen lds
  v_mfma_f32_16x16x32_bf16 v[156:159], v[36:39], a[60:63], v[156:159]
  s_waitcnt lgkmcnt(4)
  s_add_u32 s50, s35, 1970432
  s_add_u32 m0, s36, 28896
  v_mfma_f32_16x16x32_bf16 v[160:163], v[40:43], a[48:51], v[160:163]
  ds_read_b64_tr_b16 v[36:37], v2 offset:37152
  s_waitcnt vmcnt(8)
  v_mfma_f32_16x16x32_bf16 v[164:167], v[40:43], a[52:55], v[164:167]
  ds_read_b64_tr_b16 v[38:39], v2 offset:37664
  v_add_u32 v17, 5, v30
  v_mfma_f32_16x16x32_bf16 v[168:171], v[40:43], a[56:59], v[168:171]
  buffer_store_dword v17, v16, s[20:23], 0 offen sc1
  v_mfma_f32_16x16x32_bf16 v[172:175], v[40:43], a[60:63], v[172:175]
  s_waitcnt lgkmcnt(4)
  v_lshlrev_b32 v29, 16, v25
  v_and_b32 v25, s44, v25
  v_mfma_f32_16x16x32_bf16 v[112:115], v[44:47], a[64:67], v[112:115]
  ds_read_b64_tr_b16 v[40:41], v2 offset:37160
  v_mul_f32 v29, v29, v94
  v_mfma_f32_16x16x32_bf16 v[116:119], v[44:47], a[68:71], v[116:119]
  ds_read_b64_tr_b16 v[42:43], v2 offset:37672
  v_mul_f32 v25, v25, v95
  v_mfma_f32_16x16x32_bf16 v[120:123], v[44:47], a[72:75], v[120:123]
  buffer_load_dwordx4 v4, s[8:11], s50 offen lds
  v_mfma_f32_16x16x32_bf16 v[124:127], v[44:47], a[76:79], v[124:127]
  s_waitcnt lgkmcnt(4)
  v_cvt_pk_bf16_f32 v25, v29, v25
  v_lshlrev_b32 v28, 16, v26
  v_mfma_f32_16x16x32_bf16 v[128:131], v[32:35], a[64:67], v[128:131]
  ds_read_b64_tr_b16 v[44:45], v1 offset:41280
  v_and_b32 v26, s44, v26
  v_mfma_f32_16x16x32_bf16 v[132:135], v[32:35], a[68:71], v[132:135]
  ds_read_b64_tr_b16 v[46:47], v1 offset:41792
  v_mul_f32 v28, v28, v108
  v_mfma_f32_16x16x32_bf16 v[136:139], v[32:35], a[72:75], v[136:139]
  v_mul_f32 v26, v26, v109
  v_cvt_pk_bf16_f32 v26, v28, v26
  v_mfma_f32_16x16x32_bf16 v[140:143], v[32:35], a[76:79], v[140:143]
  s_waitcnt lgkmcnt(4)
  v_lshlrev_b32 v29, 16, v27
  v_and_b32 v27, s44, v27
  v_mfma_f32_16x16x32_bf16 v[144:147], v[36:39], a[64:67], v[144:147]
  ds_read_b64_tr_b16 v[32:33], v1 offset:41288
  v_mul_f32 v29, v29, v110
  v_mfma_f32_16x16x32_bf16 v[148:151], v[36:39], a[68:71], v[148:151]
  ds_read_b64_tr_b16 v[34:35], v1 offset:41800
  v_mul_f32 v27, v27, v111
  v_mfma_f32_16x16x32_bf16 v[152:155], v[36:39], a[72:75], v[152:155]
  v_cvt_pk_bf16_f32 v27, v29, v27
  v_mfma_f32_16x16x32_bf16 v[156:159], v[36:39], a[76:79], v[156:159]
  s_waitcnt lgkmcnt(4)
  v_mfma_f32_16x16x32_bf16 v[160:163], v[40:43], a[64:67], v[160:163]
  ds_read_b64_tr_b16 v[36:37], v2 offset:41280
  v_mfma_f32_16x16x32_bf16 v[164:167], v[40:43], a[68:71], v[164:167]
  ds_read_b64_tr_b16 v[38:39], v2 offset:41792
  s_waitcnt lgkmcnt(4)
  v_mfma_f32_16x16x32_bf16 v[168:171], v[40:43], a[72:75], v[168:171]
  buffer_store_dwordx4 v[24:27], v11, s[20:23], s84 offen offset:3072 sc1
  v_mfma_f32_16x16x32_bf16 v[172:175], v[40:43], a[76:79], v[172:175]
  v_mfma_f32_16x16x32_bf16 v[112:115], v[44:47], a[80:83], v[112:115]
  ds_read_b64_tr_b16 v[40:41], v2 offset:41288
  v_mfma_f32_16x16x32_bf16 v[116:119], v[44:47], a[84:87], v[116:119]
  ds_read_b64_tr_b16 v[42:43], v2 offset:41800
  s_waitcnt lgkmcnt(4)
  v_mfma_f32_16x16x32_bf16 v[120:123], v[44:47], a[88:91], v[120:123]
  v_mfma_f32_16x16x32_bf16 v[124:127], v[44:47], a[92:95], v[124:127]
  v_mfma_f32_16x16x32_bf16 v[128:131], v[32:35], a[80:83], v[128:131]
  ds_read_b64_tr_b16 v[44:45], v1 offset:45408
  v_mfma_f32_16x16x32_bf16 v[132:135], v[32:35], a[84:87], v[132:135]
  ds_read_b64_tr_b16 v[46:47], v1 offset:45920
  s_waitcnt lgkmcnt(4)
  v_mfma_f32_16x16x32_bf16 v[136:139], v[32:35], a[88:91], v[136:139]
  v_mfma_f32_16x16x32_bf16 v[140:143], v[32:35], a[92:95], v[140:143]
  v_mfma_f32_16x16x32_bf16 v[144:147], v[36:39], a[80:83], v[144:147]
  ds_read_b64_tr_b16 v[32:33], v1 offset:45416
  v_mfma_f32_16x16x32_bf16 v[148:151], v[36:39], a[84:87], v[148:151]
  ds_read_b64_tr_b16 v[34:35], v1 offset:45928
  s_waitcnt lgkmcnt(4)
  v_mfma_f32_16x16x32_bf16 v[152:155], v[36:39], a[88:91], v[152:155]
  v_mfma_f32_16x16x32_bf16 v[156:159], v[36:39], a[92:95], v[156:159]
  v_mfma_f32_16x16x32_bf16 v[160:163], v[40:43], a[80:83], v[160:163]
  ds_read_b64_tr_b16 v[36:37], v2 offset:45408
  v_mfma_f32_16x16x32_bf16 v[164:167], v[40:43], a[84:87], v[164:167]
  ds_read_b64_tr_b16 v[38:39], v2 offset:45920
  s_waitcnt lgkmcnt(4)
  v_mfma_f32_16x16x32_bf16 v[168:171], v[40:43], a[88:91], v[168:171]
  v_mfma_f32_16x16x32_bf16 v[172:175], v[40:43], a[92:95], v[172:175]
  v_mfma_f32_16x16x32_bf16 v[112:115], v[44:47], a[96:99], v[112:115]
  ds_read_b64_tr_b16 v[40:41], v2 offset:45416
  v_mfma_f32_16x16x32_bf16 v[116:119], v[44:47], a[100:103], v[116:119]
  ds_read_b64_tr_b16 v[42:43], v2 offset:45928
  s_waitcnt lgkmcnt(4)
  v_mfma_f32_16x16x32_bf16 v[120:123], v[44:47], a[104:107], v[120:123]
  v_mfma_f32_16x16x32_bf16 v[124:127], v[44:47], a[108:111], v[124:127]
  v_mfma_f32_16x16x32_bf16 v[128:131], v[32:35], a[96:99], v[128:131]
  ds_read_b64_tr_b16 v[44:45], v1 offset:49536
  v_mfma_f32_16x16x32_bf16 v[132:135], v[32:35], a[100:103], v[132:135]
  ds_read_b64_tr_b16 v[46:47], v1 offset:50048
  s_waitcnt vmcnt(10) lgkmcnt(4)
  v_mfma_f32_16x16x32_bf16 v[136:139], v[32:35], a[104:107], v[136:139]
  s_barrier
  s_add_u32 s51, s35, 2289920
  s_add_u32 m0, s36, 33024
  v_mfma_f32_16x16x32_bf16 v[140:143], v[32:35], a[108:111], v[140:143]
  buffer_load_dwordx4 v4, s[8:11], s51 offen lds
  v_mfma_f32_16x16x32_bf16 v[144:147], v[36:39], a[96:99], v[144:147]
  ds_read_b64_tr_b16 v[32:33], v1 offset:49544
  s_add_u32 s50, s35, 2609408
  v_mfma_f32_16x16x32_bf16 v[148:151], v[36:39], a[100:103], v[148:151]
  ds_read_b64_tr_b16 v[34:35], v1 offset:50056
  s_waitcnt lgkmcnt(4)
  v_mfma_f32_16x16x32_bf16 v[152:155], v[36:39], a[104:107], v[152:155]
  s_add_u32 m0, s36, 37152
  v_mfma_f32_16x16x32_bf16 v[156:159], v[36:39], a[108:111], v[156:159]
  buffer_load_dwordx4 v4, s[8:11], s50 offen lds
  v_mfma_f32_16x16x32_bf16 v[160:163], v[40:43], a[96:99], v[160:163]
  ds_read_b64_tr_b16 v[36:37], v2 offset:49536
  s_add_u32 s51, s35, 2662656
  v_mfma_f32_16x16x32_bf16 v[164:167], v[40:43], a[100:103], v[164:167]
  ds_read_b64_tr_b16 v[38:39], v2 offset:50048
  s_waitcnt lgkmcnt(4)
  v_mfma_f32_16x16x32_bf16 v[168:171], v[40:43], a[104:107], v[168:171]
  s_add_u32 m0, s36, 41280
  ds_read_b128 v[20:23], v8 offset:16384
  v_mfma_f32_16x16x32_bf16 v[172:175], v[40:43], a[108:111], v[172:175]
  buffer_load_dwordx4 v5, s[8:11], s51 offen lds
  v_mfma_f32_16x16x32_bf16 v[176:179], v[44:47], a[112:115], v[176:179]
  ds_read_b64_tr_b16 v[40:41], v2 offset:49544
  v_mfma_f32_16x16x32_bf16 v[180:183], v[44:47], a[116:119], v[180:183]
  ds_read_b64_tr_b16 v[42:43], v2 offset:50056
  s_waitcnt lgkmcnt(5)
  v_mfma_f32_16x16x32_bf16 v[184:187], v[44:47], a[120:123], v[184:187]
  ds_read_b128 v[24:27], v8 offset:18432
  s_add_u32 s77, s42, 27271168
  v_mfma_f32_16x16x32_bf16 v[188:191], v[44:47], a[124:127], v[188:191]
  v_mfma_f32_16x16x32_bf16 v[192:195], v[32:35], a[112:115], v[192:195]
  ds_read_b64_tr_b16 v[44:45], v1 offset:0
  s_waitcnt lgkmcnt(4)
  v_mfma_f32_16x16x32_bf16 v[196:199], v[32:35], a[116:119], v[196:199]
  ds_read_b64_tr_b16 v[46:47], v1 offset:512
  v_lshlrev_b32 v28, 16, v20
  v_mfma_f32_16x16x32_bf16 v[200:203], v[32:35], a[120:123], v[200:203]
  v_and_b32 v20, s44, v20
  v_mul_f32 v28, v28, v112
  v_mfma_f32_16x16x32_bf16 v[204:207], v[32:35], a[124:127], v[204:207]
  v_mul_f32 v20, v20, v113
  v_cvt_pk_bf16_f32 v20, v28, v20
  v_mfma_f32_16x16x32_bf16 v[208:211], v[36:39], a[112:115], v[208:211]
  ds_read_b64_tr_b16 v[32:33], v1 offset:8
  v_lshlrev_b32 v29, 16, v21
  v_mfma_f32_16x16x32_bf16 v[212:215], v[36:39], a[116:119], v[212:215]
  ds_read_b64_tr_b16 v[34:35], v1 offset:520
  v_and_b32 v21, s44, v21
  v_mfma_f32_16x16x32_bf16 v[216:219], v[36:39], a[120:123], v[216:219]
  v_mul_f32 v29, v29, v114
  v_mul_f32 v21, v21, v115
  v_mfma_f32_16x16x32_bf16 v[220:223], v[36:39], a[124:127], v[220:223]
  s_waitcnt lgkmcnt(5)
  v_cvt_pk_bf16_f32 v21, v29, v21
  v_lshlrev_b32 v28, 16, v22
  v_mfma_f32_16x16x32_bf16 v[224:227], v[40:43], a[112:115], v[224:227]
  ds_read_b64_tr_b16 v[36:37], v2 offset:0
  v_and_b32 v22, s44, v22
  v_mfma_f32_16x16x32_bf16 v[228:231], v[40:43], a[116:119], v[228:231]
  ds_read_b64_tr_b16 v[38:39], v2 offset:512
  v_mul_f32 v28, v28, v128
  v_mfma_f32_16x16x32_bf16 v[232:235], v[40:43], a[120:123], v[232:235]
  v_mul_f32 v22, v22, v129
  v_cvt_pk_bf16_f32 v22, v28, v22
  v_mfma_f32_16x16x32_bf16 v[236:239], v[40:43], a[124:127], v[236:239]
  s_waitcnt lgkmcnt(4)
  v_lshlrev_b32 v29, 16, v23
  v_and_b32 v23, s44, v23
  v_mfma_f32_16x16x32_bf16 v[176:179], v[44:47], a[128:131], v[176:179]
  ds_read_b64_tr_b16 v[40:41], v2 offset:8
  v_mul_f32 v29, v29, v130
  v_mfma_f32_16x16x32_bf16 v[180:183], v[44:47], a[132:135], v[180:183]
  ds_read_b64_tr_b16 v[42:43], v2 offset:520
  v_mul_f32 v23, v23, v131
  v_mfma_f32_16x16x32_bf16 v[184:187], v[44:47], a[136:139], v[184:187]
  v_cvt_pk_bf16_f32 v23, v29, v23
  v_lshlrev_b32 v28, 16, v24
  v_mfma_f32_16x16x32_bf16 v[188:191], v[44:47], a[140:143], v[188:191]
  s_waitcnt lgkmcnt(4)
  v_and_b32 v24, s44, v24
  v_mul_f32 v28, v28, v116
  v_mfma_f32_16x16x32_bf16 v[192:195], v[32:35], a[128:131], v[192:195]
  ds_read_b64_tr_b16 v[44:45], v1 offset:4128
  v_mul_f32 v24, v24, v117
  v_mfma_f32_16x16x32_bf16 v[196:199], v[32:35], a[132:135], v[196:199]
  ds_read_b64_tr_b16 v[46:47], v1 offset:4640
  v_cvt_pk_bf16_f32 v24, v28, v24
  v_mfma_f32_16x16x32_bf16 v[200:203], v[32:35], a[136:139], v[200:203]
  buffer_store_dwordx4 v[20:23], v11, s[20:23], s77 offen offset:0 sc1
  v_mfma_f32_16x16x32_bf16 v[204:207], v[32:35], a[140:143], v[204:207]
  s_waitcnt lgkmcnt(4)
  ds_read_b128 v[20:23], v8 offset:20480
  v_mfma_f32_16x16x32_bf16 v[208:211], v[36:39], a[128:131], v[208:211]
  ds_read_b64_tr_b16 v[32:33], v1 offset:4136
  s_add_u32 s84, s42, 27271168
  v_mfma_f32_16x16x32_bf16 v[212:215], v[36:39], a[132:135], v[212:215]
  ds_read_b64_tr_b16 v[34:35], v1 offset:4648
  v_lshlrev_b32 v29, 16, v25
  v_mfma_f32_16x16x32_bf16 v[216:219], v[36:39], a[136:139], v[216:219]
  v_and_b32 v25, s44, v25
  v_mul_f32 v29, v29, v118
  v_mfma_f32_16x16x32_bf16 v[220:223], v[36:39], a[140:143], v[220:223]
  s_waitcnt lgkmcnt(5)
  v_mul_f32 v25, v25, v119
  v_cvt_pk_bf16_f32 v25, v29, v25
  v_mfma_f32_16x16x32_bf16 v[224:227], v[40:43], a[128:131], v[224:227]
  ds_read_b64_tr_b16 v[36:37], v2 offset:4128
  v_lshlrev_b32 v28, 16, v26
  v_mfma_f32_16x16x32_bf16 v[228:231], v[40:43], a[132:135], v[228:231]
  ds_read_b64_tr_b16 v[38:39], v2 offset:4640
  v_and_b32 v26, s44, v26
  v_mfma_f32_16x16x32_bf16 v[232:235], v[40:43], a[136:139], v[232:235]
  v_mul_f32 v28, v28, v132
  v_mul_f32 v26, v26, v133
  v_mfma_f32_16x16x32_bf16 v[236:239], v[40:43], a[140:143], v[236:239]
  s_waitcnt lgkmcnt(5)
  v_cvt_pk_bf16_f32 v26, v28, v26
  v_lshlrev_b32 v29, 16, v27
  v_mfma_f32_16x16x32_bf16 v[176:179], v[44:47], a[144:147], v[176:179]
  ds_read_b64_tr_b16 v[40:41], v2 offset:4136
  v_and_b32 v27, s44, v27
  v_mfma_f32_16x16x32_bf16 v[180:183], v[44:47], a[148:151], v[180:183]
  ds_read_b64_tr_b16 v[42:43], v2 offset:4648
  v_mul_f32 v29, v29, v134
  v_mfma_f32_16x16x32_bf16 v[184:187], v[44:47], a[152:155], v[184:187]
  v_mul_f32 v27, v27, v135
  v_cvt_pk_bf16_f32 v27, v29, v27
  v_mfma_f32_16x16x32_bf16 v[188:191], v[44:47], a[156:159], v[188:191]
  s_waitcnt lgkmcnt(4)
  v_lshlrev_b32 v28, 16, v20
  v_and_b32 v20, s44, v20
  v_mfma_f32_16x16x32_bf16 v[192:195], v[32:35], a[144:147], v[192:195]
  ds_read_b64_tr_b16 v[44:45], v1 offset:8256
  s_waitcnt vmcnt(4)
  v_mfma_f32_16x16x32_bf16 v[196:199], v[32:35], a[148:151], v[196:199]
  ds_read_b64_tr_b16 v[46:47], v1 offset:8768
  s_waitcnt lgkmcnt(4)
  v_mfma_f32_16x16x32_bf16 v[200:203], v[32:35], a[152:155], v[200:203]
  s_barrier
  v_add_u32 v17, 6, v30
  s_add_u32 s50, s35, 2715904
  v_mfma_f32_16x16x32_bf16 v[204:207], v[32:35], a[156:159], v[204:207]
  buffer_store_dword v17, v16, s[20:23], 0 offen sc1
  v_mfma_f32_16x16x32_bf16 v[208:211], v[36:39], a[144:147], v[208:211]
  ds_read_b64_tr_b16 v[32:33], v1 offset:8264
  s_add_u32 m0, s36, 45408
  v_mfma_f32_16x16x32_bf16 v[212:215], v[36:39], a[148:151], v[212:215]
  ds_read_b64_tr_b16 v[34:35], v1 offset:8776
  v_mul_f32 v28, v28, v120
  v_mfma_f32_16x16x32_bf16 v[216:219], v[36:39], a[152:155], v[216:219]
  buffer_store_dwordx4 v[24:27], v11, s[20:23], s84 offen offset:1024 sc1
  v_mfma_f32_16x16x32_bf16 v[220:223], v[36:39], a[156:159], v[220:223]
  s_waitcnt lgkmcnt(4)
  ds_read_b128 v[24:27], v8 offset:22528
  v_mfma_f32_16x16x32_bf16 v[224:227], v[40:43], a[144:147], v[224:227]
  ds_read_b64_tr_b16 v[36:37], v2 offset:8256
  s_add_u32 s77, s42, 27271168
  v_mfma_f32_16x16x32_bf16 v[228:231], v[40:43], a[148:151], v[228:231]
  ds_read_b64_tr_b16 v[38:39], v2 offset:8768
  v_mul_f32 v20, v20, v121
  v_mfma_f32_16x16x32_bf16 v[232:235], v[40:43], a[152:155], v[232:235]
  buffer_load_dwordx4 v5, s[8:11], s50 offen lds
  v_mfma_f32_16x16x32_bf16 v[236:239], v[40:43], a[156:159], v[236:239]
  s_waitcnt lgkmcnt(5)
  s_lshr_b32 s51, 0x1e2f2923, s37
  s_and_b32 s51, s51, 0xff
  v_mfma_f32_16x16x32_bf16 v[176:179], v[44:47], a[160:163], v[176:179]
  ds_read_b64_tr_b16 v[40:41], v2 offset:8264
  s_mul_i32 s51, s51, 53248
  v_mfma_f32_16x16x32_bf16 v[180:183], v[44:47], a[164:167], v[180:183]
  ds_read_b64_tr_b16 v[42:43], v2 offset:8776
  s_add_u32 s51, s51, s38
  v_mfma_f32_16x16x32_bf16 v[184:187], v[44:47], a[168:171], v[184:187]
  s_add_u32 m0, s39, 49536
  v_cvt_pk_bf16_f32 v20, v28, v20
  v_lshlrev_b32 v29, 16, v21
  v_mfma_f32_16x16x32_bf16 v[188:191], v[44:47], a[172:175], v[188:191]
  s_waitcnt lgkmcnt(5)
  v_and_b32 v21, s44, v21
  v_mul_f32 v29, v29, v122
  v_mfma_f32_16x16x32_bf16 v[192:195], v[32:35], a[160:163], v[192:195]
  ds_read_b64_tr_b16 v[44:45], v1 offset:12384
  v_mul_f32 v21, v21, v123
  v_mfma_f32_16x16x32_bf16 v[196:199], v[32:35], a[164:167], v[196:199]
  ds_read_b64_tr_b16 v[46:47], v1 offset:12896
  v_cvt_pk_bf16_f32 v21, v29, v21
  v_mfma_f32_16x16x32_bf16 v[200:203], v[32:35], a[168:171], v[200:203]
  buffer_load_dwordx4 v6, s[8:11], s51 offen lds
  v_mfma_f32_16x16x32_bf16 v[204:207], v[32:35], a[172:175], v[204:207]
  s_waitcnt lgkmcnt(4)
  s_lshr_b32 s50, 0x1f302a24, s37
  s_and_b32 s50, s50, 0xff
  v_mfma_f32_16x16x32_bf16 v[208:211], v[36:39], a[160:163], v[208:211]
  ds_read_b64_tr_b16 v[32:33], v1 offset:12392
  s_mul_i32 s50, s50, 53248
  v_mfma_f32_16x16x32_bf16 v[212:215], v[36:39], a[164:167], v[212:215]
  ds_read_b64_tr_b16 v[34:35], v1 offset:12904
  s_add_u32 s50, s50, s38
  v_mfma_f32_16x16x32_bf16 v[216:219], v[36:39], a[168:171], v[216:219]
  s_add_u32 m0, s39, 0
  v_lshlrev_b32 v28, 16, v22
  v_and_b32 v22, s44, v22
  v_mfma_f32_16x16x32_bf16 v[220:223], v[36:39], a[172:175], v[220:223]
  s_waitcnt lgkmcnt(4)
  v_mul_f32 v28, v28, v136
  v_mul_f32 v22, v22, v137
  v_mfma_f32_16x16x32_bf16 v[224:227], v[40:43], a[160:163], v[224:227]
  ds_read_b64_tr_b16 v[36:37], v2 offset:12384
  v_cvt_pk_bf16_f32 v22, v28, v22
  v_mfma_f32_16x16x32_bf16 v[228:231], v[40:43], a[164:167], v[228:231]
  ds_read_b64_tr_b16 v[38:39], v2 offset:12896
  v_lshlrev_b32 v29, 16, v23
  v_mfma_f32_16x16x32_bf16 v[232:235], v[40:43], a[168:171], v[232:235]
  buffer_load_dwordx4 v6, s[8:11], s50 offen lds
  v_mfma_f32_16x16x32_bf16 v[236:239], v[40:43], a[172:175], v[236:239]
  s_waitcnt lgkmcnt(4)
  v_and_b32 v23, s44, v23
  v_mul_f32 v29, v29, v138
  v_mfma_f32_16x16x32_bf16 v[176:179], v[44:47], a[176:179], v[176:179]
  ds_read_b64_tr_b16 v[40:41], v2 offset:12392
  v_mul_f32 v23, v23, v139
  v_mfma_f32_16x16x32_bf16 v[180:183], v[44:47], a[180:183], v[180:183]
  ds_read_b64_tr_b16 v[42:43], v2 offset:12904
  v_cvt_pk_bf16_f32 v23, v29, v23
  v_mfma_f32_16x16x32_bf16 v[184:187], v[44:47], a[184:187], v[184:187]
  buffer_store_dwordx4 v[20:23], v11, s[20:23], s77 offen offset:2048 sc1
  v_mfma_f32_16x16x32_bf16 v[188:191], v[44:47], a[188:191], v[188:191]
  s_waitcnt lgkmcnt(4)
  ds_read_b128 v[20:23], v9 offset:16384
  v_mfma_f32_16x16x32_bf16 v[192:195], v[32:35], a[176:179], v[192:195]
  ds_read_b64_tr_b16 v[44:45], v1 offset:16512
  s_add_u32 s84, s42, 27271168
  v_mfma_f32_16x16x32_bf16 v[196:199], v[32:35], a[180:183], v[196:199]
  ds_read_b64_tr_b16 v[46:47], v1 offset:17024
  v_lshlrev_b32 v28, 16, v24
  v_mfma_f32_16x16x32_bf16 v[200:203], v[32:35], a[184:187], v[200:203]
  v_and_b32 v24, s44, v24
  v_mul_f32 v28, v28, v124
  v_mfma_f32_16x16x32_bf16 v[204:207], v[32:35], a[188:191], v[204:207]
  s_waitcnt lgkmcnt(5)
  v_mul_f32 v24, v24, v125
  v_cvt_pk_bf16_f32 v24, v28, v24
  v_mfma_f32_16x16x32_bf16 v[208:211], v[36:39], a[176:179], v[208:211]
  ds_read_b64_tr_b16 v[32:33], v1 offset:16520
  v_lshlrev_b32 v29, 16, v25
  v_mfma_f32_16x16x32_bf16 v[212:215], v[36:39], a[180:183], v[212:215]
  ds_read_b64_tr_b16 v[34:35], v1 offset:17032
  v_and_b32 v25, s44, v25
  v_mfma_f32_16x16x32_bf16 v[216:219], v[36:39], a[184:187], v[216:219]
  v_mul_f32 v29, v29, v126
  v_mul_f32 v25, v25, v127
  v_mfma_f32_16x16x32_bf16 v[220:223], v[36:39], a[188:191], v[220:223]
  s_waitcnt lgkmcnt(5)
  v_cvt_pk_bf16_f32 v25, v29, v25
  v_lshlrev_b32 v28, 16, v26
  v_mfma_f32_16x16x32_bf16 v[224:227], v[40:43], a[176:179], v[224:227]
  ds_read_b64_tr_b16 v[36:37], v2 offset:16512
  v_and_b32 v26, s44, v26
  v_mfma_f32_16x16x32_bf16 v[228:231], v[40:43], a[180:183], v[228:231]
  ds_read_b64_tr_b16 v[38:39], v2 offset:17024
  v_mul_f32 v28, v28, v140
  v_mfma_f32_16x16x32_bf16 v[232:235], v[40:43], a[184:187], v[232:235]
  buffer_load_dword v19, v18, s[20:23], 0 offen sc1
  v_mul_f32 v26, v26, v141
  v_mfma_f32_16x16x32_bf16 v[236:239], v[40:43], a[188:191], v[236:239]
  s_waitcnt lgkmcnt(4)
  v_cvt_pk_bf16_f32 v26, v28, v26
  v_lshlrev_b32 v29, 16, v27
  v_mfma_f32_16x16x32_bf16 v[176:179], v[44:47], a[192:195], v[176:179]
  ds_read_b64_tr_b16 v[40:41], v2 offset:16520
  v_and_b32 v27, s44, v27
  v_mfma_f32_16x16x32_bf16 v[180:183], v[44:47], a[196:199], v[180:183]
  ds_read_b64_tr_b16 v[42:43], v2 offset:17032
  v_mul_f32 v29, v29, v142
  v_mfma_f32_16x16x32_bf16 v[184:187], v[44:47], a[200:203], v[184:187]
  v_mul_f32 v27, v27, v143
  v_cvt_pk_bf16_f32 v27, v29, v27
  v_mfma_f32_16x16x32_bf16 v[188:191], v[44:47], a[204:207], v[188:191]
  s_waitcnt lgkmcnt(4)
  v_lshlrev_b32 v28, 16, v20
  v_and_b32 v20, s44, v20
  v_mfma_f32_16x16x32_bf16 v[192:195], v[32:35], a[192:195], v[192:195]
  ds_read_b64_tr_b16 v[44:45], v1 offset:20640
  v_mul_f32 v28, v28, v144
  v_mfma_f32_16x16x32_bf16 v[196:199], v[32:35], a[196:199], v[196:199]
  ds_read_b64_tr_b16 v[46:47], v1 offset:21152
  s_waitcnt vmcnt(10) lgkmcnt(4)
  v_mfma_f32_16x16x32_bf16 v[200:203], v[32:35], a[200:203], v[200:203]
  s_barrier
  s_lshr_b32 s51, 0x31312b25, s37
  s_and_b32 s51, s51, 0xff
  v_mfma_f32_16x16x32_bf16 v[204:207], v[32:35], a[204:207], v[204:207]
  buffer_store_dwordx4 v[24:27], v11, s[20:23], s84 offen offset:3072 sc1
  v_mfma_f32_16x16x32_bf16 v[208:211], v[36:39], a[192:195], v[208:211]
  ds_read_b64_tr_b16 v[32:33], v1 offset:20648
  s_mul_i32 s51, s51, 53248
  v_mfma_f32_16x16x32_bf16 v[212:215], v[36:39], a[196:199], v[212:215]
  ds_read_b64_tr_b16 v[34:35], v1 offset:21160
  s_add_u32 s51, s51, s38
  v_mfma_f32_16x16x32_bf16 v[216:219], v[36:39], a[200:203], v[216:219]
  s_add_u32 m0, s39, 4096
  ds_read_b128 v[24:27], v9 offset:18432
  v_mfma_f32_16x16x32_bf16 v[220:223], v[36:39], a[204:207], v[220:223]
  s_waitcnt lgkmcnt(5)
  s_add_u32 s77, s42, 27275264
  v_mul_f32 v20, v20, v145
  v_mfma_f32_16x16x32_bf16 v[224:227], v[40:43], a[192:195], v[224:227]
  ds_read_b64_tr_b16 v[36:37], v2 offset:20640
  v_cvt_pk_bf16_f32 v20, v28, v20
  v_mfma_f32_16x16x32_bf16 v[228:231], v[40:43], a[196:199], v[228:231]
  ds_read_b64_tr_b16 v[38:39], v2 offset:21152
  v_lshlrev_b32 v29, 16, v21
  v_mfma_f32_16x16x32_bf16 v[232:235], v[40:43], a[200:203], v[232:235]
  buffer_load_dwordx4 v6, s[8:11], s51 offen lds
  v_mfma_f32_16x16x32_bf16 v[236:239], v[40:43], a[204:207], v[236:239]
  s_waitcnt lgkmcnt(5)
  s_lshr_b32 s50, 0x33333332, s37
  s_and_b32 s50, s50, 0xff
  v_mfma_f32_16x16x32_bf16 v[176:179], v[44:47], a[0:3], v[176:179]
  ds_read_b64_tr_b16 v[40:41], v2 offset:20648
  s_mul_i32 s50, s50, 53248
  v_mfma_f32_16x16x32_bf16 v[180:183], v[44:47], a[4:7], v[180:183]
  ds_read_b64_tr_b16 v[42:43], v2 offset:21160
  s_add_u32 s50, s50, s38
  v_mfma_f32_16x16x32_bf16 v[184:187], v[44:47], a[8:11], v[184:187]
  s_add_u32 s54, s72, 57344
  v_and_b32 v21, s44, v21
  v_mul_f32 v29, v29, v146
  v_mfma_f32_16x16x32_bf16 v[188:191], v[44:47], a[12:15], v[188:191]
  s_waitcnt lgkmcnt(5)
  v_mul_f32 v21, v21, v147
  v_cvt_pk_bf16_f32 v21, v29, v21
  v_mfma_f32_16x16x32_bf16 v[192:195], v[32:35], a[0:3], v[192:195]
  ds_read_b64_tr_b16 v[44:45], v1 offset:24768
  v_lshlrev_b32 v28, 16, v22
  v_mfma_f32_16x16x32_bf16 v[196:199], v[32:35], a[4:7], v[196:199]
  ds_read_b64_tr_b16 v[46:47], v1 offset:25280
  s_add_u32 m0, s39, 8192
  v_mfma_f32_16x16x32_bf16 v[200:203], v[32:35], a[8:11], v[200:203]
  buffer_load_dwordx4 v7, s[8:11], s50 offen lds
  v_mfma_f32_16x16x32_bf16 v[204:207], v[32:35], a[12:15], v[204:207]
  s_waitcnt lgkmcnt(4)
  s_add_u32 s51, s35, 2768896
  v_and_b32 v22, s44, v22
  v_mfma_f32_16x16x32_bf16 v[208:211], v[36:39], a[0:3], v[208:211]
  ds_read_b64_tr_b16 v[32:33], v1 offset:24776
  v_mul_f32 v28, v28, v160
  v_mfma_f32_16x16x32_bf16 v[212:215], v[36:39], a[4:7], v[212:215]
  ds_read_b64_tr_b16 v[34:35], v1 offset:25288
  v_mul_f32 v22, v22, v161
  v_mfma_f32_16x16x32_bf16 v[216:219], v[36:39], a[8:11], v[216:219]
  v_cvt_pk_bf16_f32 v22, v28, v22
  v_lshlrev_b32 v29, 16, v23
  v_mfma_f32_16x16x32_bf16 v[220:223], v[36:39], a[12:15], v[220:223]
  s_waitcnt lgkmcnt(4)
  v_and_b32 v23, s44, v23
  v_mul_f32 v29, v29, v162
  v_mfma_f32_16x16x32_bf16 v[224:227], v[40:43], a[0:3], v[224:227]
  ds_read_b64_tr_b16 v[36:37], v2 offset:24768
  v_mul_f32 v23, v23, v163
  v_mfma_f32_16x16x32_bf16 v[228:231], v[40:43], a[4:7], v[228:231]
  ds_read_b64_tr_b16 v[38:39], v2 offset:25280
  v_cvt_pk_bf16_f32 v23, v29, v23
  v_mfma_f32_16x16x32_bf16 v[232:235], v[40:43], a[8:11], v[232:235]
  buffer_store_dwordx4 v[20:23], v11, s[20:23], s77 offen offset:0 sc1
  v_mfma_f32_16x16x32_bf16 v[236:239], v[40:43], a[12:15], v[236:239]
  s_waitcnt lgkmcnt(4)
  ds_read_b128 v[20:23], v9 offset:20480
  v_mfma_f32_16x16x32_bf16 v[176:179], v[44:47], a[16:19], v[176:179]
  ds_read_b64_tr_b16 v[40:41], v2 offset:24776
  s_add_u32 s84, s42, 27275264
  v_mfma_f32_16x16x32_bf16 v[180:183], v[44:47], a[20:23], v[180:183]
  ds_read_b64_tr_b16 v[42:43], v2 offset:25288
  v_lshlrev_b32 v28, 16, v24
  v_mfma_f32_16x16x32_bf16 v[184:187], v[44:47], a[24:27], v[184:187]
  v_and_b32 v24, s44, v24
  v_mul_f32 v28, v28, v148
  v_mfma_f32_16x16x32_bf16 v[188:191], v[44:47], a[28:31], v[188:191]
  s_waitcnt lgkmcnt(5)
  v_mul_f32 v24, v24, v149
  v_cvt_pk_bf16_f32 v24, v28, v24
  v_mfma_f32_16x16x32_bf16 v[192:195], v[32:35], a[16:19], v[192:195]
  ds_read_b64_tr_b16 v[44:45], v1 offset:28896
  s_waitcnt vmcnt(4)
  v_mfma_f32_16x16x32_bf16 v[196:199], v[32:35], a[20:23], v[196:199]
  ds_read_b64_tr_b16 v[46:47], v1 offset:29408
  v_sub_u32 v19, v19, v30
  v_mfma_f32_16x16x32_bf16 v[200:203], v[32:35], a[24:27], v[200:203]
  v_cmp_gt_u32 vcc, 5, v19
  s_nop 0
  v_mfma_f32_16x16x32_bf16 v[204:207], v[32:35], a[28:31], v[204:207]
  s_waitcnt lgkmcnt(5)
  s_cbranch_vccnz Lslow5
Lback5:
  s_add_u32 s56, s40, 27262976
  v_mfma_f32_16x16x32_bf16 v[208:211], v[36:39], a[16:19], v[208:211]
  ds_read_b64_tr_b16 v[32:33], v1 offset:28904
  v_lshlrev_b32 v29, 16, v25
  v_mfma_f32_16x16x32_bf16 v[212:215], v[36:39], a[20:23], v[212:215]
  ds_read_b64_tr_b16 v[34:35], v1 offset:29416
  v_and_b32 v25, s44, v25
  v_mfma_f32_16x16x32_bf16 v[216:219], v[36:39], a[24:27], v[216:219]
  v_mul_f32 v29, v29, v150
  v_mul_f32 v25, v25, v151
  v_mfma_f32_16x16x32_bf16 v[220:223], v[36:39], a[28:31], v[220:223]
  s_waitcnt lgkmcnt(4)
  v_cvt_pk_bf16_f32 v25, v29, v25
  v_lshlrev_b32 v28, 16, v26
  v_mfma_f32_16x16x32_bf16 v[224:227], v[40:43], a[16:19], v[224:227]
  ds_read_b64_tr_b16 v[36:37], v2 offset:28896
  s_add_u32 m0, s36, 12288
  v_mfma_f32_16x16x32_bf16 v[228:231], v[40:43], a[20:23], v[228:231]
  ds_read_b64_tr_b16 v[38:39], v2 offset:29408
  v_and_b32 v26, s44, v26
  v_mfma_f32_16x16x32_bf16 v[232:235], v[40:43], a[24:27], v[232:235]
  buffer_load_dwordx4 v4, s[8:11], s51 offen lds
  v_mfma_f32_16x16x32_bf16 v[236:239], v[40:43], a[28:31], v[236:239]
  s_waitcnt lgkmcnt(4)
  v_mul_f32 v28, v28, v164
  v_mul_f32 v26, v26, v165
  v_mfma_f32_16x16x32_bf16 v[176:179], v[44:47], a[32:35], v[176:179]
  ds_read_b64_tr_b16 v[40:41], v2 offset:28904
  v_cvt_pk_bf16_f32 v26, v28, v26
  v_mfma_f32_16x16x32_bf16 v[180:183], v[44:47], a[36:39], v[180:183]
  ds_read_b64_tr_b16 v[42:43], v2 offset:29416
  v_lshlrev_b32 v29, 16, v27
  v_mfma_f32_16x16x32_bf16 v[184:187], v[44:47], a[40:43], v[184:187]
  buffer_load_dword v14, off, s[64:67], s54
  v_and_b32 v27, s44, v27
  v_mfma_f32_16x16x32_bf16 v[188:191], v[44:47], a[44:47], v[188:191]
  s_waitcnt lgkmcnt(4)
  v_mul_f32 v29, v29, v166
  v_mul_f32 v27, v27, v167
  v_mfma_f32_16x16x32_bf16 v[192:195], v[32:35], a[32:35], v[192:195]
  ds_read_b64_tr_b16 v[44:45], v1 offset:33024
  v_cvt_pk_bf16_f32 v27, v29, v27
  v_mfma_f32_16x16x32_bf16 v[196:199], v[32:35], a[36:39], v[196:199]
  ds_read_b64_tr_b16 v[46:47], v1 offset:33536
  s_waitcnt lgkmcnt(4)
  v_mfma_f32_16x16x32_bf16 v[200:203], v[32:35], a[40:43], v[200:203]
  s_barrier
  s_add_u32 s50, s35, 3088384
  s_add_u32 m0, s36, 16416
  v_mfma_f32_16x16x32_bf16 v[204:207], v[32:35], a[44:47], v[204:207]
  buffer_store_dwordx4 v[24:27], v11, s[20:23], s84 offen offset:1024 sc1
  v_mfma_f32_16x16x32_bf16 v[208:211], v[36:39], a[32:35], v[208:211]
  ds_read_b64_tr_b16 v[32:33], v1 offset:33032
  v_lshlrev_b32 v28, 16, v20
  v_mfma_f32_16x16x32_bf16 v[212:215], v[36:39], a[36:39], v[212:215]
  ds_read_b64_tr_b16 v[34:35], v1 offset:33544
  v_and_b32 v20, s44, v20
  v_mfma_f32_16x16x32_bf16 v[216:219], v[36:39], a[40:43], v[216:219]
  buffer_load_dwordx4 v4, s[8:11], s50 offen lds
  v_mfma_f32_16x16x32_bf16 v[220:223], v[36:39], a[44:47], v[220:223]
  s_waitcnt lgkmcnt(4)
  s_add_u32 s51, s35, 3407872
  s_add_u32 m0, s36, 20544
  v_mfma_f32_16x16x32_bf16 v[224:227], v[40:43], a[32:35], v[224:227]
  ds_read_b64_tr_b16 v[36:37], v2 offset:33024
  v_mul_f32 v28, v28, v152
  v_mfma_f32_16x16x32_bf16 v[228:231], v[40:43], a[36:39], v[228:231]
  ds_read_b64_tr_b16 v[38:39], v2 offset:33536
  v_mul_f32 v20, v20, v153
  v_mfma_f32_16x16x32_bf16 v[232:235], v[40:43], a[40:43], v[232:235]
  buffer_load_dwordx4 v4, s[8:11], s51 offen lds
  v_mfma_f32_16x16x32_bf16 v[236:239], v[40:43], a[44:47], v[236:239]
  s_waitcnt lgkmcnt(4)
  s_add_u32 s50, s35, 2769024
  s_add_u32 m0, s36, 24672
  v_mfma_f32_16x16x32_bf16 v[176:179], v[44:47], a[48:51], v[176:179]
  ds_read_b64_tr_b16 v[40:41], v2 offset:33032
  v_cvt_pk_bf16_f32 v20, v28, v20
  v_mfma_f32_16x16x32_bf16 v[180:183], v[44:47], a[52:55], v[180:183]
  ds_read_b64_tr_b16 v[42:43], v2 offset:33544
  v_lshlrev_b32 v29, 16, v21
  v_mfma_f32_16x16x32_bf16 v[184:187], v[44:47], a[56:59], v[184:187]
  buffer_load_dwordx4 v4, s[8:11], s50 offen lds
  v_mfma_f32_16x16x32_bf16 v[188:191], v[44:47], a[60:63], v[188:191]
  s_waitcnt lgkmcnt(4)
  ds_read_b128 v[24:27], v9 offset:22528
  v_mfma_f32_16x16x32_bf16 v[192:195], v[32:35], a[48:51], v[192:195]
  ds_read_b64_tr_b16 v[44:45], v1 offset:37152
  s_add_u32 s77, s42, 27275264
  v_mfma_f32_16x16x32_bf16 v[196:199], v[32:35], a[52:55], v[196:199]
  ds_read_b64_tr_b16 v[46:47], v1 offset:37664
  v_and_b32 v21, s44, v21
  v_mfma_f32_16x16x32_bf16 v[200:203], v[32:35], a[56:59], v[200:203]
  buffer_load_dwordx4 a[208:211], v11, s[20:23], s56 offen offset:0 sc1
  v_mul_f32 v29, v29, v154
  v_mfma_f32_16x16x32_bf16 v[204:207], v[32:35], a[60:63], v[204:207]
  s_waitcnt lgkmcnt(5)
  v_mul_f32 v21, v21, v155
  v_cvt_pk_bf16_f32 v21, v29, v21
  v_mfma_f32_16x16x32_bf16 v[208:211], v[36:39], a[48:51], v[208:211]
  ds_read_b64_tr_b16 v[32:33], v1 offset:37160
  v_lshlrev_b32 v28, 16, v22
  v_mfma_f32_16x16x32_bf16 v[212:215], v[36:39], a[52:55], v[212:215]
  ds_read_b64_tr_b16 v[34:35], v1 offset:37672
  v_and_b32 v22, s44, v22
  v_mfma_f32_16x16x32_bf16 v[216:219], v[36:39], a[56:59], v[216:219]
  buffer_load_dwordx4 a[212:215], v11, s[20:23], s56 offen offset:1024 sc1
  v_mul_f32 v28, v28, v168
  v_mfma_f32_16x16x32_bf16 v[220:223], v[36:39], a[60:63], v[220:223]
  s_waitcnt lgkmcnt(5)
  v_mul_f32 v22, v22, v169
  v_cvt_pk_bf16_f32 v22, v28, v22
  v_mfma_f32_16x16x32_bf16 v[224:227], v[40:43], a[48:51], v[224:227]
  ds_read_b64_tr_b16 v[36:37], v2 offset:37152
  v_lshlrev_b32 v29, 16, v23
  v_mfma_f32_16x16x32_bf16 v[228:231], v[40:43], a[52:55], v[228:231]
  ds_read_b64_tr_b16 v[38:39], v2 offset:37664
  v_and_b32 v23, s44, v23
  v_mfma_f32_16x16x32_bf16 v[232:235], v[40:43], a[56:59], v[232:235]
  buffer_load_dwordx4 a[216:219], v11, s[20:23], s56 offen offset:2048 sc1
  v_mul_f32 v29, v29, v170
  v_mfma_f32_16x16x32_bf16 v[236:239], v[40:43], a[60:63], v[236:239]
  s_waitcnt lgkmcnt(4)
  v_mul_f32 v23, v23, v171
  v_cvt_pk_bf16_f32 v23, v29, v23
  v_mfma_f32_16x16x32_bf16 v[176:179], v[44:47], a[64:67], v[176:179]
  ds_read_b64_tr_b16 v[40:41], v2 offset:37160
  v_lshlrev_b32 v28, 16, v24
  v_mfma_f32_16x16x32_bf16 v[180:183], v[44:47], a[68:71], v[180:183]
  ds_read_b64_tr_b16 v[42:43], v2 offset:37672
  v_and_b32 v24, s44, v24
  v_mfma_f32_16x16x32_bf16 v[184:187], v[44:47], a[72:75], v[184:187]
  buffer_store_dwordx4 v[20:23], v11, s[20:23], s77 offen offset:2048 sc1
  v_mfma_f32_16x16x32_bf16 v[188:191], v[44:47], a[76:79], v[188:191]
  s_waitcnt lgkmcnt(4)
  s_add_u32 s84, s42, 27275264
  v_mul_f32 v28, v28, v156
  v_mfma_f32_16x16x32_bf16 v[192:195], v[32:35], a[64:67], v[192:195]
  ds_read_b64_tr_b16 v[44:45], v1 offset:41280
  v_mul_f32 v24, v24, v157
  v_mfma_f32_16x16x32_bf16 v[196:199], v[32:35], a[68:71], v[196:199]
  ds_read_b64_tr_b16 v[46:47], v1 offset:41792
  v_cvt_pk_bf16_f32 v24, v28, v24
  v_mfma_f32_16x16x32_bf16 v[200:203], v[32:35], a[72:75], v[200:203]
  buffer_load_dwordx4 a[220:223], v11, s[20:23], s56 offen offset:3072 sc1
  v_lshlrev_b32 v29, 16, v25
  v_mfma_f32_16x16x32_bf16 v[204:207], v[32:35], a[76:79], v[204:207]
  s_waitcnt lgkmcnt(4)
  s_add_u32 s56, s40, 27287552
  v_and_b32 v25, s44, v25
  v_mfma_f32_16x16x32_bf16 v[208:211], v[36:39], a[64:67], v[208:211]
  ds_read_b64_tr_b16 v[32:33], v1 offset:41288
  v_mul_f32 v29, v29, v158
  v_mfma_f32_16x16x32_bf16 v[212:215], v[36:39], a[68:71], v[212:215]
  ds_read_b64_tr_b16 v[34:35], v1 offset:41800
  v_mul_f32 v25, v25, v159
  v_mfma_f32_16x16x32_bf16 v[216:219], v[36:39], a[72:75], v[216:219]
  buffer_load_dwordx4 a[224:227], v11, s[20:23], s56 offen offset:0 sc1
  v_cvt_pk_bf16_f32 v25, v29, v25
  v_mfma_f32_16x16x32_bf16 v[220:223], v[36:39], a[76:79], v[220:223]
  s_waitcnt lgkmcnt(4)
  v_lshlrev_b32 v28, 16, v26
  v_and_b32 v26, s44, v26
  v_mfma_f32_16x16x32_bf16 v[224:227], v[40:43], a[64:67], v[224:227]
  ds_read_b64_tr_b16 v[36:37], v2 offset:41280
  v_mul_f32 v28, v28, v172
  v_mfma_f32_16x16x32_bf16 v[228:231], v[40:43], a[68:71], v[228:231]
  ds_read_b64_tr_b16 v[38:39], v2 offset:41792
  v_mul_f32 v26, v26, v173
  v_mfma_f32_16x16x32_bf16 v[232:235], v[40:43], a[72:75], v[232:235]
  v_cvt_pk_bf16_f32 v26, v28, v26
  v_lshlrev_b32 v29, 16, v27
  v_mfma_f32_16x16x32_bf16 v[236:239], v[40:43], a[76:79], v[236:239]
  s_waitcnt lgkmcnt(4)
  v_and_b32 v27, s44, v27
  v_mul_f32 v29, v29, v174
  v_mfma_f32_16x16x32_bf16 v[176:179], v[44:47], a[80:83], v[176:179]
  ds_read_b64_tr_b16 v[40:41], v2 offset:41288
  v_mul_f32 v27, v27, v175
  v_mfma_f32_16x16x32_bf16 v[180:183], v[44:47], a[84:87], v[180:183]
  ds_read_b64_tr_b16 v[42:43], v2 offset:41800
  v_cvt_pk_bf16_f32 v27, v29, v27
  v_mfma_f32_16x16x32_bf16 v[184:187], v[44:47], a[88:91], v[184:187]
  buffer_store_dwordx4 v[24:27], v11, s[20:23], s84 offen offset:3072 sc1
  v_mfma_f32_16x16x32_bf16 v[188:191], v[44:47], a[92:95], v[188:191]
  s_waitcnt lgkmcnt(4)
  v_mfma_f32_16x16x32_bf16 v[192:195], v[32:35], a[80:83], v[192:195]
  ds_read_b64_tr_b16 v[44:45], v1 offset:45408
  v_mfma_f32_16x16x32_bf16 v[196:199], v[32:35], a[84:87], v[196:199]
  ds_read_b64_tr_b16 v[46:47], v1 offset:45920
  s_waitcnt vmcnt(15) lgkmcnt(4)
  v_mfma_f32_16x16x32_bf16 v[200:203], v[32:35], a[88:91], v[200:203]
  s_barrier
  s_add_u32 s51, s35, 3088512
  s_add_u32 m0, s36, 28800
  v_mfma_f32_16x16x32_bf16 v[204:207], v[32:35], a[92:95], v[204:207]
  buffer_load_dwordx4 a[228:231], v11, s[20:23], s56 offen offset:1024 sc1
  v_mfma_f32_16x16x32_bf16 v[208:211], v[36:39], a[80:83], v[208:211]
  ds_read_b64_tr_b16 v[32:33], v1 offset:45416
  v_mfma_f32_16x16x32_bf16 v[212:215], v[36:39], a[84:87], v[212:215]
  ds_read_b64_tr_b16 v[34:35], v1 offset:45928
  s_waitcnt lgkmcnt(4)
  v_mfma_f32_16x16x32_bf16 v[216:219], v[36:39], a[88:91], v[216:219]
  buffer_load_dwordx4 a[232:235], v11, s[20:23], s56 offen offset:2048 sc1
  v_mfma_f32_16x16x32_bf16 v[220:223], v[36:39], a[92:95], v[220:223]
  v_mfma_f32_16x16x32_bf16 v[224:227], v[40:43], a[80:83], v[224:227]
  ds_read_b64_tr_b16 v[36:37], v2 offset:45408
  v_mfma_f32_16x16x32_bf16 v[228:231], v[40:43], a[84:87], v[228:231]
  ds_read_b64_tr_b16 v[38:39], v2 offset:45920
  s_waitcnt lgkmcnt(4)
  v_mfma_f32_16x16x32_bf16 v[232:235], v[40:43], a[88:91], v[232:235]
  buffer_load_dwordx4 a[236:239], v11, s[20:23], s56 offen offset:3072 sc1
  v_mfma_f32_16x16x32_bf16 v[236:239], v[40:43], a[92:95], v[236:239]
  s_add_u32 s56, s40, 27312128
  v_mfma_f32_16x16x32_bf16 v[176:179], v[44:47], a[96:99], v[176:179]
  ds_read_b64_tr_b16 v[40:41], v2 offset:45416
  v_mfma_f32_16x16x32_bf16 v[180:183], v[44:47], a[100:103], v[180:183]
  ds_read_b64_tr_b16 v[42:43], v2 offset:45928
  s_waitcnt lgkmcnt(4)
  v_mfma_f32_16x16x32_bf16 v[184:187], v[44:47], a[104:107], v[184:187]
  buffer_load_dwordx4 a[240:243], v11, s[20:23], s56 offen offset:0 sc1
  v_mfma_f32_16x16x32_bf16 v[188:191], v[44:47], a[108:111], v[188:191]
  v_mfma_f32_16x16x32_bf16 v[192:195], v[32:35], a[96:99], v[192:195]
  ds_read_b64_tr_b16 v[44:45], v3 offset:49536
  v_mfma_f32_16x16x32_bf16 v[196:199], v[32:35], a[100:103], v[196:199]
  ds_read_b64_tr_b16 v[46:47], v3 offset:49792
  s_waitcnt lgkmcnt(4)
  v_mfma_f32_16x16x32_bf16 v[200:203], v[32:35], a[104:107], v[200:203]
  buffer_load_dwordx4 a[244:247], v11, s[20:23], s56 offen offset:1024 sc1
  v_mfma_f32_16x16x32_bf16 v[204:207], v[32:35], a[108:111], v[204:207]
  v_mfma_f32_16x16x32_bf16 v[208:211], v[36:39], a[96:99], v[208:211]
  ds_read_b64_tr_b16 v[32:33], v3 offset:50560
  v_mfma_f32_16x16x32_bf16 v[212:215], v[36:39], a[100:103], v[212:215]
  ds_read_b64_tr_b16 v[34:35], v3 offset:50816
  s_waitcnt lgkmcnt(4)
  v_mfma_f32_16x16x32_bf16 v[216:219], v[36:39], a[104:107], v[216:219]
  buffer_load_dwordx4 a[248:251], v11, s[20:23], s56 offen offset:2048 sc1
  v_mfma_f32_16x16x32_bf16 v[220:223], v[36:39], a[108:111], v[220:223]
  v_mfma_f32_16x16x32_bf16 v[224:227], v[40:43], a[96:99], v[224:227]
  ds_read_b64_tr_b16 v[36:37], v3 offset:51584
  v_mfma_f32_16x16x32_bf16 v[228:231], v[40:43], a[100:103], v[228:231]
  ds_read_b64_tr_b16 v[38:39], v3 offset:51840
  s_waitcnt lgkmcnt(4)
  v_mfma_f32_16x16x32_bf16 v[232:235], v[40:43], a[104:107], v[232:235]
  buffer_load_dwordx4 a[252:255], v11, s[20:23], s56 offen offset:3072 sc1
  v_mfma_f32_16x16x32_bf16 v[236:239], v[40:43], a[108:111], v[236:239]
  ds_read_b128 v[20:23], v8 offset:0
  v_mfma_f32_16x16x32_bf16 v[240:243], v[44:47], a[112:115], v[240:243]
  ds_read_b64_tr_b16 v[40:41], v3 offset:52608
  v_mfma_f32_16x16x32_bf16 v[244:247], v[44:47], a[116:119], v[244:247]
  ds_read_b64_tr_b16 v[42:43], v3 offset:52864
  s_waitcnt lgkmcnt(5)
  v_mfma_f32_16x16x32_bf16 v[248:251], v[44:47], a[120:123], v[248:251]
  ds_read_b128 v[24:27], v8 offset:2048
  s_add_u32 s77, s42, 27279360
  v_mfma_f32_16x16x32_bf16 v[252:255], v[44:47], a[124:127], v[252:255]
  buffer_load_dword v19, v18, s[20:23], 0 offen sc1
  v_mfma_f32_16x16x32_bf16 v[240:243], v[32:35], a[128:131], v[240:243]
  ds_read_b64_tr_b16 v[44:45], v3 offset:0
  s_add_u32 s56, s40, 27336704
  v_mfma_f32_16x16x32_bf16 v[244:247], v[32:35], a[132:135], v[244:247]
  ds_read_b64_tr_b16 v[46:47], v3 offset:256
  s_waitcnt lgkmcnt(5)
  v_mfma_f32_16x16x32_bf16 v[248:251], v[32:35], a[136:139], v[248:251]
  buffer_load_dwordx4 v4, s[8:11], s51 offen lds
  v_mfma_f32_16x16x32_bf16 v[252:255], v[32:35], a[140:143], v[252:255]
  s_add_u32 s50, s35, 3408000
  v_lshlrev_b32 v28, 16, v20
  v_and_b32 v20, s44, v20
  v_mfma_f32_16x16x32_bf16 v[240:243], v[36:39], a[144:147], v[240:243]
  ds_read_b64_tr_b16 v[32:33], v3 offset:1024
  v_mul_f32 v28, v28, v176
  v_mfma_f32_16x16x32_bf16 v[244:247], v[36:39], a[148:151], v[244:247]
  ds_read_b64_tr_b16 v[34:35], v3 offset:1280
  s_add_u32 m0, s36, 32928
  v_mfma_f32_16x16x32_bf16 v[248:251], v[36:39], a[152:155], v[248:251]
  buffer_load_dwordx4 v4, s[8:11], s50 offen lds
  v_mfma_f32_16x16x32_bf16 v[252:255], v[36:39], a[156:159], v[252:255]
  s_waitcnt lgkmcnt(5)
  s_add_u32 s51, s35, 3727360
  v_mul_f32 v20, v20, v177
  v_mfma_f32_16x16x32_bf16 v[240:243], v[40:43], a[160:163], v[240:243]
  ds_read_b64_tr_b16 v[36:37], v3 offset:2048
  v_cvt_pk_bf16_f32 v20, v28, v20
  v_mfma_f32_16x16x32_bf16 v[244:247], v[40:43], a[164:167], v[244:247]
  ds_read_b64_tr_b16 v[38:39], v3 offset:2304
  s_add_u32 m0, s36, 37056
  v_mfma_f32_16x16x32_bf16 v[248:251], v[40:43], a[168:171], v[248:251]
  buffer_load_dwordx4 v4, s[8:11], s51 offen lds
  v_mfma_f32_16x16x32_bf16 v[252:255], v[40:43], a[172:175], v[252:255]
  s_waitcnt lgkmcnt(4)
  v_lshlrev_b32 v29, 16, v21
  v_and_b32 v21, s44, v21
  v_mfma_f32_16x16x32_bf16 v[240:243], v[44:47], a[176:179], v[240:243]
  ds_read_b64_tr_b16 v[40:41], v3 offset:3072
  v_mul_f32 v29, v29, v178
  v_mfma_f32_16x16x32_bf16 v[244:247], v[44:47], a[180:183], v[244:247]
  ds_read_b64_tr_b16 v[42:43], v3 offset:3328
  v_mul_f32 v21, v21, v179
  v_mfma_f32_16x16x32_bf16 v[248:251], v[44:47], a[184:187], v[248:251]
  v_cvt_pk_bf16_f32 v21, v29, v21
  v_lshlrev_b32 v28, 16, v22
  v_mfma_f32_16x16x32_bf16 v[252:255], v[44:47], a[188:191], v[252:255]
  s_waitcnt lgkmcnt(4)
  v_and_b32 v22, s44, v22
  v_mul_f32 v28, v28, v192
  v_mfma_f32_16x16x32_bf16 v[240:243], v[32:35], a[192:195], v[240:243]
  ds_read_b64_tr_b16 v[44:45], v3 offset:4096
  v_mul_f32 v22, v22, v193
  v_mfma_f32_16x16x32_bf16 v[244:247], v[32:35], a[196:199], v[244:247]
  ds_read_b64_tr_b16 v[46:47], v3 offset:4352
  s_waitcnt vmcnt(20) lgkmcnt(4)
  v_mfma_f32_16x16x32_bf16 v[248:251], v[32:35], a[200:203], v[248:251]
  s_barrier
  s_add_u32 s50, s35, 2822144
  s_add_u32 m0, s36, 41184
  v_mfma_f32_16x16x32_bf16 v[252:255], v[32:35], a[204:207], v[252:255]
  buffer_load_dwordx4 a[112:115], v11, s[20:23], s56 offen offset:0 sc1
  v_cvt_pk_bf16_f32 v22, v28, v22
  v_mfma_f32_16x16x32_bf16 v[240:243], v[36:39], a[0:3], v[240:243]
  ds_read_b64_tr_b16 v[32:33], v3 offset:5120
  v_lshlrev_b32 v29, 16, v23
  v_mfma_f32_16x16x32_bf16 v[244:247], v[36:39], a[4:7], v[244:247]
  ds_read_b64_tr_b16 v[34:35], v3 offset:5376
  v_and_b32 v23, s44, v23
  v_mfma_f32_16x16x32_bf16 v[248:251], v[36:39], a[8:11], v[248:251]
  buffer_load_dwordx4 a[116:119], v11, s[20:23], s56 offen offset:1024 sc1
  v_mul_f32 v29, v29, v194
  v_mfma_f32_16x16x32_bf16 v[252:255], v[36:39], a[12:15], v[252:255]
  s_waitcnt lgkmcnt(4)
  v_mul_f32 v23, v23, v195
  v_cvt_pk_bf16_f32 v23, v29, v23
  v_mfma_f32_16x16x32_bf16 v[240:243], v[40:43], a[16:19], v[240:243]
  ds_read_b64_tr_b16 v[36:37], v3 offset:6144
  v_lshlrev_b32 v28, 16, v24
  v_mfma_f32_16x16x32_bf16 v[244:247], v[40:43], a[20:23], v[244:247]
  ds_read_b64_tr_b16 v[38:39], v3 offset:6400
  v_and_b32 v24, s44, v24
  v_mfma_f32_16x16x32_bf16 v[248:251], v[40:43], a[24:27], v[248:251]
  buffer_store_dwordx4 v[20:23], v11, s[20:23], s77 offen offset:0 sc1
  v_mfma_f32_16x16x32_bf16 v[252:255], v[40:43], a[28:31], v[252:255]
  s_waitcnt lgkmcnt(4)
  ds_read_b128 v[20:23], v8 offset:4096
  v_mfma_f32_16x16x32_bf16 v[240:243], v[44:47], a[32:35], v[240:243]
  ds_read_b64_tr_b16 v[40:41], v3 offset:8192
  s_add_u32 s84, s42, 27279360
  v_mfma_f32_16x16x32_bf16 v[244:247], v[44:47], a[36:39], v[244:247]
  ds_read_b64_tr_b16 v[42:43], v3 offset:8448
  v_mul_f32 v28, v28, v180
  v_mfma_f32_16x16x32_bf16 v[248:251], v[44:47], a[40:43], v[248:251]
  buffer_load_dwordx4 a[120:123], v11, s[20:23], s56 offen offset:2048 sc1
  v_mul_f32 v24, v24, v181
  v_mfma_f32_16x16x32_bf16 v[252:255], v[44:47], a[44:47], v[252:255]
  s_waitcnt lgkmcnt(5)
  v_cvt_pk_bf16_f32 v24, v28, v24
  v_lshlrev_b32 v29, 16, v25
  v_mfma_f32_16x16x32_bf16 v[240:243], v[32:35], a[48:51], v[240:243]
  ds_read_b64_tr_b16 v[44:45], v3 offset:9216
  v_and_b32 v25, s44, v25
  v_mfma_f32_16x16x32_bf16 v[244:247], v[32:35], a[52:55], v[244:247]
  ds_read_b64_tr_b16 v[46:47], v3 offset:9472
  v_mul_f32 v29, v29, v182
  v_mfma_f32_16x16x32_bf16 v[248:251], v[32:35], a[56:59], v[248:251]
  buffer_load_dwordx4 a[124:127], v11, s[20:23], s56 offen offset:3072 sc1
  v_mul_f32 v25, v25, v183
  v_mfma_f32_16x16x32_bf16 v[252:255], v[32:35], a[60:63], v[252:255]
  s_waitcnt lgkmcnt(5)
  v_cvt_pk_bf16_f32 v25, v29, v25
  v_lshlrev_b32 v28, 16, v26
  v_mfma_f32_16x16x32_bf16 v[240:243], v[36:39], a[64:67], v[240:243]
  ds_read_b64_tr_b16 v[32:33], v1 offset:12288
  s_waitcnt vmcnt(16)
  v_mfma_f32_16x16x32_bf16 v[244:247], v[36:39], a[68:71], v[244:247]
  ds_read_b64_tr_b16 v[34:35], v1 offset:12800
  v_add_u32 v17, 7, v30
  v_mfma_f32_16x16x32_bf16 v[248:251], v[36:39], a[72:75], v[248:251]
  buffer_store_dword v17, v16, s[20:23], 0 offen sc1
  v_mfma_f32_16x16x32_bf16 v[252:255], v[36:39], a[76:79], v[252:255]
  s_waitcnt lgkmcnt(4)
  s_waitcnt vmcnt(9)
  v_sub_u32 v19, v19, v30
  v_mfma_f32_16x16x32_bf16 v[240:243], v[40:43], a[80:83], v[240:243]
  ds_read_b64_tr_b16 v[36:37], v1 offset:12296
  v_cmp_gt_u32 vcc, 6, v19
  v_mfma_f32_16x16x32_bf16 v[244:247], v[40:43], a[84:87], v[244:247]
  ds_read_b64_tr_b16 v[38:39], v1 offset:12808
  s_nop 0
  v_mfma_f32_16x16x32_bf16 v[248:251], v[40:43], a[88:91], v[248:251]
  buffer_load_dwordx4 v4, s[8:11], s50 offen lds
  v_mfma_f32_16x16x32_bf16 v[252:255], v[40:43], a[92:95], v[252:255]
  s_waitcnt lgkmcnt(4)
  s_add_u32 s51, s35, 3141632
  s_add_u32 m0, s36, 45312
  v_mfma_f32_16x16x32_bf16 v[240:243], v[44:47], a[96:99], v[240:243]
  ds_read_b64_tr_b16 v[40:41], v2 offset:12288
  s_cbranch_vccnz Lslow6
Lback6:
  v_mfma_f32_16x16x32_bf16 v[244:247], v[44:47], a[100:103], v[244:247]
  ds_read_b64_tr_b16 v[42:43], v2 offset:12800
  s_add_u32 s57, s40, 27267072
  v_mfma_f32_16x16x32_bf16 v[248:251], v[44:47], a[104:107], v[248:251]
  buffer_load_dwordx4 v4, s[8:11], s51 offen lds
  v_mfma_f32_16x16x32_bf16 v[252:255], v[44:47], a[108:111], v[252:255]
  s_waitcnt lgkmcnt(4)
  s_add_u32 s50, s35, 3727488
  s_add_u32 m0, s36, 49440
  v_mfma_f32_16x16x32_bf16 v[48:51], v[32:35], a[208:211], v[48:51]
  ds_read_b64_tr_b16 v[44:45], v2 offset:12296
  v_and_b32 v26, s44, v26
  v_mfma_f32_16x16x32_bf16 v[52:55], v[32:35], a[212:215], v[52:55]
  ds_read_b64_tr_b16 v[46:47], v2 offset:12808
  v_mul_f32 v28, v28, v196
  v_mfma_f32_16x16x32_bf16 v[56:59], v[32:35], a[216:219], v[56:59]
  buffer_load_dwordx4 v4, s[8:11], s50 offen lds
  v_mfma_f32_16x16x32_bf16 v[60:63], v[32:35], a[220:223], v[60:63]
  s_waitcnt lgkmcnt(4)
  v_mul_f32 v26, v26, v197
  v_cvt_pk_bf16_f32 v26, v28, v26
  v_mfma_f32_16x16x32_bf16 v[64:67], v[36:39], a[208:211], v[64:67]
  ds_read_b64_tr_b16 v[32:33], v1 offset:16416
  v_lshlrev_b32 v29, 16, v27
  v_mfma_f32_16x16x32_bf16 v[68:71], v[36:39], a[212:215], v[68:71]
  ds_read_b64_tr_b16 v[34:35], v1 offset:16928
  v_and_b32 v27, s44, v27
  v_mfma_f32_16x16x32_bf16 v[72:75], v[36:39], a[216:219], v[72:75]
  buffer_load_dwordx4 a[128:131], v11, s[20:23], s57 offen offset:0 sc1
  v_mul_f32 v29, v29, v198
  v_mfma_f32_16x16x32_bf16 v[76:79], v[36:39], a[220:223], v[76:79]
  s_waitcnt lgkmcnt(4)
  v_mul_f32 v27, v27, v199
  v_cvt_pk_bf16_f32 v27, v29, v27
  v_mfma_f32_16x16x32_bf16 v[80:83], v[40:43], a[208:211], v[80:83]
  ds_read_b64_tr_b16 v[36:37], v1 offset:16424
  v_lshlrev_b32 v28, 16, v20
  v_mfma_f32_16x16x32_bf16 v[84:87], v[40:43], a[212:215], v[84:87]
  ds_read_b64_tr_b16 v[38:39], v1 offset:16936
  v_and_b32 v20, s44, v20
  v_mfma_f32_16x16x32_bf16 v[88:91], v[40:43], a[216:219], v[88:91]
  buffer_store_dwordx4 v[24:27], v11, s[20:23], s84 offen offset:1024 sc1
  v_mfma_f32_16x16x32_bf16 v[92:95], v[40:43], a[220:223], v[92:95]
  s_waitcnt lgkmcnt(4)
  ds_read_b128 v[24:27], v8 offset:6144
  v_mfma_f32_16x16x32_bf16 v[96:99], v[44:47], a[208:211], v[96:99]
  ds_read_b64_tr_b16 v[40:41], v2 offset:16416
  s_add_u32 s77, s42, 27279360
  v_mfma_f32_16x16x32_bf16 v[100:103], v[44:47], a[212:215], v[100:103]
  ds_read_b64_tr_b16 v[42:43], v2 offset:16928
  v_mul_f32 v28, v28, v184
  v_mfma_f32_16x16x32_bf16 v[104:107], v[44:47], a[216:219], v[104:107]
  buffer_load_dwordx4 a[132:135], v11, s[20:23], s57 offen offset:1024 sc1
  v_mul_f32 v20, v20, v185
  v_mfma_f32_16x16x32_bf16 v[108:111], v[44:47], a[220:223], v[108:111]
  s_waitcnt lgkmcnt(5)
  v_cvt_pk_bf16_f32 v20, v28, v20
  v_lshlrev_b32 v29, 16, v21
  v_mfma_f32_16x16x32_bf16 v[48:51], v[32:35], a[224:227], v[48:51]
  ds_read_b64_tr_b16 v[44:45], v2 offset:16424
  v_and_b32 v21, s44, v21
  v_mfma_f32_16x16x32_bf16 v[52:55], v[32:35], a[228:231], v[52:55]
  ds_read_b64_tr_b16 v[46:47], v2 offset:16936
  s_waitcnt vmcnt(14) lgkmcnt(5)
  v_mfma_f32_16x16x32_bf16 v[56:59], v[32:35], a[232:235], v[56:59]
  s_barrier
  s_add_u32 s51, s35, 2822272
  s_add_u32 m0, s36, 0
  v_mfma_f32_16x16x32_bf16 v[60:63], v[32:35], a[236:239], v[60:63]
  buffer_load_dwordx4 a[136:139], v11, s[20:23], s57 offen offset:2048 sc1
  v_mul_f32 v29, v29, v186
  v_mfma_f32_16x16x32_bf16 v[64:67], v[36:39], a[224:227], v[64:67]
  ds_read_b64_tr_b16 v[32:33], v1 offset:20544
  v_mul_f32 v21, v21, v187
  v_mfma_f32_16x16x32_bf16 v[68:71], v[36:39], a[228:231], v[68:71]
  ds_read_b64_tr_b16 v[34:35], v1 offset:21056
  v_cvt_pk_bf16_f32 v21, v29, v21
  v_mfma_f32_16x16x32_bf16 v[72:75], v[36:39], a[232:235], v[72:75]
  buffer_load_dwordx4 a[140:143], v11, s[20:23], s57 offen offset:3072 sc1
  v_lshlrev_b32 v28, 16, v22
  v_mfma_f32_16x16x32_bf16 v[76:79], v[36:39], a[236:239], v[76:79]
  s_waitcnt lgkmcnt(4)
  s_add_u32 s57, s40, 27291648
  v_and_b32 v22, s44, v22
  v_mfma_f32_16x16x32_bf16 v[80:83], v[40:43], a[224:227], v[80:83]
  ds_read_b64_tr_b16 v[36:37], v1 offset:20552
  v_mul_f32 v28, v28, v200
  v_mfma_f32_16x16x32_bf16 v[84:87], v[40:43], a[228:231], v[84:87]
  ds_read_b64_tr_b16 v[38:39], v1 offset:21064
  v_mul_f32 v22, v22, v201
  v_mfma_f32_16x16x32_bf16 v[88:91], v[40:43], a[232:235], v[88:91]
  buffer_load_dwordx4 a[144:147], v11, s[20:23], s57 offen offset:0 sc1
  v_cvt_pk_bf16_f32 v22, v28, v22
  v_mfma_f32_16x16x32_bf16 v[92:95], v[40:43], a[236:239], v[92:95]
  s_waitcnt lgkmcnt(4)
  v_lshlrev_b32 v29, 16, v23
  v_and_b32 v23, s44, v23
  v_mfma_f32_16x16x32_bf16 v[96:99], v[44:47], a[224:227], v[96:99]
  ds_read_b64_tr_b16 v[40:41], v2 offset:20544
  v_mul_f32 v29, v29, v202
  v_mfma_f32_16x16x32_bf16 v[100:103], v[44:47], a[228:231], v[100:103]
  ds_read_b64_tr_b16 v[42:43], v2 offset:21056
  v_mul_f32 v23, v23, v203
  v_mfma_f32_16x16x32_bf16 v[104:107], v[44:47], a[232:235], v[104:107]
  buffer_load_dwordx4 a[148:151], v11, s[20:23], s57 offen offset:1024 sc1
  v_cvt_pk_bf16_f32 v23, v29, v23
  v_mfma_f32_16x16x32_bf16 v[108:111], v[44:47], a[236:239], v[108:111]
  s_waitcnt lgkmcnt(4)
  v_lshlrev_b32 v28, 16, v24
  v_and_b32 v24, s44, v24
  v_mfma_f32_16x16x32_bf16 v[48:51], v[32:35], a[240:243], v[48:51]
  ds_read_b64_tr_b16 v[44:45], v2 offset:20552
  v_mul_f32 v28, v28, v188
  v_mfma_f32_16x16x32_bf16 v[52:55], v[32:35], a[244:247], v[52:55]
  ds_read_b64_tr_b16 v[46:47], v2 offset:21064
  v_mul_f32 v24, v24, v189
  v_mfma_f32_16x16x32_bf16 v[56:59], v[32:35], a[248:251], v[56:59]
  buffer_store_dwordx4 v[20:23], v11, s[20:23], s77 offen offset:2048 sc1
  v_mfma_f32_16x16x32_bf16 v[60:63], v[32:35], a[252:255], v[60:63]
  s_waitcnt lgkmcnt(4)
  ds_read_b128 v[20:23], v9 offset:0
  v_mfma_f32_16x16x32_bf16 v[64:67], v[36:39], a[240:243], v[64:67]
  ds_read_b64_tr_b16 v[32:33], v1 offset:24672
  s_add_u32 s84, s42, 27279360
  v_mfma_f32_16x16x32_bf16 v[68:71], v[36:39], a[244:247], v[68:71]
  ds_read_b64_tr_b16 v[34:35], v1 offset:25184
  v_cvt_pk_bf16_f32 v24, v28, v24
  v_mfma_f32_16x16x32_bf16 v[72:75], v[36:39], a[248:251], v[72:75]
  v_lshlrev_b32 v29, 16, v25
  v_and_b32 v25, s44, v25
  v_mfma_f32_16x16x32_bf16 v[76:79], v[36:39], a[252:255], v[76:79]
  s_waitcnt lgkmcnt(5)
  v_mul_f32 v29, v29, v190
  v_mul_f32 v25, v25, v191
  v_mfma_f32_16x16x32_bf16 v[80:83], v[40:43], a[240:243], v[80:83]
  ds_read_b64_tr_b16 v[36:37], v1 offset:24680
  v_cvt_pk_bf16_f32 v25, v29, v25
  v_mfma_f32_16x16x32_bf16 v[84:87], v[40:43], a[244:247], v[84:87]
  ds_read_b64_tr_b16 v[38:39], v1 offset:25192
  v_lshlrev_b32 v28, 16, v26
  v_mfma_f32_16x16x32_bf16 v[88:91], v[40:43], a[248:251], v[88:91]
  buffer_load_dwordx4 a[152:155], v11, s[20:23], s57 offen offset:2048 sc1
  v_and_b32 v26, s44, v26
  v_mfma_f32_16x16x32_bf16 v[92:95], v[40:43], a[252:255], v[92:95]
  s_waitcnt lgkmcnt(5)
  v_mul_f32 v28, v28, v204
  v_mul_f32 v26, v26, v205
  v_mfma_f32_16x16x32_bf16 v[96:99], v[44:47], a[240:243], v[96:99]
  ds_read_b64_tr_b16 v[40:41], v2 offset:24672
  v_cvt_pk_bf16_f32 v26, v28, v26
  v_mfma_f32_16x16x32_bf16 v[100:103], v[44:47], a[244:247], v[100:103]
  ds_read_b64_tr_b16 v[42:43], v2 offset:25184
  v_lshlrev_b32 v29, 16, v27
  v_mfma_f32_16x16x32_bf16 v[104:107], v[44:47], a[248:251], v[104:107]
  buffer_load_dwordx4 a[156:159], v11, s[20:23], s57 offen offset:3072 sc1
  v_and_b32 v27, s44, v27
  v_mfma_f32_16x16x32_bf16 v[108:111], v[44:47], a[252:255], v[108:111]
  s_waitcnt lgkmcnt(4)
  v_mul_f32 v29, v29, v206
  v_mul_f32 v27, v27, v207
  v_mfma_f32_16x16x32_bf16 v[112:115], v[32:35], a[208:211], v[112:115]
  ds_read_b64_tr_b16 v[44:45], v2 offset:24680
  v_cvt_pk_bf16_f32 v27, v29, v27
  v_mfma_f32_16x16x32_bf16 v[116:119], v[32:35], a[212:215], v[116:119]
  ds_read_b64_tr_b16 v[46:47], v2 offset:25192
  v_lshlrev_b32 v28, 16, v20
  v_mfma_f32_16x16x32_bf16 v[120:123], v[32:35], a[216:219], v[120:123]
  buffer_store_dwordx4 v[24:27], v11, s[20:23], s84 offen offset:3072 sc1
  v_mfma_f32_16x16x32_bf16 v[124:127], v[32:35], a[220:223], v[124:127]
  s_waitcnt lgkmcnt(4)
  ds_read_b128 v[24:27], v9 offset:2048
  v_mfma_f32_16x16x32_bf16 v[128:131], v[36:39], a[208:211], v[128:131]
  ds_read_b64_tr_b16 v[32:33], v1 offset:28800
  s_add_u32 s77, s42, 27283456
  v_mfma_f32_16x16x32_bf16 v[132:135], v[36:39], a[212:215], v[132:135]
  ds_read_b64_tr_b16 v[34:35], v1 offset:29312
  v_and_b32 v20, s44, v20
  v_mfma_f32_16x16x32_bf16 v[136:139], v[36:39], a[216:219], v[136:139]
  buffer_load_dwordx4 v4, s[8:11], s51 offen lds
  v_mfma_f32_16x16x32_bf16 v[140:143], v[36:39], a[220:223], v[140:143]
  s_waitcnt lgkmcnt(5)
  s_add_u32 s50, s35, 3141760
  v_mul_f32 v28, v28, v208
  v_mfma_f32_16x16x32_bf16 v[144:147], v[40:43], a[208:211], v[144:147]
  ds_read_b64_tr_b16 v[36:37], v1 offset:28808
  s_add_u32 m0, s36, 4128
  v_mfma_f32_16x16x32_bf16 v[148:151], v[40:43], a[212:215], v[148:151]
  ds_read_b64_tr_b16 v[38:39], v1 offset:29320
  v_mul_f32 v20, v20, v209
  v_mfma_f32_16x16x32_bf16 v[152:155], v[40:43], a[216:219], v[152:155]
  buffer_load_dwordx4 v4, s[8:11], s50 offen lds
  v_mfma_f32_16x16x32_bf16 v[156:159], v[40:43], a[220:223], v[156:159]
  s_waitcnt lgkmcnt(5)
  s_add_u32 s51, s35, 2769152
  v_cvt_pk_bf16_f32 v20, v28, v20
  v_mfma_f32_16x16x32_bf16 v[160:163], v[44:47], a[208:211], v[160:163]
  ds_read_b64_tr_b16 v[40:41], v2 offset:28800
  v_lshlrev_b32 v29, 16, v21
  v_mfma_f32_16x16x32_bf16 v[164:167], v[44:47], a[212:215], v[164:167]
  ds_read_b64_tr_b16 v[42:43], v2 offset:29312
  s_add_u32 m0, s36, 8256
  v_mfma_f32_16x16x32_bf16 v[168:171], v[44:47], a[216:219], v[168:171]
  buffer_load_dwordx4 v4, s[8:11], s51 offen lds
  v_mfma_f32_16x16x32_bf16 v[172:175], v[44:47], a[220:223], v[172:175]
  s_waitcnt lgkmcnt(4)
  v_and_b32 v21, s44, v21
  v_mul_f32 v29, v29, v210
  v_mfma_f32_16x16x32_bf16 v[112:115], v[32:35], a[224:227], v[112:115]
  ds_read_b64_tr_b16 v[44:45], v2 offset:28808
  v_mul_f32 v21, v21, v211
  v_mfma_f32_16x16x32_bf16 v[116:119], v[32:35], a[228:231], v[116:119]
  ds_read_b64_tr_b16 v[46:47], v2 offset:29320
  s_waitcnt vmcnt(16) lgkmcnt(4)
  v_mfma_f32_16x16x32_bf16 v[120:123], v[32:35], a[232:235], v[120:123]
  s_barrier
  s_add_u32 s50, s35, 3088640
  s_add_u32 m0, s36, 12384
  v_mfma_f32_16x16x32_bf16 v[124:127], v[32:35], a[236:239], v[124:127]
  buffer_load_dwordx4 v4, s[8:11], s50 offen lds
  v_mfma_f32_16x16x32_bf16 v[128:131], v[36:39], a[224:227], v[128:131]
  ds_read_b64_tr_b16 v[32:33], v1 offset:32928
  s_add_u32 s51, s35, 3408128
  v_mfma_f32_16x16x32_bf16 v[132:135], v[36:39], a[228:231], v[132:135]
  ds_read_b64_tr_b16 v[34:35], v1 offset:33440
  v_cvt_pk_bf16_f32 v21, v29, v21
  v_mfma_f32_16x16x32_bf16 v[136:139], v[36:39], a[232:235], v[136:139]
  s_add_u32 m0, s36, 16512
  v_lshlrev_b32 v28, 16, v22
  v_and_b32 v22, s44, v22
  v_mfma_f32_16x16x32_bf16 v[140:143], v[36:39], a[236:239], v[140:143]
  s_waitcnt lgkmcnt(4)
  v_mul_f32 v28, v28, v224
  v_mul_f32 v22, v22, v225
  v_mfma_f32_16x16x32_bf16 v[144:147], v[40:43], a[224:227], v[144:147]
  ds_read_b64_tr_b16 v[36:37], v1 offset:32936
  v_cvt_pk_bf16_f32 v22, v28, v22
  v_mfma_f32_16x16x32_bf16 v[148:151], v[40:43], a[228:231], v[148:151]
  ds_read_b64_tr_b16 v[38:39], v1 offset:33448
  v_lshlrev_b32 v29, 16, v23
  v_mfma_f32_16x16x32_bf16 v[152:155], v[40:43], a[232:235], v[152:155]
  buffer_load_dwordx4 v4, s[8:11], s51 offen lds
  v_mfma_f32_16x16x32_bf16 v[156:159], v[40:43], a[236:239], v[156:159]
  s_waitcnt lgkmcnt(4)
  s_add_u32 s50, s35, 3727616
  s_add_u32 m0, s36, 20640
  v_mfma_f32_16x16x32_bf16 v[160:163], v[44:47], a[224:227], v[160:163]
  ds_read_b64_tr_b16 v[40:41], v2 offset:32928
  v_and_b32 v23, s44, v23
  v_mfma_f32_16x16x32_bf16 v[164:167], v[44:47], a[228:231], v[164:167]
  ds_read_b64_tr_b16 v[42:43], v2 offset:33440
  v_mul_f32 v29, v29, v226
  v_mfma_f32_16x16x32_bf16 v[168:171], v[44:47], a[232:235], v[168:171]
  buffer_load_dwordx4 v4, s[8:11], s50 offen lds
  v_mfma_f32_16x16x32_bf16 v[172:175], v[44:47], a[236:239], v[172:175]
  s_waitcnt lgkmcnt(4)
  v_mul_f32 v23, v23, v227
  v_cvt_pk_bf16_f32 v23, v29, v23
  v_mfma_f32_16x16x32_bf16 v[112:115], v[32:35], a[240:243], v[112:115]
  ds_read_b64_tr_b16 v[44:45], v2 offset:32936
  v_lshlrev_b32 v28, 16, v24
  v_mfma_f32_16x16x32_bf16 v[116:119], v[32:35], a[244:247], v[116:119]
  ds_read_b64_tr_b16 v[46:47], v2 offset:33448
  v_and_b32 v24, s44, v24
  v_mfma_f32_16x16x32_bf16 v[120:123], v[32:35], a[248:251], v[120:123]
  buffer_store_dwordx4 v[20:23], v11, s[20:23], s77 offen offset:0 sc1
  v_mfma_f32_16x16x32_bf16 v[124:127], v[32:35], a[252:255], v[124:127]
  s_waitcnt lgkmcnt(4)
  ds_read_b128 v[20:23], v9 offset:4096
  v_mfma_f32_16x16x32_bf16 v[128:131], v[36:39], a[240:243], v[128:131]
  ds_read_b64_tr_b16 v[32:33], v1 offset:37056
  s_add_u32 s84, s42, 27283456
  v_mfma_f32_16x16x32_bf16 v[132:135], v[36:39], a[244:247], v[132:135]
  ds_read_b64_tr_b16 v[34:35], v1 offset:37568
  v_mul_f32 v28, v28, v212
  v_mfma_f32_16x16x32_bf16 v[136:139], v[36:39], a[248:251], v[136:139]
  v_mul_f32 v24, v24, v213
  v_cvt_pk_bf16_f32 v24, v28, v24
  v_mfma_f32_16x16x32_bf16 v[140:143], v[36:39], a[252:255], v[140:143]
  s_waitcnt lgkmcnt(5)
  v_lshlrev_b32 v29, 16, v25
  v_and_b32 v25, s44, v25
  v_mfma_f32_16x16x32_bf16 v[144:147], v[40:43], a[240:243], v[144:147]
  ds_read_b64_tr_b16 v[36:37], v1 offset:37064
  v_mul_f32 v29, v29, v214
  v_mfma_f32_16x16x32_bf16 v[148:151], v[40:43], a[244:247], v[148:151]
  ds_read_b64_tr_b16 v[38:39], v1 offset:37576
  v_mul_f32 v25, v25, v215
  v_mfma_f32_16x16x32_bf16 v[152:155], v[40:43], a[248:251], v[152:155]
  v_cvt_pk_bf16_f32 v25, v29, v25
  v_lshlrev_b32 v28, 16, v26
  v_mfma_f32_16x16x32_bf16 v[156:159], v[40:43], a[252:255], v[156:159]
  s_waitcnt lgkmcnt(5)
  v_and_b32 v26, s44, v26
  v_mul_f32 v28, v28, v228
  v_mfma_f32_16x16x32_bf16 v[160:163], v[44:47], a[240:243], v[160:163]
  ds_read_b64_tr_b16 v[40:41], v2 offset:37056
  v_mul_f32 v26, v26, v229
  v_mfma_f32_16x16x32_bf16 v[164:167], v[44:47], a[244:247], v[164:167]
  ds_read_b64_tr_b16 v[42:43], v2 offset:37568
  v_cvt_pk_bf16_f32 v26, v28, v26
  v_mfma_f32_16x16x32_bf16 v[168:171], v[44:47], a[248:251], v[168:171]
  v_lshlrev_b32 v29, 16, v27
  v_and_b32 v27, s44, v27
  v_mfma_f32_16x16x32_bf16 v[172:175], v[44:47], a[252:255], v[172:175]
  s_waitcnt lgkmcnt(4)
  v_mul_f32 v29, v29, v230
  v_mul_f32 v27, v27, v231
  v_mfma_f32_16x16x32_bf16 v[48:51], v[32:35], a[112:115], v[48:51]
  ds_read_b64_tr_b16 v[44:45], v2 offset:37064
  v_cvt_pk_bf16_f32 v27, v29, v27
  v_mfma_f32_16x16x32_bf16 v[52:55], v[32:35], a[116:119], v[52:55]
  ds_read_b64_tr_b16 v[46:47], v2 offset:37576
  v_lshlrev_b32 v28, 16, v20
  v_mfma_f32_16x16x32_bf16 v[56:59], v[32:35], a[120:123], v[56:59]
  buffer_store_dwordx4 v[24:27], v11, s[20:23], s84 offen offset:1024 sc1
  v_mfma_f32_16x16x32_bf16 v[60:63], v[32:35], a[124:127], v[60:63]
  s_waitcnt lgkmcnt(4)
  ds_read_b128 v[24:27], v9 offset:6144
  v_mfma_f32_16x16x32_bf16 v[64:67], v[36:39], a[112:115], v[64:67]
  ds_read_b64_tr_b16 v[32:33], v1 offset:41184
  s_add_u32 s77, s42, 27283456
  v_mfma_f32_16x16x32_bf16 v[68:71], v[36:39], a[116:119], v[68:71]
  ds_read_b64_tr_b16 v[34:35], v1 offset:41696
  v_and_b32 v20, s44, v20
  v_mfma_f32_16x16x32_bf16 v[72:75], v[36:39], a[120:123], v[72:75]
  v_mul_f32 v28, v28, v216
  v_mul_f32 v20, v20, v217
  v_mfma_f32_16x16x32_bf16 v[76:79], v[36:39], a[124:127], v[76:79]
  s_waitcnt lgkmcnt(5)
  v_cvt_pk_bf16_f32 v20, v28, v20
  v_lshlrev_b32 v29, 16, v21
  v_mfma_f32_16x16x32_bf16 v[80:83], v[40:43], a[112:115], v[80:83]
  ds_read_b64_tr_b16 v[36:37], v1 offset:41192
  v_and_b32 v21, s44, v21
  v_mfma_f32_16x16x32_bf16 v[84:87], v[40:43], a[116:119], v[84:87]
  ds_read_b64_tr_b16 v[38:39], v1 offset:41704
  v_mul_f32 v29, v29, v218
  v_mfma_f32_16x16x32_bf16 v[88:91], v[40:43], a[120:123], v[88:91]
  v_mul_f32 v21, v21, v219
  v_cvt_pk_bf16_f32 v21, v29, v21
  v_mfma_f32_16x16x32_bf16 v[92:95], v[40:43], a[124:127], v[92:95]
  s_waitcnt lgkmcnt(5)
  v_lshlrev_b32 v28, 16, v22
  v_and_b32 v22, s44, v22
  v_mfma_f32_16x16x32_bf16 v[96:99], v[44:47], a[112:115], v[96:99]
  ds_read_b64_tr_b16 v[40:41], v2 offset:41184
  v_mul_f32 v28, v28, v232
  v_mfma_f32_16x16x32_bf16 v[100:103], v[44:47], a[116:119], v[100:103]
  ds_read_b64_tr_b16 v[42:43], v2 offset:41696
  v_mul_f32 v22, v22, v233
  v_mfma_f32_16x16x32_bf16 v[104:107], v[44:47], a[120:123], v[104:107]
  v_cvt_pk_bf16_f32 v22, v28, v22
  v_lshlrev_b32 v29, 16, v23
  v_mfma_f32_16x16x32_bf16 v[108:111], v[44:47], a[124:127], v[108:111]
  s_waitcnt vmcnt(14) lgkmcnt(4)
  v_and_b32 v23, s44, v23
  v_mul_f32 v29, v29, v234
  v_mfma_f32_16x16x32_bf16 v[48:51], v[32:35], a[128:131], v[48:51]
  ds_read_b64_tr_b16 v[44:45], v2 offset:41192
  v_mul_f32 v23, v23, v235
  v_mfma_f32_16x16x32_bf16 v[52:55], v[32:35], a[132:135], v[52:55]
  ds_read_b64_tr_b16 v[46:47], v2 offset:41704
  s_waitcnt vmcnt(7) lgkmcnt(4)
  v_mfma_f32_16x16x32_bf16 v[56:59], v[32:35], a[136:139], v[56:59]
  s_barrier
  s_add_u32 s51, s35, 2822400
  s_add_u32 m0, s36, 24768
  v_mfma_f32_16x16x32_bf16 v[60:63], v[32:35], a[140:143], v[60:63]
  buffer_load_dwordx4 v4, s[8:11], s51 offen lds
  v_mfma_f32_16x16x32_bf16 v[64:67], v[36:39], a[128:131], v[64:67]
  ds_read_b64_tr_b16 v[32:33], v1 offset:45312
  s_add_u32 s50, s35, 3141888
  v_mfma_f32_16x16x32_bf16 v[68:71], v[36:39], a[132:135], v[68:71]
  ds_read_b64_tr_b16 v[34:35], v1 offset:45824
  s_add_u32 m0, s36, 28896
  v_mfma_f32_16x16x32_bf16 v[72:75], v[36:39], a[136:139], v[72:75]
  buffer_load_dwordx4 v4, s[8:11], s50 offen lds
  v_mfma_f32_16x16x32_bf16 v[76:79], v[36:39], a[140:143], v[76:79]
  s_waitcnt lgkmcnt(4)
  s_lshr_b32 s51, 0x46403a34, s37
  s_and_b32 s51, s51, 0xff
  v_mfma_f32_16x16x32_bf16 v[80:83], v[40:43], a[128:131], v[80:83]
  ds_read_b64_tr_b16 v[36:37], v1 offset:45320
  s_mul_i32 s51, s51, 53248
  v_mfma_f32_16x16x32_bf16 v[84:87], v[40:43], a[132:135], v[84:87]
  ds_read_b64_tr_b16 v[38:39], v1 offset:45832
  s_add_u32 s51, s51, s38
  v_mfma_f32_16x16x32_bf16 v[88:91], v[40:43], a[136:139], v[88:91]
  s_add_u32 m0, s39, 33024
  v_cvt_pk_bf16_f32 v23, v29, v23
  v_lshlrev_b32 v28, 16, v24
  v_mfma_f32_16x16x32_bf16 v[92:95], v[40:43], a[140:143], v[92:95]
  s_waitcnt lgkmcnt(4)
  v_and_b32 v24, s44, v24
  v_mul_f32 v28, v28, v220
  v_mfma_f32_16x16x32_bf16 v[96:99], v[44:47], a[128:131], v[96:99]
  ds_read_b64_tr_b16 v[40:41], v2 offset:45312
  v_mul_f32 v24, v24, v221
  v_mfma_f32_16x16x32_bf16 v[100:103], v[44:47], a[132:135], v[100:103]
  ds_read_b64_tr_b16 v[42:43], v2 offset:45824
  v_cvt_pk_bf16_f32 v24, v28, v24
  v_mfma_f32_16x16x32_bf16 v[104:107], v[44:47], a[136:139], v[104:107]
  buffer_store_dwordx4 v[20:23], v11, s[20:23], s77 offen offset:2048 sc1
  v_mfma_f32_16x16x32_bf16 v[108:111], v[44:47], a[140:143], v[108:111]
  s_waitcnt lgkmcnt(4)
  s_add_u32 s84, s42, 27283456
  v_lshlrev_b32 v29, 16, v25
  v_mfma_f32_16x16x32_bf16 v[48:51], v[32:35], a[144:147], v[48:51]
  ds_read_b64_tr_b16 v[44:45], v2 offset:45320
  v_and_b32 v25, s44, v25
  v_mfma_f32_16x16x32_bf16 v[52:55], v[32:35], a[148:151], v[52:55]
  ds_read_b64_tr_b16 v[46:47], v2 offset:45832
  v_mul_f32 v29, v29, v222
  v_mfma_f32_16x16x32_bf16 v[56:59], v[32:35], a[152:155], v[56:59]
  buffer_load_dwordx4 v6, s[8:11], s51 offen lds
  v_mfma_f32_16x16x32_bf16 v[60:63], v[32:35], a[156:159], v[60:63]
  s_waitcnt lgkmcnt(4)
  v_mul_f32 v25, v25, v223
  v_cvt_pk_bf16_f32 v25, v29, v25
  v_mfma_f32_16x16x32_bf16 v[64:67], v[36:39], a[144:147], v[64:67]
  ds_read_b64_tr_b16 v[32:33], v1 offset:49440
  v_lshlrev_b32 v28, 16, v26
  v_mfma_f32_16x16x32_bf16 v[68:71], v[36:39], a[148:151], v[68:71]
  ds_read_b64_tr_b16 v[34:35], v1 offset:49952
  v_and_b32 v26, s44, v26
  v_mfma_f32_16x16x32_bf16 v[72:75], v[36:39], a[152:155], v[72:75]
  v_mul_f32 v28, v28, v236
  v_mul_f32 v26, v26, v237
  v_mfma_f32_16x16x32_bf16 v[76:79], v[36:39], a[156:159], v[76:79]
  s_waitcnt lgkmcnt(4)
  v_cvt_pk_bf16_f32 v26, v28, v26
  v_lshlrev_b32 v29, 16, v27
  v_mfma_f32_16x16x32_bf16 v[80:83], v[40:43], a[144:147], v[80:83]
  ds_read_b64_tr_b16 v[36:37], v1 offset:49448
  v_and_b32 v27, s44, v27
  v_mfma_f32_16x16x32_bf16 v[84:87], v[40:43], a[148:151], v[84:87]
  ds_read_b64_tr_b16 v[38:39], v1 offset:49960
  v_mul_f32 v29, v29, v238
  v_mfma_f32_16x16x32_bf16 v[88:91], v[40:43], a[152:155], v[88:91]
  v_mul_f32 v27, v27, v239
  v_cvt_pk_bf16_f32 v27, v29, v27
  v_mfma_f32_16x16x32_bf16 v[92:95], v[40:43], a[156:159], v[92:95]
  s_waitcnt lgkmcnt(4)
  v_mfma_f32_16x16x32_bf16 v[96:99], v[44:47], a[144:147], v[96:99]
  ds_read_b64_tr_b16 v[40:41], v2 offset:49440
  v_mfma_f32_16x16x32_bf16 v[100:103], v[44:47], a[148:151], v[100:103]
  ds_read_b64_tr_b16 v[42:43], v2 offset:49952
  v_mfma_f32_16x16x32_bf16 v[104:107], v[44:47], a[152:155], v[104:107]
  buffer_store_dwordx4 v[24:27], v11, s[20:23], s84 offen offset:3072 sc1
  v_mfma_f32_16x16x32_bf16 v[108:111], v[44:47], a[156:159], v[108:111]
  s_waitcnt lgkmcnt(4)
  ds_read_b64 v[20:21], v10 offset:0
  v_mfma_f32_16x16x32_bf16 v[112:115], v[32:35], a[112:115], v[112:115]
  ds_read_b64_tr_b16 v[44:45], v2 offset:49448
  s_waitcnt lgkmcnt(1)
  v_mfma_f32_16x16x32_bf16 v[116:119], v[32:35], a[116:119], v[116:119]
  ds_read_b64_tr_b16 v[46:47], v2 offset:49960
  v_lshlrev_b32 v28, 16, v20
  v_mfma_f32_16x16x32_bf16 v[120:123], v[32:35], a[120:123], v[120:123]
  ds_read_b64 v[24:25], v10 offset:512
  s_add_u32 s77, s43, 27262976
  v_mfma_f32_16x16x32_bf16 v[124:127], v[32:35], a[124:127], v[124:127]
  v_and_b32 v20, s44, v20
  v_mul_f32 v28, v28, v240
  v_mfma_f32_16x16x32_bf16 v[128:131], v[36:39], a[112:115], v[128:131]
  ds_read_b64_tr_b16 v[32:33], v1 offset:0
  v_mul_f32 v20, v20, v241
  v_mfma_f32_16x16x32_bf16 v[132:135], v[36:39], a[116:119], v[132:135]
  ds_read_b64_tr_b16 v[34:35], v1 offset:512
  v_cvt_pk_bf16_f32 v20, v28, v20
  v_mfma_f32_16x16x32_bf16 v[136:139], v[36:39], a[120:123], v[136:139]
  v_lshlrev_b32 v29, 16, v21
  v_and_b32 v21, s44, v21
  v_mfma_f32_16x16x32_bf16 v[140:143], v[36:39], a[124:127], v[140:143]
  v_mul_f32 v29, v29, v242
  v_mul_f32 v21, v21, v243
  v_mfma_f32_16x16x32_bf16 v[144:147], v[40:43], a[112:115], v[144:147]
  ds_read_b64_tr_b16 v[36:37], v1 offset:8
  v_cvt_pk_bf16_f32 v21, v29, v21
  v_mfma_f32_16x16x32_bf16 v[148:151], v[40:43], a[116:119], v[148:151]
  ds_read_b64_tr_b16 v[38:39], v1 offset:520
  s_waitcnt lgkmcnt(4)
  v_mfma_f32_16x16x32_bf16 v[152:155], v[40:43], a[120:123], v[152:155]
  buffer_store_dwordx2 v[20:21], v12, s[20:23], s77 offen offset:0 sc1
  v_mfma_f32_16x16x32_bf16 v[156:159], v[40:43], a[124:127], v[156:159]
  ds_read_b64 v[20:21], v10 offset:1024
  s_add_u32 s84, s43, 27262976
  v_mfma_f32_16x16x32_bf16 v[160:163], v[44:47], a[112:115], v[160:163]
  ds_read_b64_tr_b16 v[40:41], v2 offset:0
  v_lshlrev_b32 v28, 16, v24
  v_mfma_f32_16x16x32_bf16 v[164:167], v[44:47], a[116:119], v[164:167]
  ds_read_b64_tr_b16 v[42:43], v2 offset:512
  v_and_b32 v24, s44, v24
  v_mfma_f32_16x16x32_bf16 v[168:171], v[44:47], a[120:123], v[168:171]
  v_mul_f32 v28, v28, v244
  v_mul_f32 v24, v24, v245
  v_mfma_f32_16x16x32_bf16 v[172:175], v[44:47], a[124:127], v[172:175]
  s_waitcnt lgkmcnt(5)
  v_cvt_pk_bf16_f32 v24, v28, v24
  v_lshlrev_b32 v29, 16, v25
  v_mfma_f32_16x16x32_bf16 v[112:115], v[32:35], a[128:131], v[112:115]
  ds_read_b64_tr_b16 v[44:45], v2 offset:8
  v_and_b32 v25, s44, v25
  v_mfma_f32_16x16x32_bf16 v[116:119], v[32:35], a[132:135], v[116:119]
  ds_read_b64_tr_b16 v[46:47], v2 offset:520
  s_waitcnt vmcnt(10) lgkmcnt(5)
  v_mfma_f32_16x16x32_bf16 v[120:123], v[32:35], a[136:139], v[120:123]
  s_barrier
  s_lshr_b32 s50, 0x3b3b3b35, s37
  s_and_b32 s50, s50, 0xff
  v_mfma_f32_16x16x32_bf16 v[124:127], v[32:35], a[140:143], v[124:127]
  buffer_load_dword v19, v18, s[20:23], 0 offen sc1
  v_mul_f32 v29, v29, v246
  v_mfma_f32_16x16x32_bf16 v[128:131], v[36:39], a[128:131], v[128:131]
  ds_read_b64_tr_b16 v[32:33], v1 offset:4128
  s_mul_i32 s50, s50, 53248
  v_mfma_f32_16x16x32_bf16 v[132:135], v[36:39], a[132:135], v[132:135]
  ds_read_b64_tr_b16 v[34:35], v1 offset:4640
  s_add_u32 s50, s50, s38
  v_mfma_f32_16x16x32_bf16 v[136:139], v[36:39], a[136:139], v[136:139]
  s_add_u32 m0, s39, 37120
  v_mul_f32 v25, v25, v247
  v_cvt_pk_bf16_f32 v25, v29, v25
  v_mfma_f32_16x16x32_bf16 v[140:143], v[36:39], a[140:143], v[140:143]
  s_waitcnt lgkmcnt(4)
  v_lshlrev_b32 v28, 16, v20
  v_and_b32 v20, s44, v20
  v_mfma_f32_16x16x32_bf16 v[144:147], v[40:43], a[128:131], v[144:147]
  ds_read_b64_tr_b16 v[36:37], v1 offset:4136
  v_mul_f32 v28, v28, v248
  v_mfma_f32_16x16x32_bf16 v[148:151], v[40:43], a[132:135], v[148:151]
  ds_read_b64_tr_b16 v[38:39], v1 offset:4648
  v_mul_f32 v20, v20, v249
  v_mfma_f32_16x16x32_bf16 v[152:155], v[40:43], a[136:139], v[152:155]
  buffer_store_dwordx2 v[24:25], v12, s[20:23], s84 offen offset:512 sc1
  v_mfma_f32_16x16x32_bf16 v[156:159], v[40:43], a[140:143], v[156:159]
  s_waitcnt lgkmcnt(4)
  ds_read_b64 v[24:25], v10 offset:1536
  v_mfma_f32_16x16x32_bf16 v[160:163], v[44:47], a[128:131], v[160:163]
  ds_read_b64_tr_b16 v[40:41], v2 offset:4128
  s_add_u32 s77, s43, 27262976
  v_mfma_f32_16x16x32_bf16 v[164:167], v[44:47], a[132:135], v[164:167]
  ds_read_b64_tr_b16 v[42:43], v2 offset:4640
  v_cvt_pk_bf16_f32 v20, v28, v20
  v_mfma_f32_16x16x32_bf16 v[168:171], v[44:47], a[136:139], v[168:171]
  buffer_load_dwordx4 v6, s[8:11], s50 offen lds
  v_mfma_f32_16x16x32_bf16 v[172:175], v[44:47], a[140:143], v[172:175]
  s_waitcnt lgkmcnt(5)
  s_add_u32 s51, s35, 3461120
  s_add_u32 m0, s36, 41216
  v_mfma_f32_16x16x32_bf16 v[112:115], v[32:35], a[144:147], v[112:115]
  ds_read_b64_tr_b16 v[44:45], v2 offset:4136
  v_lshlrev_b32 v29, 16, v21
  v_mfma_f32_16x16x32_bf16 v[116:119], v[32:35], a[148:151], v[116:119]
  ds_read_b64_tr_b16 v[46:47], v2 offset:4648
  v_and_b32 v21, s44, v21
  v_mfma_f32_16x16x32_bf16 v[120:123], v[32:35], a[152:155], v[120:123]
  buffer_load_dwordx4 v4, s[8:11], s51 offen lds
  v_mfma_f32_16x16x32_bf16 v[124:127], v[32:35], a[156:159], v[124:127]
  s_waitcnt lgkmcnt(5)
  s_add_u32 s50, s35, 3780608
  s_add_u32 m0, s36, 45344
  v_mfma_f32_16x16x32_bf16 v[128:131], v[36:39], a[144:147], v[128:131]
  ds_read_b64_tr_b16 v[32:33], v1 offset:8256
  v_mul_f32 v29, v29, v250
  v_mfma_f32_16x16x32_bf16 v[132:135], v[36:39], a[148:151], v[132:135]
  ds_read_b64_tr_b16 v[34:35], v1 offset:8768
  v_mul_f32 v21, v21, v251
  v_mfma_f32_16x16x32_bf16 v[136:139], v[36:39], a[152:155], v[136:139]
  buffer_load_dwordx4 v4, s[8:11], s50 offen lds
  v_mfma_f32_16x16x32_bf16 v[140:143], v[36:39], a[156:159], v[140:143]
  s_waitcnt lgkmcnt(4)
  s_add_u32 s51, s35, 2875392
  s_add_u32 m0, s36, 49472
  v_mfma_f32_16x16x32_bf16 v[144:147], v[40:43], a[144:147], v[144:147]
  ds_read_b64_tr_b16 v[36:37], v1 offset:8264
  v_cvt_pk_bf16_f32 v21, v29, v21
  v_mfma_f32_16x16x32_bf16 v[148:151], v[40:43], a[148:151], v[148:151]
  ds_read_b64_tr_b16 v[38:39], v1 offset:8776
  v_lshlrev_b32 v28, 16, v24
  v_mfma_f32_16x16x32_bf16 v[152:155], v[40:43], a[152:155], v[152:155]
  buffer_store_dwordx2 v[20:21], v12, s[20:23], s77 offen offset:1024 sc1
  v_mfma_f32_16x16x32_bf16 v[156:159], v[40:43], a[156:159], v[156:159]
  s_waitcnt lgkmcnt(4)
  s_add_u32 s84, s43, 27262976
  v_and_b32 v24, s44, v24
  v_mfma_f32_16x16x32_bf16 v[160:163], v[44:47], a[144:147], v[160:163]
  ds_read_b64_tr_b16 v[40:41], v2 offset:8256
  v_mul_f32 v28, v28, v252
  v_mfma_f32_16x16x32_bf16 v[164:167], v[44:47], a[148:151], v[164:167]
  ds_read_b64_tr_b16 v[42:43], v2 offset:8768
  v_mul_f32 v24, v24, v253
  v_mfma_f32_16x16x32_bf16 v[168:171], v[44:47], a[152:155], v[168:171]
  buffer_load_dwordx4 v4, s[8:11], s51 offen lds
  v_mfma_f32_16x16x32_bf16 v[172:175], v[44:47], a[156:159], v[172:175]
  s_waitcnt lgkmcnt(4)
  v_cvt_pk_bf16_f32 v24, v28, v24
  v_lshlrev_b32 v29, 16, v25
  v_mfma_f32_16x16x32_bf16 v[176:179], v[32:35], a[208:211], v[176:179]
  ds_read_b64_tr_b16 v[44:45], v2 offset:8264
  s_add_u32 s57, s40, 27316224
  v_mfma_f32_16x16x32_bf16 v[180:183], v[32:35], a[212:215], v[180:183]
  ds_read_b64_tr_b16 v[46:47], v2 offset:8776
  v_and_b32 v25, s44, v25
  v_mfma_f32_16x16x32_bf16 v[184:187], v[32:35], a[216:219], v[184:187]
  v_mul_f32 v29, v29, v254
  v_mul_f32 v25, v25, v255
  v_mfma_f32_16x16x32_bf16 v[188:191], v[32:35], a[220:223], v[188:191]
  s_waitcnt lgkmcnt(4)
  v_cvt_pk_bf16_f32 v25, v29, v25
  v_mfma_f32_16x16x32_bf16 v[192:195], v[36:39], a[208:211], v[192:195]
  ds_read_b64_tr_b16 v[32:33], v1 offset:12384
  v_mfma_f32_16x16x32_bf16 v[196:199], v[36:39], a[212:215], v[196:199]
  ds_read_b64_tr_b16 v[34:35], v1 offset:12896
  s_waitcnt lgkmcnt(4)
  v_mfma_f32_16x16x32_bf16 v[200:203], v[36:39], a[216:219], v[200:203]
  buffer_store_dwordx2 v[24:25], v12, s[20:23], s84 offen offset:1536 sc1
  v_mfma_f32_16x16x32_bf16 v[204:207], v[36:39], a[220:223], v[204:207]
  v_mfma_f32_16x16x32_bf16 v[208:211], v[40:43], a[208:211], v[208:211]
  ds_read_b64_tr_b16 v[36:37], v1 offset:12392
  v_mfma_f32_16x16x32_bf16 v[212:215], v[40:43], a[212:215], v[212:215]
  ds_read_b64_tr_b16 v[38:39], v1 offset:12904
  s_waitcnt lgkmcnt(4)
  v_mfma_f32_16x16x32_bf16 v[216:219], v[40:43], a[216:219], v[216:219]
  v_mfma_f32_16x16x32_bf16 v[220:223], v[40:43], a[220:223], v[220:223]
  buffer_load_dwordx4 a[48:51], v11, s[20:23], s57 offen offset:0 sc1
  v_mfma_f32_16x16x32_bf16 v[224:227], v[44:47], a[208:211], v[224:227]
  ds_read_b64_tr_b16 v[40:41], v2 offset:12384
  v_mfma_f32_16x16x32_bf16 v[228:231], v[44:47], a[212:215], v[228:231]
  ds_read_b64_tr_b16 v[42:43], v2 offset:12896
  s_waitcnt lgkmcnt(4)
  v_mfma_f32_16x16x32_bf16 v[232:235], v[44:47], a[216:219], v[232:235]
  v_mfma_f32_16x16x32_bf16 v[236:239], v[44:47], a[220:223], v[236:239]
  buffer_load_dwordx4 a[52:55], v11, s[20:23], s57 offen offset:1024 sc1
  v_mfma_f32_16x16x32_bf16 v[176:179], v[32:35], a[224:227], v[176:179]
  ds_read_b64_tr_b16 v[44:45], v2 offset:12392
  v_mfma_f32_16x16x32_bf16 v[180:183], v[32:35], a[228:231], v[180:183]
  ds_read_b64_tr_b16 v[46:47], v2 offset:12904
  s_waitcnt vmcnt(15) lgkmcnt(4)
  v_mfma_f32_16x16x32_bf16 v[184:187], v[32:35], a[232:235], v[184:187]
  s_barrier
  s_add_u32 s50, s35, 3194880
  s_add_u32 m0, s36, 0
  v_mfma_f32_16x16x32_bf16 v[188:191], v[32:35], a[236:239], v[188:191]
  buffer_load_dwordx4 v4, s[8:11], s50 offen lds
  v_mfma_f32_16x16x32_bf16 v[192:195], v[36:39], a[224:227], v[192:195]
  ds_read_b64_tr_b16 v[32:33], v1 offset:16512
  s_add_u32 s51, s35, 3461248
  v_mfma_f32_16x16x32_bf16 v[196:199], v[36:39], a[228:231], v[196:199]
  ds_read_b64_tr_b16 v[34:35], v1 offset:17024
  s_waitcnt lgkmcnt(4)
  v_mfma_f32_16x16x32_bf16 v[200:203], v[36:39], a[232:235], v[200:203]
  s_add_u32 m0, s36, 4128
  v_mfma_f32_16x16x32_bf16 v[204:207], v[36:39], a[236:239], v[204:207]
  buffer_load_dwordx4 v4, s[8:11], s51 offen lds
  v_mfma_f32_16x16x32_bf16 v[208:211], v[40:43], a[224:227], v[208:211]
  ds_read_b64_tr_b16 v[36:37], v1 offset:16520
  s_add_u32 s50, s35, 3780736
  v_mfma_f32_16x16x32_bf16 v[212:215], v[40:43], a[228:231], v[212:215]
  ds_read_b64_tr_b16 v[38:39], v1 offset:17032
  s_waitcnt lgkmcnt(4)
  v_mfma_f32_16x16x32_bf16 v[216:219], v[40:43], a[232:235], v[216:219]
  s_add_u32 m0, s36, 8256
  v_mfma_f32_16x16x32_bf16 v[220:223], v[40:43], a[236:239], v[220:223]
  buffer_load_dwordx4 v4, s[8:11], s50 offen lds
  v_mfma_f32_16x16x32_bf16 v[224:227], v[44:47], a[224:227], v[224:227]
  ds_read_b64_tr_b16 v[40:41], v2 offset:16512
  v_mfma_f32_16x16x32_bf16 v[228:231], v[44:47], a[228:231], v[228:231]
  ds_read_b64_tr_b16 v[42:43], v2 offset:17024
  s_waitcnt lgkmcnt(4)
  v_mfma_f32_16x16x32_bf16 v[232:235], v[44:47], a[232:235], v[232:235]
  v_mfma_f32_16x16x32_bf16 v[236:239], v[44:47], a[236:239], v[236:239]
  v_mfma_f32_16x16x32_bf16 v[176:179], v[32:35], a[240:243], v[176:179]
  ds_read_b64_tr_b16 v[44:45], v2 offset:16520
  v_mfma_f32_16x16x32_bf16 v[180:183], v[32:35], a[244:247], v[180:183]
  ds_read_b64_tr_b16 v[46:47], v2 offset:17032
  s_waitcnt lgkmcnt(4)
  v_mfma_f32_16x16x32_bf16 v[184:187], v[32:35], a[248:251], v[184:187]
  buffer_load_dwordx4 a[56:59], v11, s[20:23], s57 offen offset:2048 sc1
  v_mfma_f32_16x16x32_bf16 v[188:191], v[32:35], a[252:255], v[188:191]
  v_mfma_f32_16x16x32_bf16 v[192:195], v[36:39], a[240:243], v[192:195]
  ds_read_b64_tr_b16 v[32:33], v1 offset:20640
  v_mfma_f32_16x16x32_bf16 v[196:199], v[36:39], a[244:247], v[196:199]
  ds_read_b64_tr_b16 v[34:35], v1 offset:21152
  s_waitcnt lgkmcnt(4)
  v_mfma_f32_16x16x32_bf16 v[200:203], v[36:39], a[248:251], v[200:203]
  buffer_load_dwordx4 a[60:63], v11, s[20:23], s57 offen offset:3072 sc1
  v_mfma_f32_16x16x32_bf16 v[204:207], v[36:39], a[252:255], v[204:207]
  s_add_u32 s57, s40, 27340800
  v_mfma_f32_16x16x32_bf16 v[208:211], v[40:43], a[240:243], v[208:211]
  ds_read_b64_tr_b16 v[36:37], v1 offset:20648
  v_mfma_f32_16x16x32_bf16 v[212:215], v[40:43], a[244:247], v[212:215]
  ds_read_b64_tr_b16 v[38:39], v1 offset:21160
  s_waitcnt lgkmcnt(4)
  v_mfma_f32_16x16x32_bf16 v[216:219], v[40:43], a[248:251], v[216:219]
  buffer_load_dwordx4 a[64:67], v11, s[20:23], s57 offen offset:0 sc1
  v_mfma_f32_16x16x32_bf16 v[220:223], v[40:43], a[252:255], v[220:223]
  v_mfma_f32_16x16x32_bf16 v[224:227], v[44:47], a[240:243], v[224:227]
  ds_read_b64_tr_b16 v[40:41], v2 offset:20640
  v_mfma_f32_16x16x32_bf16 v[228:231], v[44:47], a[244:247], v[228:231]
  ds_read_b64_tr_b16 v[42:43], v2 offset:21152
  s_waitcnt lgkmcnt(4)
  v_mfma_f32_16x16x32_bf16 v[232:235], v[44:47], a[248:251], v[232:235]
  v_mfma_f32_16x16x32_bf16 v[236:239], v[44:47], a[252:255], v[236:239]
  buffer_load_dwordx4 a[68:71], v11, s[20:23], s57 offen offset:1024 sc1
  v_mfma_f32_16x16x32_bf16 v[176:179], v[32:35], a[112:115], v[176:179]
  ds_read_b64_tr_b16 v[44:45], v2 offset:20648
  v_mfma_f32_16x16x32_bf16 v[180:183], v[32:35], a[116:119], v[180:183]
  ds_read_b64_tr_b16 v[46:47], v2 offset:21160
  s_waitcnt lgkmcnt(4)
  v_mfma_f32_16x16x32_bf16 v[184:187], v[32:35], a[120:123], v[184:187]
  buffer_load_dwordx4 a[72:75], v11, s[20:23], s57 offen offset:2048 sc1
  v_mfma_f32_16x16x32_bf16 v[188:191], v[32:35], a[124:127], v[188:191]
  v_mfma_f32_16x16x32_bf16 v[192:195], v[36:39], a[112:115], v[192:195]
  ds_read_b64_tr_b16 v[32:33], v1 offset:24768
  v_mfma_f32_16x16x32_bf16 v[196:199], v[36:39], a[116:119], v[196:199]
  ds_read_b64_tr_b16 v[34:35], v1 offset:25280
  s_waitcnt lgkmcnt(4)
  v_mfma_f32_16x16x32_bf16 v[200:203], v[36:39], a[120:123], v[200:203]
  buffer_load_dwordx4 a[76:79], v11, s[20:23], s57 offen offset:3072 sc1
  v_mfma_f32_16x16x32_bf16 v[204:207], v[36:39], a[124:127], v[204:207]
  s_waitcnt vmcnt(18)
  v_sub_u32 v19, v19, v30
  v_cmp_gt_u32 vcc, 7, v19
  v_mfma_f32_16x16x32_bf16 v[208:211], v[40:43], a[112:115], v[208:211]
  ds_read_b64_tr_b16 v[36:37], v1 offset:24776
  s_nop 0
  v_mfma_f32_16x16x32_bf16 v[212:215], v[40:43], a[116:119], v[212:215]
  ds_read_b64_tr_b16 v[38:39], v1 offset:25288
  s_waitcnt lgkmcnt(4)
  v_mfma_f32_16x16x32_bf16 v[216:219], v[40:43], a[120:123], v[216:219]
  s_cbranch_vccnz Lslow7
Lback7:
  s_add_u32 s56, s40, 27271168
  v_mfma_f32_16x16x32_bf16 v[220:223], v[40:43], a[124:127], v[220:223]
  v_mfma_f32_16x16x32_bf16 v[224:227], v[44:47], a[112:115], v[224:227]
  ds_read_b64_tr_b16 v[40:41], v2 offset:24768
  v_mfma_f32_16x16x32_bf16 v[228:231], v[44:47], a[116:119], v[228:231]
  ds_read_b64_tr_b16 v[42:43], v2 offset:25280
  s_waitcnt lgkmcnt(4)
  v_mfma_f32_16x16x32_bf16 v[232:235], v[44:47], a[120:123], v[232:235]
  buffer_load_dwordx4 a[80:83], v11, s[20:23], s56 offen offset:0 sc1
  v_mfma_f32_16x16x32_bf16 v[236:239], v[44:47], a[124:127], v[236:239]
  v_mfma_f32_16x16x32_bf16 v[176:179], v[32:35], a[128:131], v[176:179]
  ds_read_b64_tr_b16 v[44:45], v2 offset:24776
  s_add_u32 s54, s72, 65536
  v_mfma_f32_16x16x32_bf16 v[180:183], v[32:35], a[132:135], v[180:183]
  ds_read_b64_tr_b16 v[46:47], v2 offset:25288
  s_waitcnt vmcnt(16) lgkmcnt(4)
  v_mfma_f32_16x16x32_bf16 v[184:187], v[32:35], a[136:139], v[184:187]
  s_barrier
  s_add_u32 s51, s35, 2875520
  s_add_u32 m0, s36, 12384
  v_mfma_f32_16x16x32_bf16 v[188:191], v[32:35], a[140:143], v[188:191]
  buffer_load_dwordx4 v4, s[8:11], s51 offen lds
  v_mfma_f32_16x16x32_bf16 v[192:195], v[36:39], a[128:131], v[192:195]
  ds_read_b64_tr_b16 v[32:33], v1 offset:28896
  s_add_u32 s50, s35, 3195008
  v_mfma_f32_16x16x32_bf16 v[196:199], v[36:39], a[132:135], v[196:199]
  ds_read_b64_tr_b16 v[34:35], v1 offset:29408
  s_waitcnt lgkmcnt(4)
  v_mfma_f32_16x16x32_bf16 v[200:203], v[36:39], a[136:139], v[200:203]
  s_add_u32 m0, s36, 16512
  v_mfma_f32_16x16x32_bf16 v[204:207], v[36:39], a[140:143], v[204:207]
  buffer_load_dwordx4 v4, s[8:11], s50 offen lds
  v_mfma_f32_16x16x32_bf16 v[208:211], v[40:43], a[128:131], v[208:211]
  ds_read_b64_tr_b16 v[36:37], v1 offset:28904
  s_add_u32 s51, s35, 3461376
  v_mfma_f32_16x16x32_bf16 v[212:215], v[40:43], a[132:135], v[212:215]
  ds_read_b64_tr_b16 v[38:39], v1 offset:29416
  s_waitcnt lgkmcnt(4)
  v_mfma_f32_16x16x32_bf16 v[216:219], v[40:43], a[136:139], v[216:219]
  s_add_u32 m0, s36, 20640
  v_mfma_f32_16x16x32_bf16 v[220:223], v[40:43], a[140:143], v[220:223]
  buffer_load_dwordx4 v4, s[8:11], s51 offen lds
  v_mfma_f32_16x16x32_bf16 v[224:227], v[44:47], a[128:131], v[224:227]
  ds_read_b64_tr_b16 v[40:41], v2 offset:28896
  s_waitcnt vmcnt(15)
  v_mfma_f32_16x16x32_bf16 v[228:231], v[44:47], a[132:135], v[228:231]
  ds_read_b64_tr_b16 v[42:43], v2 offset:29408
  s_waitcnt lgkmcnt(4)
  v_mfma_f32_16x16x32_bf16 v[232:235], v[44:47], a[136:139], v[232:235]
  buffer_load_dwordx4 a[84:87], v11, s[20:23], s56 offen offset:1024 sc1
  v_add_u32 v17, 8, v30
  v_mfma_f32_16x16x32_bf16 v[236:239], v[44:47], a[140:143], v[236:239]
  buffer_store_dword v17, v16, s[20:23], 0 offen sc1
  v_mfma_f32_16x16x32_bf16 v[176:179], v[32:35], a[144:147], v[176:179]
  ds_read_b64_tr_b16 v[44:45], v2 offset:28904
  v_mfma_f32_16x16x32_bf16 v[180:183], v[32:35], a[148:151], v[180:183]
  ds_read_b64_tr_b16 v[46:47], v2 offset:29416
  s_waitcnt lgkmcnt(4)
  v_mfma_f32_16x16x32_bf16 v[184:187], v[32:35], a[152:155], v[184:187]
  buffer_load_dwordx4 a[88:91], v11, s[20:23], s56 offen offset:2048 sc1
  v_mfma_f32_16x16x32_bf16 v[188:191], v[32:35], a[156:159], v[188:191]
  v_mfma_f32_16x16x32_bf16 v[192:195], v[36:39], a[144:147], v[192:195]
  ds_read_b64_tr_b16 v[32:33], v3 offset:33024
  v_mfma_f32_16x16x32_bf16 v[196:199], v[36:39], a[148:151], v[196:199]
  ds_read_b64_tr_b16 v[34:35], v3 offset:33280
  s_waitcnt lgkmcnt(4)
  v_mfma_f32_16x16x32_bf16 v[200:203], v[36:39], a[152:155], v[200:203]
  buffer_load_dwordx4 a[92:95], v11, s[20:23], s56 offen offset:3072 sc1
  v_mfma_f32_16x16x32_bf16 v[204:207], v[36:39], a[156:159], v[204:207]
  s_add_u32 s56, s40, 27295744
  v_mfma_f32_16x16x32_bf16 v[208:211], v[40:43], a[144:147], v[208:211]
  ds_read_b64_tr_b16 v[36:37], v3 offset:34048
  v_mfma_f32_16x16x32_bf16 v[212:215], v[40:43], a[148:151], v[212:215]
  ds_read_b64_tr_b16 v[38:39], v3 offset:34304
  s_waitcnt lgkmcnt(4)
  v_mfma_f32_16x16x32_bf16 v[216:219], v[40:43], a[152:155], v[216:219]
  buffer_load_dwordx4 a[96:99], v11, s[20:23], s56 offen offset:0 sc1
  v_mfma_f32_16x16x32_bf16 v[220:223], v[40:43], a[156:159], v[220:223]
  v_mfma_f32_16x16x32_bf16 v[224:227], v[44:47], a[144:147], v[224:227]
  ds_read_b64_tr_b16 v[40:41], v3 offset:35072
  v_mfma_f32_16x16x32_bf16 v[228:231], v[44:47], a[148:151], v[228:231]
  ds_read_b64_tr_b16 v[42:43], v3 offset:35328
  s_waitcnt lgkmcnt(4)
  v_mfma_f32_16x16x32_bf16 v[232:235], v[44:47], a[152:155], v[232:235]
  buffer_load_dwordx4 a[100:103], v11, s[20:23], s56 offen offset:1024 sc1
  v_mfma_f32_16x16x32_bf16 v[236:239], v[44:47], a[156:159], v[236:239]
  v_mfma_f32_16x16x32_bf16 v[240:243], v[32:35], a[208:211], v[240:243]
  ds_read_b64_tr_b16 v[44:45], v3 offset:36096
  v_mfma_f32_16x16x32_bf16 v[244:247], v[32:35], a[212:215], v[244:247]
  ds_read_b64_tr_b16 v[46:47], v3 offset:36352
  s_waitcnt lgkmcnt(4)
  v_mfma_f32_16x16x32_bf16 v[248:251], v[32:35], a[216:219], v[248:251]
  buffer_load_dwordx4 a[104:107], v11, s[20:23], s56 offen offset:2048 sc1
  v_mfma_f32_16x16x32_bf16 v[252:255], v[32:35], a[220:223], v[252:255]
  buffer_load_dword v14, off, s[64:67], s54
  v_mfma_f32_16x16x32_bf16 v[240:243], v[36:39], a[224:227], v[240:243]
  ds_read_b64_tr_b16 v[32:33], v3 offset:37120
  v_mfma_f32_16x16x32_bf16 v[244:247], v[36:39], a[228:231], v[244:247]
  ds_read_b64_tr_b16 v[34:35], v3 offset:37376
  s_waitcnt lgkmcnt(4)
  v_mfma_f32_16x16x32_bf16 v[248:251], v[36:39], a[232:235], v[248:251]
  buffer_load_dwordx4 a[108:111], v11, s[20:23], s56 offen offset:3072 sc1
  v_mfma_f32_16x16x32_bf16 v[252:255], v[36:39], a[236:239], v[252:255]
  v_mfma_f32_16x16x32_bf16 v[240:243], v[40:43], a[240:243], v[240:243]
  ds_read_b64_tr_b16 v[36:37], v3 offset:38144
  v_mfma_f32_16x16x32_bf16 v[244:247], v[40:43], a[244:247], v[244:247]
  ds_read_b64_tr_b16 v[38:39], v3 offset:38400
  s_waitcnt lgkmcnt(4)
  v_mfma_f32_16x16x32_bf16 v[248:251], v[40:43], a[248:251], v[248:251]
  v_mfma_f32_16x16x32_bf16 v[252:255], v[40:43], a[252:255], v[252:255]
  v_mfma_f32_16x16x32_bf16 v[240:243], v[44:47], a[112:115], v[240:243]
  ds_read_b64_tr_b16 v[40:41], v1 offset:41216
  v_mfma_f32_16x16x32_bf16 v[244:247], v[44:47], a[116:119], v[244:247]
  ds_read_b64_tr_b16 v[42:43], v1 offset:41728
  s_waitcnt lgkmcnt(4)
  v_mfma_f32_16x16x32_bf16 v[248:251], v[44:47], a[120:123], v[248:251]
  v_mfma_f32_16x16x32_bf16 v[252:255], v[44:47], a[124:127], v[252:255]
  v_mfma_f32_16x16x32_bf16 v[240:243], v[32:35], a[128:131], v[240:243]
  ds_read_b64_tr_b16 v[44:45], v1 offset:41224
  v_mfma_f32_16x16x32_bf16 v[244:247], v[32:35], a[132:135], v[244:247]
  ds_read_b64_tr_b16 v[46:47], v1 offset:41736
  s_waitcnt vmcnt(21) lgkmcnt(4)
  v_mfma_f32_16x16x32_bf16 v[248:251], v[32:35], a[136:139], v[248:251]
  s_barrier
  s_add_u32 s50, s35, 3780864
  s_add_u32 m0, s36, 24768
  v_mfma_f32_16x16x32_bf16 v[252:255], v[32:35], a[140:143], v[252:255]
  buffer_load_dwordx4 v4, s[8:11], s50 offen lds
  v_mfma_f32_16x16x32_bf16 v[240:243], v[36:39], a[144:147], v[240:243]
  ds_read_b64_tr_b16 v[32:33], v2 offset:41216
  s_add_u32 s51, s35, 2875648
  v_mfma_f32_16x16x32_bf16 v[244:247], v[36:39], a[148:151], v[244:247]
  ds_read_b64_tr_b16 v[34:35], v2 offset:41728
  s_waitcnt vmcnt(18) lgkmcnt(4)
  v_mfma_f32_16x16x32_bf16 v[248:251], v[36:39], a[152:155], v[248:251]
  s_add_u32 m0, s36, 28896
  v_mfma_f32_16x16x32_bf16 v[252:255], v[36:39], a[156:159], v[252:255]
  buffer_load_dwordx4 v4, s[8:11], s51 offen lds
  v_mfma_f32_16x16x32_bf16 v[48:51], v[40:43], a[48:51], v[48:51]
  ds_read_b64_tr_b16 v[36:37], v2 offset:41224
  s_add_u32 s50, s35, 3195136
  v_mfma_f32_16x16x32_bf16 v[52:55], v[40:43], a[52:55], v[52:55]
  ds_read_b64_tr_b16 v[38:39], v2 offset:41736
  s_waitcnt lgkmcnt(4)
  v_mfma_f32_16x16x32_bf16 v[56:59], v[40:43], a[56:59], v[56:59]
  s_add_u32 m0, s36, 33024
  v_mfma_f32_16x16x32_bf16 v[60:63], v[40:43], a[60:63], v[60:63]
  buffer_load_dwordx4 v4, s[8:11], s50 offen lds
  v_mfma_f32_16x16x32_bf16 v[64:67], v[44:47], a[48:51], v[64:67]
  ds_read_b64_tr_b16 v[40:41], v1 offset:45344
  v_mfma_f32_16x16x32_bf16 v[68:71], v[44:47], a[52:55], v[68:71]
  ds_read_b64_tr_b16 v[42:43], v1 offset:45856
  s_waitcnt lgkmcnt(4)
  v_mfma_f32_16x16x32_bf16 v[72:75], v[44:47], a[56:59], v[72:75]
  v_mfma_f32_16x16x32_bf16 v[76:79], v[44:47], a[60:63], v[76:79]
  v_mfma_f32_16x16x32_bf16 v[80:83], v[32:35], a[48:51], v[80:83]
  ds_read_b64_tr_b16 v[44:45], v1 offset:45352
  v_mfma_f32_16x16x32_bf16 v[84:87], v[32:35], a[52:55], v[84:87]
  ds_read_b64_tr_b16 v[46:47], v1 offset:45864
  s_waitcnt lgkmcnt(4)
  v_mfma_f32_16x16x32_bf16 v[88:91], v[32:35], a[56:59], v[88:91]
  v_mfma_f32_16x16x32_bf16 v[92:95], v[32:35], a[60:63], v[92:95]
  v_mfma_f32_16x16x32_bf16 v[96:99], v[36:39], a[48:51], v[96:99]
  ds_read_b64_tr_b16 v[32:33], v2 offset:45344
  v_mfma_f32_16x16x32_bf16 v[100:103], v[36:39], a[52:55], v[100:103]
  ds_read_b64_tr_b16 v[34:35], v2 offset:45856
  s_waitcnt vmcnt(16) lgkmcnt(4)
  v_mfma_f32_16x16x32_bf16 v[104:107], v[36:39], a[56:59], v[104:107]
  v_mfma_f32_16x16x32_bf16 v[108:111], v[36:39], a[60:63], v[108:111]
  v_mfma_f32_16x16x32_bf16 v[48:51], v[40:43], a[64:67], v[48:51]
  ds_read_b64_tr_b16 v[36:37], v2 offset:45352
  v_mfma_f32_16x16x32_bf16 v[52:55], v[40:43], a[68:71], v[52:55]
  ds_read_b64_tr_b16 v[38:39], v2 offset:45864
  s_waitcnt lgkmcnt(4)
  v_mfma_f32_16x16x32_bf16 v[56:59], v[40:43], a[72:75], v[56:59]
  v_mfma_f32_16x16x32_bf16 v[60:63], v[40:43], a[76:79], v[60:63]
  v_mfma_f32_16x16x32_bf16 v[64:67], v[44:47], a[64:67], v[64:67]
  ds_read_b64_tr_b16 v[40:41], v1 offset:49472
  v_mfma_f32_16x16x32_bf16 v[68:71], v[44:47], a[68:71], v[68:71]
  ds_read_b64_tr_b16 v[42:43], v1 offset:49984
  s_waitcnt lgkmcnt(4)
  v_mfma_f32_16x16x32_bf16 v[72:75], v[44:47], a[72:75], v[72:75]
  v_mfma_f32_16x16x32_bf16 v[76:79], v[44:47], a[76:79], v[76:79]
  v_mfma_f32_16x16x32_bf16 v[80:83], v[32:35], a[64:67], v[80:83]
  ds_read_b64_tr_b16 v[44:45], v1 offset:49480
  v_mfma_f32_16x16x32_bf16 v[84:87], v[32:35], a[68:71], v[84:87]
  ds_read_b64_tr_b16 v[46:47], v1 offset:49992
  s_waitcnt lgkmcnt(4)
  v_mfma_f32_16x16x32_bf16 v[88:91], v[32:35], a[72:75], v[88:91]
  v_mfma_f32_16x16x32_bf16 v[92:95], v[32:35], a[76:79], v[92:95]
  v_mfma_f32_16x16x32_bf16 v[96:99], v[36:39], a[64:67], v[96:99]
  ds_read_b64_tr_b16 v[32:33], v2 offset:49472
  v_mfma_f32_16x16x32_bf16 v[100:103], v[36:39], a[68:71], v[100:103]
  ds_read_b64_tr_b16 v[34:35], v2 offset:49984
  s_waitcnt vmcnt(8) lgkmcnt(4)
  v_mfma_f32_16x16x32_bf16 v[104:107], v[36:39], a[72:75], v[104:107]
  v_mfma_f32_16x16x32_bf16 v[108:111], v[36:39], a[76:79], v[108:111]
  v_mfma_f32_16x16x32_bf16 v[48:51], v[40:43], a[80:83], v[48:51]
  ds_read_b64_tr_b16 v[36:37], v2 offset:49480
  v_mfma_f32_16x16x32_bf16 v[52:55], v[40:43], a[84:87], v[52:55]
  ds_read_b64_tr_b16 v[38:39], v2 offset:49992
  s_waitcnt lgkmcnt(4)
  v_mfma_f32_16x16x32_bf16 v[56:59], v[40:43], a[88:91], v[56:59]
  v_mfma_f32_16x16x32_bf16 v[60:63], v[40:43], a[92:95], v[60:63]
  v_mfma_f32_16x16x32_bf16 v[64:67], v[44:47], a[80:83], v[64:67]
  ds_read_b64_tr_b16 v[40:41], v1 offset:0
  v_mfma_f32_16x16x32_bf16 v[68:71], v[44:47], a[84:87], v[68:71]
  ds_read_b64_tr_b16 v[42:43], v1 offset:512
  s_waitcnt lgkmcnt(4)
  v_mfma_f32_16x16x32_bf16 v[72:75], v[44:47], a[88:91], v[72:75]
  v_mfma_f32_16x16x32_bf16 v[76:79], v[44:47], a[92:95], v[76:79]
  v_mfma_f32_16x16x32_bf16 v[80:83], v[32:35], a[80:83], v[80:83]
  ds_read_b64_tr_b16 v[44:45], v1 offset:8
  v_mfma_f32_16x16x32_bf16 v[84:87], v[32:35], a[84:87], v[84:87]
  ds_read_b64_tr_b16 v[46:47], v1 offset:520
  s_waitcnt lgkmcnt(4)
  v_mfma_f32_16x16x32_bf16 v[88:91], v[32:35], a[88:91], v[88:91]
  s_barrier
  s_lshr_b32 s51, 0x3c364741, s37
  s_and_b32 s51, s51, 0xff
  v_mfma_f32_16x16x32_bf16 v[92:95], v[32:35], a[92:95], v[92:95]
  s_mul_i32 s51, s51, 53248
  s_add_u32 s51, s51, s38
  s_add_u32 m0, s39, 37152
  v_mfma_f32_16x16x32_bf16 v[96:99], v[36:39], a[80:83], v[96:99]
  ds_read_b64_tr_b16 v[32:33], v2 offset:0
  v_mfma_f32_16x16x32_bf16 v[100:103], v[36:39], a[84:87], v[100:103]
  ds_read_b64_tr_b16 v[34:35], v2 offset:512
  s_waitcnt vmcnt(3) lgkmcnt(4)
  v_mfma_f32_16x16x32_bf16 v[104:107], v[36:39], a[88:91], v[104:107]
  buffer_load_dwordx4 v6, s[8:11], s51 offen lds
  v_mfma_f32_16x16x32_bf16 v[108:111], v[36:39], a[92:95], v[108:111]
  s_add_u32 s50, s35, 3514368
  s_add_u32 m0, s36, 41248
  v_mfma_f32_16x16x32_bf16 v[48:51], v[40:43], a[96:99], v[48:51]
  ds_read_b64_tr_b16 v[36:37], v2 offset:8
  v_mfma_f32_16x16x32_bf16 v[52:55], v[40:43], a[100:103], v[52:55]
  ds_read_b64_tr_b16 v[38:39], v2 offset:520
  s_waitcnt lgkmcnt(4)
  v_mfma_f32_16x16x32_bf16 v[56:59], v[40:43], a[104:107], v[56:59]
  buffer_load_dwordx4 v4, s[8:11], s50 offen lds
  v_mfma_f32_16x16x32_bf16 v[60:63], v[40:43], a[108:111], v[60:63]
  s_add_u32 s51, s35, 3833856
  s_add_u32 m0, s36, 45376
  v_mfma_f32_16x16x32_bf16 v[64:67], v[44:47], a[96:99], v[64:67]
  ds_read_b64_tr_b16 v[40:41], v1 offset:4128
  v_mfma_f32_16x16x32_bf16 v[68:71], v[44:47], a[100:103], v[68:71]
  ds_read_b64_tr_b16 v[42:43], v1 offset:4640
  s_waitcnt lgkmcnt(4)
  v_mfma_f32_16x16x32_bf16 v[72:75], v[44:47], a[104:107], v[72:75]
  buffer_load_dwordx4 v4, s[8:11], s51 offen lds
  v_mfma_f32_16x16x32_bf16 v[76:79], v[44:47], a[108:111], v[76:79]
  s_add_u32 s50, s35, 2928640
  s_add_u32 m0, s36, 49504
  v_mfma_f32_16x16x32_bf16 v[80:83], v[32:35], a[96:99], v[80:83]
  ds_read_b64_tr_b16 v[44:45], v1 offset:4136
  v_mfma_f32_16x16x32_bf16 v[84:87], v[32:35], a[100:103], v[84:87]
  ds_read_b64_tr_b16 v[46:47], v1 offset:4648
  s_waitcnt lgkmcnt(4)
  v_mfma_f32_16x16x32_bf16 v[88:91], v[32:35], a[104:107], v[88:91]
  buffer_load_dwordx4 v4, s[8:11], s50 offen lds
  v_mfma_f32_16x16x32_bf16 v[92:95], v[32:35], a[108:111], v[92:95]
  v_mfma_f32_16x16x32_bf16 v[96:99], v[36:39], a[96:99], v[96:99]
  ds_read_b64_tr_b16 v[32:33], v2 offset:4128
  v_mfma_f32_16x16x32_bf16 v[100:103], v[36:39], a[100:103], v[100:103]
  ds_read_b64_tr_b16 v[34:35], v2 offset:4640
  s_waitcnt lgkmcnt(4)
  v_mfma_f32_16x16x32_bf16 v[104:107], v[36:39], a[104:107], v[104:107]
  ds_read_b128 v[20:23], v15 offset:1664
  v_mfma_f32_16x16x32_bf16 v[108:111], v[36:39], a[108:111], v[108:111]
  ds_read_b128 v[24:27], v15 offset:1728
  v_mfma_f32_16x16x32_bf16 v[112:115], v[40:43], a[48:51], v[112:115]
  ds_read_b64_tr_b16 v[36:37], v2 offset:4136
  s_add_u32 s56, s40, 27320320
  v_mfma_f32_16x16x32_bf16 v[116:119], v[40:43], a[52:55], v[116:119]
  ds_read_b64_tr_b16 v[38:39], v2 offset:4648
  s_waitcnt lgkmcnt(6)
  v_mfma_f32_16x16x32_bf16 v[120:123], v[40:43], a[56:59], v[120:123]
  v_mfma_f32_16x16x32_bf16 v[124:127], v[40:43], a[60:63], v[124:127]
  v_mfma_f32_16x16x32_bf16 v[128:131], v[44:47], a[48:51], v[128:131]
  ds_read_b64_tr_b16 v[40:41], v1 offset:8256
  s_waitcnt lgkmcnt(4)
  v_mfma_f32_16x16x32_bf16 v[132:135], v[44:47], a[52:55], v[132:135]
  ds_read_b64_tr_b16 v[42:43], v1 offset:8768
  v_add_f32 v48, v48, v20
  v_mfma_f32_16x16x32_bf16 v[136:139], v[44:47], a[56:59], v[136:139]
  buffer_load_dwordx4 a[208:211], v11, s[20:23], s56 offen offset:0 sc1
  v_add_f32 v49, v49, v21
  v_mfma_f32_16x16x32_bf16 v[140:143], v[44:47], a[60:63], v[140:143]
  v_add_f32 v50, v50, v22
  v_add_f32 v51, v51, v23
  v_mfma_f32_16x16x32_bf16 v[144:147], v[32:35], a[48:51], v[144:147]
  ds_read_b64_tr_b16 v[44:45], v1 offset:8264
  v_add_f32 v52, v52, v20
  v_mfma_f32_16x16x32_bf16 v[148:151], v[32:35], a[52:55], v[148:151]
  ds_read_b64_tr_b16 v[46:47], v1 offset:8776
  v_add_f32 v53, v53, v21
  v_mfma_f32_16x16x32_bf16 v[152:155], v[32:35], a[56:59], v[152:155]
  v_add_f32 v54, v54, v22
  v_add_f32 v55, v55, v23
  v_mfma_f32_16x16x32_bf16 v[156:159], v[32:35], a[60:63], v[156:159]
  s_waitcnt lgkmcnt(4)
  v_add_f32 v56, v56, v20
  v_add_f32 v57, v57, v21
  v_mfma_f32_16x16x32_bf16 v[160:163], v[36:39], a[48:51], v[160:163]
  ds_read_b64_tr_b16 v[32:33], v2 offset:8256
  v_add_f32 v58, v58, v22
  v_mfma_f32_16x16x32_bf16 v[164:167], v[36:39], a[52:55], v[164:167]
  ds_read_b64_tr_b16 v[34:35], v2 offset:8768
  v_add_f32 v59, v59, v23
  v_mfma_f32_16x16x32_bf16 v[168:171], v[36:39], a[56:59], v[168:171]
  buffer_load_dwordx4 a[212:215], v11, s[20:23], s56 offen offset:1024 sc1
  v_add_f32 v60, v60, v20
  v_mfma_f32_16x16x32_bf16 v[172:175], v[36:39], a[60:63], v[172:175]
  s_waitcnt lgkmcnt(4)
  v_add_f32 v61, v61, v21
  v_add_f32 v62, v62, v22
  v_mfma_f32_16x16x32_bf16 v[112:115], v[40:43], a[64:67], v[112:115]
  ds_read_b64_tr_b16 v[36:37], v2 offset:8264
  v_add_f32 v63, v63, v23
  v_mfma_f32_16x16x32_bf16 v[116:119], v[40:43], a[68:71], v[116:119]
  ds_read_b64_tr_b16 v[38:39], v2 offset:8776
  v_add_f32 v64, v64, v24
  v_mfma_f32_16x16x32_bf16 v[120:123], v[40:43], a[72:75], v[120:123]
  buffer_load_dwordx4 a[216:219], v11, s[20:23], s56 offen offset:2048 sc1
  v_add_f32 v65, v65, v25
  v_mfma_f32_16x16x32_bf16 v[124:127], v[40:43], a[76:79], v[124:127]
  s_waitcnt lgkmcnt(4)
  ds_read_b128 v[20:23], v15 offset:1792
  v_mfma_f32_16x16x32_bf16 v[128:131], v[44:47], a[64:67], v[128:131]
  ds_read_b64_tr_b16 v[40:41], v1 offset:12384
  v_add_f32 v66, v66, v26
  v_mfma_f32_16x16x32_bf16 v[132:135], v[44:47], a[68:71], v[132:135]
  ds_read_b64_tr_b16 v[42:43], v1 offset:12896
  v_add_f32 v67, v67, v27
  v_mfma_f32_16x16x32_bf16 v[136:139], v[44:47], a[72:75], v[136:139]
  buffer_load_dwordx4 a[220:223], v11, s[20:23], s56 offen offset:3072 sc1
  v_add_f32 v68, v68, v24
  v_mfma_f32_16x16x32_bf16 v[140:143], v[44:47], a[76:79], v[140:143]
  s_waitcnt lgkmcnt(5)
  s_add_u32 s56, s40, 27344896
  v_add_f32 v69, v69, v25
  v_mfma_f32_16x16x32_bf16 v[144:147], v[32:35], a[64:67], v[144:147]
  ds_read_b64_tr_b16 v[44:45], v1 offset:12392
  v_add_f32 v70, v70, v26
  v_mfma_f32_16x16x32_bf16 v[148:151], v[32:35], a[68:71], v[148:151]
  ds_read_b64_tr_b16 v[46:47], v1 offset:12904
  s_waitcnt vmcnt(10) lgkmcnt(5)
  v_mfma_f32_16x16x32_bf16 v[152:155], v[32:35], a[72:75], v[152:155]
  s_barrier
  s_add_u32 s51, s35, 3514496
  s_add_u32 m0, s36, 0
  v_mfma_f32_16x16x32_bf16 v[156:159], v[32:35], a[76:79], v[156:159]
  buffer_load_dwordx4 v4, s[8:11], s51 offen lds
  v_mfma_f32_16x16x32_bf16 v[160:163], v[36:39], a[64:67], v[160:163]
  ds_read_b64_tr_b16 v[32:33], v2 offset:12384
  s_add_u32 s50, s35, 3833984
  v_mfma_f32_16x16x32_bf16 v[164:167], v[36:39], a[68:71], v[164:167]
  ds_read_b64_tr_b16 v[34:35], v2 offset:12896
  s_add_u32 m0, s36, 4128
  v_mfma_f32_16x16x32_bf16 v[168:171], v[36:39], a[72:75], v[168:171]
  buffer_load_dwordx4 v4, s[8:11], s50 offen lds
  v_mfma_f32_16x16x32_bf16 v[172:175], v[36:39], a[76:79], v[172:175]
  s_waitcnt lgkmcnt(4)
  s_add_u32 s51, s35, 2928768
  s_add_u32 m0, s36, 8256
  v_mfma_f32_16x16x32_bf16 v[112:115], v[40:43], a[80:83], v[112:115]
  ds_read_b64_tr_b16 v[36:37], v2 offset:12392
  v_add_f32 v71, v71, v27
  v_mfma_f32_16x16x32_bf16 v[116:119], v[40:43], a[84:87], v[116:119]
  ds_read_b64_tr_b16 v[38:39], v2 offset:12904
  v_add_f32 v72, v72, v24
  v_mfma_f32_16x16x32_bf16 v[120:123], v[40:43], a[88:91], v[120:123]
  buffer_load_dwordx4 v4, s[8:11], s51 offen lds
  v_mfma_f32_16x16x32_bf16 v[124:127], v[40:43], a[92:95], v[124:127]
  s_waitcnt lgkmcnt(4)
  v_add_f32 v73, v73, v25
  v_add_f32 v74, v74, v26
  v_mfma_f32_16x16x32_bf16 v[128:131], v[44:47], a[80:83], v[128:131]
  ds_read_b64_tr_b16 v[40:41], v1 offset:16512
  v_add_f32 v75, v75, v27
  v_mfma_f32_16x16x32_bf16 v[132:135], v[44:47], a[84:87], v[132:135]
  ds_read_b64_tr_b16 v[42:43], v1 offset:17024
  v_add_f32 v76, v76, v24
  v_mfma_f32_16x16x32_bf16 v[136:139], v[44:47], a[88:91], v[136:139]
  buffer_load_dwordx4 a[224:227], v11, s[20:23], s56 offen offset:0 sc1
  v_add_f32 v77, v77, v25
  v_mfma_f32_16x16x32_bf16 v[140:143], v[44:47], a[92:95], v[140:143]
  s_waitcnt lgkmcnt(4)
  v_add_f32 v78, v78, v26
  v_add_f32 v79, v79, v27
  v_mfma_f32_16x16x32_bf16 v[144:147], v[32:35], a[80:83], v[144:147]
  ds_read_b64_tr_b16 v[44:45], v1 offset:16520
  v_add_f32 v80, v80, v20
  v_mfma_f32_16x16x32_bf16 v[148:151], v[32:35], a[84:87], v[148:151]
  ds_read_b64_tr_b16 v[46:47], v1 offset:17032
  v_add_f32 v81, v81, v21
  v_mfma_f32_16x16x32_bf16 v[152:155], v[32:35], a[88:91], v[152:155]
  buffer_load_dwordx4 a[228:231], v11, s[20:23], s56 offen offset:1024 sc1
  v_add_f32 v82, v82, v22
  v_mfma_f32_16x16x32_bf16 v[156:159], v[32:35], a[92:95], v[156:159]
  s_waitcnt lgkmcnt(4)
  ds_read_b128 v[24:27], v15 offset:1856
  v_mfma_f32_16x16x32_bf16 v[160:163], v[36:39], a[80:83], v[160:163]
  ds_read_b64_tr_b16 v[32:33], v2 offset:16512
  v_add_f32 v83, v83, v23
  v_mfma_f32_16x16x32_bf16 v[164:167], v[36:39], a[84:87], v[164:167]
  ds_read_b64_tr_b16 v[34:35], v2 offset:17024
  v_add_f32 v84, v84, v20
  v_mfma_f32_16x16x32_bf16 v[168:171], v[36:39], a[88:91], v[168:171]
  v_add_f32 v85, v85, v21
  v_add_f32 v86, v86, v22
  v_mfma_f32_16x16x32_bf16 v[172:175], v[36:39], a[92:95], v[172:175]
  s_waitcnt lgkmcnt(5)
  v_add_f32 v87, v87, v23
  v_add_f32 v88, v88, v20
  v_mfma_f32_16x16x32_bf16 v[112:115], v[40:43], a[96:99], v[112:115]
  ds_read_b64_tr_b16 v[36:37], v2 offset:16520
  v_add_f32 v89, v89, v21
  v_mfma_f32_16x16x32_bf16 v[116:119], v[40:43], a[100:103], v[116:119]
  ds_read_b64_tr_b16 v[38:39], v2 offset:17032
  v_add_f32 v90, v90, v22
  v_mfma_f32_16x16x32_bf16 v[120:123], v[40:43], a[104:107], v[120:123]
  buffer_load_dwordx4 a[232:235], v11, s[20:23], s56 offen offset:2048 sc1
  v_add_f32 v91, v91, v23
  v_mfma_f32_16x16x32_bf16 v[124:127], v[40:43], a[108:111], v[124:127]
  s_waitcnt lgkmcnt(5)
  v_add_f32 v92, v92, v20
  v_add_f32 v93, v93, v21
  v_mfma_f32_16x16x32_bf16 v[128:131], v[44:47], a[96:99], v[128:131]
  ds_read_b64_tr_b16 v[40:41], v1 offset:20640
  v_add_f32 v94, v94, v22
  v_mfma_f32_16x16x32_bf16 v[132:135], v[44:47], a[100:103], v[132:135]
  ds_read_b64_tr_b16 v[42:43], v1 offset:21152
  v_add_f32 v95, v95, v23
  v_mfma_f32_16x16x32_bf16 v[136:139], v[44:47], a[104:107], v[136:139]
  buffer_load_dwordx4 a[236:239], v11, s[20:23], s56 offen offset:3072 sc1
  v_mfma_f32_16x16x32_bf16 v[140:143], v[44:47], a[108:111], v[140:143]
  s_waitcnt lgkmcnt(4)
  s_add_u32 s57, s40, 27275264
  v_add_f32 v96, v96, v24
  v_mfma_f32_16x16x32_bf16 v[144:147], v[32:35], a[96:99], v[144:147]
  ds_read_b64_tr_b16 v[44:45], v1 offset:20648
  v_add_f32 v97, v97, v25
  v_mfma_f32_16x16x32_bf16 v[148:151], v[32:35], a[100:103], v[148:151]
  ds_read_b64_tr_b16 v[46:47], v1 offset:21160
  v_add_f32 v98, v98, v26
  v_mfma_f32_16x16x32_bf16 v[152:155], v[32:35], a[104:107], v[152:155]
  buffer_load_dwordx4 a[240:243], v11, s[20:23], s57 offen offset:0 sc1
  v_add_f32 v99, v99, v27
  v_mfma_f32_16x16x32_bf16 v[156:159], v[32:35], a[108:111], v[156:159]
  s_waitcnt lgkmcnt(4)
  v_add_f32 v100, v100, v24
  v_add_f32 v101, v101, v25
  v_mfma_f32_16x16x32_bf16 v[160:163], v[36:39], a[96:99], v[160:163]
  ds_read_b64_tr_b16 v[32:33], v2 offset:20640
  v_add_f32 v102, v102, v26
  v_mfma_f32_16x16x32_bf16 v[164:167], v[36:39], a[100:103], v[164:167]
  ds_read_b64_tr_b16 v[34:35], v2 offset:21152
  v_add_f32 v103, v103, v27
  v_mfma_f32_16x16x32_bf16 v[168:171], v[36:39], a[104:107], v[168:171]
  buffer_load_dwordx4 a[244:247], v11, s[20:23], s57 offen offset:1024 sc1
  v_add_f32 v104, v104, v24
  v_mfma_f32_16x16x32_bf16 v[172:175], v[36:39], a[108:111], v[172:175]
  s_waitcnt lgkmcnt(4)
  ds_read_b128 v[20:23], v15 offset:1920
  v_mfma_f32_16x16x32_bf16 v[176:179], v[40:43], a[48:51], v[176:179]
  ds_read_b64_tr_b16 v[36:37], v2 offset:20648
  v_add_f32 v105, v105, v25
  v_mfma_f32_16x16x32_bf16 v[180:183], v[40:43], a[52:55], v[180:183]
  ds_read_b64_tr_b16 v[38:39], v2 offset:21160
  v_add_f32 v106, v106, v26
  v_mfma_f32_16x16x32_bf16 v[184:187], v[40:43], a[56:59], v[184:187]
  buffer_load_dwordx4 a[248:251], v11, s[20:23], s57 offen offset:2048 sc1
  v_add_f32 v107, v107, v27
  v_mfma_f32_16x16x32_bf16 v[188:191], v[40:43], a[60:63], v[188:191]
  s_waitcnt lgkmcnt(5)
  v_add_f32 v108, v108, v24
  v_add_f32 v109, v109, v25
  v_mfma_f32_16x16x32_bf16 v[192:195], v[44:47], a[48:51], v[192:195]
  ds_read_b64_tr_b16 v[40:41], v1 offset:24768
  v_add_f32 v110, v110, v26
  v_mfma_f32_16x16x32_bf16 v[196:199], v[44:47], a[52:55], v[196:199]
  ds_read_b64_tr_b16 v[42:43], v1 offset:25280
  v_add_f32 v111, v111, v27
  v_mfma_f32_16x16x32_bf16 v[200:203], v[44:47], a[56:59], v[200:203]
  buffer_load_dwordx4 a[252:255], v11, s[20:23], s57 offen offset:3072 sc1
  v_mfma_f32_16x16x32_bf16 v[204:207], v[44:47], a[60:63], v[204:207]
  s_waitcnt lgkmcnt(5)
  ds_read_b128 v[24:27], v15 offset:1984
  v_mfma_f32_16x16x32_bf16 v[208:211], v[32:35], a[48:51], v[208:211]
  ds_read_b64_tr_b16 v[44:45], v1 offset:24776
  s_waitcnt lgkmcnt(6)
  v_mfma_f32_16x16x32_bf16 v[212:215], v[32:35], a[52:55], v[212:215]
  ds_read_b64_tr_b16 v[46:47], v1 offset:25288
  s_waitcnt vmcnt(18) lgkmcnt(5)
  v_mfma_f32_16x16x32_bf16 v[216:219], v[32:35], a[56:59], v[216:219]
  s_barrier
  s_add_u32 s50, s35, 3514624
  s_add_u32 m0, s36, 12384
  v_mfma_f32_16x16x32_bf16 v[220:223], v[32:35], a[60:63], v[220:223]
  buffer_load_dwordx4 v4, s[8:11], s50 offen lds
  v_mfma_f32_16x16x32_bf16 v[224:227], v[36:39], a[48:51], v[224:227]
  ds_read_b64_tr_b16 v[32:33], v2 offset:24768
  s_add_u32 s51, s35, 3834112
  v_mfma_f32_16x16x32_bf16 v[228:231], v[36:39], a[52:55], v[228:231]
  ds_read_b64_tr_b16 v[34:35], v2 offset:25280
  s_add_u32 m0, s36, 16512
  v_mfma_f32_16x16x32_bf16 v[232:235], v[36:39], a[56:59], v[232:235]
  buffer_load_dwordx4 v4, s[8:11], s51 offen lds
  v_mfma_f32_16x16x32_bf16 v[236:239], v[36:39], a[60:63], v[236:239]
  s_waitcnt lgkmcnt(5)
  s_add_u32 s50, s35, 2928896
  s_add_u32 m0, s36, 20640
  v_mfma_f32_16x16x32_bf16 v[176:179], v[40:43], a[64:67], v[176:179]
  ds_read_b64_tr_b16 v[36:37], v2 offset:24776
  v_add_f32 v112, v112, v20
  v_mfma_f32_16x16x32_bf16 v[180:183], v[40:43], a[68:71], v[180:183]
  ds_read_b64_tr_b16 v[38:39], v2 offset:25288
  v_add_f32 v113, v113, v21
  v_mfma_f32_16x16x32_bf16 v[184:187], v[40:43], a[72:75], v[184:187]
  buffer_load_dwordx4 v4, s[8:11], s50 offen lds
  v_mfma_f32_16x16x32_bf16 v[188:191], v[40:43], a[76:79], v[188:191]
  s_waitcnt lgkmcnt(4)
  v_add_f32 v114, v114, v22
  v_add_f32 v115, v115, v23
  v_mfma_f32_16x16x32_bf16 v[192:195], v[44:47], a[64:67], v[192:195]
  ds_read_b64_tr_b16 v[40:41], v1 offset:28896
  v_add_f32 v116, v116, v20
  v_mfma_f32_16x16x32_bf16 v[196:199], v[44:47], a[68:71], v[196:199]
  ds_read_b64_tr_b16 v[42:43], v1 offset:29408
  v_add_f32 v117, v117, v21
  v_mfma_f32_16x16x32_bf16 v[200:203], v[44:47], a[72:75], v[200:203]
  buffer_load_dword v19, v18, s[20:23], 0 offen sc1
  v_add_f32 v118, v118, v22
  v_mfma_f32_16x16x32_bf16 v[204:207], v[44:47], a[76:79], v[204:207]
  s_waitcnt lgkmcnt(4)
  v_add_f32 v119, v119, v23
  v_add_f32 v120, v120, v20
  v_mfma_f32_16x16x32_bf16 v[208:211], v[32:35], a[64:67], v[208:211]
  ds_read_b64_tr_b16 v[44:45], v1 offset:28904
  v_add_f32 v121, v121, v21
  v_mfma_f32_16x16x32_bf16 v[212:215], v[32:35], a[68:71], v[212:215]
  ds_read_b64_tr_b16 v[46:47], v1 offset:29416
  v_add_f32 v122, v122, v22
  v_mfma_f32_16x16x32_bf16 v[216:219], v[32:35], a[72:75], v[216:219]
  s_waitcnt lgkmcnt(4)
  v_add_f32 v123, v123, v23
  v_add_f32 v124, v124, v20
  v_mfma_f32_16x16x32_bf16 v[220:223], v[32:35], a[76:79], v[220:223]
  v_add_f32 v125, v125, v21
  v_add_f32 v126, v126, v22
  v_mfma_f32_16x16x32_bf16 v[224:227], v[36:39], a[64:67], v[224:227]
  ds_read_b64_tr_b16 v[32:33], v2 offset:28896
  v_add_f32 v127, v127, v23
  v_mfma_f32_16x16x32_bf16 v[228:231], v[36:39], a[68:71], v[228:231]
  ds_read_b64_tr_b16 v[34:35], v2 offset:29408
  v_add_f32 v128, v128, v24
  v_mfma_f32_16x16x32_bf16 v[232:235], v[36:39], a[72:75], v[232:235]
  s_waitcnt lgkmcnt(4)
  ds_read_b128 v[20:23], v15 offset:2048
  v_mfma_f32_16x16x32_bf16 v[236:239], v[36:39], a[76:79], v[236:239]
  v_add_f32 v129, v129, v25
  v_add_f32 v130, v130, v26
  v_mfma_f32_16x16x32_bf16 v[176:179], v[40:43], a[80:83], v[176:179]
  ds_read_b64_tr_b16 v[36:37], v2 offset:28904
  v_add_f32 v131, v131, v27
  v_mfma_f32_16x16x32_bf16 v[180:183], v[40:43], a[84:87], v[180:183]
  ds_read_b64_tr_b16 v[38:39], v2 offset:29416
  v_add_f32 v132, v132, v24
  v_mfma_f32_16x16x32_bf16 v[184:187], v[40:43], a[88:91], v[184:187]
  s_waitcnt lgkmcnt(5)
  v_add_f32 v133, v133, v25
  v_add_f32 v134, v134, v26
  v_mfma_f32_16x16x32_bf16 v[188:191], v[40:43], a[92:95], v[188:191]
  v_add_f32 v135, v135, v27
  v_add_f32 v136, v136, v24
  v_mfma_f32_16x16x32_bf16 v[192:195], v[44:47], a[80:83], v[192:195]
  ds_read_b64_tr_b16 v[40:41], v1 offset:33024
  s_add_u32 s57, s40, 27299840
  v_mfma_f32_16x16x32_bf16 v[196:199], v[44:47], a[84:87], v[196:199]
  ds_read_b64_tr_b16 v[42:43], v1 offset:33536
  v_add_f32 v137, v137, v25
  v_mfma_f32_16x16x32_bf16 v[200:203], v[44:47], a[88:91], v[200:203]
  buffer_load_dwordx4 a[112:115], v11, s[20:23], s57 offen offset:0 sc1
  v_add_f32 v138, v138, v26
  v_mfma_f32_16x16x32_bf16 v[204:207], v[44:47], a[92:95], v[204:207]
  s_waitcnt lgkmcnt(5)
  v_add_f32 v139, v139, v27
  v_add_f32 v140, v140, v24
  v_mfma_f32_16x16x32_bf16 v[208:211], v[32:35], a[80:83], v[208:211]
  ds_read_b64_tr_b16 v[44:45], v1 offset:33032
  v_add_f32 v141, v141, v25
  v_mfma_f32_16x16x32_bf16 v[212:215], v[32:35], a[84:87], v[212:215]
  ds_read_b64_tr_b16 v[46:47], v1 offset:33544
  v_add_f32 v142, v142, v26
  v_mfma_f32_16x16x32_bf16 v[216:219], v[32:35], a[88:91], v[216:219]
  buffer_load_dwordx4 a[116:119], v11, s[20:23], s57 offen offset:1024 sc1
  v_add_f32 v143, v143, v27
  v_mfma_f32_16x16x32_bf16 v[220:223], v[32:35], a[92:95], v[220:223]
  s_waitcnt lgkmcnt(4)
  ds_read_b128 v[24:27], v15 offset:2112
  v_mfma_f32_16x16x32_bf16 v[224:227], v[36:39], a[80:83], v[224:227]
  ds_read_b64_tr_b16 v[32:33], v2 offset:33024
  v_add_f32 v144, v144, v20
  v_mfma_f32_16x16x32_bf16 v[228:231], v[36:39], a[84:87], v[228:231]
  ds_read_b64_tr_b16 v[34:35], v2 offset:33536
  v_add_f32 v145, v145, v21
  v_mfma_f32_16x16x32_bf16 v[232:235], v[36:39], a[88:91], v[232:235]
  buffer_load_dwordx4 a[120:123], v11, s[20:23], s57 offen offset:2048 sc1
  v_add_f32 v146, v146, v22
  v_mfma_f32_16x16x32_bf16 v[236:239], v[36:39], a[92:95], v[236:239]
  s_waitcnt lgkmcnt(5)
  v_add_f32 v147, v147, v23
  v_add_f32 v148, v148, v20
  v_mfma_f32_16x16x32_bf16 v[176:179], v[40:43], a[96:99], v[176:179]
  ds_read_b64_tr_b16 v[36:37], v2 offset:33032
  v_add_f32 v149, v149, v21
  v_mfma_f32_16x16x32_bf16 v[180:183], v[40:43], a[100:103], v[180:183]
  ds_read_b64_tr_b16 v[38:39], v2 offset:33544
  v_add_f32 v150, v150, v22
  v_mfma_f32_16x16x32_bf16 v[184:187], v[40:43], a[104:107], v[184:187]
  buffer_load_dwordx4 a[124:127], v11, s[20:23], s57 offen offset:3072 sc1
  v_add_f32 v151, v151, v23
  v_mfma_f32_16x16x32_bf16 v[188:191], v[40:43], a[108:111], v[188:191]
  s_waitcnt lgkmcnt(5)
  v_add_f32 v152, v152, v20
  v_add_f32 v153, v153, v21
  v_mfma_f32_16x16x32_bf16 v[192:195], v[44:47], a[96:99], v[192:195]
  ds_read_b64_tr_b16 v[40:41], v3 offset:37152
  s_add_u32 s57, s40, 27324416
  v_mfma_f32_16x16x32_bf16 v[196:199], v[44:47], a[100:103], v[196:199]
  ds_read_b64_tr_b16 v[42:43], v3 offset:37408
  v_add_f32 v154, v154, v22
  v_mfma_f32_16x16x32_bf16 v[200:203], v[44:47], a[104:107], v[200:203]
  buffer_load_dwordx4 a[128:131], v11, s[20:23], s57 offen offset:0 sc1
  v_add_f32 v155, v155, v23
  v_mfma_f32_16x16x32_bf16 v[204:207], v[44:47], a[108:111], v[204:207]
  s_waitcnt lgkmcnt(4)
  v_add_f32 v156, v156, v20
  v_add_f32 v157, v157, v21
  v_mfma_f32_16x16x32_bf16 v[208:211], v[32:35], a[96:99], v[208:211]
  ds_read_b64_tr_b16 v[44:45], v3 offset:38176
  v_add_f32 v158, v158, v22
  v_mfma_f32_16x16x32_bf16 v[212:215], v[32:35], a[100:103], v[212:215]
  ds_read_b64_tr_b16 v[46:47], v3 offset:38432
  s_waitcnt vmcnt(24) lgkmcnt(4)
  v_mfma_f32_16x16x32_bf16 v[216:219], v[32:35], a[104:107], v[216:219]
  s_barrier
  s_lshr_b32 s51, 0x37374842, s37
  s_and_b32 s51, s51, 0xff
  v_mfma_f32_16x16x32_bf16 v[220:223], v[32:35], a[108:111], v[220:223]
  buffer_load_dwordx4 a[132:135], v11, s[20:23], s57 offen offset:1024 sc1
  v_add_f32 v159, v159, v23
  v_mfma_f32_16x16x32_bf16 v[224:227], v[36:39], a[96:99], v[224:227]
  ds_read_b64_tr_b16 v[32:33], v3 offset:39200
  s_mul_i32 s51, s51, 53248
  v_mfma_f32_16x16x32_bf16 v[228:231], v[36:39], a[100:103], v[228:231]
  ds_read_b64_tr_b16 v[34:35], v3 offset:39456
  s_add_u32 s51, s51, s38
  v_mfma_f32_16x16x32_bf16 v[232:235], v[36:39], a[104:107], v[232:235]
  s_add_u32 m0, s39, 24768
  ds_read_b128 v[20:23], v15 offset:2176
  v_mfma_f32_16x16x32_bf16 v[236:239], v[36:39], a[108:111], v[236:239]
  s_waitcnt lgkmcnt(5)
  v_add_f32 v160, v160, v24
  v_add_f32 v161, v161, v25
  v_mfma_f32_16x16x32_bf16 v[240:243], v[40:43], a[48:51], v[240:243]
  ds_read_b64_tr_b16 v[36:37], v3 offset:40224
  v_add_f32 v162, v162, v26
  v_mfma_f32_16x16x32_bf16 v[244:247], v[40:43], a[52:55], v[244:247]
  ds_read_b64_tr_b16 v[38:39], v3 offset:40480
  v_add_f32 v163, v163, v27
  v_mfma_f32_16x16x32_bf16 v[248:251], v[40:43], a[56:59], v[248:251]
  buffer_load_dwordx4 v6, s[8:11], s51 offen lds
  v_mfma_f32_16x16x32_bf16 v[252:255], v[40:43], a[60:63], v[252:255]
  s_waitcnt lgkmcnt(5)
  s_add_u32 s50, s35, 3248128
  s_add_u32 m0, s36, 28864
  v_mfma_f32_16x16x32_bf16 v[240:243], v[44:47], a[64:67], v[240:243]
  ds_read_b64_tr_b16 v[40:41], v1 offset:41248
  v_add_f32 v164, v164, v24
  v_mfma_f32_16x16x32_bf16 v[244:247], v[44:47], a[68:71], v[244:247]
  ds_read_b64_tr_b16 v[42:43], v1 offset:41760
  v_add_f32 v165, v165, v25
  v_mfma_f32_16x16x32_bf16 v[248:251], v[44:47], a[72:75], v[248:251]
  buffer_load_dwordx4 v4, s[8:11], s50 offen lds
  v_mfma_f32_16x16x32_bf16 v[252:255], v[44:47], a[76:79], v[252:255]
  s_waitcnt lgkmcnt(5)
  s_add_u32 s51, s35, 3567616
  s_add_u32 m0, s36, 32992
  v_mfma_f32_16x16x32_bf16 v[240:243], v[32:35], a[80:83], v[240:243]
  ds_read_b64_tr_b16 v[44:45], v1 offset:41256
  v_add_f32 v166, v166, v26
  v_mfma_f32_16x16x32_bf16 v[244:247], v[32:35], a[84:87], v[244:247]
  ds_read_b64_tr_b16 v[46:47], v1 offset:41768
  v_add_f32 v167, v167, v27
  v_mfma_f32_16x16x32_bf16 v[248:251], v[32:35], a[88:91], v[248:251]
  buffer_load_dwordx4 v4, s[8:11], s51 offen lds
  v_mfma_f32_16x16x32_bf16 v[252:255], v[32:35], a[92:95], v[252:255]
  s_waitcnt lgkmcnt(4)
  v_add_f32 v168, v168, v24
  v_add_f32 v169, v169, v25
  v_mfma_f32_16x16x32_bf16 v[240:243], v[36:39], a[96:99], v[240:243]
  ds_read_b64_tr_b16 v[32:33], v2 offset:41248
  v_add_f32 v170, v170, v26
  v_mfma_f32_16x16x32_bf16 v[244:247], v[36:39], a[100:103], v[244:247]
  ds_read_b64_tr_b16 v[34:35], v2 offset:41760
  v_add_f32 v171, v171, v27
  v_mfma_f32_16x16x32_bf16 v[248:251], v[36:39], a[104:107], v[248:251]
  v_add_f32 v172, v172, v24
  v_add_f32 v173, v173, v25
  v_mfma_f32_16x16x32_bf16 v[252:255], v[36:39], a[108:111], v[252:255]
  s_waitcnt vmcnt(24) lgkmcnt(4)
  v_add_f32 v174, v174, v26
  v_add_f32 v175, v175, v27
  v_mfma_f32_16x16x32_bf16 v[48:51], v[40:43], a[208:211], v[48:51]
  ds_read_b64_tr_b16 v[36:37], v2 offset:41256
  v_add_f32 v176, v176, v20
  v_mfma_f32_16x16x32_bf16 v[52:55], v[40:43], a[212:215], v[52:55]
  ds_read_b64_tr_b16 v[38:39], v2 offset:41768
  v_add_f32 v177, v177, v21
  v_mfma_f32_16x16x32_bf16 v[56:59], v[40:43], a[216:219], v[56:59]
  ds_read_b128 v[24:27], v15 offset:2240
  v_add_f32 v178, v178, v22
  v_mfma_f32_16x16x32_bf16 v[60:63], v[40:43], a[220:223], v[60:63]
  s_waitcnt lgkmcnt(5)
  v_add_f32 v179, v179, v23
  v_add_f32 v180, v180, v20
  v_mfma_f32_16x16x32_bf16 v[64:67], v[44:47], a[208:211], v[64:67]
  ds_read_b64_tr_b16 v[40:41], v1 offset:45376
  v_add_f32 v181, v181, v21
  v_mfma_f32_16x16x32_bf16 v[68:71], v[44:47], a[212:215], v[68:71]
  ds_read_b64_tr_b16 v[42:43], v1 offset:45888
  v_add_f32 v182, v182, v22
  v_mfma_f32_16x16x32_bf16 v[72:75], v[44:47], a[216:219], v[72:75]
  buffer_load_dwordx4 a[136:139], v11, s[20:23], s57 offen offset:2048 sc1
  v_add_f32 v183, v183, v23
  v_mfma_f32_16x16x32_bf16 v[76:79], v[44:47], a[220:223], v[76:79]
  s_waitcnt lgkmcnt(5)
  v_add_f32 v184, v184, v20
  v_add_f32 v185, v185, v21
  v_mfma_f32_16x16x32_bf16 v[80:83], v[32:35], a[208:211], v[80:83]
  ds_read_b64_tr_b16 v[44:45], v1 offset:45384
  v_add_f32 v186, v186, v22
  v_mfma_f32_16x16x32_bf16 v[84:87], v[32:35], a[212:215], v[84:87]
  ds_read_b64_tr_b16 v[46:47], v1 offset:45896
  v_add_f32 v187, v187, v23
  v_mfma_f32_16x16x32_bf16 v[88:91], v[32:35], a[216:219], v[88:91]
  buffer_load_dwordx4 a[140:143], v11, s[20:23], s57 offen offset:3072 sc1
  v_add_f32 v188, v188, v20
  v_mfma_f32_16x16x32_bf16 v[92:95], v[32:35], a[220:223], v[92:95]
  s_waitcnt lgkmcnt(5)
  s_add_u32 s57, s40, 27348992
  v_add_f32 v189, v189, v21
  v_mfma_f32_16x16x32_bf16 v[96:99], v[36:39], a[208:211], v[96:99]
  ds_read_b64_tr_b16 v[32:33], v2 offset:45376
  v_add_f32 v190, v190, v22
  v_mfma_f32_16x16x32_bf16 v[100:103], v[36:39], a[212:215], v[100:103]
  ds_read_b64_tr_b16 v[34:35], v2 offset:45888
  v_add_f32 v191, v191, v23
  v_mfma_f32_16x16x32_bf16 v[104:107], v[36:39], a[216:219], v[104:107]
  ds_read_b128 v[20:23], v15 offset:2304
  s_waitcnt lgkmcnt(7)
  v_mfma_f32_16x16x32_bf16 v[108:111], v[36:39], a[220:223], v[108:111]
  s_waitcnt vmcnt(19) lgkmcnt(5)
  v_add_f32 v192, v192, v24
  v_add_f32 v193, v193, v25
  v_mfma_f32_16x16x32_bf16 v[48:51], v[40:43], a[224:227], v[48:51]
  ds_read_b64_tr_b16 v[36:37], v2 offset:45384
  v_add_f32 v194, v194, v26
  v_mfma_f32_16x16x32_bf16 v[52:55], v[40:43], a[228:231], v[52:55]
  ds_read_b64_tr_b16 v[38:39], v2 offset:45896
  v_add_f32 v195, v195, v27
  v_mfma_f32_16x16x32_bf16 v[56:59], v[40:43], a[232:235], v[56:59]
  buffer_load_dwordx4 a[144:147], v11, s[20:23], s57 offen offset:0 sc1
  v_add_f32 v196, v196, v24
  v_mfma_f32_16x16x32_bf16 v[60:63], v[40:43], a[236:239], v[60:63]
  s_waitcnt lgkmcnt(5)
  v_add_f32 v197, v197, v25
  v_add_f32 v198, v198, v26
  v_mfma_f32_16x16x32_bf16 v[64:67], v[44:47], a[224:227], v[64:67]
  ds_read_b64_tr_b16 v[40:41], v1 offset:49504
  v_add_f32 v199, v199, v27
  v_mfma_f32_16x16x32_bf16 v[68:71], v[44:47], a[228:231], v[68:71]
  ds_read_b64_tr_b16 v[42:43], v1 offset:50016
  v_add_f32 v200, v200, v24
  v_mfma_f32_16x16x32_bf16 v[72:75], v[44:47], a[232:235], v[72:75]
  buffer_load_dwordx4 a[148:151], v11, s[20:23], s57 offen offset:1024 sc1
  v_add_f32 v201, v201, v25
  v_mfma_f32_16x16x32_bf16 v[76:79], v[44:47], a[236:239], v[76:79]
  s_waitcnt lgkmcnt(5)
  v_add_f32 v202, v202, v26
  v_add_f32 v203, v203, v27
  v_mfma_f32_16x16x32_bf16 v[80:83], v[32:35], a[224:227], v[80:83]
  ds_read_b64_tr_b16 v[44:45], v1 offset:49512
  v_add_f32 v204, v204, v24
  v_mfma_f32_16x16x32_bf16 v[84:87], v[32:35], a[228:231], v[84:87]
  ds_read_b64_tr_b16 v[46:47], v1 offset:50024
  s_waitcnt lgkmcnt(4)
  v_mfma_f32_16x16x32_bf16 v[88:91], v[32:35], a[232:235], v[88:91]
  s_barrier
  s_add_u32 s50, s35, 3887104
  s_add_u32 m0, s36, 37120
  v_mfma_f32_16x16x32_bf16 v[92:95], v[32:35], a[236:239], v[92:95]
  buffer_load_dwordx4 v4, s[8:11], s50 offen lds
  v_mfma_f32_16x16x32_bf16 v[96:99], v[36:39], a[224:227], v[96:99]
  ds_read_b64_tr_b16 v[32:33], v2 offset:49504
  s_add_u32 s51, s35, 2981888
  v_mfma_f32_16x16x32_bf16 v[100:103], v[36:39], a[228:231], v[100:103]
  ds_read_b64_tr_b16 v[34:35], v2 offset:50016
  s_add_u32 m0, s36, 41248
  v_mfma_f32_16x16x32_bf16 v[104:107], v[36:39], a[232:235], v[104:107]
  buffer_load_dwordx4 v4, s[8:11], s51 offen lds
  v_mfma_f32_16x16x32_bf16 v[108:111], v[36:39], a[236:239], v[108:111]
  s_waitcnt vmcnt(19) lgkmcnt(4)
  s_add_u32 s50, s35, 3301376
  s_add_u32 m0, s36, 45376
  v_mfma_f32_16x16x32_bf16 v[48:51], v[40:43], a[240:243], v[48:51]
  ds_read_b64_tr_b16 v[36:37], v2 offset:49512
  v_add_f32 v205, v205, v25
  v_mfma_f32_16x16x32_bf16 v[52:55], v[40:43], a[244:247], v[52:55]
  ds_read_b64_tr_b16 v[38:39], v2 offset:50024
  v_add_f32 v206, v206, v26
  v_mfma_f32_16x16x32_bf16 v[56:59], v[40:43], a[248:251], v[56:59]
  buffer_load_dwordx4 v4, s[8:11], s50 offen lds
  v_mfma_f32_16x16x32_bf16 v[60:63], v[40:43], a[252:255], v[60:63]
  s_waitcnt lgkmcnt(4)
  v_add_f32 v207, v207, v27
  v_add_f32 v208, v208, v20
  v_mfma_f32_16x16x32_bf16 v[64:67], v[44:47], a[240:243], v[64:67]
  ds_read_b64_tr_b16 v[40:41], v1 offset:0
  v_add_f32 v209, v209, v21
  v_mfma_f32_16x16x32_bf16 v[68:71], v[44:47], a[244:247], v[68:71]
  ds_read_b64_tr_b16 v[42:43], v1 offset:512
  v_add_f32 v210, v210, v22
  v_mfma_f32_16x16x32_bf16 v[72:75], v[44:47], a[248:251], v[72:75]
  buffer_load_dwordx4 a[152:155], v11, s[20:23], s57 offen offset:2048 sc1
  v_add_f32 v211, v211, v23
  v_mfma_f32_16x16x32_bf16 v[76:79], v[44:47], a[252:255], v[76:79]
  s_waitcnt lgkmcnt(4)
  ds_read_b128 v[24:27], v15 offset:2368
  v_mfma_f32_16x16x32_bf16 v[80:83], v[32:35], a[240:243], v[80:83]
  ds_read_b64_tr_b16 v[44:45], v1 offset:8
  v_add_f32 v212, v212, v20
  v_mfma_f32_16x16x32_bf16 v[84:87], v[32:35], a[244:247], v[84:87]
  ds_read_b64_tr_b16 v[46:47], v1 offset:520
  v_add_f32 v213, v213, v21
  v_mfma_f32_16x16x32_bf16 v[88:91], v[32:35], a[248:251], v[88:91]
  buffer_load_dwordx4 a[156:159], v11, s[20:23], s57 offen offset:3072 sc1
  v_add_f32 v214, v214, v22
  v_mfma_f32_16x16x32_bf16 v[92:95], v[32:35], a[252:255], v[92:95]
  s_waitcnt lgkmcnt(5)
  s_waitcnt vmcnt(18)
  v_sub_u32 v19, v19, v30
  v_mfma_f32_16x16x32_bf16 v[96:99], v[36:39], a[240:243], v[96:99]
  ds_read_b64_tr_b16 v[32:33], v2 offset:0
  v_cmp_gt_u32 vcc, 8, v19
  v_mfma_f32_16x16x32_bf16 v[100:103], v[36:39], a[244:247], v[100:103]
  ds_read_b64_tr_b16 v[34:35], v2 offset:512
  s_nop 0
  v_mfma_f32_16x16x32_bf16 v[104:107], v[36:39], a[248:251], v[104:107]
  s_waitcnt lgkmcnt(5)
  s_cbranch_vccnz Lslow8
Lback8:
  s_add_u32 s56, s40, 27279360
  v_mfma_f32_16x16x32_bf16 v[108:111], v[36:39], a[252:255], v[108:111]
  buffer_load_dwordx4 a[160:163], v11, s[20:23], s56 offen offset:0 sc1
  v_add_f32 v215, v215, v23
  v_mfma_f32_16x16x32_bf16 v[112:115], v[40:43], a[208:211], v[112:115]
  ds_read_b64_tr_b16 v[36:37], v2 offset:8
  v_add_f32 v216, v216, v20
  v_mfma_f32_16x16x32_bf16 v[116:119], v[40:43], a[212:215], v[116:119]
  ds_read_b64_tr_b16 v[38:39], v2 offset:520
  v_add_f32 v217, v217, v21
  v_mfma_f32_16x16x32_bf16 v[120:123], v[40:43], a[216:219], v[120:123]
  v_add_f32 v218, v218, v22
  v_add_f32 v219, v219, v23
  v_mfma_f32_16x16x32_bf16 v[124:127], v[40:43], a[220:223], v[124:127]
  s_waitcnt lgkmcnt(4)
  v_add_f32 v220, v220, v20
  v_add_f32 v221, v221, v21
  v_mfma_f32_16x16x32_bf16 v[128:131], v[44:47], a[208:211], v[128:131]
  ds_read_b64_tr_b16 v[40:41], v1 offset:4128
  v_add_f32 v222, v222, v22
  v_mfma_f32_16x16x32_bf16 v[132:135], v[44:47], a[212:215], v[132:135]
  ds_read_b64_tr_b16 v[42:43], v1 offset:4640
  v_add_f32 v223, v223, v23
  v_mfma_f32_16x16x32_bf16 v[136:139], v[44:47], a[216:219], v[136:139]
  buffer_load_dwordx4 a[164:167], v11, s[20:23], s56 offen offset:1024 sc1
  v_add_f32 v224, v224, v24
  v_mfma_f32_16x16x32_bf16 v[140:143], v[44:47], a[220:223], v[140:143]
  s_waitcnt lgkmcnt(4)
  ds_read_b128 v[20:23], v15 offset:2432
  v_mfma_f32_16x16x32_bf16 v[144:147], v[32:35], a[208:211], v[144:147]
  ds_read_b64_tr_b16 v[44:45], v1 offset:4136
  v_add_f32 v225, v225, v25
  v_mfma_f32_16x16x32_bf16 v[148:151], v[32:35], a[212:215], v[148:151]
  ds_read_b64_tr_b16 v[46:47], v1 offset:4648
  v_add_f32 v226, v226, v26
  v_mfma_f32_16x16x32_bf16 v[152:155], v[32:35], a[216:219], v[152:155]
  buffer_load_dwordx4 a[168:171], v11, s[20:23], s56 offen offset:2048 sc1
  v_add_f32 v227, v227, v27
  v_mfma_f32_16x16x32_bf16 v[156:159], v[32:35], a[220:223], v[156:159]
  s_waitcnt lgkmcnt(5)
  v_add_f32 v228, v228, v24
  v_add_f32 v229, v229, v25
  v_mfma_f32_16x16x32_bf16 v[160:163], v[36:39], a[208:211], v[160:163]
  ds_read_b64_tr_b16 v[32:33], v2 offset:4128
  v_add_f32 v230, v230, v26
  v_mfma_f32_16x16x32_bf16 v[164:167], v[36:39], a[212:215], v[164:167]
  ds_read_b64_tr_b16 v[34:35], v2 offset:4640
  v_add_f32 v231, v231, v27
  v_mfma_f32_16x16x32_bf16 v[168:171], v[36:39], a[216:219], v[168:171]
  buffer_load_dwordx4 a[172:175], v11, s[20:23], s56 offen offset:3072 sc1
  v_add_f32 v232, v232, v24
  v_mfma_f32_16x16x32_bf16 v[172:175], v[36:39], a[220:223], v[172:175]
  s_waitcnt lgkmcnt(5)
  s_add_u32 s56, s40, 27303936
  v_add_f32 v233, v233, v25
  v_mfma_f32_16x16x32_bf16 v[112:115], v[40:43], a[224:227], v[112:115]
  ds_read_b64_tr_b16 v[36:37], v2 offset:4136
  v_add_f32 v234, v234, v26
  v_mfma_f32_16x16x32_bf16 v[116:119], v[40:43], a[228:231], v[116:119]
  ds_read_b64_tr_b16 v[38:39], v2 offset:4648
  v_add_f32 v235, v235, v27
  v_mfma_f32_16x16x32_bf16 v[120:123], v[40:43], a[232:235], v[120:123]
  buffer_load_dwordx4 a[176:179], v11, s[20:23], s56 offen offset:0 sc1
  v_add_f32 v236, v236, v24
  v_mfma_f32_16x16x32_bf16 v[124:127], v[40:43], a[236:239], v[124:127]
  s_waitcnt lgkmcnt(4)
  v_add_f32 v237, v237, v25
  v_add_f32 v238, v238, v26
  v_mfma_f32_16x16x32_bf16 v[128:131], v[44:47], a[224:227], v[128:131]
  ds_read_b64_tr_b16 v[40:41], v1 offset:8256
  v_add_f32 v239, v239, v27
  v_mfma_f32_16x16x32_bf16 v[132:135], v[44:47], a[228:231], v[132:135]
  ds_read_b64_tr_b16 v[42:43], v1 offset:8768
  v_add_f32 v240, v240, v20
  v_mfma_f32_16x16x32_bf16 v[136:139], v[44:47], a[232:235], v[136:139]
  buffer_load_dwordx4 a[180:183], v11, s[20:23], s56 offen offset:1024 sc1
  v_add_f32 v241, v241, v21
  v_mfma_f32_16x16x32_bf16 v[140:143], v[44:47], a[236:239], v[140:143]
  s_waitcnt lgkmcnt(4)
  v_add_f32 v242, v242, v22
  v_add_f32 v243, v243, v23
  v_mfma_f32_16x16x32_bf16 v[144:147], v[32:35], a[224:227], v[144:147]
  ds_read_b64_tr_b16 v[44:45], v1 offset:8264
  v_add_f32 v244, v244, v20
  v_mfma_f32_16x16x32_bf16 v[148:151], v[32:35], a[228:231], v[148:151]
  ds_read_b64_tr_b16 v[46:47], v1 offset:8776
  s_waitcnt lgkmcnt(4)
  v_mfma_f32_16x16x32_bf16 v[152:155], v[32:35], a[232:235], v[152:155]
  s_barrier
  s_add_u32 s51, s35, 3620864
  s_add_u32 m0, s36, 49504
  v_mfma_f32_16x16x32_bf16 v[156:159], v[32:35], a[236:239], v[156:159]
  buffer_load_dwordx4 v4, s[8:11], s51 offen lds
  v_mfma_f32_16x16x32_bf16 v[160:163], v[36:39], a[224:227], v[160:163]
  ds_read_b64_tr_b16 v[32:33], v2 offset:8256
  s_add_u32 s50, s35, 3940352
  v_mfma_f32_16x16x32_bf16 v[164:167], v[36:39], a[228:231], v[164:167]
  ds_read_b64_tr_b16 v[34:35], v2 offset:8768
  s_add_u32 m0, s36, 0
  v_mfma_f32_16x16x32_bf16 v[168:171], v[36:39], a[232:235], v[168:171]
  buffer_load_dwordx4 v4, s[8:11], s50 offen lds
  v_mfma_f32_16x16x32_bf16 v[172:175], v[36:39], a[236:239], v[172:175]
  s_waitcnt lgkmcnt(4)
  s_add_u32 s51, s35, 3035136
  s_add_u32 m0, s36, 4128
  v_mfma_f32_16x16x32_bf16 v[112:115], v[40:43], a[240:243], v[112:115]
  ds_read_b64_tr_b16 v[36:37], v2 offset:8264
  v_add_f32 v245, v245, v21
  v_mfma_f32_16x16x32_bf16 v[116:119], v[40:43], a[244:247], v[116:119]
  ds_read_b64_tr_b16 v[38:39], v2 offset:8776
  v_add_f32 v246, v246, v22
  v_mfma_f32_16x16x32_bf16 v[120:123], v[40:43], a[248:251], v[120:123]
  buffer_load_dwordx4 v4, s[8:11], s51 offen lds
  v_mfma_f32_16x16x32_bf16 v[124:127], v[40:43], a[252:255], v[124:127]
  s_waitcnt lgkmcnt(4)
  v_add_f32 v247, v247, v23
  v_add_f32 v248, v248, v20
  v_mfma_f32_16x16x32_bf16 v[128:131], v[44:47], a[240:243], v[128:131]
  ds_read_b64_tr_b16 v[40:41], v1 offset:12384
  v_add_f32 v249, v249, v21
  v_mfma_f32_16x16x32_bf16 v[132:135], v[44:47], a[244:247], v[132:135]
  ds_read_b64_tr_b16 v[42:43], v1 offset:12896
  v_add_f32 v250, v250, v22
  v_mfma_f32_16x16x32_bf16 v[136:139], v[44:47], a[248:251], v[136:139]
  v_add_f32 v251, v251, v23
  v_add_f32 v252, v252, v20
  v_mfma_f32_16x16x32_bf16 v[140:143], v[44:47], a[252:255], v[140:143]
  s_waitcnt lgkmcnt(4)
  v_add_f32 v253, v253, v21
  v_add_f32 v254, v254, v22
  v_mfma_f32_16x16x32_bf16 v[144:147], v[32:35], a[240:243], v[144:147]
  ds_read_b64_tr_b16 v[44:45], v1 offset:12392
  v_add_f32 v255, v255, v23
  v_mfma_f32_16x16x32_bf16 v[148:151], v[32:35], a[244:247], v[148:151]
  ds_read_b64_tr_b16 v[46:47], v1 offset:12904
  s_waitcnt lgkmcnt(4)
  v_mfma_f32_16x16x32_bf16 v[152:155], v[32:35], a[248:251], v[152:155]
  buffer_load_dwordx4 a[184:187], v11, s[20:23], s56 offen offset:2048 sc1
  v_mfma_f32_16x16x32_bf16 v[156:159], v[32:35], a[252:255], v[156:159]
  v_mfma_f32_16x16x32_bf16 v[160:163], v[36:39], a[240:243], v[160:163]
  ds_read_b64_tr_b16 v[32:33], v2 offset:12384
  v_mfma_f32_16x16x32_bf16 v[164:167], v[36:39], a[244:247], v[164:167]
  ds_read_b64_tr_b16 v[34:35], v2 offset:12896
  s_waitcnt lgkmcnt(4)
  v_mfma_f32_16x16x32_bf16 v[168:171], v[36:39], a[248:251], v[168:171]
  buffer_load_dwordx4 a[188:191], v11, s[20:23], s56 offen offset:3072 sc1
  v_mfma_f32_16x16x32_bf16 v[172:175], v[36:39], a[252:255], v[172:175]
  s_add_u32 s56, s40, 27328512
  v_mfma_f32_16x16x32_bf16 v[176:179], v[40:43], a[208:211], v[176:179]
  ds_read_b64_tr_b16 v[36:37], v2 offset:12392
  v_mfma_f32_16x16x32_bf16 v[180:183], v[40:43], a[212:215], v[180:183]
  ds_read_b64_tr_b16 v[38:39], v2 offset:12904
  s_waitcnt lgkmcnt(4)
  v_mfma_f32_16x16x32_bf16 v[184:187], v[40:43], a[216:219], v[184:187]
  buffer_load_dwordx4 a[192:195], v11, s[20:23], s56 offen offset:0 sc1
  v_mfma_f32_16x16x32_bf16 v[188:191], v[40:43], a[220:223], v[188:191]
  v_mfma_f32_16x16x32_bf16 v[192:195], v[44:47], a[208:211], v[192:195]
  ds_read_b64_tr_b16 v[40:41], v1 offset:16512
  v_mfma_f32_16x16x32_bf16 v[196:199], v[44:47], a[212:215], v[196:199]
  ds_read_b64_tr_b16 v[42:43], v1 offset:17024
  s_waitcnt lgkmcnt(4)
  v_mfma_f32_16x16x32_bf16 v[200:203], v[44:47], a[216:219], v[200:203]
  buffer_load_dwordx4 a[196:199], v11, s[20:23], s56 offen offset:1024 sc1
  v_mfma_f32_16x16x32_bf16 v[204:207], v[44:47], a[220:223], v[204:207]
  v_mfma_f32_16x16x32_bf16 v[208:211], v[32:35], a[208:211], v[208:211]
  ds_read_b64_tr_b16 v[44:45], v1 offset:16520
  v_mfma_f32_16x16x32_bf16 v[212:215], v[32:35], a[212:215], v[212:215]
  ds_read_b64_tr_b16 v[46:47], v1 offset:17032
  s_waitcnt lgkmcnt(4)
  v_mfma_f32_16x16x32_bf16 v[216:219], v[32:35], a[216:219], v[216:219]
  buffer_load_dwordx4 a[200:203], v11, s[20:23], s56 offen offset:2048 sc1
  v_mfma_f32_16x16x32_bf16 v[220:223], v[32:35], a[220:223], v[220:223]
  v_mfma_f32_16x16x32_bf16 v[224:227], v[36:39], a[208:211], v[224:227]
  ds_read_b64_tr_b16 v[32:33], v2 offset:16512
  v_mfma_f32_16x16x32_bf16 v[228:231], v[36:39], a[212:215], v[228:231]
  ds_read_b64_tr_b16 v[34:35], v2 offset:17024
  s_waitcnt lgkmcnt(4)
  v_mfma_f32_16x16x32_bf16 v[232:235], v[36:39], a[216:219], v[232:235]
  buffer_load_dwordx4 a[204:207], v11, s[20:23], s56 offen offset:3072 sc1
  v_mfma_f32_16x16x32_bf16 v[236:239], v[36:39], a[220:223], v[236:239]
  s_add_u32 s56, s40, 27353088
  v_mfma_f32_16x16x32_bf16 v[176:179], v[40:43], a[224:227], v[176:179]
  ds_read_b64_tr_b16 v[36:37], v2 offset:16520
  v_mfma_f32_16x16x32_bf16 v[180:183], v[40:43], a[228:231], v[180:183]
  ds_read_b64_tr_b16 v[38:39], v2 offset:17032
  s_waitcnt lgkmcnt(4)
  v_mfma_f32_16x16x32_bf16 v[184:187], v[40:43], a[232:235], v[184:187]
  buffer_load_dwordx4 a[0:3], v11, s[20:23], s56 offen offset:0 sc1
  v_mfma_f32_16x16x32_bf16 v[188:191], v[40:43], a[236:239], v[188:191]
  v_mfma_f32_16x16x32_bf16 v[192:195], v[44:47], a[224:227], v[192:195]
  ds_read_b64_tr_b16 v[40:41], v1 offset:20640
  v_mfma_f32_16x16x32_bf16 v[196:199], v[44:47], a[228:231], v[196:199]
  ds_read_b64_tr_b16 v[42:43], v1 offset:21152
  s_waitcnt lgkmcnt(4)
  v_mfma_f32_16x16x32_bf16 v[200:203], v[44:47], a[232:235], v[200:203]
  buffer_load_dwordx4 a[4:7], v11, s[20:23], s56 offen offset:1024 sc1
  v_mfma_f32_16x16x32_bf16 v[204:207], v[44:47], a[236:239], v[204:207]
  v_mfma_f32_16x16x32_bf16 v[208:211], v[32:35], a[224:227], v[208:211]
  ds_read_b64_tr_b16 v[44:45], v1 offset:20648
  v_mfma_f32_16x16x32_bf16 v[212:215], v[32:35], a[228:231], v[212:215]
  ds_read_b64_tr_b16 v[46:47], v1 offset:21160
  s_waitcnt vmcnt(26) lgkmcnt(4)
  v_mfma_f32_16x16x32_bf16 v[216:219], v[32:35], a[232:235], v[216:219]
  s_barrier
  s_add_u32 s50, s35, 3354624
  s_add_u32 m0, s36, 8256
  v_mfma_f32_16x16x32_bf16 v[220:223], v[32:35], a[236:239], v[220:223]
  buffer_load_dwordx4 v4, s[8:11], s50 offen lds
  v_mfma_f32_16x16x32_bf16 v[224:227], v[36:39], a[224:227], v[224:227]
  ds_read_b64_tr_b16 v[32:33], v2 offset:20640
  s_add_u32 s51, s35, 3674112
  v_mfma_f32_16x16x32_bf16 v[228:231], v[36:39], a[228:231], v[228:231]
  ds_read_b64_tr_b16 v[34:35], v2 offset:21152
  s_waitcnt lgkmcnt(4)
  v_mfma_f32_16x16x32_bf16 v[232:235], v[36:39], a[232:235], v[232:235]
  s_add_u32 m0, s36, 12384
  v_mfma_f32_16x16x32_bf16 v[236:239], v[36:39], a[236:239], v[236:239]
  buffer_load_dwordx4 v4, s[8:11], s51 offen lds
  v_mfma_f32_16x16x32_bf16 v[176:179], v[40:43], a[240:243], v[176:179]
  ds_read_b64_tr_b16 v[36:37], v2 offset:20648
  s_add_u32 s50, s35, 3993600
  v_mfma_f32_16x16x32_bf16 v[180:183], v[40:43], a[244:247], v[180:183]
  ds_read_b64_tr_b16 v[38:39], v2 offset:21160
  s_waitcnt lgkmcnt(4)
  v_mfma_f32_16x16x32_bf16 v[184:187], v[40:43], a[248:251], v[184:187]
  s_add_u32 m0, s36, 16512
  v_mfma_f32_16x16x32_bf16 v[188:191], v[40:43], a[252:255], v[188:191]
  buffer_load_dwordx4 v4, s[8:11], s50 offen lds
  v_mfma_f32_16x16x32_bf16 v[192:195], v[44:47], a[240:243], v[192:195]
  ds_read_b64_tr_b16 v[40:41], v3 offset:24768
  v_mfma_f32_16x16x32_bf16 v[196:199], v[44:47], a[244:247], v[196:199]
  ds_read_b64_tr_b16 v[42:43], v3 offset:25024
  s_waitcnt lgkmcnt(4)
  v_mfma_f32_16x16x32_bf16 v[200:203], v[44:47], a[248:251], v[200:203]
  v_mfma_f32_16x16x32_bf16 v[204:207], v[44:47], a[252:255], v[204:207]
  v_mfma_f32_16x16x32_bf16 v[208:211], v[32:35], a[240:243], v[208:211]
  ds_read_b64_tr_b16 v[44:45], v3 offset:25792
  v_mfma_f32_16x16x32_bf16 v[212:215], v[32:35], a[244:247], v[212:215]
  ds_read_b64_tr_b16 v[46:47], v3 offset:26048
  s_waitcnt lgkmcnt(4)
  v_mfma_f32_16x16x32_bf16 v[216:219], v[32:35], a[248:251], v[216:219]
  buffer_load_dwordx4 a[8:11], v11, s[20:23], s56 offen offset:2048 sc1
  v_mfma_f32_16x16x32_bf16 v[220:223], v[32:35], a[252:255], v[220:223]
  v_mfma_f32_16x16x32_bf16 v[224:227], v[36:39], a[240:243], v[224:227]
  ds_read_b64_tr_b16 v[32:33], v3 offset:26816
  v_mfma_f32_16x16x32_bf16 v[228:231], v[36:39], a[244:247], v[228:231]
  ds_read_b64_tr_b16 v[34:35], v3 offset:27072
  s_waitcnt lgkmcnt(4)
  v_mfma_f32_16x16x32_bf16 v[232:235], v[36:39], a[248:251], v[232:235]
  buffer_load_dwordx4 a[12:15], v11, s[20:23], s56 offen offset:3072 sc1
  v_mfma_f32_16x16x32_bf16 v[236:239], v[36:39], a[252:255], v[236:239]
  s_add_u32 s57, s40, 27283456
  v_mfma_f32_16x16x32_bf16 v[240:243], v[40:43], a[208:211], v[240:243]
  ds_read_b64_tr_b16 v[36:37], v1 offset:28864
  v_mfma_f32_16x16x32_bf16 v[244:247], v[40:43], a[212:215], v[244:247]
  ds_read_b64_tr_b16 v[38:39], v1 offset:29376
  s_waitcnt lgkmcnt(4)
  v_mfma_f32_16x16x32_bf16 v[248:251], v[40:43], a[216:219], v[248:251]
  buffer_load_dwordx4 a[16:19], v11, s[20:23], s57 offen offset:0 sc1
  v_mfma_f32_16x16x32_bf16 v[252:255], v[40:43], a[220:223], v[252:255]
  v_mfma_f32_16x16x32_bf16 v[240:243], v[44:47], a[224:227], v[240:243]
  ds_read_b64_tr_b16 v[40:41], v1 offset:28872
  v_mfma_f32_16x16x32_bf16 v[244:247], v[44:47], a[228:231], v[244:247]
  ds_read_b64_tr_b16 v[42:43], v1 offset:29384
  s_waitcnt lgkmcnt(4)
  v_mfma_f32_16x16x32_bf16 v[248:251], v[44:47], a[232:235], v[248:251]
  buffer_load_dwordx4 a[20:23], v11, s[20:23], s57 offen offset:1024 sc1
  v_mfma_f32_16x16x32_bf16 v[252:255], v[44:47], a[236:239], v[252:255]
  v_mfma_f32_16x16x32_bf16 v[240:243], v[32:35], a[240:243], v[240:243]
  ds_read_b64_tr_b16 v[44:45], v2 offset:28864
  v_mfma_f32_16x16x32_bf16 v[244:247], v[32:35], a[244:247], v[244:247]
  ds_read_b64_tr_b16 v[46:47], v2 offset:29376
  s_waitcnt lgkmcnt(4)
  v_mfma_f32_16x16x32_bf16 v[248:251], v[32:35], a[248:251], v[248:251]
  buffer_load_dwordx4 a[24:27], v11, s[20:23], s57 offen offset:2048 sc1
  v_mfma_f32_16x16x32_bf16 v[252:255], v[32:35], a[252:255], v[252:255]
  v_mfma_f32_16x16x32_bf16 v[48:51], v[36:39], a[112:115], v[48:51]
  ds_read_b64_tr_b16 v[32:33], v2 offset:28872
  v_mfma_f32_16x16x32_bf16 v[52:55], v[36:39], a[116:119], v[52:55]
  ds_read_b64_tr_b16 v[34:35], v2 offset:29384
  s_waitcnt lgkmcnt(4)
  v_mfma_f32_16x16x32_bf16 v[56:59], v[36:39], a[120:123], v[56:59]
  v_mfma_f32_16x16x32_bf16 v[60:63], v[36:39], a[124:127], v[60:63]
  buffer_load_dwordx4 a[28:31], v11, s[20:23], s57 offen offset:3072 sc1
  v_mfma_f32_16x16x32_bf16 v[64:67], v[40:43], a[112:115], v[64:67]
  ds_read_b64_tr_b16 v[36:37], v1 offset:32992
  s_add_u32 s57, s40, 27308032
  v_mfma_f32_16x16x32_bf16 v[68:71], v[40:43], a[116:119], v[68:71]
  ds_read_b64_tr_b16 v[38:39], v1 offset:33504
  s_waitcnt lgkmcnt(4)
  v_mfma_f32_16x16x32_bf16 v[72:75], v[40:43], a[120:123], v[72:75]
  v_mfma_f32_16x16x32_bf16 v[76:79], v[40:43], a[124:127], v[76:79]
  buffer_load_dwordx4 a[32:35], v11, s[20:23], s57 offen offset:0 sc1
  v_mfma_f32_16x16x32_bf16 v[80:83], v[44:47], a[112:115], v[80:83]
  ds_read_b64_tr_b16 v[40:41], v1 offset:33000
  v_mfma_f32_16x16x32_bf16 v[84:87], v[44:47], a[116:119], v[84:87]
  ds_read_b64_tr_b16 v[42:43], v1 offset:33512
  s_waitcnt lgkmcnt(4)
  v_mfma_f32_16x16x32_bf16 v[88:91], v[44:47], a[120:123], v[88:91]
  v_mfma_f32_16x16x32_bf16 v[92:95], v[44:47], a[124:127], v[92:95]
  v_mfma_f32_16x16x32_bf16 v[96:99], v[32:35], a[112:115], v[96:99]
  ds_read_b64_tr_b16 v[44:45], v2 offset:32992
  v_mfma_f32_16x16x32_bf16 v[100:103], v[32:35], a[116:119], v[100:103]
  ds_read_b64_tr_b16 v[46:47], v2 offset:33504
  s_waitcnt vmcnt(29) lgkmcnt(4)
  v_mfma_f32_16x16x32_bf16 v[104:107], v[32:35], a[120:123], v[104:107]
  s_barrier
  s_add_u32 s51, s35, 4046848
  s_add_u32 m0, s36, 20640
  v_mfma_f32_16x16x32_bf16 v[108:111], v[32:35], a[124:127], v[108:111]
  buffer_load_dwordx4 v5, s[8:11], s51 offen lds
  v_mfma_f32_16x16x32_bf16 v[48:51], v[36:39], a[128:131], v[48:51]
  ds_read_b64_tr_b16 v[32:33], v2 offset:33000
  s_add_u32 s50, s35, 4100096
  v_mfma_f32_16x16x32_bf16 v[52:55], v[36:39], a[132:135], v[52:55]
  ds_read_b64_tr_b16 v[34:35], v2 offset:33512
  s_waitcnt lgkmcnt(4)
  v_mfma_f32_16x16x32_bf16 v[56:59], v[36:39], a[136:139], v[56:59]
  s_add_u32 m0, s36, 24768
  v_mfma_f32_16x16x32_bf16 v[60:63], v[36:39], a[140:143], v[60:63]
  buffer_load_dwordx4 v5, s[8:11], s50 offen lds
  v_mfma_f32_16x16x32_bf16 v[64:67], v[40:43], a[128:131], v[64:67]
  ds_read_b64_tr_b16 v[36:37], v1 offset:37120
  s_add_u32 s54, s72, 73728
  v_mfma_f32_16x16x32_bf16 v[68:71], v[40:43], a[132:135], v[68:71]
  ds_read_b64_tr_b16 v[38:39], v1 offset:37632
  s_waitcnt lgkmcnt(4)
  v_mfma_f32_16x16x32_bf16 v[72:75], v[40:43], a[136:139], v[72:75]
  buffer_load_dwordx4 a[36:39], v11, s[20:23], s57 offen offset:1024 sc1
  v_mfma_f32_16x16x32_bf16 v[76:79], v[40:43], a[140:143], v[76:79]
  v_mfma_f32_16x16x32_bf16 v[80:83], v[44:47], a[128:131], v[80:83]
  ds_read_b64_tr_b16 v[40:41], v1 offset:37128
  v_mfma_f32_16x16x32_bf16 v[84:87], v[44:47], a[132:135], v[84:87]
  ds_read_b64_tr_b16 v[42:43], v1 offset:37640
  s_waitcnt lgkmcnt(4)
  v_mfma_f32_16x16x32_bf16 v[88:91], v[44:47], a[136:139], v[88:91]
  buffer_load_dwordx4 a[40:43], v11, s[20:23], s57 offen offset:2048 sc1
  v_mfma_f32_16x16x32_bf16 v[92:95], v[44:47], a[140:143], v[92:95]
  v_mfma_f32_16x16x32_bf16 v[96:99], v[32:35], a[128:131], v[96:99]
  ds_read_b64_tr_b16 v[44:45], v2 offset:37120
  v_mfma_f32_16x16x32_bf16 v[100:103], v[32:35], a[132:135], v[100:103]
  ds_read_b64_tr_b16 v[46:47], v2 offset:37632
  s_waitcnt vmcnt(31) lgkmcnt(4)
  v_mfma_f32_16x16x32_bf16 v[104:107], v[32:35], a[136:139], v[104:107]
  buffer_load_dwordx4 a[44:47], v11, s[20:23], s57 offen offset:3072 sc1
  v_mfma_f32_16x16x32_bf16 v[108:111], v[32:35], a[140:143], v[108:111]
  s_add_u32 s57, s40, 27332608
  v_mfma_f32_16x16x32_bf16 v[48:51], v[36:39], a[144:147], v[48:51]
  ds_read_b64_tr_b16 v[32:33], v2 offset:37128
  v_lshrrev_b32 v28, 4, v11
  v_mfma_f32_16x16x32_bf16 v[52:55], v[36:39], a[148:151], v[52:55]
  ds_read_b64_tr_b16 v[34:35], v2 offset:37640
  v_and_b32 v29, 15, v28
  v_mfma_f32_16x16x32_bf16 v[56:59], v[36:39], a[152:155], v[56:59]
  buffer_load_dword v14, off, s[64:67], s54
  v_mul_u32_u24 v29, 1664, v29
  v_mfma_f32_16x16x32_bf16 v[60:63], v[36:39], a[156:159], v[60:63]
  s_waitcnt lgkmcnt(4)
  v_lshrrev_b32 v28, 4, v28
  v_lshlrev_b32 v28, 3, v28
  v_mfma_f32_16x16x32_bf16 v[64:67], v[40:43], a[144:147], v[64:67]
  ds_read_b64_tr_b16 v[36:37], v1 offset:41248
  v_add_u32 v31, v29, v28
  v_mfma_f32_16x16x32_bf16 v[68:71], v[40:43], a[148:151], v[68:71]
  ds_read_b64_tr_b16 v[38:39], v1 offset:41760
  v_add_u32 v30, v31, v28
  v_mfma_f32_16x16x32_bf16 v[72:75], v[40:43], a[152:155], v[72:75]
  buffer_load_dwordx4 a[48:51], v11, s[20:23], s57 offen offset:0 sc1
  v_mfma_f32_16x16x32_bf16 v[76:79], v[40:43], a[156:159], v[76:79]
  s_waitcnt lgkmcnt(4)
  v_mfma_f32_16x16x32_bf16 v[80:83], v[44:47], a[144:147], v[80:83]
  ds_read_b64_tr_b16 v[40:41], v1 offset:41256
  v_mfma_f32_16x16x32_bf16 v[84:87], v[44:47], a[148:151], v[84:87]
  ds_read_b64_tr_b16 v[42:43], v1 offset:41768
  s_waitcnt lgkmcnt(4)
  v_mfma_f32_16x16x32_bf16 v[88:91], v[44:47], a[152:155], v[88:91]
  buffer_load_dwordx4 a[52:55], v11, s[20:23], s57 offen offset:1024 sc1
  v_mfma_f32_16x16x32_bf16 v[92:95], v[44:47], a[156:159], v[92:95]
  v_mfma_f32_16x16x32_bf16 v[96:99], v[32:35], a[144:147], v[96:99]
  ds_read_b64_tr_b16 v[44:45], v2 offset:41248
  v_mfma_f32_16x16x32_bf16 v[100:103], v[32:35], a[148:151], v[100:103]
  ds_read_b64_tr_b16 v[46:47], v2 offset:41760
  s_waitcnt vmcnt(31) lgkmcnt(4)
  v_mfma_f32_16x16x32_bf16 v[104:107], v[32:35], a[152:155], v[104:107]
  buffer_load_dwordx4 a[56:59], v11, s[20:23], s57 offen offset:2048 sc1
  v_mfma_f32_16x16x32_bf16 v[108:111], v[32:35], a[156:159], v[108:111]
  v_mfma_f32_16x16x32_bf16 v[48:51], v[36:39], a[160:163], v[48:51]
  ds_read_b64_tr_b16 v[32:33], v2 offset:41256
  v_mfma_f32_16x16x32_bf16 v[52:55], v[36:39], a[164:167], v[52:55]
  ds_read_b64_tr_b16 v[34:35], v2 offset:41768
  s_waitcnt lgkmcnt(4)
  v_mfma_f32_16x16x32_bf16 v[56:59], v[36:39], a[168:171], v[56:59]
  buffer_load_dwordx4 a[60:63], v11, s[20:23], s57 offen offset:3072 sc1
  v_mfma_f32_16x16x32_bf16 v[60:63], v[36:39], a[172:175], v[60:63]
  s_add_u32 s57, s40, 27357184
  v_mfma_f32_16x16x32_bf16 v[64:67], v[40:43], a[160:163], v[64:67]
  ds_read_b64_tr_b16 v[36:37], v1 offset:45376
  v_mfma_f32_16x16x32_bf16 v[68:71], v[40:43], a[164:167], v[68:71]
  ds_read_b64_tr_b16 v[38:39], v1 offset:45888
  s_waitcnt lgkmcnt(4)
  v_mfma_f32_16x16x32_bf16 v[72:75], v[40:43], a[168:171], v[72:75]
  buffer_load_dwordx4 a[64:67], v11, s[20:23], s57 offen offset:0 sc1
  v_mfma_f32_16x16x32_bf16 v[76:79], v[40:43], a[172:175], v[76:79]
  v_mfma_f32_16x16x32_bf16 v[80:83], v[44:47], a[160:163], v[80:83]
  ds_read_b64_tr_b16 v[40:41], v1 offset:45384
  v_mfma_f32_16x16x32_bf16 v[84:87], v[44:47], a[164:167], v[84:87]
  ds_read_b64_tr_b16 v[42:43], v1 offset:45896
  s_waitcnt lgkmcnt(4)
  v_mfma_f32_16x16x32_bf16 v[88:91], v[44:47], a[168:171], v[88:91]
  buffer_load_dwordx4 a[68:71], v11, s[20:23], s57 offen offset:1024 sc1
  v_mfma_f32_16x16x32_bf16 v[92:95], v[44:47], a[172:175], v[92:95]
  v_mfma_f32_16x16x32_bf16 v[96:99], v[32:35], a[160:163], v[96:99]
  ds_read_b64_tr_b16 v[44:45], v2 offset:45376
  v_mfma_f32_16x16x32_bf16 v[100:103], v[32:35], a[164:167], v[100:103]
  ds_read_b64_tr_b16 v[46:47], v2 offset:45888
  s_waitcnt vmcnt(28) lgkmcnt(4)
  v_mfma_f32_16x16x32_bf16 v[104:107], v[32:35], a[168:171], v[104:107]
  s_barrier
  s_add_u32 s51, s35, 3248256
  s_add_u32 m0, s36, 28896
  v_mfma_f32_16x16x32_bf16 v[108:111], v[32:35], a[172:175], v[108:111]
  buffer_load_dwordx4 v4, s[8:11], s51 offen lds
  v_mfma_f32_16x16x32_bf16 v[48:51], v[36:39], a[176:179], v[48:51]
  ds_read_b64_tr_b16 v[32:33], v2 offset:45384
  s_add_u32 s50, s35, 3567744
  v_mfma_f32_16x16x32_bf16 v[52:55], v[36:39], a[180:183], v[52:55]
  ds_read_b64_tr_b16 v[34:35], v2 offset:45896
  s_waitcnt lgkmcnt(4)
  v_mfma_f32_16x16x32_bf16 v[56:59], v[36:39], a[184:187], v[56:59]
  s_add_u32 m0, s36, 33024
  v_mfma_f32_16x16x32_bf16 v[60:63], v[36:39], a[188:191], v[60:63]
  buffer_load_dwordx4 v4, s[8:11], s50 offen lds
  v_mfma_f32_16x16x32_bf16 v[64:67], v[40:43], a[176:179], v[64:67]
  ds_read_b64_tr_b16 v[36:37], v1 offset:49504
  s_add_u32 s51, s35, 3887232
  v_mfma_f32_16x16x32_bf16 v[68:71], v[40:43], a[180:183], v[68:71]
  ds_read_b64_tr_b16 v[38:39], v1 offset:50016
  s_waitcnt lgkmcnt(4)
  v_mfma_f32_16x16x32_bf16 v[72:75], v[40:43], a[184:187], v[72:75]
  s_add_u32 m0, s36, 37152
  v_mfma_f32_16x16x32_bf16 v[76:79], v[40:43], a[188:191], v[76:79]
  buffer_load_dwordx4 v4, s[8:11], s51 offen lds
  v_mfma_f32_16x16x32_bf16 v[80:83], v[44:47], a[176:179], v[80:83]
  ds_read_b64_tr_b16 v[40:41], v1 offset:49512
  v_mfma_f32_16x16x32_bf16 v[84:87], v[44:47], a[180:183], v[84:87]
  ds_read_b64_tr_b16 v[42:43], v1 offset:50024
  s_waitcnt lgkmcnt(4)
  v_mfma_f32_16x16x32_bf16 v[88:91], v[44:47], a[184:187], v[88:91]
  buffer_load_dwordx4 a[72:75], v11, s[20:23], s57 offen offset:2048 sc1
  v_mfma_f32_16x16x32_bf16 v[92:95], v[44:47], a[188:191], v[92:95]
  v_mfma_f32_16x16x32_bf16 v[96:99], v[32:35], a[176:179], v[96:99]
  ds_read_b64_tr_b16 v[44:45], v2 offset:49504
  v_mfma_f32_16x16x32_bf16 v[100:103], v[32:35], a[180:183], v[100:103]
  ds_read_b64_tr_b16 v[46:47], v2 offset:50016
  s_waitcnt vmcnt(28) lgkmcnt(4)
  v_mfma_f32_16x16x32_bf16 v[104:107], v[32:35], a[184:187], v[104:107]
  buffer_load_dwordx4 a[76:79], v11, s[20:23], s57 offen offset:3072 sc1
  v_mfma_f32_16x16x32_bf16 v[108:111], v[32:35], a[188:191], v[108:111]
  s_add_u32 s56, s40, 27361280
  v_mfma_f32_16x16x32_bf16 v[48:51], v[36:39], a[192:195], v[48:51]
  ds_read_b64_tr_b16 v[32:33], v2 offset:49512
  v_mfma_f32_16x16x32_bf16 v[52:55], v[36:39], a[196:199], v[52:55]
  ds_read_b64_tr_b16 v[34:35], v2 offset:50024
  s_waitcnt lgkmcnt(4)
  v_mfma_f32_16x16x32_bf16 v[56:59], v[36:39], a[200:203], v[56:59]
  v_mfma_f32_16x16x32_bf16 v[60:63], v[36:39], a[204:207], v[60:63]
  v_mfma_f32_16x16x32_bf16 v[64:67], v[40:43], a[192:195], v[64:67]
  ds_read_b64_tr_b16 v[36:37], v1 offset:0
  v_mfma_f32_16x16x32_bf16 v[68:71], v[40:43], a[196:199], v[68:71]
  ds_read_b64_tr_b16 v[38:39], v1 offset:512
  s_waitcnt lgkmcnt(4)
  v_mfma_f32_16x16x32_bf16 v[72:75], v[40:43], a[200:203], v[72:75]
  buffer_load_dwordx2 a[80:81], v12, s[20:23], s56 offen offset:0 sc1
  v_mfma_f32_16x16x32_bf16 v[76:79], v[40:43], a[204:207], v[76:79]
  v_mfma_f32_16x16x32_bf16 v[80:83], v[44:47], a[192:195], v[80:83]
  ds_read_b64_tr_b16 v[40:41], v1 offset:8
  v_mfma_f32_16x16x32_bf16 v[84:87], v[44:47], a[196:199], v[84:87]
  ds_read_b64_tr_b16 v[42:43], v1 offset:520
  s_waitcnt lgkmcnt(4)
  v_mfma_f32_16x16x32_bf16 v[88:91], v[44:47], a[200:203], v[88:91]
  buffer_load_dwordx2 a[82:83], v12, s[20:23], s56 offen offset:2048 sc1
  v_mfma_f32_16x16x32_bf16 v[92:95], v[44:47], a[204:207], v[92:95]
  v_mfma_f32_16x16x32_bf16 v[96:99], v[32:35], a[192:195], v[96:99]
  ds_read_b64_tr_b16 v[44:45], v2 offset:0
  v_mfma_f32_16x16x32_bf16 v[100:103], v[32:35], a[196:199], v[100:103]
  ds_read_b64_tr_b16 v[46:47], v2 offset:512
  s_waitcnt vmcnt(24) lgkmcnt(4)
  v_mfma_f32_16x16x32_bf16 v[104:107], v[32:35], a[200:203], v[104:107]
  buffer_load_dwordx2 a[84:85], v12, s[20:23], s56 offen offset:512 sc1
  v_mfma_f32_16x16x32_bf16 v[108:111], v[32:35], a[204:207], v[108:111]
  v_mfma_f32_16x16x32_bf16 v[48:51], v[36:39], a[0:3], v[48:51]
  ds_read_b64_tr_b16 v[32:33], v2 offset:8
  v_mfma_f32_16x16x32_bf16 v[52:55], v[36:39], a[4:7], v[52:55]
  ds_read_b64_tr_b16 v[34:35], v2 offset:520
  s_waitcnt lgkmcnt(4)
  v_mfma_f32_16x16x32_bf16 v[56:59], v[36:39], a[8:11], v[56:59]
  buffer_load_dwordx2 a[86:87], v12, s[20:23], s56 offen offset:2560 sc1
  v_mfma_f32_16x16x32_bf16 v[60:63], v[36:39], a[12:15], v[60:63]
  v_mfma_f32_16x16x32_bf16 v[64:67], v[40:43], a[0:3], v[64:67]
  ds_read_b64_tr_b16 v[36:37], v1 offset:4128
  v_mfma_f32_16x16x32_bf16 v[68:71], v[40:43], a[4:7], v[68:71]
  ds_read_b64_tr_b16 v[38:39], v1 offset:4640
  s_waitcnt lgkmcnt(4)
  v_mfma_f32_16x16x32_bf16 v[72:75], v[40:43], a[8:11], v[72:75]
  buffer_load_dwordx2 a[88:89], v12, s[20:23], s56 offen offset:1024 sc1
  v_mfma_f32_16x16x32_bf16 v[76:79], v[40:43], a[12:15], v[76:79]
  v_mfma_f32_16x16x32_bf16 v[80:83], v[44:47], a[0:3], v[80:83]
  ds_read_b64_tr_b16 v[40:41], v1 offset:4136
  v_mfma_f32_16x16x32_bf16 v[84:87], v[44:47], a[4:7], v[84:87]
  ds_read_b64_tr_b16 v[42:43], v1 offset:4648
  s_waitcnt lgkmcnt(4)
  v_mfma_f32_16x16x32_bf16 v[88:91], v[44:47], a[8:11], v[88:91]
  buffer_load_dwordx2 a[90:91], v12, s[20:23], s56 offen offset:3072 sc1
  v_mfma_f32_16x16x32_bf16 v[92:95], v[44:47], a[12:15], v[92:95]
  v_mfma_f32_16x16x32_bf16 v[96:99], v[32:35], a[0:3], v[96:99]
  ds_read_b64_tr_b16 v[44:45], v2 offset:4128
  v_mfma_f32_16x16x32_bf16 v[100:103], v[32:35], a[4:7], v[100:103]
  ds_read_b64_tr_b16 v[46:47], v2 offset:4640
  s_waitcnt vmcnt(24) lgkmcnt(4)
  v_mfma_f32_16x16x32_bf16 v[104:107], v[32:35], a[8:11], v[104:107]
  s_barrier
  s_add_u32 s50, s35, 2982016
  s_add_u32 m0, s36, 41280
  v_mfma_f32_16x16x32_bf16 v[108:111], v[32:35], a[12:15], v[108:111]
  buffer_load_dwordx2 a[92:93], v12, s[20:23], s56 offen offset:1536 sc1
  v_mfma_f32_16x16x32_bf16 v[48:51], v[36:39], a[16:19], v[48:51]
  ds_read_b64_tr_b16 v[32:33], v2 offset:4136
  v_mfma_f32_16x16x32_bf16 v[52:55], v[36:39], a[20:23], v[52:55]
  ds_read_b64_tr_b16 v[34:35], v2 offset:4648
  s_waitcnt lgkmcnt(4)
  v_mfma_f32_16x16x32_bf16 v[56:59], v[36:39], a[24:27], v[56:59]
  buffer_load_dwordx2 a[94:95], v12, s[20:23], s56 offen offset:3584 sc1
  v_mfma_f32_16x16x32_bf16 v[60:63], v[36:39], a[28:31], v[60:63]
  buffer_load_dwordx4 v4, s[8:11], s50 offen lds
  v_mfma_f32_16x16x32_bf16 v[64:67], v[40:43], a[16:19], v[64:67]
  ds_read_b64_tr_b16 v[36:37], v1 offset:8256
  s_add_u32 s51, s35, 3301504
  v_mfma_f32_16x16x32_bf16 v[68:71], v[40:43], a[20:23], v[68:71]
  ds_read_b64_tr_b16 v[38:39], v1 offset:8768
  s_waitcnt lgkmcnt(4)
  v_mfma_f32_16x16x32_bf16 v[72:75], v[40:43], a[24:27], v[72:75]
  s_add_u32 m0, s36, 45408
  s_add_u32 s57, s40, 27365376
  v_mfma_f32_16x16x32_bf16 v[76:79], v[40:43], a[28:31], v[76:79]
  buffer_load_dwordx2 a[96:97], v12, s[20:23], s57 offen offset:0 sc1
  v_mfma_f32_16x16x32_bf16 v[80:83], v[44:47], a[16:19], v[80:83]
  ds_read_b64_tr_b16 v[40:41], v1 offset:8264
  v_mfma_f32_16x16x32_bf16 v[84:87], v[44:47], a[20:23], v[84:87]
  ds_read_b64_tr_b16 v[42:43], v1 offset:8776
  s_waitcnt lgkmcnt(4)
  v_mfma_f32_16x16x32_bf16 v[88:91], v[44:47], a[24:27], v[88:91]
  buffer_load_dwordx2 a[98:99], v12, s[20:23], s57 offen offset:2048 sc1
  v_mfma_f32_16x16x32_bf16 v[92:95], v[44:47], a[28:31], v[92:95]
  v_mfma_f32_16x16x32_bf16 v[96:99], v[32:35], a[16:19], v[96:99]
  ds_read_b64_tr_b16 v[44:45], v2 offset:8256
  v_mfma_f32_16x16x32_bf16 v[100:103], v[32:35], a[20:23], v[100:103]
  ds_read_b64_tr_b16 v[46:47], v2 offset:8768
  s_waitcnt vmcnt(23) lgkmcnt(4)
  v_mfma_f32_16x16x32_bf16 v[104:107], v[32:35], a[24:27], v[104:107]
  buffer_load_dwordx2 a[100:101], v12, s[20:23], s57 offen offset:512 sc1
  v_mfma_f32_16x16x32_bf16 v[108:111], v[32:35], a[28:31], v[108:111]
  v_mfma_f32_16x16x32_bf16 v[48:51], v[36:39], a[32:35], v[48:51]
  ds_read_b64_tr_b16 v[32:33], v2 offset:8264
  v_mfma_f32_16x16x32_bf16 v[52:55], v[36:39], a[36:39], v[52:55]
  ds_read_b64_tr_b16 v[34:35], v2 offset:8776
  s_waitcnt lgkmcnt(4)
  v_mfma_f32_16x16x32_bf16 v[56:59], v[36:39], a[40:43], v[56:59]
  buffer_load_dwordx2 a[102:103], v12, s[20:23], s57 offen offset:2560 sc1
  v_mfma_f32_16x16x32_bf16 v[60:63], v[36:39], a[44:47], v[60:63]
  v_mfma_f32_16x16x32_bf16 v[64:67], v[40:43], a[32:35], v[64:67]
  ds_read_b64_tr_b16 v[36:37], v1 offset:12384
  v_mfma_f32_16x16x32_bf16 v[68:71], v[40:43], a[36:39], v[68:71]
  ds_read_b64_tr_b16 v[38:39], v1 offset:12896
  s_waitcnt lgkmcnt(4)
  v_mfma_f32_16x16x32_bf16 v[72:75], v[40:43], a[40:43], v[72:75]
  buffer_load_dwordx2 a[104:105], v12, s[20:23], s57 offen offset:1024 sc1
  v_mfma_f32_16x16x32_bf16 v[76:79], v[40:43], a[44:47], v[76:79]
  v_mfma_f32_16x16x32_bf16 v[80:83], v[44:47], a[32:35], v[80:83]
  ds_read_b64_tr_b16 v[40:41], v1 offset:12392
  v_mfma_f32_16x16x32_bf16 v[84:87], v[44:47], a[36:39], v[84:87]
  ds_read_b64_tr_b16 v[42:43], v1 offset:12904
  s_waitcnt lgkmcnt(4)
  v_mfma_f32_16x16x32_bf16 v[88:91], v[44:47], a[40:43], v[88:91]
  buffer_load_dwordx2 a[106:107], v12, s[20:23], s57 offen offset:3072 sc1
  v_mfma_f32_16x16x32_bf16 v[92:95], v[44:47], a[44:47], v[92:95]
  v_mfma_f32_16x16x32_bf16 v[96:99], v[32:35], a[32:35], v[96:99]
  ds_read_b64_tr_b16 v[44:45], v2 offset:12384
  v_mfma_f32_16x16x32_bf16 v[100:103], v[32:35], a[36:39], v[100:103]
  ds_read_b64_tr_b16 v[46:47], v2 offset:12896
  s_waitcnt vmcnt(22) lgkmcnt(4)
  v_mfma_f32_16x16x32_bf16 v[104:107], v[32:35], a[40:43], v[104:107]
  buffer_load_dwordx2 a[108:109], v12, s[20:23], s57 offen offset:1536 sc1
  v_mfma_f32_16x16x32_bf16 v[108:111], v[32:35], a[44:47], v[108:111]
  v_mfma_f32_16x16x32_bf16 v[48:51], v[36:39], a[48:51], v[48:51]
  ds_read_b64_tr_b16 v[32:33], v2 offset:12392
  v_mfma_f32_16x16x32_bf16 v[52:55], v[36:39], a[52:55], v[52:55]
  ds_read_b64_tr_b16 v[34:35], v2 offset:12904
  s_waitcnt lgkmcnt(4)
  v_mfma_f32_16x16x32_bf16 v[56:59], v[36:39], a[56:59], v[56:59]
  v_mfma_f32_16x16x32_bf16 v[60:63], v[36:39], a[60:63], v[60:63]
  buffer_load_dwordx2 a[110:111], v12, s[20:23], s57 offen offset:3584 sc1
  v_mfma_f32_16x16x32_bf16 v[64:67], v[40:43], a[48:51], v[64:67]
  ds_read_b64_tr_b16 v[36:37], v1 offset:16512
  v_mfma_f32_16x16x32_bf16 v[68:71], v[40:43], a[52:55], v[68:71]
  ds_read_b64_tr_b16 v[38:39], v1 offset:17024
  s_waitcnt lgkmcnt(4)
  v_mfma_f32_16x16x32_bf16 v[72:75], v[40:43], a[56:59], v[72:75]
  v_mfma_f32_16x16x32_bf16 v[76:79], v[40:43], a[60:63], v[76:79]
  buffer_load_dwordx4 v4, s[8:11], s51 offen lds
  v_mfma_f32_16x16x32_bf16 v[80:83], v[44:47], a[48:51], v[80:83]
  ds_read_b64_tr_b16 v[40:41], v1 offset:16520
  s_add_u32 s50, s35, 3620992
  v_mfma_f32_16x16x32_bf16 v[84:87], v[44:47], a[52:55], v[84:87]
  ds_read_b64_tr_b16 v[42:43], v1 offset:17032
  s_waitcnt lgkmcnt(4)
  v_mfma_f32_16x16x32_bf16 v[88:91], v[44:47], a[56:59], v[88:91]
  v_mfma_f32_16x16x32_bf16 v[92:95], v[44:47], a[60:63], v[92:95]
  s_add_u32 m0, s36, 49536
  v_mfma_f32_16x16x32_bf16 v[96:99], v[32:35], a[48:51], v[96:99]
  ds_read_b64_tr_b16 v[44:45], v2 offset:16512
  v_mfma_f32_16x16x32_bf16 v[100:103], v[32:35], a[52:55], v[100:103]
  ds_read_b64_tr_b16 v[46:47], v2 offset:17024
  s_waitcnt vmcnt(18) lgkmcnt(4)
  v_mfma_f32_16x16x32_bf16 v[104:107], v[32:35], a[56:59], v[104:107]
  s_barrier
  v_mfma_f32_16x16x32_bf16 v[108:111], v[32:35], a[60:63], v[108:111]
  buffer_load_dwordx4 v4, s[8:11], s50 offen lds
  v_mfma_f32_16x16x32_bf16 v[48:51], v[36:39], a[64:67], v[48:51]
  ds_read_b64_tr_b16 v[32:33], v2 offset:16520
  s_add_u32 s51, s35, 3940480
  v_mfma_f32_16x16x32_bf16 v[52:55], v[36:39], a[68:71], v[52:55]
  ds_read_b64_tr_b16 v[34:35], v2 offset:17032
  s_waitcnt lgkmcnt(4)
  v_mfma_f32_16x16x32_bf16 v[56:59], v[36:39], a[72:75], v[56:59]
  s_add_u32 m0, s36, 0
  v_mfma_f32_16x16x32_bf16 v[60:63], v[36:39], a[76:79], v[60:63]
  buffer_load_dwordx4 v4, s[8:11], s51 offen lds
  v_mfma_f32_16x16x32_bf16 v[64:67], v[40:43], a[64:67], v[64:67]
  ds_read_b64_tr_b16 v[36:37], v1 offset:20640
  s_add_u32 s50, s35, 3035264
  v_mfma_f32_16x16x32_bf16 v[68:71], v[40:43], a[68:71], v[68:71]
  ds_read_b64_tr_b16 v[38:39], v1 offset:21152
  s_waitcnt lgkmcnt(4)
  v_mfma_f32_16x16x32_bf16 v[72:75], v[40:43], a[72:75], v[72:75]
  s_add_u32 m0, s36, 4128
  v_mfma_f32_16x16x32_bf16 v[76:79], v[40:43], a[76:79], v[76:79]
  buffer_load_dwordx4 v4, s[8:11], s50 offen lds
  v_mfma_f32_16x16x32_bf16 v[80:83], v[44:47], a[64:67], v[80:83]
  ds_read_b64_tr_b16 v[40:41], v1 offset:20648
  s_add_u32 s51, s35, 3354752
  v_mfma_f32_16x16x32_bf16 v[84:87], v[44:47], a[68:71], v[84:87]
  ds_read_b64_tr_b16 v[42:43], v1 offset:21160
  s_waitcnt lgkmcnt(4)
  v_mfma_f32_16x16x32_bf16 v[88:91], v[44:47], a[72:75], v[88:91]
  s_add_u32 m0, s36, 8256
  v_mfma_f32_16x16x32_bf16 v[92:95], v[44:47], a[76:79], v[92:95]
  buffer_load_dwordx4 v4, s[8:11], s51 offen lds
  v_mfma_f32_16x16x32_bf16 v[96:99], v[32:35], a[64:67], v[96:99]
  ds_read_b64_tr_b16 v[44:45], v2 offset:20640
  s_add_u32 s50, s35, 3674240
  v_mfma_f32_16x16x32_bf16 v[100:103], v[32:35], a[68:71], v[100:103]
  ds_read_b64_tr_b16 v[46:47], v2 offset:21152
  s_waitcnt vmcnt(14) lgkmcnt(4)
  v_mfma_f32_16x16x32_bf16 v[104:107], v[32:35], a[72:75], v[104:107]
  s_add_u32 m0, s36, 12384
  v_mfma_f32_16x16x32_bf16 v[108:111], v[32:35], a[76:79], v[108:111]
  buffer_load_dwordx4 v4, s[8:11], s50 offen lds
  v_mfma_f32_16x16x32_bf16 v[48:51], v[36:39], a[80:83], v[48:51]
  ds_read_b64_tr_b16 v[32:33], v2 offset:20648
  v_mfma_f32_16x16x32_bf16 v[52:55], v[36:39], a[84:87], v[52:55]
  ds_read_b64_tr_b16 v[34:35], v2 offset:21160
  s_waitcnt lgkmcnt(4)
  v_mfma_f32_16x16x32_bf16 v[56:59], v[36:39], a[88:91], v[56:59]
  v_mfma_f32_16x16x32_bf16 v[60:63], v[36:39], a[92:95], v[60:63]
  v_mfma_f32_16x16x32_bf16 v[64:67], v[40:43], a[80:83], v[64:67]
  ds_read_b64_tr_b16 v[36:37], v1 offset:24768
  v_mfma_f32_16x16x32_bf16 v[68:71], v[40:43], a[84:87], v[68:71]
  ds_read_b64_tr_b16 v[38:39], v1 offset:25280
  s_waitcnt lgkmcnt(4)
  v_mfma_f32_16x16x32_bf16 v[72:75], v[40:43], a[88:91], v[72:75]
  v_mfma_f32_16x16x32_bf16 v[76:79], v[40:43], a[92:95], v[76:79]
  v_mfma_f32_16x16x32_bf16 v[80:83], v[44:47], a[80:83], v[80:83]
  ds_read_b64_tr_b16 v[40:41], v1 offset:24776
  v_mfma_f32_16x16x32_bf16 v[84:87], v[44:47], a[84:87], v[84:87]
  ds_read_b64_tr_b16 v[42:43], v1 offset:25288
  s_waitcnt lgkmcnt(4)
  v_mfma_f32_16x16x32_bf16 v[88:91], v[44:47], a[88:91], v[88:91]
  v_mfma_f32_16x16x32_bf16 v[92:95], v[44:47], a[92:95], v[92:95]
  v_mfma_f32_16x16x32_bf16 v[96:99], v[32:35], a[80:83], v[96:99]
  ds_read_b64_tr_b16 v[44:45], v2 offset:24768
  v_mfma_f32_16x16x32_bf16 v[100:103], v[32:35], a[84:87], v[100:103]
  ds_read_b64_tr_b16 v[46:47], v2 offset:25280
  s_waitcnt vmcnt(6) lgkmcnt(4)
  v_mfma_f32_16x16x32_bf16 v[104:107], v[32:35], a[88:91], v[104:107]
  v_mfma_f32_16x16x32_bf16 v[108:111], v[32:35], a[92:95], v[108:111]
  v_mfma_f32_16x16x32_bf16 v[48:51], v[36:39], a[96:99], v[48:51]
  ds_read_b64_tr_b16 v[32:33], v2 offset:24776
  v_mfma_f32_16x16x32_bf16 v[52:55], v[36:39], a[100:103], v[52:55]
  ds_read_b64_tr_b16 v[34:35], v2 offset:25288
  s_waitcnt lgkmcnt(4)
  v_mfma_f32_16x16x32_bf16 v[56:59], v[36:39], a[104:107], v[56:59]
  v_mfma_f32_16x16x32_bf16 v[60:63], v[36:39], a[108:111], v[60:63]
  v_mfma_f32_16x16x32_bf16 v[64:67], v[40:43], a[96:99], v[64:67]
  ds_read_b64_tr_b16 v[36:37], v1 offset:28896
  v_mfma_f32_16x16x32_bf16 v[68:71], v[40:43], a[100:103], v[68:71]
  ds_read_b64_tr_b16 v[38:39], v1 offset:29408
  s_waitcnt lgkmcnt(4)
  v_mfma_f32_16x16x32_bf16 v[72:75], v[40:43], a[104:107], v[72:75]
  v_mfma_f32_16x16x32_bf16 v[76:79], v[40:43], a[108:111], v[76:79]
  v_mfma_f32_16x16x32_bf16 v[80:83], v[44:47], a[96:99], v[80:83]
  ds_read_b64_tr_b16 v[40:41], v1 offset:28904
  v_mfma_f32_16x16x32_bf16 v[84:87], v[44:47], a[100:103], v[84:87]
  ds_read_b64_tr_b16 v[42:43], v1 offset:29416
  s_waitcnt lgkmcnt(4)
  v_mfma_f32_16x16x32_bf16 v[88:91], v[44:47], a[104:107], v[88:91]
  v_mfma_f32_16x16x32_bf16 v[92:95], v[44:47], a[108:111], v[92:95]
  v_mfma_f32_16x16x32_bf16 v[96:99], v[32:35], a[96:99], v[96:99]
  ds_read_b64_tr_b16 v[44:45], v2 offset:28896
  v_mfma_f32_16x16x32_bf16 v[100:103], v[32:35], a[100:103], v[100:103]
  ds_read_b64_tr_b16 v[46:47], v2 offset:29408
  s_waitcnt lgkmcnt(4)
  v_mfma_f32_16x16x32_bf16 v[104:107], v[32:35], a[104:107], v[104:107]
  s_barrier
  s_add_u32 s51, s35, 3993728
  s_add_u32 m0, s36, 16512
  v_mfma_f32_16x16x32_bf16 v[108:111], v[32:35], a[108:111], v[108:111]
  buffer_load_dwordx4 v4, s[8:11], s51 offen lds
  v_mfma_f32_16x16x32_bf16 v[112:115], v[36:39], a[112:115], v[112:115]
  ds_read_b64_tr_b16 v[32:33], v2 offset:28904
  s_add_u32 s50, s35, 4046976
  v_mfma_f32_16x16x32_bf16 v[116:119], v[36:39], a[116:119], v[116:119]
  ds_read_b64_tr_b16 v[34:35], v2 offset:29416
  s_waitcnt lgkmcnt(4)
  v_mfma_f32_16x16x32_bf16 v[120:123], v[36:39], a[120:123], v[120:123]
  s_add_u32 m0, s36, 20640
  ds_read_b128 v[20:23], v8 offset:8192
  v_mfma_f32_16x16x32_bf16 v[124:127], v[36:39], a[124:127], v[124:127]
  buffer_load_dwordx4 v5, s[8:11], s50 offen lds
  v_mfma_f32_16x16x32_bf16 v[128:131], v[40:43], a[112:115], v[128:131]
  ds_read_b64_tr_b16 v[36:37], v1 offset:33024
  s_add_u32 s51, s35, 4100224
  v_mfma_f32_16x16x32_bf16 v[132:135], v[40:43], a[116:119], v[132:135]
  ds_read_b64_tr_b16 v[38:39], v1 offset:33536
  s_add_u32 m0, s36, 24768
  v_mfma_f32_16x16x32_bf16 v[136:139], v[40:43], a[120:123], v[136:139]
  buffer_load_dwordx4 v5, s[8:11], s51 offen lds
  v_mfma_f32_16x16x32_bf16 v[140:143], v[40:43], a[124:127], v[140:143]
  s_waitcnt lgkmcnt(5)
  ds_read_b128 v[24:27], v8 offset:10240
  v_mfma_f32_16x16x32_bf16 v[144:147], v[44:47], a[112:115], v[144:147]
  ds_read_b64_tr_b16 v[40:41], v1 offset:33032
  s_waitcnt lgkmcnt(4)
  v_mfma_f32_16x16x32_bf16 v[148:151], v[44:47], a[116:119], v[148:151]
  ds_read_b64_tr_b16 v[42:43], v1 offset:33544
  v_lshlrev_b32 v28, 16, v20
  v_mfma_f32_16x16x32_bf16 v[152:155], v[44:47], a[120:123], v[152:155]
  v_and_b32 v20, s44, v20
  v_mul_f32 v28, v28, v48
  v_mfma_f32_16x16x32_bf16 v[156:159], v[44:47], a[124:127], v[156:159]
  v_mul_f32 v20, v20, v49
  v_cvt_pk_bf16_f32 v20, v28, v20
  v_mfma_f32_16x16x32_bf16 v[160:163], v[32:35], a[112:115], v[160:163]
  ds_read_b64_tr_b16 v[44:45], v2 offset:33024
  v_lshlrev_b32 v29, 16, v21
  v_mfma_f32_16x16x32_bf16 v[164:167], v[32:35], a[116:119], v[164:167]
  ds_read_b64_tr_b16 v[46:47], v2 offset:33536
  v_and_b32 v21, s44, v21
  v_mfma_f32_16x16x32_bf16 v[168:171], v[32:35], a[120:123], v[168:171]
  v_mul_f32 v29, v29, v50
  v_mul_f32 v21, v21, v51
  v_mfma_f32_16x16x32_bf16 v[172:175], v[32:35], a[124:127], v[172:175]
  s_waitcnt lgkmcnt(5)
  v_cvt_pk_bf16_f32 v21, v29, v21
  v_lshlrev_b32 v28, 16, v22
  v_mfma_f32_16x16x32_bf16 v[112:115], v[36:39], a[128:131], v[112:115]
  ds_read_b64_tr_b16 v[32:33], v2 offset:33032
  v_and_b32 v22, s44, v22
  v_mfma_f32_16x16x32_bf16 v[116:119], v[36:39], a[132:135], v[116:119]
  ds_read_b64_tr_b16 v[34:35], v2 offset:33544
  v_mul_f32 v28, v28, v64
  v_mfma_f32_16x16x32_bf16 v[120:123], v[36:39], a[136:139], v[120:123]
  v_mul_f32 v22, v22, v65
  v_cvt_pk_bf16_f32 v22, v28, v22
  v_mfma_f32_16x16x32_bf16 v[124:127], v[36:39], a[140:143], v[124:127]
  s_waitcnt lgkmcnt(4)
  v_lshlrev_b32 v29, 16, v23
  v_and_b32 v23, s44, v23
  v_mfma_f32_16x16x32_bf16 v[128:131], v[40:43], a[128:131], v[128:131]
  ds_read_b64_tr_b16 v[36:37], v1 offset:37152
  v_mul_f32 v29, v29, v66
  v_mfma_f32_16x16x32_bf16 v[132:135], v[40:43], a[132:135], v[132:135]
  ds_read_b64_tr_b16 v[38:39], v1 offset:37664
  v_mul_f32 v23, v23, v67
  v_mfma_f32_16x16x32_bf16 v[136:139], v[40:43], a[136:139], v[136:139]
  v_cvt_pk_bf16_f32 v23, v29, v23
  v_lshlrev_b32 v28, 16, v24
  v_mfma_f32_16x16x32_bf16 v[140:143], v[40:43], a[140:143], v[140:143]
  s_waitcnt lgkmcnt(4)
  v_and_b32 v24, s44, v24
  v_mul_f32 v28, v28, v52
  v_mfma_f32_16x16x32_bf16 v[144:147], v[44:47], a[128:131], v[144:147]
  ds_read_b64_tr_b16 v[40:41], v1 offset:37160
  v_mul_f32 v24, v24, v53
  v_mfma_f32_16x16x32_bf16 v[148:151], v[44:47], a[132:135], v[148:151]
  ds_read_b64_tr_b16 v[42:43], v1 offset:37672
  v_cvt_pk_bf16_f32 v24, v28, v24
  v_mfma_f32_16x16x32_bf16 v[152:155], v[44:47], a[136:139], v[152:155]
  buffer_store_dwordx4 v[20:23], v30, s[16:19], s46 offen offset:0 nt
  v_mfma_f32_16x16x32_bf16 v[156:159], v[44:47], a[140:143], v[156:159]
  s_waitcnt lgkmcnt(4)
  ds_read_b128 v[20:23], v8 offset:12288
  v_mfma_f32_16x16x32_bf16 v[160:163], v[32:35], a[128:131], v[160:163]
  ds_read_b64_tr_b16 v[44:45], v2 offset:37152
  v_lshlrev_b32 v29, 16, v25
  v_mfma_f32_16x16x32_bf16 v[164:167], v[32:35], a[132:135], v[164:167]
  ds_read_b64_tr_b16 v[46:47], v2 offset:37664
  v_and_b32 v25, s44, v25
  v_mfma_f32_16x16x32_bf16 v[168:171], v[32:35], a[136:139], v[168:171]
  v_mul_f32 v29, v29, v54
  v_mul_f32 v25, v25, v55
  v_mfma_f32_16x16x32_bf16 v[172:175], v[32:35], a[140:143], v[172:175]
  s_waitcnt lgkmcnt(5)
  v_cvt_pk_bf16_f32 v25, v29, v25
  v_lshlrev_b32 v28, 16, v26
  v_mfma_f32_16x16x32_bf16 v[112:115], v[36:39], a[144:147], v[112:115]
  ds_read_b64_tr_b16 v[32:33], v2 offset:37160
  v_and_b32 v26, s44, v26
  v_mfma_f32_16x16x32_bf16 v[116:119], v[36:39], a[148:151], v[116:119]
  ds_read_b64_tr_b16 v[34:35], v2 offset:37672
  v_mul_f32 v28, v28, v68
  v_mfma_f32_16x16x32_bf16 v[120:123], v[36:39], a[152:155], v[120:123]
  v_mul_f32 v26, v26, v69
  v_cvt_pk_bf16_f32 v26, v28, v26
  v_mfma_f32_16x16x32_bf16 v[124:127], v[36:39], a[156:159], v[124:127]
  s_waitcnt lgkmcnt(5)
  v_lshlrev_b32 v29, 16, v27
  v_and_b32 v27, s44, v27
  v_mfma_f32_16x16x32_bf16 v[128:131], v[40:43], a[144:147], v[128:131]
  ds_read_b64_tr_b16 v[36:37], v1 offset:41280
  v_mul_f32 v29, v29, v70
  v_mfma_f32_16x16x32_bf16 v[132:135], v[40:43], a[148:151], v[132:135]
  ds_read_b64_tr_b16 v[38:39], v1 offset:41792
  v_mul_f32 v27, v27, v71
  v_mfma_f32_16x16x32_bf16 v[136:139], v[40:43], a[152:155], v[136:139]
  v_cvt_pk_bf16_f32 v27, v29, v27
  s_waitcnt lgkmcnt(6)
  v_mfma_f32_16x16x32_bf16 v[140:143], v[40:43], a[156:159], v[140:143]
  s_waitcnt lgkmcnt(4)
  v_lshlrev_b32 v28, 16, v20
  v_and_b32 v20, s44, v20
  v_mfma_f32_16x16x32_bf16 v[144:147], v[44:47], a[144:147], v[144:147]
  ds_read_b64_tr_b16 v[40:41], v1 offset:41288
  v_mul_f32 v28, v28, v56
  v_mfma_f32_16x16x32_bf16 v[148:151], v[44:47], a[148:151], v[148:151]
  ds_read_b64_tr_b16 v[42:43], v1 offset:41800
  v_mul_f32 v20, v20, v57
  v_mfma_f32_16x16x32_bf16 v[152:155], v[44:47], a[152:155], v[152:155]
  buffer_store_dwordx4 v[24:27], v30, s[16:19], s47 offen offset:0 nt
  v_mfma_f32_16x16x32_bf16 v[156:159], v[44:47], a[156:159], v[156:159]
  s_waitcnt lgkmcnt(4)
  ds_read_b128 v[24:27], v8 offset:14336
  v_mfma_f32_16x16x32_bf16 v[160:163], v[32:35], a[144:147], v[160:163]
  ds_read_b64_tr_b16 v[44:45], v2 offset:41280
  v_cvt_pk_bf16_f32 v20, v28, v20
  v_mfma_f32_16x16x32_bf16 v[164:167], v[32:35], a[148:151], v[164:167]
  ds_read_b64_tr_b16 v[46:47], v2 offset:41792
  s_waitcnt vmcnt(8) lgkmcnt(5)
  v_mfma_f32_16x16x32_bf16 v[168:171], v[32:35], a[152:155], v[168:171]
  s_barrier
  s_lshr_b32 s50, 0x3849433d, s37
  s_and_b32 s50, s50, 0xff
  v_mfma_f32_16x16x32_bf16 v[172:175], v[32:35], a[156:159], v[172:175]
  s_mul_i32 s50, s50, 53248
  s_add_u32 s50, s50, s38
  s_add_u32 m0, s39, 28896
  v_mfma_f32_16x16x32_bf16 v[112:115], v[36:39], a[160:163], v[112:115]
  ds_read_b64_tr_b16 v[32:33], v2 offset:41288
  v_lshlrev_b32 v29, 16, v21
  v_mfma_f32_16x16x32_bf16 v[116:119], v[36:39], a[164:167], v[116:119]
  ds_read_b64_tr_b16 v[34:35], v2 offset:41800
  v_and_b32 v21, s44, v21
  v_mfma_f32_16x16x32_bf16 v[120:123], v[36:39], a[168:171], v[120:123]
  buffer_load_dwordx4 v6, s[8:11], s50 offen lds
  v_mfma_f32_16x16x32_bf16 v[124:127], v[36:39], a[172:175], v[124:127]
  s_waitcnt lgkmcnt(5)
  s_lshr_b32 s51, 0x394a443e, s37
  s_and_b32 s51, s51, 0xff
  v_mfma_f32_16x16x32_bf16 v[128:131], v[40:43], a[160:163], v[128:131]
  ds_read_b64_tr_b16 v[36:37], v1 offset:45408
  s_mul_i32 s51, s51, 53248
  v_mfma_f32_16x16x32_bf16 v[132:135], v[40:43], a[164:167], v[132:135]
  ds_read_b64_tr_b16 v[38:39], v1 offset:45920
  s_add_u32 s51, s51, s38
  v_mfma_f32_16x16x32_bf16 v[136:139], v[40:43], a[168:171], v[136:139]
  s_add_u32 m0, s39, 32992
  v_mul_f32 v29, v29, v58
  v_mul_f32 v21, v21, v59
  v_mfma_f32_16x16x32_bf16 v[140:143], v[40:43], a[172:175], v[140:143]
  s_waitcnt lgkmcnt(4)
  v_cvt_pk_bf16_f32 v21, v29, v21
  v_lshlrev_b32 v28, 16, v22
  v_mfma_f32_16x16x32_bf16 v[144:147], v[44:47], a[160:163], v[144:147]
  ds_read_b64_tr_b16 v[40:41], v1 offset:45416
  v_and_b32 v22, s44, v22
  v_mfma_f32_16x16x32_bf16 v[148:151], v[44:47], a[164:167], v[148:151]
  ds_read_b64_tr_b16 v[42:43], v1 offset:45928
  v_mul_f32 v28, v28, v72
  v_mfma_f32_16x16x32_bf16 v[152:155], v[44:47], a[168:171], v[152:155]
  buffer_load_dwordx4 v6, s[8:11], s51 offen lds
  v_mfma_f32_16x16x32_bf16 v[156:159], v[44:47], a[172:175], v[156:159]
  s_waitcnt lgkmcnt(4)
  s_lshr_b32 s50, 0x4b4b453f, s37
  s_and_b32 s50, s50, 0xff
  v_mfma_f32_16x16x32_bf16 v[160:163], v[32:35], a[160:163], v[160:163]
  ds_read_b64_tr_b16 v[44:45], v2 offset:45408
  s_mul_i32 s50, s50, 53248
  v_mfma_f32_16x16x32_bf16 v[164:167], v[32:35], a[164:167], v[164:167]
  ds_read_b64_tr_b16 v[46:47], v2 offset:45920
  s_add_u32 s50, s50, s38
  v_mfma_f32_16x16x32_bf16 v[168:171], v[32:35], a[168:171], v[168:171]
  v_mul_f32 v22, v22, v73
  v_cvt_pk_bf16_f32 v22, v28, v22
  v_mfma_f32_16x16x32_bf16 v[172:175], v[32:35], a[172:175], v[172:175]
  s_waitcnt lgkmcnt(4)
  v_lshlrev_b32 v29, 16, v23
  v_and_b32 v23, s44, v23
  v_mfma_f32_16x16x32_bf16 v[112:115], v[36:39], a[176:179], v[112:115]
  ds_read_b64_tr_b16 v[32:33], v2 offset:45416
  v_mul_f32 v29, v29, v74
  v_mfma_f32_16x16x32_bf16 v[116:119], v[36:39], a[180:183], v[116:119]
  ds_read_b64_tr_b16 v[34:35], v2 offset:45928
  v_mul_f32 v23, v23, v75
  v_mfma_f32_16x16x32_bf16 v[120:123], v[36:39], a[184:187], v[120:123]
  v_cvt_pk_bf16_f32 v23, v29, v23
  v_lshlrev_b32 v28, 16, v24
  v_mfma_f32_16x16x32_bf16 v[124:127], v[36:39], a[188:191], v[124:127]
  s_waitcnt lgkmcnt(4)
  v_and_b32 v24, s44, v24
  v_mul_f32 v28, v28, v60
  v_mfma_f32_16x16x32_bf16 v[128:131], v[40:43], a[176:179], v[128:131]
  ds_read_b64_tr_b16 v[36:37], v1 offset:49536
  s_add_u32 m0, s39, 37088
  v_mfma_f32_16x16x32_bf16 v[132:135], v[40:43], a[180:183], v[132:135]
  ds_read_b64_tr_b16 v[38:39], v1 offset:50048
  v_mul_f32 v24, v24, v61
  v_mfma_f32_16x16x32_bf16 v[136:139], v[40:43], a[184:187], v[136:139]
  buffer_store_dwordx4 v[20:23], v30, s[16:19], s48 offen offset:0 nt
  v_mfma_f32_16x16x32_bf16 v[140:143], v[40:43], a[188:191], v[140:143]
  s_waitcnt lgkmcnt(4)
  ds_read_b128 v[20:23], v9 offset:8192
  v_mfma_f32_16x16x32_bf16 v[144:147], v[44:47], a[176:179], v[144:147]
  ds_read_b64_tr_b16 v[40:41], v1 offset:49544
  v_cvt_pk_bf16_f32 v24, v28, v24
  v_mfma_f32_16x16x32_bf16 v[148:151], v[44:47], a[180:183], v[148:151]
  ds_read_b64_tr_b16 v[42:43], v1 offset:50056
  v_lshlrev_b32 v29, 16, v25
  v_mfma_f32_16x16x32_bf16 v[152:155], v[44:47], a[184:187], v[152:155]
  buffer_load_dwordx4 v6, s[8:11], s50 offen lds
  v_mfma_f32_16x16x32_bf16 v[156:159], v[44:47], a[188:191], v[156:159]
  s_waitcnt lgkmcnt(5)
  v_and_b32 v25, s44, v25
  v_mul_f32 v29, v29, v62
  v_mfma_f32_16x16x32_bf16 v[160:163], v[32:35], a[176:179], v[160:163]
  ds_read_b64_tr_b16 v[44:45], v2 offset:49536
  v_mul_f32 v25, v25, v63
  v_mfma_f32_16x16x32_bf16 v[164:167], v[32:35], a[180:183], v[164:167]
  ds_read_b64_tr_b16 v[46:47], v2 offset:50048
  v_cvt_pk_bf16_f32 v25, v29, v25
  v_mfma_f32_16x16x32_bf16 v[168:171], v[32:35], a[184:187], v[168:171]
  v_lshlrev_b32 v28, 16, v26
  v_and_b32 v26, s44, v26
  v_mfma_f32_16x16x32_bf16 v[172:175], v[32:35], a[188:191], v[172:175]
  s_waitcnt lgkmcnt(5)
  v_mul_f32 v28, v28, v76
  v_mul_f32 v26, v26, v77
  v_mfma_f32_16x16x32_bf16 v[112:115], v[36:39], a[192:195], v[112:115]
  ds_read_b64_tr_b16 v[32:33], v2 offset:49544
  v_cvt_pk_bf16_f32 v26, v28, v26
  v_mfma_f32_16x16x32_bf16 v[116:119], v[36:39], a[196:199], v[116:119]
  ds_read_b64_tr_b16 v[34:35], v2 offset:50056
  v_lshlrev_b32 v29, 16, v27
  v_mfma_f32_16x16x32_bf16 v[120:123], v[36:39], a[200:203], v[120:123]
  v_and_b32 v27, s44, v27
  v_mul_f32 v29, v29, v78
  v_mfma_f32_16x16x32_bf16 v[124:127], v[36:39], a[204:207], v[124:127]
  s_waitcnt lgkmcnt(4)
  v_mul_f32 v27, v27, v79
  v_cvt_pk_bf16_f32 v27, v29, v27
  v_mfma_f32_16x16x32_bf16 v[128:131], v[40:43], a[192:195], v[128:131]
  ds_read_b64_tr_b16 v[36:37], v1 offset:0
  v_lshlrev_b32 v28, 16, v20
  v_mfma_f32_16x16x32_bf16 v[132:135], v[40:43], a[196:199], v[132:135]
  ds_read_b64_tr_b16 v[38:39], v1 offset:512
  v_and_b32 v20, s44, v20
  v_mfma_f32_16x16x32_bf16 v[136:139], v[40:43], a[200:203], v[136:139]
  buffer_store_dwordx4 v[24:27], v30, s[16:19], s49 offen offset:0 nt
  v_mfma_f32_16x16x32_bf16 v[140:143], v[40:43], a[204:207], v[140:143]
  s_waitcnt lgkmcnt(4)
  ds_read_b128 v[24:27], v9 offset:10240
  v_mfma_f32_16x16x32_bf16 v[144:147], v[44:47], a[192:195], v[144:147]
  ds_read_b64_tr_b16 v[40:41], v1 offset:8
  v_mul_f32 v28, v28, v80
  v_mfma_f32_16x16x32_bf16 v[148:151], v[44:47], a[196:199], v[148:151]
  ds_read_b64_tr_b16 v[42:43], v1 offset:520
  v_mul_f32 v20, v20, v81
  v_mfma_f32_16x16x32_bf16 v[152:155], v[44:47], a[200:203], v[152:155]
  v_cvt_pk_bf16_f32 v20, v28, v20
  v_lshlrev_b32 v29, 16, v21
  v_mfma_f32_16x16x32_bf16 v[156:159], v[44:47], a[204:207], v[156:159]
  s_waitcnt lgkmcnt(5)
  v_and_b32 v21, s44, v21
  v_mul_f32 v29, v29, v82
  v_mfma_f32_16x16x32_bf16 v[160:163], v[32:35], a[192:195], v[160:163]
  ds_read_b64_tr_b16 v[44:45], v2 offset:0
  v_mul_f32 v21, v21, v83
  v_mfma_f32_16x16x32_bf16 v[164:167], v[32:35], a[196:199], v[164:167]
  ds_read_b64_tr_b16 v[46:47], v2 offset:512
  s_waitcnt vmcnt(10) lgkmcnt(5)
  v_mfma_f32_16x16x32_bf16 v[168:171], v[32:35], a[200:203], v[168:171]
  s_barrier
  s_lshr_b32 s51, 0x4d4d4d4c, s37
  s_and_b32 s51, s51, 0xff
  v_mfma_f32_16x16x32_bf16 v[172:175], v[32:35], a[204:207], v[172:175]
  s_mul_i32 s51, s51, 53248
  s_add_u32 s51, s51, s38
  s_add_u32 m0, s39, 41184
  v_mfma_f32_16x16x32_bf16 v[112:115], v[36:39], a[0:3], v[112:115]
  ds_read_b64_tr_b16 v[32:33], v2 offset:8
  v_cvt_pk_bf16_f32 v21, v29, v21
  v_mfma_f32_16x16x32_bf16 v[116:119], v[36:39], a[4:7], v[116:119]
  ds_read_b64_tr_b16 v[34:35], v2 offset:520
  v_lshlrev_b32 v28, 16, v22
  v_mfma_f32_16x16x32_bf16 v[120:123], v[36:39], a[8:11], v[120:123]
  buffer_load_dwordx4 v7, s[8:11], s51 offen lds
  v_mfma_f32_16x16x32_bf16 v[124:127], v[36:39], a[12:15], v[124:127]
  s_waitcnt lgkmcnt(4)
  s_add_u32 s50, s35, 3248384
  v_and_b32 v22, s44, v22
  v_mfma_f32_16x16x32_bf16 v[128:131], v[40:43], a[0:3], v[128:131]
  ds_read_b64_tr_b16 v[36:37], v1 offset:4128
  v_mul_f32 v28, v28, v96
  v_mfma_f32_16x16x32_bf16 v[132:135], v[40:43], a[4:7], v[132:135]
  ds_read_b64_tr_b16 v[38:39], v1 offset:4640
  v_mul_f32 v22, v22, v97
  v_mfma_f32_16x16x32_bf16 v[136:139], v[40:43], a[8:11], v[136:139]
  v_cvt_pk_bf16_f32 v22, v28, v22
  v_lshlrev_b32 v29, 16, v23
  v_mfma_f32_16x16x32_bf16 v[140:143], v[40:43], a[12:15], v[140:143]
  s_waitcnt lgkmcnt(4)
  v_and_b32 v23, s44, v23
  v_mul_f32 v29, v29, v98
  v_mfma_f32_16x16x32_bf16 v[144:147], v[44:47], a[0:3], v[144:147]
  ds_read_b64_tr_b16 v[40:41], v1 offset:4136
  v_mul_f32 v23, v23, v99
  v_mfma_f32_16x16x32_bf16 v[148:151], v[44:47], a[4:7], v[148:151]
  ds_read_b64_tr_b16 v[42:43], v1 offset:4648
  v_cvt_pk_bf16_f32 v23, v29, v23
  v_mfma_f32_16x16x32_bf16 v[152:155], v[44:47], a[8:11], v[152:155]
  buffer_store_dwordx4 v[20:23], v30, s[16:19], s46 offen offset:64 nt
  v_mfma_f32_16x16x32_bf16 v[156:159], v[44:47], a[12:15], v[156:159]
  s_waitcnt lgkmcnt(4)
  ds_read_b128 v[20:23], v9 offset:12288
  v_mfma_f32_16x16x32_bf16 v[160:163], v[32:35], a[0:3], v[160:163]
  ds_read_b64_tr_b16 v[44:45], v2 offset:4128
  v_lshlrev_b32 v28, 16, v24
  v_mfma_f32_16x16x32_bf16 v[164:167], v[32:35], a[4:7], v[164:167]
  ds_read_b64_tr_b16 v[46:47], v2 offset:4640
  v_and_b32 v24, s44, v24
  v_mfma_f32_16x16x32_bf16 v[168:171], v[32:35], a[8:11], v[168:171]
  v_mul_f32 v28, v28, v84
  v_mul_f32 v24, v24, v85
  v_mfma_f32_16x16x32_bf16 v[172:175], v[32:35], a[12:15], v[172:175]
  s_waitcnt lgkmcnt(5)
  v_cvt_pk_bf16_f32 v24, v28, v24
  v_lshlrev_b32 v29, 16, v25
  v_mfma_f32_16x16x32_bf16 v[112:115], v[36:39], a[16:19], v[112:115]
  ds_read_b64_tr_b16 v[32:33], v2 offset:4136
  v_and_b32 v25, s44, v25
  v_mfma_f32_16x16x32_bf16 v[116:119], v[36:39], a[20:23], v[116:119]
  ds_read_b64_tr_b16 v[34:35], v2 offset:4648
  v_mul_f32 v29, v29, v86
  v_mfma_f32_16x16x32_bf16 v[120:123], v[36:39], a[24:27], v[120:123]
  v_mul_f32 v25, v25, v87
  v_cvt_pk_bf16_f32 v25, v29, v25
  v_mfma_f32_16x16x32_bf16 v[124:127], v[36:39], a[28:31], v[124:127]
  s_waitcnt lgkmcnt(5)
  v_lshlrev_b32 v28, 16, v26
  v_and_b32 v26, s44, v26
  v_mfma_f32_16x16x32_bf16 v[128:131], v[40:43], a[16:19], v[128:131]
  ds_read_b64_tr_b16 v[36:37], v1 offset:8256
  v_mul_f32 v28, v28, v100
  v_mfma_f32_16x16x32_bf16 v[132:135], v[40:43], a[20:23], v[132:135]
  ds_read_b64_tr_b16 v[38:39], v1 offset:8768
  s_add_u32 m0, s36, 45280
  v_mfma_f32_16x16x32_bf16 v[136:139], v[40:43], a[24:27], v[136:139]
  buffer_load_dwordx4 v4, s[8:11], s50 offen lds
  v_mfma_f32_16x16x32_bf16 v[140:143], v[40:43], a[28:31], v[140:143]
  s_waitcnt lgkmcnt(4)
  s_add_u32 s51, s35, 3567872
  v_mul_f32 v26, v26, v101
  v_mfma_f32_16x16x32_bf16 v[144:147], v[44:47], a[16:19], v[144:147]
  ds_read_b64_tr_b16 v[40:41], v1 offset:8264
  v_cvt_pk_bf16_f32 v26, v28, v26
  v_mfma_f32_16x16x32_bf16 v[148:151], v[44:47], a[20:23], v[148:151]
  ds_read_b64_tr_b16 v[42:43], v1 offset:8776
  v_lshlrev_b32 v29, 16, v27
  v_mfma_f32_16x16x32_bf16 v[152:155], v[44:47], a[24:27], v[152:155]
  s_add_u32 m0, s36, 49408
  v_and_b32 v27, s44, v27
  v_mul_f32 v29, v29, v102
  v_mfma_f32_16x16x32_bf16 v[156:159], v[44:47], a[28:31], v[156:159]
  s_waitcnt lgkmcnt(4)
  v_mul_f32 v27, v27, v103
  v_cvt_pk_bf16_f32 v27, v29, v27
  v_mfma_f32_16x16x32_bf16 v[160:163], v[32:35], a[16:19], v[160:163]
  ds_read_b64_tr_b16 v[44:45], v2 offset:8256
  v_lshlrev_b32 v28, 16, v20
  v_mfma_f32_16x16x32_bf16 v[164:167], v[32:35], a[20:23], v[164:167]
  ds_read_b64_tr_b16 v[46:47], v2 offset:8768
  v_and_b32 v20, s44, v20
  v_mfma_f32_16x16x32_bf16 v[168:171], v[32:35], a[24:27], v[168:171]
  buffer_store_dwordx4 v[24:27], v30, s[16:19], s47 offen offset:64 nt
  v_mfma_f32_16x16x32_bf16 v[172:175], v[32:35], a[28:31], v[172:175]
  s_waitcnt lgkmcnt(4)
  ds_read_b128 v[24:27], v9 offset:14336
  v_mfma_f32_16x16x32_bf16 v[112:115], v[36:39], a[32:35], v[112:115]
  ds_read_b64_tr_b16 v[32:33], v2 offset:8264
  v_mul_f32 v28, v28, v88
  v_mfma_f32_16x16x32_bf16 v[116:119], v[36:39], a[36:39], v[116:119]
  ds_read_b64_tr_b16 v[34:35], v2 offset:8776
  v_mul_f32 v20, v20, v89
  v_mfma_f32_16x16x32_bf16 v[120:123], v[36:39], a[40:43], v[120:123]
  buffer_load_dwordx4 v4, s[8:11], s51 offen lds
  v_mfma_f32_16x16x32_bf16 v[124:127], v[36:39], a[44:47], v[124:127]
  s_waitcnt lgkmcnt(5)
  v_cvt_pk_bf16_f32 v20, v28, v20
  v_lshlrev_b32 v29, 16, v21
  v_mfma_f32_16x16x32_bf16 v[128:131], v[40:43], a[32:35], v[128:131]
  ds_read_b64_tr_b16 v[36:37], v1 offset:12384
  v_and_b32 v21, s44, v21
  v_mfma_f32_16x16x32_bf16 v[132:135], v[40:43], a[36:39], v[132:135]
  ds_read_b64_tr_b16 v[38:39], v1 offset:12896
  v_mul_f32 v29, v29, v90
  v_mfma_f32_16x16x32_bf16 v[136:139], v[40:43], a[40:43], v[136:139]
  v_mul_f32 v21, v21, v91
  v_cvt_pk_bf16_f32 v21, v29, v21
  v_mfma_f32_16x16x32_bf16 v[140:143], v[40:43], a[44:47], v[140:143]
  s_waitcnt lgkmcnt(5)
  v_lshlrev_b32 v28, 16, v22
  v_and_b32 v22, s44, v22
  v_mfma_f32_16x16x32_bf16 v[144:147], v[44:47], a[32:35], v[144:147]
  ds_read_b64_tr_b16 v[40:41], v1 offset:12392
  v_mul_f32 v28, v28, v104
  v_mfma_f32_16x16x32_bf16 v[148:151], v[44:47], a[36:39], v[148:151]
  ds_read_b64_tr_b16 v[42:43], v1 offset:12904
  v_mul_f32 v22, v22, v105
  v_mfma_f32_16x16x32_bf16 v[152:155], v[44:47], a[40:43], v[152:155]
  v_cvt_pk_bf16_f32 v22, v28, v22
  v_lshlrev_b32 v29, 16, v23
  v_mfma_f32_16x16x32_bf16 v[156:159], v[44:47], a[44:47], v[156:159]
  s_waitcnt lgkmcnt(4)
  v_and_b32 v23, s44, v23
  v_mul_f32 v29, v29, v106
  v_mfma_f32_16x16x32_bf16 v[160:163], v[32:35], a[32:35], v[160:163]
  ds_read_b64_tr_b16 v[44:45], v2 offset:12384
  v_mul_f32 v23, v23, v107
  v_mfma_f32_16x16x32_bf16 v[164:167], v[32:35], a[36:39], v[164:167]
  ds_read_b64_tr_b16 v[46:47], v2 offset:12896
  s_waitcnt vmcnt(12) lgkmcnt(4)
  v_mfma_f32_16x16x32_bf16 v[168:171], v[32:35], a[40:43], v[168:171]
  s_barrier
  s_add_u32 s50, s35, 3887360
  s_add_u32 m0, s36, 0
  v_mfma_f32_16x16x32_bf16 v[172:175], v[32:35], a[44:47], v[172:175]
  buffer_load_dwordx4 v4, s[8:11], s50 offen lds
  v_mfma_f32_16x16x32_bf16 v[112:115], v[36:39], a[48:51], v[112:115]
  ds_read_b64_tr_b16 v[32:33], v2 offset:12392
  s_add_u32 s51, s35, 2982144
  v_mfma_f32_16x16x32_bf16 v[116:119], v[36:39], a[52:55], v[116:119]
  ds_read_b64_tr_b16 v[34:35], v2 offset:12904
  s_add_u32 m0, s36, 4128
  v_mfma_f32_16x16x32_bf16 v[120:123], v[36:39], a[56:59], v[120:123]
  buffer_load_dwordx4 v4, s[8:11], s51 offen lds
  v_mfma_f32_16x16x32_bf16 v[124:127], v[36:39], a[60:63], v[124:127]
  s_waitcnt lgkmcnt(4)
  s_add_u32 s50, s35, 3301632
  s_add_u32 m0, s36, 8256
  v_mfma_f32_16x16x32_bf16 v[128:131], v[40:43], a[48:51], v[128:131]
  ds_read_b64_tr_b16 v[36:37], v1 offset:16512
  v_cvt_pk_bf16_f32 v23, v29, v23
  v_mfma_f32_16x16x32_bf16 v[132:135], v[40:43], a[52:55], v[132:135]
  ds_read_b64_tr_b16 v[38:39], v1 offset:17024
  v_lshlrev_b32 v28, 16, v24
  v_mfma_f32_16x16x32_bf16 v[136:139], v[40:43], a[56:59], v[136:139]
  buffer_store_dwordx4 v[20:23], v30, s[16:19], s48 offen offset:64 nt
  v_mfma_f32_16x16x32_bf16 v[140:143], v[40:43], a[60:63], v[140:143]
  s_waitcnt lgkmcnt(4)
  v_and_b32 v24, s44, v24
  v_mul_f32 v28, v28, v92
  v_mfma_f32_16x16x32_bf16 v[144:147], v[44:47], a[48:51], v[144:147]
  ds_read_b64_tr_b16 v[40:41], v1 offset:16520
  v_mul_f32 v24, v24, v93
  v_mfma_f32_16x16x32_bf16 v[148:151], v[44:47], a[52:55], v[148:151]
  ds_read_b64_tr_b16 v[42:43], v1 offset:17032
  v_cvt_pk_bf16_f32 v24, v28, v24
  v_mfma_f32_16x16x32_bf16 v[152:155], v[44:47], a[56:59], v[152:155]
  buffer_load_dwordx4 v4, s[8:11], s50 offen lds
  v_mfma_f32_16x16x32_bf16 v[156:159], v[44:47], a[60:63], v[156:159]
  s_waitcnt lgkmcnt(4)
  v_lshlrev_b32 v29, 16, v25
  v_and_b32 v25, s44, v25
  v_mfma_f32_16x16x32_bf16 v[160:163], v[32:35], a[48:51], v[160:163]
  ds_read_b64_tr_b16 v[44:45], v2 offset:16512
  v_mul_f32 v29, v29, v94
  v_mfma_f32_16x16x32_bf16 v[164:167], v[32:35], a[52:55], v[164:167]
  ds_read_b64_tr_b16 v[46:47], v2 offset:17024
  v_mul_f32 v25, v25, v95
  v_mfma_f32_16x16x32_bf16 v[168:171], v[32:35], a[56:59], v[168:171]
  v_cvt_pk_bf16_f32 v25, v29, v25
  v_lshlrev_b32 v28, 16, v26
  v_mfma_f32_16x16x32_bf16 v[172:175], v[32:35], a[60:63], v[172:175]
  s_waitcnt lgkmcnt(4)
  v_and_b32 v26, s44, v26
  v_mul_f32 v28, v28, v108
  v_mfma_f32_16x16x32_bf16 v[112:115], v[36:39], a[64:67], v[112:115]
  ds_read_b64_tr_b16 v[32:33], v2 offset:16520
  v_mul_f32 v26, v26, v109
  v_mfma_f32_16x16x32_bf16 v[116:119], v[36:39], a[68:71], v[116:119]
  ds_read_b64_tr_b16 v[34:35], v2 offset:17032
  v_cvt_pk_bf16_f32 v26, v28, v26
  v_mfma_f32_16x16x32_bf16 v[120:123], v[36:39], a[72:75], v[120:123]
  v_lshlrev_b32 v29, 16, v27
  v_and_b32 v27, s44, v27
  v_mfma_f32_16x16x32_bf16 v[124:127], v[36:39], a[76:79], v[124:127]
  s_waitcnt lgkmcnt(4)
  v_mul_f32 v29, v29, v110
  v_mul_f32 v27, v27, v111
  v_mfma_f32_16x16x32_bf16 v[128:131], v[40:43], a[64:67], v[128:131]
  ds_read_b64_tr_b16 v[36:37], v1 offset:20640
  v_cvt_pk_bf16_f32 v27, v29, v27
  v_mfma_f32_16x16x32_bf16 v[132:135], v[40:43], a[68:71], v[132:135]
  ds_read_b64_tr_b16 v[38:39], v1 offset:21152
  s_waitcnt lgkmcnt(4)
  v_mfma_f32_16x16x32_bf16 v[136:139], v[40:43], a[72:75], v[136:139]
  buffer_store_dwordx4 v[24:27], v30, s[16:19], s49 offen offset:64 nt
  v_mfma_f32_16x16x32_bf16 v[140:143], v[40:43], a[76:79], v[140:143]
  v_mfma_f32_16x16x32_bf16 v[144:147], v[44:47], a[64:67], v[144:147]
  ds_read_b64_tr_b16 v[40:41], v1 offset:20648
  v_mfma_f32_16x16x32_bf16 v[148:151], v[44:47], a[68:71], v[148:151]
  ds_read_b64_tr_b16 v[42:43], v1 offset:21160
  s_waitcnt lgkmcnt(4)
  v_mfma_f32_16x16x32_bf16 v[152:155], v[44:47], a[72:75], v[152:155]
  v_mfma_f32_16x16x32_bf16 v[156:159], v[44:47], a[76:79], v[156:159]
  v_mfma_f32_16x16x32_bf16 v[160:163], v[32:35], a[64:67], v[160:163]
  ds_read_b64_tr_b16 v[44:45], v2 offset:20640
  v_mfma_f32_16x16x32_bf16 v[164:167], v[32:35], a[68:71], v[164:167]
  ds_read_b64_tr_b16 v[46:47], v2 offset:21152
  s_waitcnt lgkmcnt(4)
  v_mfma_f32_16x16x32_bf16 v[168:171], v[32:35], a[72:75], v[168:171]
  v_mfma_f32_16x16x32_bf16 v[172:175], v[32:35], a[76:79], v[172:175]
  v_mfma_f32_16x16x32_bf16 v[112:115], v[36:39], a[80:83], v[112:115]
  ds_read_b64_tr_b16 v[32:33], v2 offset:20648
  v_mfma_f32_16x16x32_bf16 v[116:119], v[36:39], a[84:87], v[116:119]
  ds_read_b64_tr_b16 v[34:35], v2 offset:21160
  s_waitcnt lgkmcnt(4)
  v_mfma_f32_16x16x32_bf16 v[120:123], v[36:39], a[88:91], v[120:123]
  v_mfma_f32_16x16x32_bf16 v[124:127], v[36:39], a[92:95], v[124:127]
  v_mfma_f32_16x16x32_bf16 v[128:131], v[40:43], a[80:83], v[128:131]
  ds_read_b64_tr_b16 v[36:37], v1 offset:24768
  v_mfma_f32_16x16x32_bf16 v[132:135], v[40:43], a[84:87], v[132:135]
  ds_read_b64_tr_b16 v[38:39], v1 offset:25280
  s_waitcnt lgkmcnt(4)
  v_mfma_f32_16x16x32_bf16 v[136:139], v[40:43], a[88:91], v[136:139]
  v_mfma_f32_16x16x32_bf16 v[140:143], v[40:43], a[92:95], v[140:143]
  v_mfma_f32_16x16x32_bf16 v[144:147], v[44:47], a[80:83], v[144:147]
  ds_read_b64_tr_b16 v[40:41], v1 offset:24776
  v_mfma_f32_16x16x32_bf16 v[148:151], v[44:47], a[84:87], v[148:151]
  ds_read_b64_tr_b16 v[42:43], v1 offset:25288
  s_waitcnt lgkmcnt(4)
  v_mfma_f32_16x16x32_bf16 v[152:155], v[44:47], a[88:91], v[152:155]
  v_mfma_f32_16x16x32_bf16 v[156:159], v[44:47], a[92:95], v[156:159]
  v_mfma_f32_16x16x32_bf16 v[160:163], v[32:35], a[80:83], v[160:163]
  ds_read_b64_tr_b16 v[44:45], v2 offset:24768
  v_mfma_f32_16x16x32_bf16 v[164:167], v[32:35], a[84:87], v[164:167]
  ds_read_b64_tr_b16 v[46:47], v2 offset:25280
  s_waitcnt vmcnt(11) lgkmcnt(4)
  v_mfma_f32_16x16x32_bf16 v[168:171], v[32:35], a[88:91], v[168:171]
  s_barrier
  s_add_u32 s51, s35, 3621120
  s_add_u32 m0, s36, 12384
  v_mfma_f32_16x16x32_bf16 v[172:175], v[32:35], a[92:95], v[172:175]
  buffer_load_dwordx4 v4, s[8:11], s51 offen lds
  v_mfma_f32_16x16x32_bf16 v[112:115], v[36:39], a[96:99], v[112:115]
  ds_read_b64_tr_b16 v[32:33], v2 offset:24776
  s_add_u32 s50, s35, 3940608
  v_mfma_f32_16x16x32_bf16 v[116:119], v[36:39], a[100:103], v[116:119]
  ds_read_b64_tr_b16 v[34:35], v2 offset:25288
  s_waitcnt lgkmcnt(4)
  v_mfma_f32_16x16x32_bf16 v[120:123], v[36:39], a[104:107], v[120:123]
  s_add_u32 m0, s36, 16512
  v_mfma_f32_16x16x32_bf16 v[124:127], v[36:39], a[108:111], v[124:127]
  buffer_load_dwordx4 v4, s[8:11], s50 offen lds
  v_mfma_f32_16x16x32_bf16 v[128:131], v[40:43], a[96:99], v[128:131]
  ds_read_b64_tr_b16 v[36:37], v3 offset:28896
  s_add_u32 s51, s35, 3035392
  v_mfma_f32_16x16x32_bf16 v[132:135], v[40:43], a[100:103], v[132:135]
  ds_read_b64_tr_b16 v[38:39], v3 offset:29152
  s_waitcnt lgkmcnt(4)
  v_mfma_f32_16x16x32_bf16 v[136:139], v[40:43], a[104:107], v[136:139]
  s_add_u32 m0, s36, 20640
  v_mfma_f32_16x16x32_bf16 v[140:143], v[40:43], a[108:111], v[140:143]
  buffer_load_dwordx4 v4, s[8:11], s51 offen lds
  v_mfma_f32_16x16x32_bf16 v[144:147], v[44:47], a[96:99], v[144:147]
  ds_read_b64_tr_b16 v[40:41], v3 offset:29920
  v_mfma_f32_16x16x32_bf16 v[148:151], v[44:47], a[100:103], v[148:151]
  ds_read_b64_tr_b16 v[42:43], v3 offset:30176
  s_waitcnt lgkmcnt(4)
  v_mfma_f32_16x16x32_bf16 v[152:155], v[44:47], a[104:107], v[152:155]
  v_mfma_f32_16x16x32_bf16 v[156:159], v[44:47], a[108:111], v[156:159]
  v_mfma_f32_16x16x32_bf16 v[160:163], v[32:35], a[96:99], v[160:163]
  ds_read_b64_tr_b16 v[44:45], v3 offset:30944
  v_mfma_f32_16x16x32_bf16 v[164:167], v[32:35], a[100:103], v[164:167]
  ds_read_b64_tr_b16 v[46:47], v3 offset:31200
  s_waitcnt lgkmcnt(4)
  v_mfma_f32_16x16x32_bf16 v[168:171], v[32:35], a[104:107], v[168:171]
  ds_read_b128 v[20:23], v8 offset:16384
  v_mfma_f32_16x16x32_bf16 v[172:175], v[32:35], a[108:111], v[172:175]
  ds_read_b128 v[24:27], v8 offset:18432
  v_mfma_f32_16x16x32_bf16 v[240:243], v[36:39], a[112:115], v[240:243]
  ds_read_b64_tr_b16 v[32:33], v3 offset:31968
  v_mfma_f32_16x16x32_bf16 v[244:247], v[36:39], a[116:119], v[244:247]
  ds_read_b64_tr_b16 v[34:35], v3 offset:32224
  s_waitcnt lgkmcnt(6)
  v_mfma_f32_16x16x32_bf16 v[248:251], v[36:39], a[120:123], v[248:251]
  v_mfma_f32_16x16x32_bf16 v[252:255], v[36:39], a[124:127], v[252:255]
  v_mfma_f32_16x16x32_bf16 v[240:243], v[40:43], a[128:131], v[240:243]
  ds_read_b64_tr_b16 v[36:37], v3 offset:32992
  s_waitcnt lgkmcnt(4)
  v_mfma_f32_16x16x32_bf16 v[244:247], v[40:43], a[132:135], v[244:247]
  ds_read_b64_tr_b16 v[38:39], v3 offset:33248
  v_lshlrev_b32 v28, 16, v20
  v_mfma_f32_16x16x32_bf16 v[248:251], v[40:43], a[136:139], v[248:251]
  v_and_b32 v20, s44, v20
  v_mul_f32 v28, v28, v112
  v_mfma_f32_16x16x32_bf16 v[252:255], v[40:43], a[140:143], v[252:255]
  v_mul_f32 v20, v20, v113
  v_cvt_pk_bf16_f32 v20, v28, v20
  v_mfma_f32_16x16x32_bf16 v[240:243], v[44:47], a[144:147], v[240:243]
  ds_read_b64_tr_b16 v[40:41], v3 offset:34016
  v_lshlrev_b32 v29, 16, v21
  v_mfma_f32_16x16x32_bf16 v[244:247], v[44:47], a[148:151], v[244:247]
  ds_read_b64_tr_b16 v[42:43], v3 offset:34272
  v_and_b32 v21, s44, v21
  v_mfma_f32_16x16x32_bf16 v[248:251], v[44:47], a[152:155], v[248:251]
  v_mul_f32 v29, v29, v114
  v_mul_f32 v21, v21, v115
  v_mfma_f32_16x16x32_bf16 v[252:255], v[44:47], a[156:159], v[252:255]
  s_waitcnt lgkmcnt(4)
  v_cvt_pk_bf16_f32 v21, v29, v21
  v_lshlrev_b32 v28, 16, v22
  v_mfma_f32_16x16x32_bf16 v[240:243], v[32:35], a[160:163], v[240:243]
  ds_read_b64_tr_b16 v[44:45], v3 offset:35040
  v_and_b32 v22, s44, v22
  v_mfma_f32_16x16x32_bf16 v[244:247], v[32:35], a[164:167], v[244:247]
  ds_read_b64_tr_b16 v[46:47], v3 offset:35296
  v_mul_f32 v28, v28, v128
  v_mfma_f32_16x16x32_bf16 v[248:251], v[32:35], a[168:171], v[248:251]
  v_mul_f32 v22, v22, v129
  v_cvt_pk_bf16_f32 v22, v28, v22
  v_mfma_f32_16x16x32_bf16 v[252:255], v[32:35], a[172:175], v[252:255]
  s_waitcnt lgkmcnt(4)
  v_lshlrev_b32 v29, 16, v23
  v_and_b32 v23, s44, v23
  v_mfma_f32_16x16x32_bf16 v[240:243], v[36:39], a[176:179], v[240:243]
  ds_read_b64_tr_b16 v[32:33], v3 offset:36064
  v_mul_f32 v29, v29, v130
  v_mfma_f32_16x16x32_bf16 v[244:247], v[36:39], a[180:183], v[244:247]
  ds_read_b64_tr_b16 v[34:35], v3 offset:36320
  v_mul_f32 v23, v23, v131
  v_mfma_f32_16x16x32_bf16 v[248:251], v[36:39], a[184:187], v[248:251]
  v_cvt_pk_bf16_f32 v23, v29, v23
  v_lshlrev_b32 v28, 16, v24
  v_mfma_f32_16x16x32_bf16 v[252:255], v[36:39], a[188:191], v[252:255]
  s_waitcnt lgkmcnt(4)
  v_and_b32 v24, s44, v24
  v_mul_f32 v28, v28, v116
  v_mfma_f32_16x16x32_bf16 v[240:243], v[40:43], a[192:195], v[240:243]
  ds_read_b64_tr_b16 v[36:37], v3 offset:37088
  v_mul_f32 v24, v24, v117
  v_mfma_f32_16x16x32_bf16 v[244:247], v[40:43], a[196:199], v[244:247]
  ds_read_b64_tr_b16 v[38:39], v3 offset:37344
  v_cvt_pk_bf16_f32 v24, v28, v24
  v_mfma_f32_16x16x32_bf16 v[248:251], v[40:43], a[200:203], v[248:251]
  buffer_store_dwordx4 v[20:23], v30, s[16:19], s46 offen offset:128 nt
  v_mfma_f32_16x16x32_bf16 v[252:255], v[40:43], a[204:207], v[252:255]
  s_waitcnt lgkmcnt(4)
  ds_read_b128 v[20:23], v8 offset:20480
  v_mfma_f32_16x16x32_bf16 v[240:243], v[44:47], a[0:3], v[240:243]
  ds_read_b64_tr_b16 v[40:41], v3 offset:38112
  v_lshlrev_b32 v29, 16, v25
  v_mfma_f32_16x16x32_bf16 v[244:247], v[44:47], a[4:7], v[244:247]
  ds_read_b64_tr_b16 v[42:43], v3 offset:38368
  v_and_b32 v25, s44, v25
  v_mfma_f32_16x16x32_bf16 v[248:251], v[44:47], a[8:11], v[248:251]
  v_mul_f32 v29, v29, v118
  v_mul_f32 v25, v25, v119
  v_mfma_f32_16x16x32_bf16 v[252:255], v[44:47], a[12:15], v[252:255]
  s_waitcnt lgkmcnt(5)
  v_cvt_pk_bf16_f32 v25, v29, v25
  v_lshlrev_b32 v28, 16, v26
  v_mfma_f32_16x16x32_bf16 v[240:243], v[32:35], a[16:19], v[240:243]
  ds_read_b64_tr_b16 v[44:45], v3 offset:39136
  v_and_b32 v26, s44, v26
  v_mfma_f32_16x16x32_bf16 v[244:247], v[32:35], a[20:23], v[244:247]
  ds_read_b64_tr_b16 v[46:47], v3 offset:39392
  s_waitcnt vmcnt(8) lgkmcnt(5)
  v_mfma_f32_16x16x32_bf16 v[248:251], v[32:35], a[24:27], v[248:251]
  s_barrier
  s_add_u32 s50, s35, 3354880
  s_add_u32 m0, s36, 24768
  v_mfma_f32_16x16x32_bf16 v[252:255], v[32:35], a[28:31], v[252:255]
  buffer_load_dwordx4 v4, s[8:11], s50 offen lds
  v_mfma_f32_16x16x32_bf16 v[240:243], v[36:39], a[32:35], v[240:243]
  ds_read_b64_tr_b16 v[32:33], v3 offset:41184
  s_add_u32 s51, s35, 3674368
  v_mfma_f32_16x16x32_bf16 v[244:247], v[36:39], a[36:39], v[244:247]
  ds_read_b64_tr_b16 v[34:35], v3 offset:41440
  s_add_u32 m0, s36, 28896
  v_mfma_f32_16x16x32_bf16 v[248:251], v[36:39], a[40:43], v[248:251]
  buffer_load_dwordx4 v4, s[8:11], s51 offen lds
  v_mfma_f32_16x16x32_bf16 v[252:255], v[36:39], a[44:47], v[252:255]
  s_waitcnt lgkmcnt(4)
  v_mul_f32 v28, v28, v132
  v_mul_f32 v26, v26, v133
  v_mfma_f32_16x16x32_bf16 v[240:243], v[40:43], a[48:51], v[240:243]
  ds_read_b64_tr_b16 v[36:37], v3 offset:42208
  v_cvt_pk_bf16_f32 v26, v28, v26
  v_mfma_f32_16x16x32_bf16 v[244:247], v[40:43], a[52:55], v[244:247]
  ds_read_b64_tr_b16 v[38:39], v3 offset:42464
  v_lshlrev_b32 v29, 16, v27
  v_mfma_f32_16x16x32_bf16 v[248:251], v[40:43], a[56:59], v[248:251]
  v_and_b32 v27, s44, v27
  v_mul_f32 v29, v29, v134
  v_mfma_f32_16x16x32_bf16 v[252:255], v[40:43], a[60:63], v[252:255]
  s_waitcnt lgkmcnt(4)
  v_mul_f32 v27, v27, v135
  v_cvt_pk_bf16_f32 v27, v29, v27
  v_mfma_f32_16x16x32_bf16 v[240:243], v[44:47], a[64:67], v[240:243]
  ds_read_b64_tr_b16 v[40:41], v1 offset:45280
  v_lshlrev_b32 v28, 16, v20
  v_mfma_f32_16x16x32_bf16 v[244:247], v[44:47], a[68:71], v[244:247]
  ds_read_b64_tr_b16 v[42:43], v1 offset:45792
  v_and_b32 v20, s44, v20
  v_mfma_f32_16x16x32_bf16 v[248:251], v[44:47], a[72:75], v[248:251]
  buffer_store_dwordx4 v[24:27], v30, s[16:19], s47 offen offset:128 nt
  v_mfma_f32_16x16x32_bf16 v[252:255], v[44:47], a[76:79], v[252:255]
  s_waitcnt lgkmcnt(4)
  ds_read_b128 v[24:27], v8 offset:22528
  v_mfma_f32_16x16x32_bf16 v[240:243], v[32:35], a[80:83], v[240:243]
  ds_read_b64_tr_b16 v[44:45], v1 offset:45288
  v_mul_f32 v28, v28, v120
  v_mfma_f32_16x16x32_bf16 v[244:247], v[32:35], a[84:87], v[244:247]
  ds_read_b64_tr_b16 v[46:47], v1 offset:45800
  v_mul_f32 v20, v20, v121
  v_mfma_f32_16x16x32_bf16 v[248:251], v[32:35], a[88:91], v[248:251]
  v_cvt_pk_bf16_f32 v20, v28, v20
  v_lshlrev_b32 v29, 16, v21
  v_mfma_f32_16x16x32_bf16 v[252:255], v[32:35], a[92:95], v[252:255]
  s_waitcnt lgkmcnt(5)
  v_and_b32 v21, s44, v21
  v_mul_f32 v29, v29, v122
  v_mfma_f32_16x16x32_bf16 v[240:243], v[36:39], a[96:99], v[240:243]
  ds_read_b64_tr_b16 v[32:33], v2 offset:45280
  v_mul_f32 v21, v21, v123
  v_mfma_f32_16x16x32_bf16 v[244:247], v[36:39], a[100:103], v[244:247]
  ds_read_b64_tr_b16 v[34:35], v2 offset:45792
  v_cvt_pk_bf16_f32 v21, v29, v21
  v_mfma_f32_16x16x32_bf16 v[248:251], v[36:39], a[104:107], v[248:251]
  v_lshlrev_b32 v28, 16, v22
  v_and_b32 v22, s44, v22
  v_mfma_f32_16x16x32_bf16 v[252:255], v[36:39], a[108:111], v[252:255]
  s_waitcnt lgkmcnt(5)
  v_mul_f32 v28, v28, v136
  v_mul_f32 v22, v22, v137
  v_mfma_f32_16x16x32_bf16 v[176:179], v[40:43], a[112:115], v[176:179]
  ds_read_b64_tr_b16 v[36:37], v2 offset:45288
  v_cvt_pk_bf16_f32 v22, v28, v22
  v_mfma_f32_16x16x32_bf16 v[180:183], v[40:43], a[116:119], v[180:183]
  ds_read_b64_tr_b16 v[38:39], v2 offset:45800
  v_lshlrev_b32 v29, 16, v23
  v_mfma_f32_16x16x32_bf16 v[184:187], v[40:43], a[120:123], v[184:187]
  v_and_b32 v23, s44, v23
  v_mul_f32 v29, v29, v138
  v_mfma_f32_16x16x32_bf16 v[188:191], v[40:43], a[124:127], v[188:191]
  s_waitcnt lgkmcnt(4)
  v_mul_f32 v23, v23, v139
  v_cvt_pk_bf16_f32 v23, v29, v23
  v_mfma_f32_16x16x32_bf16 v[192:195], v[44:47], a[112:115], v[192:195]
  ds_read_b64_tr_b16 v[40:41], v1 offset:49408
  v_lshlrev_b32 v28, 16, v24
  v_mfma_f32_16x16x32_bf16 v[196:199], v[44:47], a[116:119], v[196:199]
  ds_read_b64_tr_b16 v[42:43], v1 offset:49920
  v_and_b32 v24, s44, v24
  v_mfma_f32_16x16x32_bf16 v[200:203], v[44:47], a[120:123], v[200:203]
  buffer_store_dwordx4 v[20:23], v30, s[16:19], s48 offen offset:128 nt
  v_mfma_f32_16x16x32_bf16 v[204:207], v[44:47], a[124:127], v[204:207]
  s_waitcnt lgkmcnt(4)
  ds_read_b128 v[20:23], v9 offset:16384
  v_mfma_f32_16x16x32_bf16 v[208:211], v[32:35], a[112:115], v[208:211]
  ds_read_b64_tr_b16 v[44:45], v1 offset:49416
  v_mul_f32 v28, v28, v124
  v_mfma_f32_16x16x32_bf16 v[212:215], v[32:35], a[116:119], v[212:215]
  ds_read_b64_tr_b16 v[46:47], v1 offset:49928
  v_mul_f32 v24, v24, v125
  v_mfma_f32_16x16x32_bf16 v[216:219], v[32:35], a[120:123], v[216:219]
  v_cvt_pk_bf16_f32 v24, v28, v24
  v_lshlrev_b32 v29, 16, v25
  v_mfma_f32_16x16x32_bf16 v[220:223], v[32:35], a[124:127], v[220:223]
  s_waitcnt lgkmcnt(5)
  v_and_b32 v25, s44, v25
  v_mul_f32 v29, v29, v126
  v_mfma_f32_16x16x32_bf16 v[224:227], v[36:39], a[112:115], v[224:227]
  ds_read_b64_tr_b16 v[32:33], v2 offset:49408
  v_mul_f32 v25, v25, v127
  v_mfma_f32_16x16x32_bf16 v[228:231], v[36:39], a[116:119], v[228:231]
  ds_read_b64_tr_b16 v[34:35], v2 offset:49920
  v_cvt_pk_bf16_f32 v25, v29, v25
  v_mfma_f32_16x16x32_bf16 v[232:235], v[36:39], a[120:123], v[232:235]
  v_lshlrev_b32 v28, 16, v26
  v_and_b32 v26, s44, v26
  v_mfma_f32_16x16x32_bf16 v[236:239], v[36:39], a[124:127], v[236:239]
  s_waitcnt lgkmcnt(5)
  v_mul_f32 v28, v28, v140
  v_mul_f32 v26, v26, v141
  v_mfma_f32_16x16x32_bf16 v[176:179], v[40:43], a[128:131], v[176:179]
  ds_read_b64_tr_b16 v[36:37], v2 offset:49416
  v_cvt_pk_bf16_f32 v26, v28, v26
  v_mfma_f32_16x16x32_bf16 v[180:183], v[40:43], a[132:135], v[180:183]
  ds_read_b64_tr_b16 v[38:39], v2 offset:49928
  v_lshlrev_b32 v29, 16, v27
  v_mfma_f32_16x16x32_bf16 v[184:187], v[40:43], a[136:139], v[184:187]
  v_and_b32 v27, s44, v27
  v_mul_f32 v29, v29, v142
  v_mfma_f32_16x16x32_bf16 v[188:191], v[40:43], a[140:143], v[188:191]
  s_waitcnt lgkmcnt(4)
  v_mul_f32 v27, v27, v143
  v_cvt_pk_bf16_f32 v27, v29, v27
  v_mfma_f32_16x16x32_bf16 v[192:195], v[44:47], a[128:131], v[192:195]
  ds_read_b64_tr_b16 v[40:41], v1 offset:0
  v_lshlrev_b32 v28, 16, v20
  v_mfma_f32_16x16x32_bf16 v[196:199], v[44:47], a[132:135], v[196:199]
  ds_read_b64_tr_b16 v[42:43], v1 offset:512
  v_and_b32 v20, s44, v20
  v_mfma_f32_16x16x32_bf16 v[200:203], v[44:47], a[136:139], v[200:203]
  buffer_store_dwordx4 v[24:27], v30, s[16:19], s49 offen offset:128 nt
  v_mfma_f32_16x16x32_bf16 v[204:207], v[44:47], a[140:143], v[204:207]
  s_waitcnt lgkmcnt(4)
  ds_read_b128 v[24:27], v9 offset:18432
  v_mfma_f32_16x16x32_bf16 v[208:211], v[32:35], a[128:131], v[208:211]
  ds_read_b64_tr_b16 v[44:45], v1 offset:8
  v_mul_f32 v28, v28, v144
  v_mfma_f32_16x16x32_bf16 v[212:215], v[32:35], a[132:135], v[212:215]
  ds_read_b64_tr_b16 v[46:47], v1 offset:520
  s_waitcnt vmcnt(7) lgkmcnt(5)
  v_mfma_f32_16x16x32_bf16 v[216:219], v[32:35], a[136:139], v[216:219]
  s_barrier
  s_add_u32 s50, s35, 3993856
  s_add_u32 m0, s36, 33024
  v_mfma_f32_16x16x32_bf16 v[220:223], v[32:35], a[140:143], v[220:223]
  buffer_load_dwordx4 v4, s[8:11], s50 offen lds
  v_mfma_f32_16x16x32_bf16 v[224:227], v[36:39], a[128:131], v[224:227]
  ds_read_b64_tr_b16 v[32:33], v2 offset:0
  s_add_u32 s51, s35, 4047104
  v_mfma_f32_16x16x32_bf16 v[228:231], v[36:39], a[132:135], v[228:231]
  ds_read_b64_tr_b16 v[34:35], v2 offset:512
  s_add_u32 m0, s36, 37152
  v_mfma_f32_16x16x32_bf16 v[232:235], v[36:39], a[136:139], v[232:235]
  buffer_load_dwordx4 v5, s[8:11], s51 offen lds
  v_mfma_f32_16x16x32_bf16 v[236:239], v[36:39], a[140:143], v[236:239]
  s_waitcnt lgkmcnt(5)
  s_add_u32 s50, s35, 4100352
  s_add_u32 m0, s36, 41280
  v_mfma_f32_16x16x32_bf16 v[176:179], v[40:43], a[144:147], v[176:179]
  ds_read_b64_tr_b16 v[36:37], v2 offset:8
  v_mul_f32 v20, v20, v145
  v_mfma_f32_16x16x32_bf16 v[180:183], v[40:43], a[148:151], v[180:183]
  ds_read_b64_tr_b16 v[38:39], v2 offset:520
  v_cvt_pk_bf16_f32 v20, v28, v20
  v_mfma_f32_16x16x32_bf16 v[184:187], v[40:43], a[152:155], v[184:187]
  buffer_load_dwordx4 v5, s[8:11], s50 offen lds
  v_mfma_f32_16x16x32_bf16 v[188:191], v[40:43], a[156:159], v[188:191]
  s_waitcnt lgkmcnt(4)
  v_lshlrev_b32 v29, 16, v21
  v_and_b32 v21, s44, v21
  v_mfma_f32_16x16x32_bf16 v[192:195], v[44:47], a[144:147], v[192:195]
  ds_read_b64_tr_b16 v[40:41], v1 offset:4128
  v_mul_f32 v29, v29, v146
  v_mfma_f32_16x16x32_bf16 v[196:199], v[44:47], a[148:151], v[196:199]
  ds_read_b64_tr_b16 v[42:43], v1 offset:4640
  v_mul_f32 v21, v21, v147
  v_mfma_f32_16x16x32_bf16 v[200:203], v[44:47], a[152:155], v[200:203]
  v_cvt_pk_bf16_f32 v21, v29, v21
  v_lshlrev_b32 v28, 16, v22
  v_mfma_f32_16x16x32_bf16 v[204:207], v[44:47], a[156:159], v[204:207]
  s_waitcnt lgkmcnt(4)
  v_and_b32 v22, s44, v22
  v_mul_f32 v28, v28, v160
  v_mfma_f32_16x16x32_bf16 v[208:211], v[32:35], a[144:147], v[208:211]
  ds_read_b64_tr_b16 v[44:45], v1 offset:4136
  v_mul_f32 v22, v22, v161
  v_mfma_f32_16x16x32_bf16 v[212:215], v[32:35], a[148:151], v[212:215]
  ds_read_b64_tr_b16 v[46:47], v1 offset:4648
  v_cvt_pk_bf16_f32 v22, v28, v22
  v_mfma_f32_16x16x32_bf16 v[216:219], v[32:35], a[152:155], v[216:219]
  v_lshlrev_b32 v29, 16, v23
  v_and_b32 v23, s44, v23
  v_mfma_f32_16x16x32_bf16 v[220:223], v[32:35], a[156:159], v[220:223]
  s_waitcnt lgkmcnt(4)
  v_mul_f32 v29, v29, v162
  v_mul_f32 v23, v23, v163
  v_mfma_f32_16x16x32_bf16 v[224:227], v[36:39], a[144:147], v[224:227]
  ds_read_b64_tr_b16 v[32:33], v2 offset:4128
  v_cvt_pk_bf16_f32 v23, v29, v23
  v_mfma_f32_16x16x32_bf16 v[228:231], v[36:39], a[148:151], v[228:231]
  ds_read_b64_tr_b16 v[34:35], v2 offset:4640
  v_lshlrev_b32 v28, 16, v24
  v_mfma_f32_16x16x32_bf16 v[232:235], v[36:39], a[152:155], v[232:235]
  buffer_store_dwordx4 v[20:23], v30, s[16:19], s46 offen offset:192 nt
  v_mfma_f32_16x16x32_bf16 v[236:239], v[36:39], a[156:159], v[236:239]
  s_waitcnt lgkmcnt(4)
  ds_read_b128 v[20:23], v9 offset:20480
  v_mfma_f32_16x16x32_bf16 v[176:179], v[40:43], a[160:163], v[176:179]
  ds_read_b64_tr_b16 v[36:37], v2 offset:4136
  v_and_b32 v24, s44, v24
  v_mfma_f32_16x16x32_bf16 v[180:183], v[40:43], a[164:167], v[180:183]
  ds_read_b64_tr_b16 v[38:39], v2 offset:4648
  v_mul_f32 v28, v28, v148
  v_mfma_f32_16x16x32_bf16 v[184:187], v[40:43], a[168:171], v[184:187]
  v_mul_f32 v24, v24, v149
  v_cvt_pk_bf16_f32 v24, v28, v24
  v_mfma_f32_16x16x32_bf16 v[188:191], v[40:43], a[172:175], v[188:191]
  s_waitcnt lgkmcnt(5)
  v_lshlrev_b32 v29, 16, v25
  v_and_b32 v25, s44, v25
  v_mfma_f32_16x16x32_bf16 v[192:195], v[44:47], a[160:163], v[192:195]
  ds_read_b64_tr_b16 v[40:41], v1 offset:8256
  v_mul_f32 v29, v29, v150
  v_mfma_f32_16x16x32_bf16 v[196:199], v[44:47], a[164:167], v[196:199]
  ds_read_b64_tr_b16 v[42:43], v1 offset:8768
  v_mul_f32 v25, v25, v151
  v_mfma_f32_16x16x32_bf16 v[200:203], v[44:47], a[168:171], v[200:203]
  v_cvt_pk_bf16_f32 v25, v29, v25
  v_lshlrev_b32 v28, 16, v26
  v_mfma_f32_16x16x32_bf16 v[204:207], v[44:47], a[172:175], v[204:207]
  s_waitcnt lgkmcnt(5)
  v_and_b32 v26, s44, v26
  v_mul_f32 v28, v28, v164
  v_mfma_f32_16x16x32_bf16 v[208:211], v[32:35], a[160:163], v[208:211]
  ds_read_b64_tr_b16 v[44:45], v1 offset:8264
  v_mul_f32 v26, v26, v165
  v_mfma_f32_16x16x32_bf16 v[212:215], v[32:35], a[164:167], v[212:215]
  ds_read_b64_tr_b16 v[46:47], v1 offset:8776
  v_cvt_pk_bf16_f32 v26, v28, v26
  v_mfma_f32_16x16x32_bf16 v[216:219], v[32:35], a[168:171], v[216:219]
  v_lshlrev_b32 v29, 16, v27
  v_and_b32 v27, s44, v27
  v_mfma_f32_16x16x32_bf16 v[220:223], v[32:35], a[172:175], v[220:223]
  s_waitcnt lgkmcnt(4)
  v_mul_f32 v29, v29, v166
  v_mul_f32 v27, v27, v167
  v_mfma_f32_16x16x32_bf16 v[224:227], v[36:39], a[160:163], v[224:227]
  ds_read_b64_tr_b16 v[32:33], v1 offset:12384
  v_cvt_pk_bf16_f32 v27, v29, v27
  v_mfma_f32_16x16x32_bf16 v[228:231], v[36:39], a[164:167], v[228:231]
  ds_read_b64_tr_b16 v[34:35], v1 offset:12896
  v_lshlrev_b32 v28, 16, v20
  v_mfma_f32_16x16x32_bf16 v[232:235], v[36:39], a[168:171], v[232:235]
  buffer_store_dwordx4 v[24:27], v30, s[16:19], s47 offen offset:192 nt
  v_mfma_f32_16x16x32_bf16 v[236:239], v[36:39], a[172:175], v[236:239]
  s_waitcnt lgkmcnt(4)
  ds_read_b128 v[24:27], v9 offset:22528
  v_mfma_f32_16x16x32_bf16 v[176:179], v[40:43], a[176:179], v[176:179]
  ds_read_b64_tr_b16 v[36:37], v1 offset:12392
  v_and_b32 v20, s44, v20
  v_mfma_f32_16x16x32_bf16 v[180:183], v[40:43], a[180:183], v[180:183]
  ds_read_b64_tr_b16 v[38:39], v1 offset:12904
  v_mul_f32 v28, v28, v152
  v_mfma_f32_16x16x32_bf16 v[184:187], v[40:43], a[184:187], v[184:187]
  v_mul_f32 v20, v20, v153
  v_cvt_pk_bf16_f32 v20, v28, v20
  v_mfma_f32_16x16x32_bf16 v[188:191], v[40:43], a[188:191], v[188:191]
  s_waitcnt lgkmcnt(5)
  v_lshlrev_b32 v29, 16, v21
  v_and_b32 v21, s44, v21
  v_mfma_f32_16x16x32_bf16 v[192:195], v[44:47], a[176:179], v[192:195]
  ds_read_b64_tr_b16 v[40:41], v1 offset:16512
  v_mul_f32 v29, v29, v154
  v_mfma_f32_16x16x32_bf16 v[196:199], v[44:47], a[180:183], v[196:199]
  ds_read_b64_tr_b16 v[42:43], v1 offset:17024
  v_mul_f32 v21, v21, v155
  v_mfma_f32_16x16x32_bf16 v[200:203], v[44:47], a[184:187], v[200:203]
  v_cvt_pk_bf16_f32 v21, v29, v21
  v_lshlrev_b32 v28, 16, v22
  v_mfma_f32_16x16x32_bf16 v[204:207], v[44:47], a[188:191], v[204:207]
  s_waitcnt lgkmcnt(5)
  v_and_b32 v22, s44, v22
  v_mul_f32 v28, v28, v168
  v_mfma_f32_16x16x32_bf16 v[176:179], v[32:35], a[192:195], v[176:179]
  ds_read_b64_tr_b16 v[44:45], v1 offset:16520
  v_mul_f32 v22, v22, v169
  v_mfma_f32_16x16x32_bf16 v[180:183], v[32:35], a[196:199], v[180:183]
  ds_read_b64_tr_b16 v[46:47], v1 offset:17032
  s_waitcnt vmcnt(2) lgkmcnt(4)
  v_mfma_f32_16x16x32_bf16 v[184:187], v[32:35], a[200:203], v[184:187]
  s_barrier
  v_cvt_pk_bf16_f32 v22, v28, v22
  v_lshlrev_b32 v29, 16, v23
  v_mfma_f32_16x16x32_bf16 v[188:191], v[32:35], a[204:207], v[188:191]
  v_and_b32 v23, s44, v23
  v_mul_f32 v29, v29, v170
  v_mfma_f32_16x16x32_bf16 v[192:195], v[36:39], a[192:195], v[192:195]
  ds_read_b64_tr_b16 v[32:33], v1 offset:20640
  v_mul_f32 v23, v23, v171
  v_mfma_f32_16x16x32_bf16 v[196:199], v[36:39], a[196:199], v[196:199]
  ds_read_b64_tr_b16 v[34:35], v1 offset:21152
  v_cvt_pk_bf16_f32 v23, v29, v23
  v_mfma_f32_16x16x32_bf16 v[200:203], v[36:39], a[200:203], v[200:203]
  buffer_store_dwordx4 v[20:23], v30, s[16:19], s48 offen offset:192 nt
  v_mfma_f32_16x16x32_bf16 v[204:207], v[36:39], a[204:207], v[204:207]
  s_waitcnt lgkmcnt(4)
  v_lshlrev_b32 v28, 16, v24
  v_and_b32 v24, s44, v24
  v_mfma_f32_16x16x32_bf16 v[176:179], v[40:43], a[0:3], v[176:179]
  ds_read_b64_tr_b16 v[36:37], v1 offset:20648
  v_mul_f32 v28, v28, v156
  v_mfma_f32_16x16x32_bf16 v[180:183], v[40:43], a[4:7], v[180:183]
  ds_read_b64_tr_b16 v[38:39], v1 offset:21160
  v_mul_f32 v24, v24, v157
  v_mfma_f32_16x16x32_bf16 v[184:187], v[40:43], a[8:11], v[184:187]
  v_cvt_pk_bf16_f32 v24, v28, v24
  v_lshlrev_b32 v29, 16, v25
  v_mfma_f32_16x16x32_bf16 v[188:191], v[40:43], a[12:15], v[188:191]
  s_waitcnt lgkmcnt(4)
  v_and_b32 v25, s44, v25
  v_mul_f32 v29, v29, v158
  v_mfma_f32_16x16x32_bf16 v[192:195], v[44:47], a[0:3], v[192:195]
  ds_read_b64_tr_b16 v[40:41], v1 offset:24768
  v_mul_f32 v25, v25, v159
  v_mfma_f32_16x16x32_bf16 v[196:199], v[44:47], a[4:7], v[196:199]
  ds_read_b64_tr_b16 v[42:43], v1 offset:25280
  v_cvt_pk_bf16_f32 v25, v29, v25
  v_mfma_f32_16x16x32_bf16 v[200:203], v[44:47], a[8:11], v[200:203]
  v_lshlrev_b32 v28, 16, v26
  v_and_b32 v26, s44, v26
  v_mfma_f32_16x16x32_bf16 v[204:207], v[44:47], a[12:15], v[204:207]
  s_waitcnt lgkmcnt(4)
  v_mul_f32 v28, v28, v172
  v_mul_f32 v26, v26, v173
  v_mfma_f32_16x16x32_bf16 v[176:179], v[32:35], a[16:19], v[176:179]
  ds_read_b64_tr_b16 v[44:45], v1 offset:24776
  v_cvt_pk_bf16_f32 v26, v28, v26
  v_mfma_f32_16x16x32_bf16 v[180:183], v[32:35], a[20:23], v[180:183]
  ds_read_b64_tr_b16 v[46:47], v1 offset:25288
  v_lshlrev_b32 v29, 16, v27
  v_mfma_f32_16x16x32_bf16 v[184:187], v[32:35], a[24:27], v[184:187]
  v_and_b32 v27, s44, v27
  v_mul_f32 v29, v29, v174
  v_mfma_f32_16x16x32_bf16 v[188:191], v[32:35], a[28:31], v[188:191]
  s_waitcnt lgkmcnt(4)
  v_mul_f32 v27, v27, v175
  v_cvt_pk_bf16_f32 v27, v29, v27
  v_mfma_f32_16x16x32_bf16 v[192:195], v[36:39], a[16:19], v[192:195]
  ds_read_b64_tr_b16 v[32:33], v1 offset:28896
  v_mfma_f32_16x16x32_bf16 v[196:199], v[36:39], a[20:23], v[196:199]
  ds_read_b64_tr_b16 v[34:35], v1 offset:29408
  v_mfma_f32_16x16x32_bf16 v[200:203], v[36:39], a[24:27], v[200:203]
  buffer_store_dwordx4 v[24:27], v30, s[16:19], s49 offen offset:192 nt
  v_mfma_f32_16x16x32_bf16 v[204:207], v[36:39], a[28:31], v[204:207]
  s_waitcnt lgkmcnt(4)
  ds_read_b64 v[20:21], v10 offset:0
  v_mfma_f32_16x16x32_bf16 v[176:179], v[40:43], a[32:35], v[176:179]
  ds_read_b64_tr_b16 v[36:37], v1 offset:28904
  s_waitcnt lgkmcnt(1)
  v_mfma_f32_16x16x32_bf16 v[180:183], v[40:43], a[36:39], v[180:183]
  ds_read_b64_tr_b16 v[38:39], v1 offset:29416
  v_lshlrev_b32 v28, 16, v20
  v_mfma_f32_16x16x32_bf16 v[184:187], v[40:43], a[40:43], v[184:187]
  ds_read_b64 v[24:25], v10 offset:512
  s_add_u32 s77, s46, s76
  v_mfma_f32_16x16x32_bf16 v[188:191], v[40:43], a[44:47], v[188:191]
  v_and_b32 v20, s44, v20
  v_mul_f32 v28, v28, v240
  v_mfma_f32_16x16x32_bf16 v[192:195], v[44:47], a[32:35], v[192:195]
  ds_read_b64_tr_b16 v[40:41], v1 offset:33024
  v_mul_f32 v20, v20, v241
  v_mfma_f32_16x16x32_bf16 v[196:199], v[44:47], a[36:39], v[196:199]
  ds_read_b64_tr_b16 v[42:43], v1 offset:33536
  v_cvt_pk_bf16_f32 v20, v28, v20
  v_mfma_f32_16x16x32_bf16 v[200:203], v[44:47], a[40:43], v[200:203]
  v_lshlrev_b32 v29, 16, v21
  v_and_b32 v21, s44, v21
  v_mfma_f32_16x16x32_bf16 v[204:207], v[44:47], a[44:47], v[204:207]
  v_mul_f32 v29, v29, v242
  v_mul_f32 v21, v21, v243
  v_mfma_f32_16x16x32_bf16 v[176:179], v[32:35], a[48:51], v[176:179]
  ds_read_b64_tr_b16 v[44:45], v1 offset:33032
  v_cvt_pk_bf16_f32 v21, v29, v21
  v_mfma_f32_16x16x32_bf16 v[180:183], v[32:35], a[52:55], v[180:183]
  ds_read_b64_tr_b16 v[46:47], v1 offset:33544
  s_waitcnt lgkmcnt(4)
  v_mfma_f32_16x16x32_bf16 v[184:187], v[32:35], a[56:59], v[184:187]
  buffer_store_dwordx2 v[20:21], v31, s[16:19], s77 offen nt
  v_mfma_f32_16x16x32_bf16 v[188:191], v[32:35], a[60:63], v[188:191]
  ds_read_b64 v[20:21], v10 offset:1024
  s_add_u32 s84, s47, s76
  v_mfma_f32_16x16x32_bf16 v[192:195], v[36:39], a[48:51], v[192:195]
  ds_read_b64_tr_b16 v[32:33], v1 offset:37152
  v_lshlrev_b32 v28, 16, v24
  v_mfma_f32_16x16x32_bf16 v[196:199], v[36:39], a[52:55], v[196:199]
  ds_read_b64_tr_b16 v[34:35], v1 offset:37664
  v_and_b32 v24, s44, v24
  v_mfma_f32_16x16x32_bf16 v[200:203], v[36:39], a[56:59], v[200:203]
  v_mul_f32 v28, v28, v244
  v_mul_f32 v24, v24, v245
  v_mfma_f32_16x16x32_bf16 v[204:207], v[36:39], a[60:63], v[204:207]
  s_waitcnt lgkmcnt(5)
  v_cvt_pk_bf16_f32 v24, v28, v24
  v_lshlrev_b32 v29, 16, v25
  v_mfma_f32_16x16x32_bf16 v[176:179], v[40:43], a[64:67], v[176:179]
  ds_read_b64_tr_b16 v[36:37], v1 offset:37160
  v_and_b32 v25, s44, v25
  v_mfma_f32_16x16x32_bf16 v[180:183], v[40:43], a[68:71], v[180:183]
  ds_read_b64_tr_b16 v[38:39], v1 offset:37672
  v_mul_f32 v29, v29, v246
  v_mfma_f32_16x16x32_bf16 v[184:187], v[40:43], a[72:75], v[184:187]
  v_mul_f32 v25, v25, v247
  v_cvt_pk_bf16_f32 v25, v29, v25
  v_mfma_f32_16x16x32_bf16 v[188:191], v[40:43], a[76:79], v[188:191]
  s_waitcnt lgkmcnt(5)
  s_waitcnt lgkmcnt(4)
  v_lshlrev_b32 v28, 16, v20
  v_mfma_f32_16x16x32_bf16 v[192:195], v[44:47], a[64:67], v[192:195]
  ds_read_b64_tr_b16 v[40:41], v1 offset:41280
  v_and_b32 v20, s44, v20
  v_mfma_f32_16x16x32_bf16 v[196:199], v[44:47], a[68:71], v[196:199]
  ds_read_b64_tr_b16 v[42:43], v1 offset:41792
  v_mul_f32 v28, v28, v248
  v_mfma_f32_16x16x32_bf16 v[200:203], v[44:47], a[72:75], v[200:203]
  buffer_store_dwordx2 v[24:25], v31, s[16:19], s84 offen nt
  v_mfma_f32_16x16x32_bf16 v[204:207], v[44:47], a[76:79], v[204:207]
  s_waitcnt lgkmcnt(4)
  ds_read_b64 v[24:25], v10 offset:1536
  v_mfma_f32_16x16x32_bf16 v[176:179], v[32:35], a[80:83], v[176:179]
  ds_read_b64_tr_b16 v[44:45], v1 offset:41288
  s_add_u32 s77, s48, s76
  v_mfma_f32_16x16x32_bf16 v[180:183], v[32:35], a[84:87], v[180:183]
  ds_read_b64_tr_b16 v[46:47], v1 offset:41800
  s_waitcnt lgkmcnt(5)
  v_mfma_f32_16x16x32_bf16 v[184:187], v[32:35], a[88:91], v[184:187]
  s_barrier
  v_mul_f32 v20, v20, v249
  v_cvt_pk_bf16_f32 v20, v28, v20
  v_mfma_f32_16x16x32_bf16 v[188:191], v[32:35], a[92:95], v[188:191]
  v_lshlrev_b32 v29, 16, v21
  v_and_b32 v21, s44, v21
  v_mfma_f32_16x16x32_bf16 v[192:195], v[36:39], a[80:83], v[192:195]
  ds_read_b64_tr_b16 v[32:33], v2 offset:8256
  v_mul_f32 v29, v29, v250
  v_mfma_f32_16x16x32_bf16 v[196:199], v[36:39], a[84:87], v[196:199]
  ds_read_b64_tr_b16 v[34:35], v2 offset:8768
  v_mul_f32 v21, v21, v251
  v_mfma_f32_16x16x32_bf16 v[200:203], v[36:39], a[88:91], v[200:203]
  v_cvt_pk_bf16_f32 v21, v29, v21
  s_waitcnt lgkmcnt(4)
  v_mfma_f32_16x16x32_bf16 v[204:207], v[36:39], a[92:95], v[204:207]
  buffer_store_dwordx2 v[20:21], v31, s[16:19], s77 offen nt
  v_mfma_f32_16x16x32_bf16 v[176:179], v[40:43], a[96:99], v[176:179]
  ds_read_b64_tr_b16 v[36:37], v2 offset:8264
  s_add_u32 s84, s49, s76
  v_mfma_f32_16x16x32_bf16 v[180:183], v[40:43], a[100:103], v[180:183]
  ds_read_b64_tr_b16 v[38:39], v2 offset:8776
  v_lshlrev_b32 v28, 16, v24
  v_mfma_f32_16x16x32_bf16 v[184:187], v[40:43], a[104:107], v[184:187]
  v_and_b32 v24, s44, v24
  v_mul_f32 v28, v28, v252
  v_mfma_f32_16x16x32_bf16 v[188:191], v[40:43], a[108:111], v[188:191]
  s_waitcnt lgkmcnt(4)
  v_mul_f32 v24, v24, v253
  v_cvt_pk_bf16_f32 v24, v28, v24
  v_mfma_f32_16x16x32_bf16 v[192:195], v[44:47], a[96:99], v[192:195]
  ds_read_b64_tr_b16 v[40:41], v2 offset:12384
  v_lshlrev_b32 v29, 16, v25
  v_mfma_f32_16x16x32_bf16 v[196:199], v[44:47], a[100:103], v[196:199]
  ds_read_b64_tr_b16 v[42:43], v2 offset:12896
  v_and_b32 v25, s44, v25
  v_mfma_f32_16x16x32_bf16 v[200:203], v[44:47], a[104:107], v[200:203]
  v_mul_f32 v29, v29, v254
  v_mul_f32 v25, v25, v255
  v_mfma_f32_16x16x32_bf16 v[204:207], v[44:47], a[108:111], v[204:207]
  s_waitcnt lgkmcnt(4)
  v_cvt_pk_bf16_f32 v25, v29, v25
  v_mfma_f32_16x16x32_bf16 v[208:211], v[32:35], a[176:179], v[208:211]
  ds_read_b64_tr_b16 v[44:45], v2 offset:12392
  v_mfma_f32_16x16x32_bf16 v[212:215], v[32:35], a[180:183], v[212:215]
  ds_read_b64_tr_b16 v[46:47], v2 offset:12904
  s_waitcnt lgkmcnt(4)
  v_mfma_f32_16x16x32_bf16 v[216:219], v[32:35], a[184:187], v[216:219]
  buffer_store_dwordx2 v[24:25], v31, s[16:19], s84 offen nt
  v_mfma_f32_16x16x32_bf16 v[220:223], v[32:35], a[188:191], v[220:223]
  ds_read_b128 v[20:23], v8 offset:0
  v_mfma_f32_16x16x32_bf16 v[224:227], v[36:39], a[176:179], v[224:227]
  ds_read_b64_tr_b16 v[32:33], v2 offset:16512
  s_waitcnt lgkmcnt(1)
  v_mfma_f32_16x16x32_bf16 v[228:231], v[36:39], a[180:183], v[228:231]
  ds_read_b64_tr_b16 v[34:35], v2 offset:17024
  v_lshlrev_b32 v28, 16, v20
  v_mfma_f32_16x16x32_bf16 v[232:235], v[36:39], a[184:187], v[232:235]
  ds_read_b128 v[24:27], v8 offset:2048
  v_and_b32 v20, s44, v20
  v_mfma_f32_16x16x32_bf16 v[236:239], v[36:39], a[188:191], v[236:239]
  v_mul_f32 v28, v28, v176
  v_mul_f32 v20, v20, v177
  v_mfma_f32_16x16x32_bf16 v[208:211], v[40:43], a[192:195], v[208:211]
  ds_read_b64_tr_b16 v[36:37], v2 offset:16520
  v_cvt_pk_bf16_f32 v20, v28, v20
  v_mfma_f32_16x16x32_bf16 v[212:215], v[40:43], a[196:199], v[212:215]
  ds_read_b64_tr_b16 v[38:39], v2 offset:17032
  v_lshlrev_b32 v29, 16, v21
  v_mfma_f32_16x16x32_bf16 v[216:219], v[40:43], a[200:203], v[216:219]
  v_and_b32 v21, s44, v21
  v_mul_f32 v29, v29, v178
  v_mfma_f32_16x16x32_bf16 v[220:223], v[40:43], a[204:207], v[220:223]
  v_mul_f32 v21, v21, v179
  v_cvt_pk_bf16_f32 v21, v29, v21
  v_mfma_f32_16x16x32_bf16 v[224:227], v[44:47], a[192:195], v[224:227]
  ds_read_b64_tr_b16 v[40:41], v2 offset:20640
  v_lshlrev_b32 v28, 16, v22
  v_mfma_f32_16x16x32_bf16 v[228:231], v[44:47], a[196:199], v[228:231]
  ds_read_b64_tr_b16 v[42:43], v2 offset:21152
  v_and_b32 v22, s44, v22
  v_mfma_f32_16x16x32_bf16 v[232:235], v[44:47], a[200:203], v[232:235]
  v_mul_f32 v28, v28, v192
  v_mul_f32 v22, v22, v193
  v_mfma_f32_16x16x32_bf16 v[236:239], v[44:47], a[204:207], v[236:239]
  s_waitcnt lgkmcnt(5)
  v_cvt_pk_bf16_f32 v22, v28, v22
  v_lshlrev_b32 v29, 16, v23
  v_mfma_f32_16x16x32_bf16 v[208:211], v[32:35], a[0:3], v[208:211]
  ds_read_b64_tr_b16 v[44:45], v2 offset:20648
  v_and_b32 v23, s44, v23
  v_mfma_f32_16x16x32_bf16 v[212:215], v[32:35], a[4:7], v[212:215]
  ds_read_b64_tr_b16 v[46:47], v2 offset:21160
  v_mul_f32 v29, v29, v194
  v_mfma_f32_16x16x32_bf16 v[216:219], v[32:35], a[8:11], v[216:219]
  v_mul_f32 v23, v23, v195
  v_cvt_pk_bf16_f32 v23, v29, v23
  v_mfma_f32_16x16x32_bf16 v[220:223], v[32:35], a[12:15], v[220:223]
  s_waitcnt lgkmcnt(4)
  v_lshlrev_b32 v28, 16, v24
  v_and_b32 v24, s44, v24
  v_mfma_f32_16x16x32_bf16 v[224:227], v[36:39], a[0:3], v[224:227]
  ds_read_b64_tr_b16 v[32:33], v2 offset:24768
  v_mul_f32 v28, v28, v180
  v_mfma_f32_16x16x32_bf16 v[228:231], v[36:39], a[4:7], v[228:231]
  ds_read_b64_tr_b16 v[34:35], v2 offset:25280
  v_mul_f32 v24, v24, v181
  v_mfma_f32_16x16x32_bf16 v[232:235], v[36:39], a[8:11], v[232:235]
  buffer_store_dwordx4 v[20:23], v30, s[16:19], s46 offen offset:256 nt
  v_mfma_f32_16x16x32_bf16 v[236:239], v[36:39], a[12:15], v[236:239]
  s_waitcnt lgkmcnt(4)
  ds_read_b128 v[20:23], v8 offset:4096
  v_mfma_f32_16x16x32_bf16 v[208:211], v[40:43], a[16:19], v[208:211]
  ds_read_b64_tr_b16 v[36:37], v2 offset:24776
  v_cvt_pk_bf16_f32 v24, v28, v24
  v_mfma_f32_16x16x32_bf16 v[212:215], v[40:43], a[20:23], v[212:215]
  ds_read_b64_tr_b16 v[38:39], v2 offset:25288
  v_lshlrev_b32 v29, 16, v25
  v_mfma_f32_16x16x32_bf16 v[216:219], v[40:43], a[24:27], v[216:219]
  v_and_b32 v25, s44, v25
  v_mul_f32 v29, v29, v182
  v_mfma_f32_16x16x32_bf16 v[220:223], v[40:43], a[28:31], v[220:223]
  s_waitcnt lgkmcnt(5)
  v_mul_f32 v25, v25, v183
  v_cvt_pk_bf16_f32 v25, v29, v25
  v_mfma_f32_16x16x32_bf16 v[224:227], v[44:47], a[16:19], v[224:227]
  ds_read_b64_tr_b16 v[40:41], v2 offset:28896
  v_lshlrev_b32 v28, 16, v26
  v_mfma_f32_16x16x32_bf16 v[228:231], v[44:47], a[20:23], v[228:231]
  ds_read_b64_tr_b16 v[42:43], v2 offset:29408
  v_and_b32 v26, s44, v26
  v_mfma_f32_16x16x32_bf16 v[232:235], v[44:47], a[24:27], v[232:235]
  v_mul_f32 v28, v28, v196
  v_mul_f32 v26, v26, v197
  v_mfma_f32_16x16x32_bf16 v[236:239], v[44:47], a[28:31], v[236:239]
  s_waitcnt lgkmcnt(5)
  v_cvt_pk_bf16_f32 v26, v28, v26
  v_lshlrev_b32 v29, 16, v27
  v_mfma_f32_16x16x32_bf16 v[208:211], v[32:35], a[32:35], v[208:211]
  ds_read_b64_tr_b16 v[44:45], v2 offset:28904
  v_and_b32 v27, s44, v27
  v_mfma_f32_16x16x32_bf16 v[212:215], v[32:35], a[36:39], v[212:215]
  ds_read_b64_tr_b16 v[46:47], v2 offset:29416
  s_waitcnt lgkmcnt(4)
  v_mfma_f32_16x16x32_bf16 v[216:219], v[32:35], a[40:43], v[216:219]
  s_barrier
  v_mul_f32 v29, v29, v198
  v_mul_f32 v27, v27, v199
  v_mfma_f32_16x16x32_bf16 v[220:223], v[32:35], a[44:47], v[220:223]
  v_cvt_pk_bf16_f32 v27, v29, v27
  v_lshlrev_b32 v28, 16, v20
  v_mfma_f32_16x16x32_bf16 v[224:227], v[36:39], a[32:35], v[224:227]
  ds_read_b64_tr_b16 v[32:33], v2 offset:33024
  v_and_b32 v20, s44, v20
  v_mfma_f32_16x16x32_bf16 v[228:231], v[36:39], a[36:39], v[228:231]
  ds_read_b64_tr_b16 v[34:35], v2 offset:33536
  v_mul_f32 v28, v28, v184
  v_mfma_f32_16x16x32_bf16 v[232:235], v[36:39], a[40:43], v[232:235]
  buffer_store_dwordx4 v[24:27], v30, s[16:19], s47 offen offset:256 nt
  v_mfma_f32_16x16x32_bf16 v[236:239], v[36:39], a[44:47], v[236:239]
  s_waitcnt lgkmcnt(4)
  ds_read_b128 v[24:27], v8 offset:6144
  v_mfma_f32_16x16x32_bf16 v[208:211], v[40:43], a[48:51], v[208:211]
  ds_read_b64_tr_b16 v[36:37], v2 offset:33032
  v_mul_f32 v20, v20, v185
  v_mfma_f32_16x16x32_bf16 v[212:215], v[40:43], a[52:55], v[212:215]
  ds_read_b64_tr_b16 v[38:39], v2 offset:33544
  v_cvt_pk_bf16_f32 v20, v28, v20
  v_mfma_f32_16x16x32_bf16 v[216:219], v[40:43], a[56:59], v[216:219]
  v_lshlrev_b32 v29, 16, v21
  v_and_b32 v21, s44, v21
  v_mfma_f32_16x16x32_bf16 v[220:223], v[40:43], a[60:63], v[220:223]
  s_waitcnt lgkmcnt(5)
  v_mul_f32 v29, v29, v186
  v_mul_f32 v21, v21, v187
  v_mfma_f32_16x16x32_bf16 v[224:227], v[44:47], a[48:51], v[224:227]
  ds_read_b64_tr_b16 v[40:41], v2 offset:37152
  v_cvt_pk_bf16_f32 v21, v29, v21
  v_mfma_f32_16x16x32_bf16 v[228:231], v[44:47], a[52:55], v[228:231]
  ds_read_b64_tr_b16 v[42:43], v2 offset:37664
  v_lshlrev_b32 v28, 16, v22
  v_mfma_f32_16x16x32_bf16 v[232:235], v[44:47], a[56:59], v[232:235]
  v_and_b32 v22, s44, v22
  v_mul_f32 v28, v28, v200
  v_mfma_f32_16x16x32_bf16 v[236:239], v[44:47], a[60:63], v[236:239]
  s_waitcnt lgkmcnt(5)
  v_mul_f32 v22, v22, v201
  v_cvt_pk_bf16_f32 v22, v28, v22
  v_mfma_f32_16x16x32_bf16 v[208:211], v[32:35], a[64:67], v[208:211]
  ds_read_b64_tr_b16 v[44:45], v2 offset:37160
  v_lshlrev_b32 v29, 16, v23
  v_mfma_f32_16x16x32_bf16 v[212:215], v[32:35], a[68:71], v[212:215]
  ds_read_b64_tr_b16 v[46:47], v2 offset:37672
  v_and_b32 v23, s44, v23
  v_mfma_f32_16x16x32_bf16 v[216:219], v[32:35], a[72:75], v[216:219]
  v_mul_f32 v29, v29, v202
  v_mul_f32 v23, v23, v203
  v_mfma_f32_16x16x32_bf16 v[220:223], v[32:35], a[76:79], v[220:223]
  s_waitcnt lgkmcnt(4)
  v_cvt_pk_bf16_f32 v23, v29, v23
  v_lshlrev_b32 v28, 16, v24
  v_mfma_f32_16x16x32_bf16 v[224:227], v[36:39], a[64:67], v[224:227]
  ds_read_b64_tr_b16 v[32:33], v2 offset:41280
  v_and_b32 v24, s44, v24
  v_mfma_f32_16x16x32_bf16 v[228:231], v[36:39], a[68:71], v[228:231]
  ds_read_b64_tr_b16 v[34:35], v2 offset:41792
  v_mul_f32 v28, v28, v188
  v_mfma_f32_16x16x32_bf16 v[232:235], v[36:39], a[72:75], v[232:235]
  buffer_store_dwordx4 v[20:23], v30, s[16:19], s48 offen offset:256 nt
  v_mfma_f32_16x16x32_bf16 v[236:239], v[36:39], a[76:79], v[236:239]
  s_waitcnt lgkmcnt(4)
  ds_read_b128 v[20:23], v9 offset:0
  v_mfma_f32_16x16x32_bf16 v[208:211], v[40:43], a[80:83], v[208:211]
  ds_read_b64_tr_b16 v[36:37], v2 offset:41288
  v_mul_f32 v24, v24, v189
  v_mfma_f32_16x16x32_bf16 v[212:215], v[40:43], a[84:87], v[212:215]
  ds_read_b64_tr_b16 v[38:39], v2 offset:41800
  v_cvt_pk_bf16_f32 v24, v28, v24
  v_mfma_f32_16x16x32_bf16 v[216:219], v[40:43], a[88:91], v[216:219]
  v_lshlrev_b32 v29, 16, v25
  v_and_b32 v25, s44, v25
  v_mfma_f32_16x16x32_bf16 v[220:223], v[40:43], a[92:95], v[220:223]
  s_waitcnt lgkmcnt(5)
  v_mul_f32 v29, v29, v190
  v_mul_f32 v25, v25, v191
  v_mfma_f32_16x16x32_bf16 v[224:227], v[44:47], a[80:83], v[224:227]
  v_cvt_pk_bf16_f32 v25, v29, v25
  v_lshlrev_b32 v28, 16, v26
  v_mfma_f32_16x16x32_bf16 v[228:231], v[44:47], a[84:87], v[228:231]
  v_and_b32 v26, s44, v26
  v_mul_f32 v28, v28, v204
  v_mfma_f32_16x16x32_bf16 v[232:235], v[44:47], a[88:91], v[232:235]
  v_mul_f32 v26, v26, v205
  v_cvt_pk_bf16_f32 v26, v28, v26
  v_mfma_f32_16x16x32_bf16 v[236:239], v[44:47], a[92:95], v[236:239]
  s_waitcnt lgkmcnt(3)
  v_lshlrev_b32 v29, 16, v27
  v_and_b32 v27, s44, v27
  v_mfma_f32_16x16x32_bf16 v[208:211], v[32:35], a[96:99], v[208:211]
  v_mul_f32 v29, v29, v206
  v_mul_f32 v27, v27, v207
  v_mfma_f32_16x16x32_bf16 v[212:215], v[32:35], a[100:103], v[212:215]
  v_cvt_pk_bf16_f32 v27, v29, v27
  v_mfma_f32_16x16x32_bf16 v[216:219], v[32:35], a[104:107], v[216:219]
  buffer_store_dwordx4 v[24:27], v30, s[16:19], s49 offen offset:256 nt
  v_mfma_f32_16x16x32_bf16 v[220:223], v[32:35], a[108:111], v[220:223]
  s_waitcnt lgkmcnt(0)
  ds_read_b128 v[24:27], v9 offset:2048
  v_mfma_f32_16x16x32_bf16 v[224:227], v[36:39], a[96:99], v[224:227]
  v_mfma_f32_16x16x32_bf16 v[228:231], v[36:39], a[100:103], v[228:231]
  v_mfma_f32_16x16x32_bf16 v[232:235], v[36:39], a[104:107], v[232:235]
  v_mfma_f32_16x16x32_bf16 v[236:239], v[36:39], a[108:111], v[236:239]
  v_lshlrev_b32 v28, 16, v20
  v_and_b32 v20, s44, v20
  v_mul_f32 v28, v28, v208
  v_mul_f32 v20, v20, v209
  v_cvt_pk_bf16_f32 v20, v28, v20
  v_lshlrev_b32 v29, 16, v21
  v_and_b32 v21, s44, v21
  v_mul_f32 v29, v29, v210
  v_mul_f32 v21, v21, v211
  v_cvt_pk_bf16_f32 v21, v29, v21
  v_lshlrev_b32 v28, 16, v22
  v_and_b32 v22, s44, v22
  v_mul_f32 v28, v28, v224
  v_mul_f32 v22, v22, v225
  v_cvt_pk_bf16_f32 v22, v28, v22
  v_lshlrev_b32 v29, 16, v23
  v_and_b32 v23, s44, v23
  v_mul_f32 v29, v29, v226
  v_mul_f32 v23, v23, v227
  v_cvt_pk_bf16_f32 v23, v29, v23
  buffer_store_dwordx4 v[20:23], v30, s[16:19], s46 offen offset:320 nt
  ds_read_b128 v[20:23], v9 offset:4096
  s_waitcnt lgkmcnt(1)
  v_lshlrev_b32 v28, 16, v24
  v_and_b32 v24, s44, v24
  v_mul_f32 v28, v28, v212
  v_mul_f32 v24, v24, v213
  v_cvt_pk_bf16_f32 v24, v28, v24
  v_lshlrev_b32 v29, 16, v25
  v_and_b32 v25, s44, v25
  v_mul_f32 v29, v29, v214
  v_mul_f32 v25, v25, v215
  v_cvt_pk_bf16_f32 v25, v29, v25
  v_lshlrev_b32 v28, 16, v26
  v_and_b32 v26, s44, v26
  v_mul_f32 v28, v28, v228
  v_mul_f32 v26, v26, v229
  v_cvt_pk_bf16_f32 v26, v28, v26
  v_lshlrev_b32 v29, 16, v27
  v_and_b32 v27, s44, v27
  v_mul_f32 v29, v29, v230
  v_mul_f32 v27, v27, v231
  v_cvt_pk_bf16_f32 v27, v29, v27
  buffer_store_dwordx4 v[24:27], v30, s[16:19], s47 offen offset:320 nt
  ds_read_b128 v[24:27], v9 offset:6144
  s_waitcnt lgkmcnt(1)
  v_lshlrev_b32 v28, 16, v20
  v_and_b32 v20, s44, v20
  v_mul_f32 v28, v28, v216
  v_mul_f32 v20, v20, v217
  v_cvt_pk_bf16_f32 v20, v28, v20
  v_lshlrev_b32 v29, 16, v21
  v_and_b32 v21, s44, v21
  v_mul_f32 v29, v29, v218
  v_mul_f32 v21, v21, v219
  v_cvt_pk_bf16_f32 v21, v29, v21
  v_lshlrev_b32 v28, 16, v22
  v_and_b32 v22, s44, v22
  v_mul_f32 v28, v28, v232
  v_mul_f32 v22, v22, v233
  v_cvt_pk_bf16_f32 v22, v28, v22
  v_lshlrev_b32 v29, 16, v23
  v_and_b32 v23, s44, v23
  v_mul_f32 v29, v29, v234
  v_mul_f32 v23, v23, v235
  v_cvt_pk_bf16_f32 v23, v29, v23
  buffer_store_dwordx4 v[20:23], v30, s[16:19], s48 offen offset:320 nt
  s_waitcnt lgkmcnt(0)
  v_lshlrev_b32 v28, 16, v24
  v_and_b32 v24, s44, v24
  v_mul_f32 v28, v28, v220
  v_mul_f32 v24, v24, v221
  v_cvt_pk_bf16_f32 v24, v28, v24
  v_lshlrev_b32 v29, 16, v25
  v_and_b32 v25, s44, v25
  v_mul_f32 v29, v29, v222
  v_mul_f32 v25, v25, v223
  v_cvt_pk_bf16_f32 v25, v29, v25
  v_lshlrev_b32 v28, 16, v26
  v_and_b32 v26, s44, v26
  v_mul_f32 v28, v28, v236
  v_mul_f32 v26, v26, v237
  v_cvt_pk_bf16_f32 v26, v28, v26
  v_lshlrev_b32 v29, 16, v27
  v_and_b32 v27, s44, v27
  v_mul_f32 v29, v29, v238
  v_mul_f32 v27, v27, v239
  v_cvt_pk_bf16_f32 v27, v29, v27
  buffer_store_dwordx4 v[24:27], v30, s[16:19], s49 offen offset:320 nt
Lend:
  s_endpgm
Lslow1:
  s_mov_b32 s59, 0x100000
Lspin1:
  buffer_load_dword v19, v18, s[20:23], 0 offen sc1
  s_waitcnt vmcnt(0)
  v_sub_u32 v19, v19, v30
  v_cmp_gt_u32 vcc, 1, v19
  s_sub_u32 s59, s59, 1

  s_cbranch_vccz Lback1
  s_cmp_lg_u32 s59, 0
  s_cbranch_scc1 Lspin1
  s_branch Lback1
Lslow2:
  s_mov_b32 s59, 0x100000
Lspin2:
  buffer_load_dword v19, v18, s[20:23], 0 offen sc1
  s_waitcnt vmcnt(0)
  v_sub_u32 v19, v19, v30
  v_cmp_gt_u32 vcc, 2, v19
  s_sub_u32 s59, s59, 1

  s_cbranch_vccz Lback2
  s_cmp_lg_u32 s59, 0
  s_cbranch_scc1 Lspin2
  s_branch Lback2
Lslow3:
  s_mov_b32 s59, 0x100000
Lspin3:
  buffer_load_dword v19, v18, s[20:23], 0 offen sc1
  s_waitcnt vmcnt(0)
  v_sub_u32 v19, v19, v30
  v_cmp_gt_u32 vcc, 3, v19
  s_sub_u32 s59, s59, 1

  s_cbranch_vccz Lback3
  s_cmp_lg_u32 s59, 0
  s_cbranch_scc1 Lspin3
  s_branch Lback3
Lslow4:
  s_mov_b32 s59, 0x100000
Lspin4:
  buffer_load_dword v19, v18, s[20:23], 0 offen sc1
  s_waitcnt vmcnt(0)
  v_sub_u32 v19, v19, v30
  v_cmp_gt_u32 vcc, 4, v19
  s_sub_u32 s59, s59, 1

  s_cbranch_vccz Lback4
  s_cmp_lg_u32 s59, 0
  s_cbranch_scc1 Lspin4
  s_branch Lback4
Lslow5:
  s_mov_b32 s59, 0x100000
Lspin5:
  buffer_load_dword v19, v18, s[20:23], 0 offen sc1
  s_waitcnt vmcnt(0)
  v_sub_u32 v19, v19, v30
  v_cmp_gt_u32 vcc, 5, v19
  s_sub_u32 s59, s59, 1

  s_cbranch_vccz Lback5
  s_cmp_lg_u32 s59, 0
  s_cbranch_scc1 Lspin5
  s_branch Lback5
Lslow6:
  s_mov_b32 s59, 0x100000
Lspin6:
  buffer_load_dword v19, v18, s[20:23], 0 offen sc1
  s_waitcnt vmcnt(0)
  v_sub_u32 v19, v19, v30
  v_cmp_gt_u32 vcc, 6, v19
  s_sub_u32 s59, s59, 1

  s_cbranch_vccz Lback6
  s_cmp_lg_u32 s59, 0
  s_cbranch_scc1 Lspin6
  s_branch Lback6
Lslow7:
  s_mov_b32 s59, 0x100000
Lspin7:
  buffer_load_dword v19, v18, s[20:23], 0 offen sc1
  s_waitcnt vmcnt(0)
  v_sub_u32 v19, v19, v30
  v_cmp_gt_u32 vcc, 7, v19
  s_sub_u32 s59, s59, 1

  s_cbranch_vccz Lback7
  s_cmp_lg_u32 s59, 0
  s_cbranch_scc1 Lspin7
  s_branch Lback7
Lslow8:
  s_mov_b32 s59, 0x100000
Lspin8:
  buffer_load_dword v19, v18, s[20:23], 0 offen sc1
  s_waitcnt vmcnt(0)
  v_sub_u32 v19, v19, v30
  v_cmp_gt_u32 vcc, 8, v19
  s_sub_u32 s59, s59, 1

  s_cbranch_vccz Lback8
  s_cmp_lg_u32 s59, 0
  s_cbranch_scc1 Lspin8
  s_branch Lback8
Lcode_end:
.section .rodata,"a"
.p2align 6
.amdhsa_kernel standalone__dcn_v2_cross__recsys_kernel
  .amdhsa_next_free_vgpr 512
  .amdhsa_next_free_sgpr 102
  .amdhsa_accum_offset 256
  .amdhsa_group_segment_fixed_size 0
  .amdhsa_kernarg_size 48
  .amdhsa_user_sgpr_count 2
  .amdhsa_user_sgpr_kernarg_segment_ptr 1
  .amdhsa_system_sgpr_workgroup_id_x 1
.end_amdhsa_kernel
```
